```python
import torch

def _softmax(x, axis=-1):
    return torch.softmax(x, dim=axis)
def _gelu(x):
    return torch.nn.functional.gelu(x, approximate="tanh")
def _silu(x):
    return torch.nn.functional.silu(x)
def _sigmoid(x):
    return torch.sigmoid(x)
def _layernorm(x, axis=-1, eps=1e-5):
    m = x.mean(dim=axis, keepdim=True)
    v = x.var(dim=axis, keepdim=True, unbiased=False)
    return (x - m) / torch.sqrt(v + eps)
def _scatter_add(tgt, idx, src, axis=0):
    return tgt.clone().index_add_(axis, idx, src)
def _segment_sum(src, seg, n):
    out = torch.zeros((n,) + src.shape[1:], dtype=src.dtype)
    return out.index_add_(0, seg, src)
def _pad(x, pw):
    flat = tuple(v for pair in reversed(pw) for v in pair)
    return torch.nn.functional.pad(x, flat)

kernel_name = 'interleave_layers__mha_block__mixer_s_mlp__prompt'

def setup_inputs():

    _w = (lambda a: (lambda t: t.to(torch.bfloat16) if t.is_floating_point() else t)(torch.as_tensor(a)))
    def _A_setup():
        B, S, D, H = 1, 2048, 448, 16
        return {
            "x": _w((lambda *s: torch.randn(*s, dtype=torch.bfloat16) * 0.05)(B, S, D)),
            "wqkv": _w((lambda *s: torch.randn(*s, dtype=torch.bfloat16) * 0.05)(D, 3 * D)),
            "wo": _w((lambda *s: torch.randn(*s, dtype=torch.bfloat16) * 0.05)(D, D)),
        }
    _A_in = _A_setup()

    def _B_setup():
        B, S, D, F = 1, 2048, 448, 1792
        return {
            "x":  _w((lambda *s: torch.randn(*s, dtype=torch.bfloat16) * 0.05)(B, S, D)),
            "w1": _w((lambda *s: torch.randn(*s, dtype=torch.bfloat16) * 0.8)(D, D) * (D ** -0.5)),
            "w2": _w((lambda *s: torch.randn(*s, dtype=torch.bfloat16) * 0.8)(D, D) * (D ** -0.5)),
            "w3": _w((lambda *s: torch.randn(*s, dtype=torch.bfloat16) * 0.8)(D, F) * (D ** -0.5)),
            "w4": _w((lambda *s: torch.randn(*s, dtype=torch.bfloat16) * 0.8)(F, D) * (F ** -0.5)),
        }
    _B_in = _B_setup()

    return {
        "A_x": _A_in["x"],
        "A_wqkv": _A_in["wqkv"],
        "A_wo": _A_in["wo"],
        "B_x": _B_in["x"],
        "B_w1": _B_in["w1"],
        "B_w2": _B_in["w2"],
        "B_w3": _B_in["w3"],
        "B_w4": _B_in["w4"],
    }

def reference(A_x, A_wqkv, A_wo, B_x, B_w1, B_w2, B_w3, B_w4):
    def _A_ref(x, wqkv, wo):
        B, S, D = x.shape
        H = 16
        Dh = D // H
        qkv = (lambda x, *d: x.permute(*d))((x @ wqkv).reshape(B, S, 3, H, Dh), 2, 0, 3, 1, 4)
        q, k, v = qkv[0], qkv[1], qkv[2]
        scores = torch.einsum("bhqd,bhkd->bhqk", q, k) * (Dh ** -0.5)
        p = _softmax(scores, axis=-1)
        o = torch.einsum("bhqk,bhkd->bhqd", p, v)
        return (lambda x, *d: x.permute(*d))(o, 0, 2, 1, 3).reshape(B, S, D) @ wo

    def _B_ref(x, w1, w2, w3, w4):
        B, S, D = x.shape
        h = _gelu(_layernorm(x, axis=-1) @ w1)
        c = D // 4
        g0 = _pad(h[:, :, 0*c:1*c], ((0, 0), (1, 0), (0, 0)))[:, :S, :]
        g1 = _pad(h[:, :, 1*c:2*c], ((0, 0), (0, 1), (0, 0)))[:, 1:, :]
        g2 = _pad(h[:, :, 2*c:3*c], ((0, 0), (2, 0), (0, 0)))[:, :S, :]
        g3 = _pad(h[:, :, 3*c:   ], ((0, 0), (0, 2), (0, 0)))[:, 2:, :]
        hs = torch.concatenate([g0, g1, g2, g3], axis=-1) @ w2
        x1 = x + hs
        h2 = _gelu(_layernorm(x1, axis=-1) @ w3) @ w4
        return x1 + h2

    x = A_x
    x = x + _A_ref(_layernorm(x, axis=-1), A_wqkv, A_wo)
    x = x + _B_ref(_layernorm(x, axis=-1), B_w1, B_w2, B_w3, B_w4)
    x = x + _A_ref(_layernorm(x, axis=-1), A_wqkv, A_wo)
    x = x + _B_ref(_layernorm(x, axis=-1), B_w1, B_w2, B_w3, B_w4)
    return x
```

```asm
; @launch grid=(256,1,1) block=(256,1,1) lds=163840
.amdgcn_target "amdgcn-amd-amdhsa--gfx950"
.text
.globl interleave_layers__mha_block__mixer_s_mlp__prompt_kernel
.p2align 8
.type interleave_layers__mha_block__mixer_s_mlp__prompt_kernel,@function
interleave_layers__mha_block__mixer_s_mlp__prompt_kernel:
    s_cmp_ge_u32 s2, 256
    s_cbranch_scc1 Lc_end
    s_load_dwordx4 s[40:43], s[0:1], 0
    s_load_dwordx2 s[44:45], s[0:1], 16
    s_load_dwordx8 s[48:55], s[0:1], 32
    s_load_dwordx4 s[56:59], s[0:1], 64
    s_load_dwordx2 s[46:47], s[0:1], 80
    v_lshrrev_b32 v1, 6, v0
    s_nop 0
    v_readfirstlane_b32 s12, v1
    v_and_b32 v0, 63, v0
    v_lshlrev_b32 v1, 4, v0
    s_and_b32 s13, s2, 7
    s_lshr_b32 s14, s2, 3
    s_getpc_b64 s[64:65]
Lpc_main:
    s_sub_u32 s64, s64, Lpc_main-interleave_layers__mha_block__mixer_s_mlp__prompt_kernel
    s_subb_u32 s65, s65, 0
    s_lshl_b32 s28, s14, 2
    s_add_u32 s28, s28, s12
    s_lshl_b32 s28, s28, 9
    v_lshl_add_u32 v4, v0, 7, s28
    v_min_u32 v4, 53380, v4
    s_mov_b64 exec, 15
    global_load_dword a255, v4, s[64:65]
    s_mov_b64 exec, -1
    s_getreg_b32 s19, hwreg(HW_REG_XCC_ID, 0, 4)
    s_add_u32 s19, s19, 1
    v_mov_b32 v15, s19
    s_lshr_b32 s28, s14, 3
    s_lshr_b32 s29, s13, 1
    s_lshl_b32 s29, s29, 2
    s_add_u32 s28, s28, s29
    s_lshl_b32 s28, s28, 2
    s_add_u32 s16, s28, s12
    s_lshl_b32 s79, s13, 3
    s_and_b32 s28, s14, 7
    s_add_u32 s79, s79, s28
    s_and_b32 s79, s79, 15
    s_mul_i32 s30, s16, 28672
    s_mul_i32 s31, s12, 28672
    s_mul_i32 s28, s14, 1
    s_mul_i32 s29, s28, 9363
    s_lshr_b32 s29, s29, 16
    s_mul_i32 s29, s29, 7
    s_sub_u32 s28, s28, s29
    s_lshl_b32 s15, s28, 7
    s_mul_i32 s18, s28, 172032
    v_lshrrev_b32 v10, 3, v0
    v_mul_u32_u24 v11, 896, v10
    v_lshrrev_b32 v10, 4, v0
    v_xor_b32 v10, v10, v0
    v_and_b32 v10, 7, v10
    v_lshl_add_u32 v2, v10, 4, v11
    v_xor_b32 v10, 4, v10
    v_lshl_add_u32 v3, v10, 4, v11
    s_waitcnt lgkmcnt(0)
    s_mov_b32 s20, s40
    s_mov_b32 s21, s41
    s_mov_b32 s22, 1835008
    s_mov_b32 s23, 0x00020000
    s_mov_b32 s4, s46
    s_mov_b32 s5, s47
    s_mov_b32 s6, 268435456
    s_mov_b32 s7, 0x00020000
    s_add_u32 m0, s31, 0
    s_add_u32 s38, s30, s15
    s_add_u32 s15, s15, 128
    s_cmp_eq_u32 s15, 896
    s_cselect_b32 s15, 0, s15
    s_add_u32 s37, s38, 0
    buffer_load_dwordx4 v2, s[20:23], s37 offen lds
    s_add_u32 m0, s31, 1024
    s_add_u32 s37, s38, 7168
    buffer_load_dwordx4 v3, s[20:23], s37 offen lds
    s_add_u32 m0, s31, 2048
    s_add_u32 s37, s38, 14336
    buffer_load_dwordx4 v2, s[20:23], s37 offen lds
    s_add_u32 m0, s31, 3072
    s_add_u32 s37, s38, 21504
    buffer_load_dwordx4 v3, s[20:23], s37 offen lds
    s_mov_b32 s24, s42
    s_mov_b32 s25, s43
    s_mov_b32 s26, 1204224
    s_mov_b32 s27, 0x00020000
    s_mov_b32 s8, s56
    s_mov_b32 s9, s57
    s_mov_b32 s10, 1835008
    s_mov_b32 s11, 0x00020000
    s_mov_b32 s80, s58
    s_mov_b32 s81, s59
    s_mov_b32 s82, 256
    s_mov_b32 s83, 0x00020000
    s_add_u32 m0, s31, 4096
    s_add_u32 s38, s30, s15
    s_add_u32 s15, s15, 128
    s_cmp_eq_u32 s15, 896
    s_cselect_b32 s15, 0, s15
    s_add_u32 s37, s38, 0
    buffer_load_dwordx4 v2, s[20:23], s37 offen lds
    s_add_u32 m0, s31, 5120
    s_add_u32 s37, s38, 7168
    buffer_load_dwordx4 v3, s[20:23], s37 offen lds
    s_add_u32 m0, s31, 6144
    s_add_u32 s37, s38, 14336
    buffer_load_dwordx4 v2, s[20:23], s37 offen lds
    s_add_u32 m0, s31, 7168
    s_add_u32 s37, s38, 21504
    buffer_load_dwordx4 v3, s[20:23], s37 offen lds
    s_add_u32 m0, s31, 8192
    s_add_u32 s38, s30, s15
    s_add_u32 s15, s15, 128
    s_cmp_eq_u32 s15, 896
    s_cselect_b32 s15, 0, s15
    s_add_u32 s37, s38, 0
    buffer_load_dwordx4 v2, s[20:23], s37 offen lds
    s_add_u32 m0, s31, 9216
    s_add_u32 s37, s38, 7168
    buffer_load_dwordx4 v3, s[20:23], s37 offen lds
    s_add_u32 m0, s31, 10240
    s_add_u32 s37, s38, 14336
    buffer_load_dwordx4 v2, s[20:23], s37 offen lds
    s_add_u32 m0, s31, 11264
    s_add_u32 s37, s38, 21504
    buffer_load_dwordx4 v3, s[20:23], s37 offen lds
    s_mov_b64 s[100:101], s[44:45]
    v_and_b32 v10, 31, v0
    v_lshl_add_u32 v11, v10, 7, s31
    v_bfe_u32 v10, v0, 1, 3
    v_lshrrev_b32 v12, 5, v0
    v_xor_b32 v10, v10, v12
    v_xor_b32 v12, 0, v10
    v_lshl_add_u32 v4, v12, 4, v11
    v_xor_b32 v12, 2, v10
    v_lshl_add_u32 v5, v12, 4, v11
    v_xor_b32 v12, 4, v10
    v_lshl_add_u32 v6, v12, 4, v11
    v_xor_b32 v12, 6, v10
    v_lshl_add_u32 v7, v12, 4, v11
    s_mov_b32 s35, s79
    s_lshl_b32 s36, s35, 1
    s_lshr_b32 s36, 0x77771ddc, s36
    s_bfe_i32 s36, s36, 0x20000
    s_sub_u32 s36, 0, s36
    s_mul_i32 s35, s35, 56
    s_lshr_b32 s28, s12, 1
    s_mul_i32 s28, s28, 43008
    s_mul_i32 s29, s36, 56
    s_add_u32 s29, s29, 1792
    s_bitcmp1_b32 s12, 0
    s_cselect_b32 s29, 896, s29
    s_add_u32 s28, s28, s35
    s_add_u32 s32, s28, s29
    s_mul_i32 s33, s12, 43008
    s_add_u32 s33, s33, s35
    s_lshl_b32 s34, s12, 10
    v_lshrrev_b32 v10, 2, v0
    v_mul_u32_u24 v10, 2688, v10
    v_and_b32 v11, 3, v0
    v_lshl_add_u32 v251, v11, 4, v10
    s_mul_i32 s77, s13, 26
    s_add_u32 s77, s77, s14
    s_cmp_lt_u32 s14, 26
    s_cselect_b32 s78, s77, 202
    s_min_u32 s77, s78, 201
    s_mul_i32 s92, s12, 7
    s_mov_b32 s91, 0
    s_cmp_ge_u32 s77, 48
    s_cbranch_scc1 Lp_not_qkv
    s_mov_b32 s84, s24
    s_mov_b32 s85, s25
    s_mov_b32 s86, 1204224
    s_mov_b32 s87, 0x00020000
    s_movk_i32 s88, 2688
    s_mov_b32 s89, 1
    s_mov_b32 s91, 1
    s_lshr_b32 s93, s77, 4
    s_and_b32 s94, s77, 15
    s_and_b32 s96, s77, 1
    s_cmp_eq_u32 s96, 0
    s_cselect_b32 s90, 0x75643120, s0
    s_cselect_b32 s90, s90, 0x76054231
    s_cmp_eq_u32 s93, 2
    s_cselect_b32 s90, s90, 0x76543210
    s_mul_i32 s96, s77, 56
    s_mul_i32 s97, s94, 84
    s_add_u32 s97, s97, s93
    s_add_u32 s98, s92, 0
    s_mul_i32 s70, s98, 43008
    s_add_u32 s70, s70, s96
    s_mul_i32 s98, s98, 3
    s_add_u32 s98, s98, s97
    s_lshl_b32 s98, s98, 10
    s_add_u32 s3, s98, 4415488
    s_add_u32 s98, s92, 1
    s_mul_i32 s71, s98, 43008
    s_add_u32 s71, s71, s96
    s_mul_i32 s98, s98, 3
    s_add_u32 s98, s98, s97
    s_lshl_b32 s98, s98, 10
    s_add_u32 s56, s98, 4415488
    s_add_u32 s98, s92, 2
    s_mul_i32 s72, s98, 43008
    s_add_u32 s72, s72, s96
    s_mul_i32 s98, s98, 3
    s_add_u32 s98, s98, s97
    s_lshl_b32 s98, s98, 10
    s_add_u32 s57, s98, 4415488
    s_add_u32 s98, s92, 3
    s_mul_i32 s73, s98, 43008
    s_add_u32 s73, s73, s96
    s_mul_i32 s98, s98, 3
    s_add_u32 s98, s98, s97
    s_lshl_b32 s98, s98, 10
    s_add_u32 s58, s98, 4415488
    s_add_u32 s98, s92, 4
    s_mul_i32 s74, s98, 43008
    s_add_u32 s74, s74, s96
    s_mul_i32 s98, s98, 3
    s_add_u32 s98, s98, s97
    s_lshl_b32 s98, s98, 10
    s_add_u32 s59, s98, 4415488
    s_add_u32 s98, s92, 5
    s_mul_i32 s75, s98, 43008
    s_add_u32 s75, s75, s96
    s_mul_i32 s98, s98, 3
    s_add_u32 s98, s98, s97
    s_lshl_b32 s98, s98, 10
    s_add_u32 s61, s98, 4415488
    s_add_u32 s98, s92, 6
    s_mul_i32 s76, s98, 43008
    s_add_u32 s76, s76, s96
    s_mul_i32 s98, s98, 3
    s_add_u32 s98, s98, s97
    s_lshl_b32 s98, s98, 10
    s_add_u32 s65, s98, 4415488
    s_branch Lp_tbl
Lp_not_qkv:
    s_cmp_ge_u32 s77, 90
    s_cbranch_scc1 Lp_not_s1
    s_movk_i32 s88, 896
    s_cmp_ge_u32 s77, 62
    s_cbranch_scc1 Lp_w12
    s_mov_b32 s84, s100
    s_mov_b32 s85, s101
    s_mov_b32 s86, 401408
    s_mov_b32 s87, 0x00020000
    s_sub_u32 s93, s77, 48
    s_mov_b32 s94, 0
    s_mov_b32 s89, 0
    s_mov_b32 s95, 1
    s_branch Lp_s1
Lp_w12:
    s_cmp_ge_u32 s77, 76
    s_cbranch_scc1 Lp_w2
    s_mov_b32 s84, s48
    s_mov_b32 s85, s49
    s_mov_b32 s86, 401408
    s_mov_b32 s87, 0x00020000
    s_sub_u32 s93, s77, 62
    s_mov_b32 s94, 401408
    s_mov_b32 s89, 1
    s_mov_b32 s95, 1
    s_branch Lp_s1
Lp_w2:
    s_mov_b32 s84, s50
    s_mov_b32 s85, s51
    s_mov_b32 s86, 401408
    s_mov_b32 s87, 0x00020000
    s_sub_u32 s93, s77, 76
    s_mov_b32 s94, 802816
    s_mov_b32 s89, 0
    s_mov_b32 s95, 0
Lp_s1:
    s_lshl_b32 s96, s93, 6
    s_lshr_b32 s97, s93, 1
    s_mul_i32 s98, s97, 57344
    s_add_u32 s94, s94, s98
    s_and_b32 s98, s93, 1
    s_lshl_b32 s98, s98, 11
    s_add_u32 s94, s94, s98
    s_mul_i32 s97, s97, s95
    s_lshl_b32 s97, s97, 1
    s_sub_u32 s97, 14, s97
    s_add_u32 s98, s92, 0
    s_mul_i32 s70, s98, 14336
    s_add_u32 s70, s70, s96
    s_lshr_b32 s69, s98, 1
    s_add_u32 s69, s69, s97
    s_cmp_ge_u32 s69, 14
    s_cselect_b32 s99, 14, 0
    s_sub_u32 s69, s69, s99
    s_lshl_b32 s69, s69, 12
    s_and_b32 s98, s98, 1
    s_lshl_b32 s98, s98, 9
    s_add_u32 s98, s98, s69
    s_add_u32 s3, s98, s94
    s_add_u32 s98, s92, 1
    s_mul_i32 s71, s98, 14336
    s_add_u32 s71, s71, s96
    s_lshr_b32 s69, s98, 1
    s_add_u32 s69, s69, s97
    s_cmp_ge_u32 s69, 14
    s_cselect_b32 s99, 14, 0
    s_sub_u32 s69, s69, s99
    s_lshl_b32 s69, s69, 12
    s_and_b32 s98, s98, 1
    s_lshl_b32 s98, s98, 9
    s_add_u32 s98, s98, s69
    s_add_u32 s56, s98, s94
    s_add_u32 s98, s92, 2
    s_mul_i32 s72, s98, 14336
    s_add_u32 s72, s72, s96
    s_lshr_b32 s69, s98, 1
    s_add_u32 s69, s69, s97
    s_cmp_ge_u32 s69, 14
    s_cselect_b32 s99, 14, 0
    s_sub_u32 s69, s69, s99
    s_lshl_b32 s69, s69, 12
    s_and_b32 s98, s98, 1
    s_lshl_b32 s98, s98, 9
    s_add_u32 s98, s98, s69
    s_add_u32 s57, s98, s94
    s_add_u32 s98, s92, 3
    s_mul_i32 s73, s98, 14336
    s_add_u32 s73, s73, s96
    s_lshr_b32 s69, s98, 1
    s_add_u32 s69, s69, s97
    s_cmp_ge_u32 s69, 14
    s_cselect_b32 s99, 14, 0
    s_sub_u32 s69, s69, s99
    s_lshl_b32 s69, s69, 12
    s_and_b32 s98, s98, 1
    s_lshl_b32 s98, s98, 9
    s_add_u32 s98, s98, s69
    s_add_u32 s58, s98, s94
    s_add_u32 s98, s92, 4
    s_mul_i32 s74, s98, 14336
    s_add_u32 s74, s74, s96
    s_lshr_b32 s69, s98, 1
    s_add_u32 s69, s69, s97
    s_cmp_ge_u32 s69, 14
    s_cselect_b32 s99, 14, 0
    s_sub_u32 s69, s69, s99
    s_lshl_b32 s69, s69, 12
    s_and_b32 s98, s98, 1
    s_lshl_b32 s98, s98, 9
    s_add_u32 s98, s98, s69
    s_add_u32 s59, s98, s94
    s_add_u32 s98, s92, 5
    s_mul_i32 s75, s98, 14336
    s_add_u32 s75, s75, s96
    s_lshr_b32 s69, s98, 1
    s_add_u32 s69, s69, s97
    s_cmp_ge_u32 s69, 14
    s_cselect_b32 s99, 14, 0
    s_sub_u32 s69, s69, s99
    s_lshl_b32 s69, s69, 12
    s_and_b32 s98, s98, 1
    s_lshl_b32 s98, s98, 9
    s_add_u32 s98, s98, s69
    s_add_u32 s61, s98, s94
    s_add_u32 s98, s92, 6
    s_mul_i32 s76, s98, 14336
    s_add_u32 s76, s76, s96
    s_lshr_b32 s69, s98, 1
    s_add_u32 s69, s69, s97
    s_cmp_ge_u32 s69, 14
    s_cselect_b32 s99, 14, 0
    s_sub_u32 s69, s69, s99
    s_lshl_b32 s69, s69, 12
    s_and_b32 s98, s98, 1
    s_lshl_b32 s98, s98, 9
    s_add_u32 s98, s98, s69
    s_add_u32 s65, s98, s94
    s_cmp_ge_u32 s77, 62
    s_cbranch_scc1 Lp_s1l
    s_lshr_b32 s97, s93, 1
    s_sub_u32 s97, 6, s97
    s_mul_i32 s95, s12, 6
    s_add_u32 s98, s95, 0
    s_lshr_b32 s69, s98, 2
    s_add_u32 s69, s69, s97
    s_cmp_ge_u32 s69, 6
    s_cselect_b32 s99, 6, 0
    s_sub_u32 s69, s69, s99
    s_lshl_b32 s69, s69, 13
    s_bfe_u32 s68, s98, 0x10001
    s_lshl_b32 s68, s68, 12
    s_add_u32 s69, s69, s68
    s_and_b32 s98, s98, 1
    s_lshl_b32 s98, s98, 9
    s_add_u32 s98, s98, s69
    s_add_u32 s3, s98, s94
    s_add_u32 s98, s95, 1
    s_lshr_b32 s69, s98, 2
    s_add_u32 s69, s69, s97
    s_cmp_ge_u32 s69, 6
    s_cselect_b32 s99, 6, 0
    s_sub_u32 s69, s69, s99
    s_lshl_b32 s69, s69, 13
    s_bfe_u32 s68, s98, 0x10001
    s_lshl_b32 s68, s68, 12
    s_add_u32 s69, s69, s68
    s_and_b32 s98, s98, 1
    s_lshl_b32 s98, s98, 9
    s_add_u32 s98, s98, s69
    s_add_u32 s56, s98, s94
    s_add_u32 s98, s95, 2
    s_lshr_b32 s69, s98, 2
    s_add_u32 s69, s69, s97
    s_cmp_ge_u32 s69, 6
    s_cselect_b32 s99, 6, 0
    s_sub_u32 s69, s69, s99
    s_lshl_b32 s69, s69, 13
    s_bfe_u32 s68, s98, 0x10001
    s_lshl_b32 s68, s68, 12
    s_add_u32 s69, s69, s68
    s_and_b32 s98, s98, 1
    s_lshl_b32 s98, s98, 9
    s_add_u32 s98, s98, s69
    s_add_u32 s57, s98, s94
    s_add_u32 s98, s95, 3
    s_lshr_b32 s69, s98, 2
    s_add_u32 s69, s69, s97
    s_cmp_ge_u32 s69, 6
    s_cselect_b32 s99, 6, 0
    s_sub_u32 s69, s69, s99
    s_lshl_b32 s69, s69, 13
    s_bfe_u32 s68, s98, 0x10001
    s_lshl_b32 s68, s68, 12
    s_add_u32 s69, s69, s68
    s_and_b32 s98, s98, 1
    s_lshl_b32 s98, s98, 9
    s_add_u32 s98, s98, s69
    s_add_u32 s58, s98, s94
    s_add_u32 s98, s95, 4
    s_lshr_b32 s69, s98, 2
    s_add_u32 s69, s69, s97
    s_cmp_ge_u32 s69, 6
    s_cselect_b32 s99, 6, 0
    s_sub_u32 s69, s69, s99
    s_lshl_b32 s69, s69, 13
    s_bfe_u32 s68, s98, 0x10001
    s_lshl_b32 s68, s68, 12
    s_add_u32 s69, s69, s68
    s_and_b32 s98, s98, 1
    s_lshl_b32 s98, s98, 9
    s_add_u32 s98, s98, s69
    s_add_u32 s59, s98, s94
    s_add_u32 s98, s95, 5
    s_lshr_b32 s69, s98, 2
    s_add_u32 s69, s69, s97
    s_cmp_ge_u32 s69, 6
    s_cselect_b32 s99, 6, 0
    s_sub_u32 s69, s69, s99
    s_lshl_b32 s69, s69, 13
    s_bfe_u32 s68, s98, 0x10001
    s_lshl_b32 s68, s68, 12
    s_add_u32 s69, s69, s68
    s_and_b32 s98, s98, 1
    s_lshl_b32 s98, s98, 9
    s_add_u32 s98, s98, s69
    s_add_u32 s61, s98, s94
    s_mov_b32 s98, s12
    s_mov_b32 s69, 49152
    s_bfe_u32 s68, s98, 0x10001
    s_lshl_b32 s68, s68, 12
    s_add_u32 s69, s69, s68
    s_and_b32 s98, s98, 1
    s_lshl_b32 s98, s98, 9
    s_add_u32 s98, s98, s69
    s_add_u32 s65, s98, s94
Lp_s1l:
    s_mov_b32 s90, 0x75316420
    v_bfe_u32 v248, v0, 4, 1
    v_lshlrev_b32 v248, 10, v248
    v_lshrrev_b32 v249, 5, v0
    v_lshl_add_u32 v248, v249, 8, v248
    v_and_b32 v249, 15, v0
    v_lshl_add_u32 v248, v249, 4, v248
    s_branch Lp_go
Lp_not_s1:
    s_cmp_ge_u32 s77, 146
    s_cbranch_scc1 Lp_w4
    s_mov_b32 s84, s52
    s_mov_b32 s85, s53
    s_mov_b32 s86, 1605632
    s_mov_b32 s87, 0x00020000
    s_movk_i32 s88, 3584
    s_mov_b32 s89, 1
    s_mov_b32 s90, 0x75643120
    s_sub_u32 s93, s77, 90
    s_lshl_b32 s96, s93, 6
    s_lshr_b32 s97, s93, 3
    s_lshl_b32 s97, s97, 2
    s_sub_u32 s97, 28, s97
    s_mul_i32 s94, s93, 28
    s_add_u32 s98, s92, 0
    s_mul_i32 s70, s98, 57344
    s_add_u32 s70, s70, s96
    s_add_u32 s69, s98, s97
    s_cmp_ge_u32 s69, 28
    s_cselect_b32 s99, 28, 0
    s_sub_u32 s69, s69, s99
    s_add_u32 s69, s69, s94
    s_lshl_b32 s69, s69, 10
    s_add_u32 s3, s69, 1204224
    s_add_u32 s98, s92, 1
    s_mul_i32 s71, s98, 57344
    s_add_u32 s71, s71, s96
    s_add_u32 s69, s98, s97
    s_cmp_ge_u32 s69, 28
    s_cselect_b32 s99, 28, 0
    s_sub_u32 s69, s69, s99
    s_add_u32 s69, s69, s94
    s_lshl_b32 s69, s69, 10
    s_add_u32 s56, s69, 1204224
    s_add_u32 s98, s92, 2
    s_mul_i32 s72, s98, 57344
    s_add_u32 s72, s72, s96
    s_add_u32 s69, s98, s97
    s_cmp_ge_u32 s69, 28
    s_cselect_b32 s99, 28, 0
    s_sub_u32 s69, s69, s99
    s_add_u32 s69, s69, s94
    s_lshl_b32 s69, s69, 10
    s_add_u32 s57, s69, 1204224
    s_add_u32 s98, s92, 3
    s_mul_i32 s73, s98, 57344
    s_add_u32 s73, s73, s96
    s_add_u32 s69, s98, s97
    s_cmp_ge_u32 s69, 28
    s_cselect_b32 s99, 28, 0
    s_sub_u32 s69, s69, s99
    s_add_u32 s69, s69, s94
    s_lshl_b32 s69, s69, 10
    s_add_u32 s58, s69, 1204224
    s_add_u32 s98, s92, 4
    s_mul_i32 s74, s98, 57344
    s_add_u32 s74, s74, s96
    s_add_u32 s69, s98, s97
    s_cmp_ge_u32 s69, 28
    s_cselect_b32 s99, 28, 0
    s_sub_u32 s69, s69, s99
    s_add_u32 s69, s69, s94
    s_lshl_b32 s69, s69, 10
    s_add_u32 s59, s69, 1204224
    s_add_u32 s98, s92, 5
    s_mul_i32 s75, s98, 57344
    s_add_u32 s75, s75, s96
    s_add_u32 s69, s98, s97
    s_cmp_ge_u32 s69, 28
    s_cselect_b32 s99, 28, 0
    s_sub_u32 s69, s69, s99
    s_add_u32 s69, s69, s94
    s_lshl_b32 s69, s69, 10
    s_add_u32 s61, s69, 1204224
    s_add_u32 s98, s92, 6
    s_mul_i32 s76, s98, 57344
    s_add_u32 s76, s76, s96
    s_add_u32 s69, s98, s97
    s_cmp_ge_u32 s69, 28
    s_cselect_b32 s99, 28, 0
    s_sub_u32 s69, s69, s99
    s_add_u32 s69, s69, s94
    s_lshl_b32 s69, s69, 10
    s_add_u32 s65, s69, 1204224
    s_branch Lp_tbl
Lp_w4:
    s_mov_b32 s84, s54
    s_mov_b32 s85, s55
    s_mov_b32 s86, 1605632
    s_mov_b32 s87, 0x00020000
    s_movk_i32 s88, 896
    s_mov_b32 s89, 0
    s_mov_b32 s90, 0x76543210
    s_sub_u32 s93, s77, 146
    s_mul_i32 s94, s93, 4682
    s_lshr_b32 s94, s94, 16
    s_mul_i32 s96, s94, 14
    s_sub_u32 s93, s93, s96
    s_lshl_b32 s96, s93, 6
    s_mul_i32 s95, s94, 57344
    s_add_u32 s96, s96, s95
    s_lshr_b32 s97, s93, 1
    s_lshl_b32 s95, s97, 2
    s_add_u32 s95, s95, s94
    s_mul_i32 s95, s95, 56
    s_and_b32 s93, s93, 1
    s_add_u32 s95, s95, s93
    s_sub_u32 s97, 7, s97
    s_add_u32 s98, s92, 0
    s_lshr_b32 s69, s98, 2
    s_mul_i32 s70, s69, 229376
    s_and_b32 s68, s98, 3
    s_mul_i32 s68, s68, 14336
    s_add_u32 s70, s70, s68
    s_add_u32 s70, s70, s96
    s_add_u32 s69, s69, s97
    s_cmp_ge_u32 s69, 7
    s_cselect_b32 s99, 7, 0
    s_sub_u32 s69, s69, s99
    s_lshl_b32 s69, s69, 2
    s_bfe_u32 s68, s98, 0x10001
    s_mul_i32 s68, s68, 28
    s_add_u32 s69, s69, s68
    s_and_b32 s68, s98, 1
    s_lshl_b32 s68, s68, 1
    s_add_u32 s69, s69, s68
    s_add_u32 s69, s69, s95
    s_lshl_b32 s69, s69, 10
    s_add_u32 s3, s69, 2809856
    s_add_u32 s98, s92, 1
    s_lshr_b32 s69, s98, 2
    s_mul_i32 s71, s69, 229376
    s_and_b32 s68, s98, 3
    s_mul_i32 s68, s68, 14336
    s_add_u32 s71, s71, s68
    s_add_u32 s71, s71, s96
    s_add_u32 s69, s69, s97
    s_cmp_ge_u32 s69, 7
    s_cselect_b32 s99, 7, 0
    s_sub_u32 s69, s69, s99
    s_lshl_b32 s69, s69, 2
    s_bfe_u32 s68, s98, 0x10001
    s_mul_i32 s68, s68, 28
    s_add_u32 s69, s69, s68
    s_and_b32 s68, s98, 1
    s_lshl_b32 s68, s68, 1
    s_add_u32 s69, s69, s68
    s_add_u32 s69, s69, s95
    s_lshl_b32 s69, s69, 10
    s_add_u32 s56, s69, 2809856
    s_add_u32 s98, s92, 2
    s_lshr_b32 s69, s98, 2
    s_mul_i32 s72, s69, 229376
    s_and_b32 s68, s98, 3
    s_mul_i32 s68, s68, 14336
    s_add_u32 s72, s72, s68
    s_add_u32 s72, s72, s96
    s_add_u32 s69, s69, s97
    s_cmp_ge_u32 s69, 7
    s_cselect_b32 s99, 7, 0
    s_sub_u32 s69, s69, s99
    s_lshl_b32 s69, s69, 2
    s_bfe_u32 s68, s98, 0x10001
    s_mul_i32 s68, s68, 28
    s_add_u32 s69, s69, s68
    s_and_b32 s68, s98, 1
    s_lshl_b32 s68, s68, 1
    s_add_u32 s69, s69, s68
    s_add_u32 s69, s69, s95
    s_lshl_b32 s69, s69, 10
    s_add_u32 s57, s69, 2809856
    s_add_u32 s98, s92, 3
    s_lshr_b32 s69, s98, 2
    s_mul_i32 s73, s69, 229376
    s_and_b32 s68, s98, 3
    s_mul_i32 s68, s68, 14336
    s_add_u32 s73, s73, s68
    s_add_u32 s73, s73, s96
    s_add_u32 s69, s69, s97
    s_cmp_ge_u32 s69, 7
    s_cselect_b32 s99, 7, 0
    s_sub_u32 s69, s69, s99
    s_lshl_b32 s69, s69, 2
    s_bfe_u32 s68, s98, 0x10001
    s_mul_i32 s68, s68, 28
    s_add_u32 s69, s69, s68
    s_and_b32 s68, s98, 1
    s_lshl_b32 s68, s68, 1
    s_add_u32 s69, s69, s68
    s_add_u32 s69, s69, s95
    s_lshl_b32 s69, s69, 10
    s_add_u32 s58, s69, 2809856
    s_add_u32 s98, s92, 4
    s_lshr_b32 s69, s98, 2
    s_mul_i32 s74, s69, 229376
    s_and_b32 s68, s98, 3
    s_mul_i32 s68, s68, 14336
    s_add_u32 s74, s74, s68
    s_add_u32 s74, s74, s96
    s_add_u32 s69, s69, s97
    s_cmp_ge_u32 s69, 7
    s_cselect_b32 s99, 7, 0
    s_sub_u32 s69, s69, s99
    s_lshl_b32 s69, s69, 2
    s_bfe_u32 s68, s98, 0x10001
    s_mul_i32 s68, s68, 28
    s_add_u32 s69, s69, s68
    s_and_b32 s68, s98, 1
    s_lshl_b32 s68, s68, 1
    s_add_u32 s69, s69, s68
    s_add_u32 s69, s69, s95
    s_lshl_b32 s69, s69, 10
    s_add_u32 s59, s69, 2809856
    s_add_u32 s98, s92, 5
    s_lshr_b32 s69, s98, 2
    s_mul_i32 s75, s69, 229376
    s_and_b32 s68, s98, 3
    s_mul_i32 s68, s68, 14336
    s_add_u32 s75, s75, s68
    s_add_u32 s75, s75, s96
    s_add_u32 s69, s69, s97
    s_cmp_ge_u32 s69, 7
    s_cselect_b32 s99, 7, 0
    s_sub_u32 s69, s69, s99
    s_lshl_b32 s69, s69, 2
    s_bfe_u32 s68, s98, 0x10001
    s_mul_i32 s68, s68, 28
    s_add_u32 s69, s69, s68
    s_and_b32 s68, s98, 1
    s_lshl_b32 s68, s68, 1
    s_add_u32 s69, s69, s68
    s_add_u32 s69, s69, s95
    s_lshl_b32 s69, s69, 10
    s_add_u32 s61, s69, 2809856
    s_add_u32 s98, s92, 6
    s_lshr_b32 s69, s98, 2
    s_mul_i32 s76, s69, 229376
    s_and_b32 s68, s98, 3
    s_mul_i32 s68, s68, 14336
    s_add_u32 s76, s76, s68
    s_add_u32 s76, s76, s96
    s_add_u32 s69, s69, s97
    s_cmp_ge_u32 s69, 7
    s_cselect_b32 s99, 7, 0
    s_sub_u32 s69, s69, s99
    s_lshl_b32 s69, s69, 2
    s_bfe_u32 s68, s98, 0x10001
    s_mul_i32 s68, s68, 28
    s_add_u32 s69, s69, s68
    s_and_b32 s68, s98, 1
    s_lshl_b32 s68, s68, 1
    s_add_u32 s69, s69, s68
    s_add_u32 s69, s69, s95
    s_lshl_b32 s69, s69, 10
    s_add_u32 s65, s69, 2809856
Lp_tbl:
    v_mov_b32 v248, v1
Lp_go:
    v_lshrrev_b32 v249, 2, v0
    v_mul_lo_u32 v249, v249, s88
    v_and_b32 v250, 3, v0
    v_lshl_add_u32 v249, v250, 4, v249
    s_mul_i32 s67, s12, 7168
    s_add_u32 s67, s67, 1024
    s_add_u32 s28, s79, s36
    s_bitcmp0_b32 s28, 0
    s_cselect_b32 s28, 0x75643120, s0
    s_cselect_b32 s28, s28, 0x76054231
    v_lshrrev_b32 v10, 5, v0
    v_lshlrev_b32 v10, 9, v10
    v_bfe_u32 v11, v0, 2, 2
    v_lshl_add_u32 v10, v11, 6, v10
    v_bfe_u32 v11, v0, 4, 1
    v_and_b32 v12, 3, v0
    v_lshl_add_u32 v11, v11, 2, v12
    v_lshl_add_u32 v253, v11, 3, v10
    v_add_u32 v252, 114688, v253
    v_add_u32 v253, 77824, v253
    v_lshlrev_b32 v11, 2, v11
    v_lshrrev_b32 v12, v11, s90
    v_and_b32 v12, 7, v12
    v_lshl_add_u32 v31, v12, 3, v10
    v_add_u32 v31, s67, v31
    v_lshrrev_b32 v11, v11, s28
    v_and_b32 v11, 7, v11
    v_lshl_add_u32 v13, v11, 3, v10
    v_add_u32 v254, 114688, v13
    v_add_u32 v13, 77824, v13
    s_mov_b32 s40, s16
    s_and_b32 s29, s79, 15
    s_lshl_b32 s29, s29, 6
    s_add_u32 s29, s29, s40
    s_lshl_b32 s41, s29, 11
    s_add_u32 s41, s41, 25776128
    s_lshl_b32 s42, s29, 12
    s_add_u32 s42, s42, 27873280
    s_lshr_b32 s29, s29, 2
    s_lshl_b32 s29, s29, 5
    s_add_u32 s29, s29, s12
    s_lshl_b32 s29, s29, 2
    s_add_u32 s44, s29, 54312960
    s_lshl_b32 s43, s36, 18
    s_add_u32 s43, s43, s42
    s_lshl_b32 s29, s12, 7
    s_add_u32 s29, s29, 0
    v_and_b32 v8, 31, v0
    v_lshl_add_u32 v8, v8, 2, s29
    v_lshrrev_b32 v9, 5, v0
    v_lshl_add_u32 v9, v9, 4, s29
    s_mov_b32 s45, 0x3f803f80
    s_mov_b32 s46, 0x3f80
    s_mov_b32 s47, 0x3f800000
    v_mov_b32 v16, 0
    v_mov_b32 v17, 0
    v_mov_b32 v18, 0
    v_mov_b32 v19, 0
    s_waitcnt vmcnt(8)
    ds_read_b128 v[128:131], v4 offset:0
    ds_read_b128 v[132:135], v5 offset:0
    ds_read_b128 v[136:139], v6 offset:0
    ds_read_b128 v[140:143], v7 offset:0
    s_add_u32 m0, s31, 12288
    s_add_u32 s38, s30, s15
    s_add_u32 s15, s15, 128
    s_cmp_eq_u32 s15, 896
    s_cselect_b32 s15, 0, s15
    s_add_u32 s37, s38, 0
    buffer_load_dwordx4 v2, s[20:23], s37 offen lds
    s_add_u32 m0, s31, 13312
    s_add_u32 s37, s38, 7168
    buffer_load_dwordx4 v3, s[20:23], s37 offen lds
    s_add_u32 m0, s31, 14336
    s_add_u32 s37, s38, 14336
    buffer_load_dwordx4 v2, s[20:23], s37 offen lds
    s_add_u32 m0, s31, 15360
    s_add_u32 s37, s38, 21504
    buffer_load_dwordx4 v3, s[20:23], s37 offen lds
    s_waitcnt vmcnt(8)
    ds_read_b128 v[144:147], v4 offset:4096
    ds_read_b128 v[148:151], v5 offset:4096
    ds_read_b128 v[152:155], v6 offset:4096
    ds_read_b128 v[156:159], v7 offset:4096
    s_add_u32 m0, s31, 16384
    s_add_u32 s38, s30, s15
    s_add_u32 s15, s15, 128
    s_cmp_eq_u32 s15, 896
    s_cselect_b32 s15, 0, s15
    s_add_u32 s37, s38, 0
    buffer_load_dwordx4 v2, s[20:23], s37 offen lds
    s_add_u32 m0, s31, 17408
    s_add_u32 s37, s38, 7168
    buffer_load_dwordx4 v3, s[20:23], s37 offen lds
    s_add_u32 m0, s31, 18432
    s_add_u32 s37, s38, 14336
    buffer_load_dwordx4 v2, s[20:23], s37 offen lds
    s_add_u32 m0, s31, 19456
    s_add_u32 s37, s38, 21504
    buffer_load_dwordx4 v3, s[20:23], s37 offen lds
    s_waitcnt lgkmcnt(7)
    v_dot2_f32_bf16 v16, v128, s45, v16
    v_dot2_f32_bf16 v18, v128, v128, v18
    v_dot2_f32_bf16 v17, v129, s45, v17
    v_dot2_f32_bf16 v19, v129, v129, v19
    v_dot2_f32_bf16 v16, v130, s45, v16
    v_dot2_f32_bf16 v18, v130, v130, v18
    v_dot2_f32_bf16 v17, v131, s45, v17
    v_dot2_f32_bf16 v19, v131, v131, v19
    s_waitcnt lgkmcnt(6)
    v_dot2_f32_bf16 v16, v132, s45, v16
    v_dot2_f32_bf16 v18, v132, v132, v18
    v_dot2_f32_bf16 v17, v133, s45, v17
    v_dot2_f32_bf16 v19, v133, v133, v19
    v_dot2_f32_bf16 v16, v134, s45, v16
    v_dot2_f32_bf16 v18, v134, v134, v18
    v_dot2_f32_bf16 v17, v135, s45, v17
    v_dot2_f32_bf16 v19, v135, v135, v19
    s_waitcnt lgkmcnt(5)
    v_dot2_f32_bf16 v16, v136, s45, v16
    v_dot2_f32_bf16 v18, v136, v136, v18
    v_dot2_f32_bf16 v17, v137, s45, v17
    v_dot2_f32_bf16 v19, v137, v137, v19
    v_dot2_f32_bf16 v16, v138, s45, v16
    v_dot2_f32_bf16 v18, v138, v138, v18
    v_dot2_f32_bf16 v17, v139, s45, v17
    v_dot2_f32_bf16 v19, v139, v139, v19
    s_waitcnt lgkmcnt(4)
    v_dot2_f32_bf16 v16, v140, s45, v16
    v_dot2_f32_bf16 v18, v140, v140, v18
    v_dot2_f32_bf16 v17, v141, s45, v17
    v_dot2_f32_bf16 v19, v141, v141, v19
    v_dot2_f32_bf16 v16, v142, s45, v16
    v_dot2_f32_bf16 v18, v142, v142, v18
    v_dot2_f32_bf16 v17, v143, s45, v17
    v_dot2_f32_bf16 v19, v143, v143, v19
    s_waitcnt vmcnt(8)
    ds_read_b128 v[160:163], v4 offset:8192
    ds_read_b128 v[164:167], v5 offset:8192
    ds_read_b128 v[168:171], v6 offset:8192
    ds_read_b128 v[172:175], v7 offset:8192
    s_add_u32 m0, s31, 20480
    s_add_u32 s38, s30, s15
    s_add_u32 s15, s15, 128
    s_cmp_eq_u32 s15, 896
    s_cselect_b32 s15, 0, s15
    s_add_u32 s37, s38, 0
    buffer_load_dwordx4 v2, s[20:23], s37 offen lds
    s_add_u32 m0, s31, 21504
    s_add_u32 s37, s38, 7168
    buffer_load_dwordx4 v3, s[20:23], s37 offen lds
    s_add_u32 m0, s31, 22528
    s_add_u32 s37, s38, 14336
    buffer_load_dwordx4 v2, s[20:23], s37 offen lds
    s_add_u32 m0, s31, 23552
    s_add_u32 s37, s38, 21504
    buffer_load_dwordx4 v3, s[20:23], s37 offen lds
    s_waitcnt lgkmcnt(7)
    v_dot2_f32_bf16 v16, v144, s45, v16
    v_dot2_f32_bf16 v18, v144, v144, v18
    v_dot2_f32_bf16 v17, v145, s45, v17
    v_dot2_f32_bf16 v19, v145, v145, v19
    v_dot2_f32_bf16 v16, v146, s45, v16
    v_dot2_f32_bf16 v18, v146, v146, v18
    v_dot2_f32_bf16 v17, v147, s45, v17
    v_dot2_f32_bf16 v19, v147, v147, v19
    s_waitcnt lgkmcnt(6)
    v_dot2_f32_bf16 v16, v148, s45, v16
    v_dot2_f32_bf16 v18, v148, v148, v18
    v_dot2_f32_bf16 v17, v149, s45, v17
    v_dot2_f32_bf16 v19, v149, v149, v19
    v_dot2_f32_bf16 v16, v150, s45, v16
    v_dot2_f32_bf16 v18, v150, v150, v18
    v_dot2_f32_bf16 v17, v151, s45, v17
    v_dot2_f32_bf16 v19, v151, v151, v19
    s_waitcnt lgkmcnt(5)
    v_dot2_f32_bf16 v16, v152, s45, v16
    v_dot2_f32_bf16 v18, v152, v152, v18
    v_dot2_f32_bf16 v17, v153, s45, v17
    v_dot2_f32_bf16 v19, v153, v153, v19
    v_dot2_f32_bf16 v16, v154, s45, v16
    v_dot2_f32_bf16 v18, v154, v154, v18
    v_dot2_f32_bf16 v17, v155, s45, v17
    v_dot2_f32_bf16 v19, v155, v155, v19
    s_waitcnt lgkmcnt(4)
    v_dot2_f32_bf16 v16, v156, s45, v16
    v_dot2_f32_bf16 v18, v156, v156, v18
    v_dot2_f32_bf16 v17, v157, s45, v17
    v_dot2_f32_bf16 v19, v157, v157, v19
    v_dot2_f32_bf16 v16, v158, s45, v16
    v_dot2_f32_bf16 v18, v158, v158, v18
    v_dot2_f32_bf16 v17, v159, s45, v17
    v_dot2_f32_bf16 v19, v159, v159, v19
    s_waitcnt vmcnt(8)
    ds_read_b128 v[176:179], v4 offset:12288
    ds_read_b128 v[180:183], v5 offset:12288
    ds_read_b128 v[184:187], v6 offset:12288
    ds_read_b128 v[188:191], v7 offset:12288
    s_add_u32 m0, s31, 24576
    s_add_u32 s38, s30, s15
    s_add_u32 s15, s15, 128
    s_cmp_eq_u32 s15, 896
    s_cselect_b32 s15, 0, s15
    s_add_u32 s37, s38, 0
    buffer_load_dwordx4 v2, s[20:23], s37 offen lds
    s_add_u32 m0, s31, 25600
    s_add_u32 s37, s38, 7168
    buffer_load_dwordx4 v3, s[20:23], s37 offen lds
    s_add_u32 m0, s31, 26624
    s_add_u32 s37, s38, 14336
    buffer_load_dwordx4 v2, s[20:23], s37 offen lds
    s_add_u32 m0, s31, 27648
    s_add_u32 s37, s38, 21504
    buffer_load_dwordx4 v3, s[20:23], s37 offen lds
    s_cmp_lt_u32 s2, 208
    s_cbranch_scc1 Lf_noinit
    s_sub_u32 s28, s2, 208
    s_cmp_ge_u32 s28, 32
    s_cbranch_scc1 Lf_halo
    s_lshl_b32 s29, s28, 2
    s_add_u32 s29, s29, s12
    s_sub_u32 s35, s29, 96
    s_mul_i32 s35, s35, 24
    v_min_u32 v10, 23, v0
    v_add_u32 v10, s35, v10
    v_lshlrev_b32 v10, 7, v10
    s_lshl_b32 s29, s29, 10
    s_add_u32 s29, s29, 54214656
    s_cmp_lt_u32 s28, 24
    s_cselect_b32 s29, s29, 54312960
    s_cselect_b64 vcc, -1, 0
    v_cndmask_b32 v10, v10, v1, vcc
    s_mov_b32 s35, 0
    s_branch Lf_clear
Lf_halo:
    s_bfe_u32 s29, s28, 0x10003
    s_and_b32 s28, s28, 7
    s_mul_i32 s29, s29, 22147072
    s_mul_i32 s35, s28, 290304
    s_add_u32 s29, s29, s35
    s_and_b32 s35, s12, 1
    s_lshl_b32 s35, s35, 10
    s_add_u32 s29, s29, s35
    s_lshr_b32 s35, s12, 1
    s_mul_i32 s39, s35, 274176
    s_add_u32 s29, s29, s39
    s_add_u32 s29, s29, 14049280
    v_min_u32 v11, 55, v0
    v_lshrrev_b32 v10, 3, v11
    v_mul_u32_u24 v10, 2304, v10
    v_and_b32 v11, 7, v11
    v_lshl_add_u32 v10, v11, 4, v10
    s_mul_i32 s35, s35, 7
    s_cmp_eq_u32 s28, s35
    s_cselect_b32 s35, 0, -1
Lf_clear:
    v_mov_b32 v24, s35
    v_mov_b32 v25, s35
    v_mov_b32 v26, s35
    v_mov_b32 v27, s35
    buffer_store_dwordx4 v[24:27], v10, s[4:7], s29 offen sc1
Lf_noinit:
    s_nop 1
    s_waitcnt lgkmcnt(7)
    v_dot2_f32_bf16 v16, v160, s45, v16
    v_dot2_f32_bf16 v18, v160, v160, v18
    v_dot2_f32_bf16 v17, v161, s45, v17
    v_dot2_f32_bf16 v19, v161, v161, v19
    v_dot2_f32_bf16 v16, v162, s45, v16
    v_dot2_f32_bf16 v18, v162, v162, v18
    v_dot2_f32_bf16 v17, v163, s45, v17
    v_dot2_f32_bf16 v19, v163, v163, v19
    s_waitcnt lgkmcnt(6)
    v_dot2_f32_bf16 v16, v164, s45, v16
    v_dot2_f32_bf16 v18, v164, v164, v18
    v_dot2_f32_bf16 v17, v165, s45, v17
    v_dot2_f32_bf16 v19, v165, v165, v19
    v_dot2_f32_bf16 v16, v166, s45, v16
    v_dot2_f32_bf16 v18, v166, v166, v18
    v_dot2_f32_bf16 v17, v167, s45, v17
    v_dot2_f32_bf16 v19, v167, v167, v19
    s_waitcnt lgkmcnt(5)
    v_dot2_f32_bf16 v16, v168, s45, v16
    v_dot2_f32_bf16 v18, v168, v168, v18
    v_dot2_f32_bf16 v17, v169, s45, v17
    v_dot2_f32_bf16 v19, v169, v169, v19
    v_dot2_f32_bf16 v16, v170, s45, v16
    v_dot2_f32_bf16 v18, v170, v170, v18
    v_dot2_f32_bf16 v17, v171, s45, v17
    v_dot2_f32_bf16 v19, v171, v171, v19
    s_waitcnt lgkmcnt(4)
    v_dot2_f32_bf16 v16, v172, s45, v16
    v_dot2_f32_bf16 v18, v172, v172, v18
    v_dot2_f32_bf16 v17, v173, s45, v17
    v_dot2_f32_bf16 v19, v173, v173, v19
    v_dot2_f32_bf16 v16, v174, s45, v16
    v_dot2_f32_bf16 v18, v174, v174, v18
    v_dot2_f32_bf16 v17, v175, s45, v17
    v_dot2_f32_bf16 v19, v175, v175, v19
    s_waitcnt vmcnt(8)
    ds_read_b128 v[192:195], v4 offset:16384
    ds_read_b128 v[196:199], v5 offset:16384
    ds_read_b128 v[200:203], v6 offset:16384
    ds_read_b128 v[204:207], v7 offset:16384
    s_add_u32 m0, s34, 114688
    s_add_u32 s37, s32, s18
    s_add_u32 s18, s18, 172032
    s_cmp_eq_u32 s18, 1204224
    s_cselect_b32 s18, 0, s18
    buffer_load_dwordx4 v251, s[24:27], s37 offen lds
    s_add_u32 m0, s34, 118784
    s_add_u32 s37, s37, 86016
    buffer_load_dwordx4 v251, s[24:27], s37 offen lds
    s_waitcnt lgkmcnt(7)
    v_dot2_f32_bf16 v16, v176, s45, v16
    v_dot2_f32_bf16 v18, v176, v176, v18
    v_dot2_f32_bf16 v17, v177, s45, v17
    v_dot2_f32_bf16 v19, v177, v177, v19
    v_dot2_f32_bf16 v16, v178, s45, v16
    v_dot2_f32_bf16 v18, v178, v178, v18
    v_dot2_f32_bf16 v17, v179, s45, v17
    v_dot2_f32_bf16 v19, v179, v179, v19
    s_waitcnt lgkmcnt(6)
    v_dot2_f32_bf16 v16, v180, s45, v16
    v_dot2_f32_bf16 v18, v180, v180, v18
    v_dot2_f32_bf16 v17, v181, s45, v17
    v_dot2_f32_bf16 v19, v181, v181, v19
    v_dot2_f32_bf16 v16, v182, s45, v16
    v_dot2_f32_bf16 v18, v182, v182, v18
    v_dot2_f32_bf16 v17, v183, s45, v17
    v_dot2_f32_bf16 v19, v183, v183, v19
    s_waitcnt lgkmcnt(5)
    v_dot2_f32_bf16 v16, v184, s45, v16
    v_dot2_f32_bf16 v18, v184, v184, v18
    v_dot2_f32_bf16 v17, v185, s45, v17
    v_dot2_f32_bf16 v19, v185, v185, v19
    v_dot2_f32_bf16 v16, v186, s45, v16
    v_dot2_f32_bf16 v18, v186, v186, v18
    v_dot2_f32_bf16 v17, v187, s45, v17
    v_dot2_f32_bf16 v19, v187, v187, v19
    s_waitcnt lgkmcnt(4)
    v_dot2_f32_bf16 v16, v188, s45, v16
    v_dot2_f32_bf16 v18, v188, v188, v18
    v_dot2_f32_bf16 v17, v189, s45, v17
    v_dot2_f32_bf16 v19, v189, v189, v19
    v_dot2_f32_bf16 v16, v190, s45, v16
    v_dot2_f32_bf16 v18, v190, v190, v18
    v_dot2_f32_bf16 v17, v191, s45, v17
    v_dot2_f32_bf16 v19, v191, v191, v19
    s_waitcnt vmcnt(6)
    ds_read_b128 v[208:211], v4 offset:20480
    ds_read_b128 v[212:215], v5 offset:20480
    ds_read_b128 v[216:219], v6 offset:20480
    ds_read_b128 v[220:223], v7 offset:20480
    s_add_u32 m0, s34, 122880
    s_add_u32 s37, s32, s18
    s_add_u32 s18, s18, 172032
    s_cmp_eq_u32 s18, 1204224
    s_cselect_b32 s18, 0, s18
    buffer_load_dwordx4 v251, s[24:27], s37 offen lds
    s_add_u32 m0, s34, 126976
    s_add_u32 s37, s37, 86016
    buffer_load_dwordx4 v251, s[24:27], s37 offen lds
    s_waitcnt lgkmcnt(7)
    v_dot2_f32_bf16 v16, v192, s45, v16
    v_dot2_f32_bf16 v18, v192, v192, v18
    v_dot2_f32_bf16 v17, v193, s45, v17
    v_dot2_f32_bf16 v19, v193, v193, v19
    v_dot2_f32_bf16 v16, v194, s45, v16
    v_dot2_f32_bf16 v18, v194, v194, v18
    v_dot2_f32_bf16 v17, v195, s45, v17
    v_dot2_f32_bf16 v19, v195, v195, v19
    s_waitcnt lgkmcnt(6)
    v_dot2_f32_bf16 v16, v196, s45, v16
    v_dot2_f32_bf16 v18, v196, v196, v18
    v_dot2_f32_bf16 v17, v197, s45, v17
    v_dot2_f32_bf16 v19, v197, v197, v19
    v_dot2_f32_bf16 v16, v198, s45, v16
    v_dot2_f32_bf16 v18, v198, v198, v18
    v_dot2_f32_bf16 v17, v199, s45, v17
    v_dot2_f32_bf16 v19, v199, v199, v19
    s_waitcnt lgkmcnt(5)
    v_dot2_f32_bf16 v16, v200, s45, v16
    v_dot2_f32_bf16 v18, v200, v200, v18
    v_dot2_f32_bf16 v17, v201, s45, v17
    v_dot2_f32_bf16 v19, v201, v201, v19
    v_dot2_f32_bf16 v16, v202, s45, v16
    v_dot2_f32_bf16 v18, v202, v202, v18
    v_dot2_f32_bf16 v17, v203, s45, v17
    v_dot2_f32_bf16 v19, v203, v203, v19
    s_waitcnt lgkmcnt(4)
    v_dot2_f32_bf16 v16, v204, s45, v16
    v_dot2_f32_bf16 v18, v204, v204, v18
    v_dot2_f32_bf16 v17, v205, s45, v17
    v_dot2_f32_bf16 v19, v205, v205, v19
    v_dot2_f32_bf16 v16, v206, s45, v16
    v_dot2_f32_bf16 v18, v206, v206, v18
    v_dot2_f32_bf16 v17, v207, s45, v17
    v_dot2_f32_bf16 v19, v207, v207, v19
    s_waitcnt vmcnt(4)
    ds_read_b128 v[224:227], v4 offset:24576
    ds_read_b128 v[228:231], v5 offset:24576
    ds_read_b128 v[232:235], v6 offset:24576
    ds_read_b128 v[236:239], v7 offset:24576
    s_add_u32 m0, s34, 131072
    s_add_u32 s37, s32, s18
    s_add_u32 s18, s18, 172032
    s_cmp_eq_u32 s18, 1204224
    s_cselect_b32 s18, 0, s18
    buffer_load_dwordx4 v251, s[24:27], s37 offen lds
    s_add_u32 m0, s34, 135168
    s_add_u32 s37, s37, 86016
    buffer_load_dwordx4 v251, s[24:27], s37 offen lds
    s_waitcnt lgkmcnt(7)
    v_dot2_f32_bf16 v16, v208, s45, v16
    v_dot2_f32_bf16 v18, v208, v208, v18
    v_dot2_f32_bf16 v17, v209, s45, v17
    v_dot2_f32_bf16 v19, v209, v209, v19
    v_dot2_f32_bf16 v16, v210, s45, v16
    v_dot2_f32_bf16 v18, v210, v210, v18
    v_dot2_f32_bf16 v17, v211, s45, v17
    v_dot2_f32_bf16 v19, v211, v211, v19
    s_waitcnt lgkmcnt(6)
    v_dot2_f32_bf16 v16, v212, s45, v16
    v_dot2_f32_bf16 v18, v212, v212, v18
    v_dot2_f32_bf16 v17, v213, s45, v17
    v_dot2_f32_bf16 v19, v213, v213, v19
    v_dot2_f32_bf16 v16, v214, s45, v16
    v_dot2_f32_bf16 v18, v214, v214, v18
    v_dot2_f32_bf16 v17, v215, s45, v17
    v_dot2_f32_bf16 v19, v215, v215, v19
    s_waitcnt lgkmcnt(5)
    v_dot2_f32_bf16 v16, v216, s45, v16
    v_dot2_f32_bf16 v18, v216, v216, v18
    v_dot2_f32_bf16 v17, v217, s45, v17
    v_dot2_f32_bf16 v19, v217, v217, v19
    v_dot2_f32_bf16 v16, v218, s45, v16
    v_dot2_f32_bf16 v18, v218, v218, v18
    v_dot2_f32_bf16 v17, v219, s45, v17
    v_dot2_f32_bf16 v19, v219, v219, v19
    s_waitcnt lgkmcnt(4)
    v_dot2_f32_bf16 v16, v220, s45, v16
    v_dot2_f32_bf16 v18, v220, v220, v18
    v_dot2_f32_bf16 v17, v221, s45, v17
    v_dot2_f32_bf16 v19, v221, v221, v19
    v_dot2_f32_bf16 v16, v222, s45, v16
    v_dot2_f32_bf16 v18, v222, v222, v18
    v_dot2_f32_bf16 v17, v223, s45, v17
    v_dot2_f32_bf16 v19, v223, v223, v19
    s_waitcnt lgkmcnt(3)
    v_dot2_f32_bf16 v16, v224, s45, v16
    v_dot2_f32_bf16 v18, v224, v224, v18
    v_dot2_f32_bf16 v17, v225, s45, v17
    v_dot2_f32_bf16 v19, v225, v225, v19
    v_dot2_f32_bf16 v16, v226, s45, v16
    v_dot2_f32_bf16 v18, v226, v226, v18
    v_dot2_f32_bf16 v17, v227, s45, v17
    v_dot2_f32_bf16 v19, v227, v227, v19
    s_waitcnt lgkmcnt(2)
    v_dot2_f32_bf16 v16, v228, s45, v16
    v_dot2_f32_bf16 v18, v228, v228, v18
    v_dot2_f32_bf16 v17, v229, s45, v17
    v_dot2_f32_bf16 v19, v229, v229, v19
    v_dot2_f32_bf16 v16, v230, s45, v16
    v_dot2_f32_bf16 v18, v230, v230, v18
    v_dot2_f32_bf16 v17, v231, s45, v17
    v_dot2_f32_bf16 v19, v231, v231, v19
    s_waitcnt lgkmcnt(1)
    v_dot2_f32_bf16 v16, v232, s45, v16
    v_dot2_f32_bf16 v18, v232, v232, v18
    v_dot2_f32_bf16 v17, v233, s45, v17
    v_dot2_f32_bf16 v19, v233, v233, v19
    v_dot2_f32_bf16 v16, v234, s45, v16
    v_dot2_f32_bf16 v18, v234, v234, v18
    v_dot2_f32_bf16 v17, v235, s45, v17
    v_dot2_f32_bf16 v19, v235, v235, v19
    s_waitcnt lgkmcnt(0)
    v_dot2_f32_bf16 v16, v236, s45, v16
    v_dot2_f32_bf16 v18, v236, v236, v18
    v_dot2_f32_bf16 v17, v237, s45, v17
    v_dot2_f32_bf16 v19, v237, v237, v19
    v_dot2_f32_bf16 v16, v238, s45, v16
    v_dot2_f32_bf16 v18, v238, v238, v18
    v_dot2_f32_bf16 v17, v239, s45, v17
    v_dot2_f32_bf16 v19, v239, v239, v19
    s_nop 1
    v_add_f32 v16, v16, v17
    s_add_u32 m0, s34, 139264
    s_add_u32 s37, s32, s18
    s_add_u32 s18, s18, 172032
    s_cmp_eq_u32 s18, 1204224
    s_cselect_b32 s18, 0, s18
    buffer_load_dwordx4 v251, s[24:27], s37 offen lds
    v_add_f32 v18, v18, v19
    s_add_u32 m0, s34, 143360
    s_add_u32 s37, s37, 86016
    buffer_load_dwordx4 v251, s[24:27], s37 offen lds
    v_permlane32_swap_b32 v16, v18
    s_add_u32 m0, s34, 147456
    s_add_u32 s37, s32, s18
    s_add_u32 s18, s18, 172032
    s_cmp_eq_u32 s18, 1204224
    s_cselect_b32 s18, 0, s18
    buffer_load_dwordx4 v251, s[24:27], s37 offen lds
    v_add_f32 v16, v16, v18
    v_mov_b32 v17, v16
    s_nop 1
    v_permlane32_swap_b32 v16, v17
    v_mul_f32 v12, 0x3b124925, v16
    v_mul_f32 v10, 0x3b124925, v17
    v_fma_f32 v10, -v12, v12, v10
    v_max_f32 v10, 0, v10
    v_add_f32 v14, 0x3727c5ac, v10
    v_rsq_f32 v14, v14
    v_sub_f32 v11, 0, v12
    v_dot2_f32_bf16 v80, v128, s46, v11
    v_dot2_f32_bf16 v81, v128, s47, v11
    v_dot2_f32_bf16 v82, v129, s46, v11
    v_dot2_f32_bf16 v83, v129, s47, v11
    v_dot2_f32_bf16 v84, v130, s46, v11
    v_dot2_f32_bf16 v85, v130, s47, v11
    v_dot2_f32_bf16 v86, v131, s46, v11
    v_dot2_f32_bf16 v87, v131, s47, v11
    v_dot2_f32_bf16 v88, v132, s46, v11
    v_dot2_f32_bf16 v89, v132, s47, v11
    v_dot2_f32_bf16 v90, v133, s46, v11
    v_dot2_f32_bf16 v91, v133, s47, v11
    v_dot2_f32_bf16 v92, v134, s46, v11
    v_dot2_f32_bf16 v93, v134, s47, v11
    v_dot2_f32_bf16 v94, v135, s46, v11
    s_add_u32 m0, s34, 151552
    s_add_u32 s37, s37, 86016
    buffer_load_dwordx4 v251, s[24:27], s37 offen lds
    v_dot2_f32_bf16 v95, v135, s47, v11
    v_cvt_pk_bf16_f32 v128, v80, v81
    v_cvt_pk_bf16_f32 v129, v82, v83
    v_cvt_pk_bf16_f32 v130, v84, v85
    v_cvt_pk_bf16_f32 v131, v86, v87
    v_dot2_f32_bf16 v80, v136, s46, v11
    v_dot2_f32_bf16 v81, v136, s47, v11
    v_dot2_f32_bf16 v82, v137, s46, v11
    v_dot2_f32_bf16 v83, v137, s47, v11
    v_dot2_f32_bf16 v84, v138, s46, v11
    v_dot2_f32_bf16 v85, v138, s47, v11
    v_dot2_f32_bf16 v86, v139, s46, v11
    v_dot2_f32_bf16 v87, v139, s47, v11
    v_cvt_pk_bf16_f32 v132, v88, v89
    v_cvt_pk_bf16_f32 v133, v90, v91
    v_cvt_pk_bf16_f32 v134, v92, v93
    v_cvt_pk_bf16_f32 v135, v94, v95
    v_dot2_f32_bf16 v88, v140, s46, v11
    v_dot2_f32_bf16 v89, v140, s47, v11
    v_dot2_f32_bf16 v90, v141, s46, v11
    v_dot2_f32_bf16 v91, v141, s47, v11
    v_dot2_f32_bf16 v92, v142, s46, v11
    v_dot2_f32_bf16 v93, v142, s47, v11
    v_dot2_f32_bf16 v94, v143, s46, v11
    v_dot2_f32_bf16 v95, v143, s47, v11
    v_cvt_pk_bf16_f32 v136, v80, v81
    v_cvt_pk_bf16_f32 v137, v82, v83
    v_cvt_pk_bf16_f32 v138, v84, v85
    v_cvt_pk_bf16_f32 v139, v86, v87
    v_dot2_f32_bf16 v80, v144, s46, v11
    v_dot2_f32_bf16 v81, v144, s47, v11
    v_dot2_f32_bf16 v82, v145, s46, v11
    v_dot2_f32_bf16 v83, v145, s47, v11
    v_dot2_f32_bf16 v84, v146, s46, v11
    v_dot2_f32_bf16 v85, v146, s47, v11
    v_dot2_f32_bf16 v86, v147, s46, v11
    v_dot2_f32_bf16 v87, v147, s47, v11
    s_add_u32 m0, s34, 155648
    s_add_u32 s37, s32, s18
    s_add_u32 s18, s18, 172032
    s_cmp_eq_u32 s18, 1204224
    s_cselect_b32 s18, 0, s18
    buffer_load_dwordx4 v251, s[24:27], s37 offen lds
    v_cvt_pk_bf16_f32 v140, v88, v89
    v_cvt_pk_bf16_f32 v141, v90, v91
    v_cvt_pk_bf16_f32 v142, v92, v93
    v_cvt_pk_bf16_f32 v143, v94, v95
    v_dot2_f32_bf16 v88, v148, s46, v11
    v_dot2_f32_bf16 v89, v148, s47, v11
    v_dot2_f32_bf16 v90, v149, s46, v11
    v_dot2_f32_bf16 v91, v149, s47, v11
    v_dot2_f32_bf16 v92, v150, s46, v11
    v_dot2_f32_bf16 v93, v150, s47, v11
    v_dot2_f32_bf16 v94, v151, s46, v11
    v_dot2_f32_bf16 v95, v151, s47, v11
    v_cvt_pk_bf16_f32 v144, v80, v81
    v_cvt_pk_bf16_f32 v145, v82, v83
    v_cvt_pk_bf16_f32 v146, v84, v85
    v_cvt_pk_bf16_f32 v147, v86, v87
    v_dot2_f32_bf16 v80, v152, s46, v11
    v_dot2_f32_bf16 v81, v152, s47, v11
    v_dot2_f32_bf16 v82, v153, s46, v11
    v_dot2_f32_bf16 v83, v153, s47, v11
    v_dot2_f32_bf16 v84, v154, s46, v11
    v_dot2_f32_bf16 v85, v154, s47, v11
    v_dot2_f32_bf16 v86, v155, s46, v11
    v_dot2_f32_bf16 v87, v155, s47, v11
    v_cvt_pk_bf16_f32 v148, v88, v89
    v_cvt_pk_bf16_f32 v149, v90, v91
    v_cvt_pk_bf16_f32 v150, v92, v93
    v_cvt_pk_bf16_f32 v151, v94, v95
    v_dot2_f32_bf16 v88, v156, s46, v11
    v_dot2_f32_bf16 v89, v156, s47, v11
    v_dot2_f32_bf16 v90, v157, s46, v11
    v_dot2_f32_bf16 v91, v157, s47, v11
    v_dot2_f32_bf16 v92, v158, s46, v11
    v_dot2_f32_bf16 v93, v158, s47, v11
    v_dot2_f32_bf16 v94, v159, s46, v11
    s_add_u32 m0, s34, 159744
    s_add_u32 s37, s37, 86016
    buffer_load_dwordx4 v251, s[24:27], s37 offen lds
    v_dot2_f32_bf16 v95, v159, s47, v11
    v_cvt_pk_bf16_f32 v152, v80, v81
    v_cvt_pk_bf16_f32 v153, v82, v83
    v_cvt_pk_bf16_f32 v154, v84, v85
    v_cvt_pk_bf16_f32 v155, v86, v87
    v_dot2_f32_bf16 v80, v160, s46, v11
    v_dot2_f32_bf16 v81, v160, s47, v11
    v_dot2_f32_bf16 v82, v161, s46, v11
    v_dot2_f32_bf16 v83, v161, s47, v11
    v_dot2_f32_bf16 v84, v162, s46, v11
    v_dot2_f32_bf16 v85, v162, s47, v11
    v_dot2_f32_bf16 v86, v163, s46, v11
    v_dot2_f32_bf16 v87, v163, s47, v11
    v_cvt_pk_bf16_f32 v156, v88, v89
    v_cvt_pk_bf16_f32 v157, v90, v91
    v_cvt_pk_bf16_f32 v158, v92, v93
    v_cvt_pk_bf16_f32 v159, v94, v95
    v_dot2_f32_bf16 v88, v164, s46, v11
    v_dot2_f32_bf16 v89, v164, s47, v11
    v_dot2_f32_bf16 v90, v165, s46, v11
    v_dot2_f32_bf16 v91, v165, s47, v11
    v_dot2_f32_bf16 v92, v166, s46, v11
    v_dot2_f32_bf16 v93, v166, s47, v11
    v_dot2_f32_bf16 v94, v167, s46, v11
    v_dot2_f32_bf16 v95, v167, s47, v11
    v_cvt_pk_bf16_f32 v160, v80, v81
    v_cvt_pk_bf16_f32 v161, v82, v83
    v_cvt_pk_bf16_f32 v162, v84, v85
    v_cvt_pk_bf16_f32 v163, v86, v87
    v_dot2_f32_bf16 v80, v168, s46, v11
    v_dot2_f32_bf16 v81, v168, s47, v11
    v_dot2_f32_bf16 v82, v169, s46, v11
    v_dot2_f32_bf16 v83, v169, s47, v11
    v_dot2_f32_bf16 v84, v170, s46, v11
    v_dot2_f32_bf16 v85, v170, s47, v11
    v_dot2_f32_bf16 v86, v171, s46, v11
    v_dot2_f32_bf16 v87, v171, s47, v11
    v_cvt_pk_bf16_f32 v164, v88, v89
    v_cvt_pk_bf16_f32 v165, v90, v91
    v_cvt_pk_bf16_f32 v166, v92, v93
    v_cvt_pk_bf16_f32 v167, v94, v95
    v_dot2_f32_bf16 v88, v172, s46, v11
    v_dot2_f32_bf16 v89, v172, s47, v11
    v_dot2_f32_bf16 v90, v173, s46, v11
    v_dot2_f32_bf16 v91, v173, s47, v11
    v_dot2_f32_bf16 v92, v174, s46, v11
    v_dot2_f32_bf16 v93, v174, s47, v11
    v_dot2_f32_bf16 v94, v175, s46, v11
    v_dot2_f32_bf16 v95, v175, s47, v11
    v_cvt_pk_bf16_f32 v168, v80, v81
    v_cvt_pk_bf16_f32 v169, v82, v83
    v_cvt_pk_bf16_f32 v170, v84, v85
    v_cvt_pk_bf16_f32 v171, v86, v87
    v_dot2_f32_bf16 v80, v176, s46, v11
    v_dot2_f32_bf16 v81, v176, s47, v11
    v_dot2_f32_bf16 v82, v177, s46, v11
    v_dot2_f32_bf16 v83, v177, s47, v11
    v_dot2_f32_bf16 v84, v178, s46, v11
    v_dot2_f32_bf16 v85, v178, s47, v11
    v_dot2_f32_bf16 v86, v179, s46, v11
    v_dot2_f32_bf16 v87, v179, s47, v11
    v_cvt_pk_bf16_f32 v172, v88, v89
    v_cvt_pk_bf16_f32 v173, v90, v91
    v_cvt_pk_bf16_f32 v174, v92, v93
    v_cvt_pk_bf16_f32 v175, v94, v95
    v_dot2_f32_bf16 v88, v180, s46, v11
    v_dot2_f32_bf16 v89, v180, s47, v11
    v_dot2_f32_bf16 v90, v181, s46, v11
    v_dot2_f32_bf16 v91, v181, s47, v11
    v_dot2_f32_bf16 v92, v182, s46, v11
    v_dot2_f32_bf16 v93, v182, s47, v11
    v_dot2_f32_bf16 v94, v183, s46, v11
    v_dot2_f32_bf16 v95, v183, s47, v11
    v_cvt_pk_bf16_f32 v176, v80, v81
    v_cvt_pk_bf16_f32 v177, v82, v83
    v_cvt_pk_bf16_f32 v178, v84, v85
    v_cvt_pk_bf16_f32 v179, v86, v87
    v_dot2_f32_bf16 v80, v184, s46, v11
    v_dot2_f32_bf16 v81, v184, s47, v11
    v_dot2_f32_bf16 v82, v185, s46, v11
    v_dot2_f32_bf16 v83, v185, s47, v11
    v_dot2_f32_bf16 v84, v186, s46, v11
    v_dot2_f32_bf16 v85, v186, s47, v11
    v_dot2_f32_bf16 v86, v187, s46, v11
    v_dot2_f32_bf16 v87, v187, s47, v11
    v_cvt_pk_bf16_f32 v180, v88, v89
    v_cvt_pk_bf16_f32 v181, v90, v91
    v_cvt_pk_bf16_f32 v182, v92, v93
    v_cvt_pk_bf16_f32 v183, v94, v95
    v_dot2_f32_bf16 v88, v188, s46, v11
    v_dot2_f32_bf16 v89, v188, s47, v11
    v_dot2_f32_bf16 v90, v189, s46, v11
    v_dot2_f32_bf16 v91, v189, s47, v11
    v_dot2_f32_bf16 v92, v190, s46, v11
    v_dot2_f32_bf16 v93, v190, s47, v11
    v_dot2_f32_bf16 v94, v191, s46, v11
    v_dot2_f32_bf16 v95, v191, s47, v11
    v_cvt_pk_bf16_f32 v184, v80, v81
    v_cvt_pk_bf16_f32 v185, v82, v83
    v_cvt_pk_bf16_f32 v186, v84, v85
    v_cvt_pk_bf16_f32 v187, v86, v87
    v_dot2_f32_bf16 v80, v192, s46, v11
    v_dot2_f32_bf16 v81, v192, s47, v11
    v_dot2_f32_bf16 v82, v193, s46, v11
    v_dot2_f32_bf16 v83, v193, s47, v11
    v_dot2_f32_bf16 v84, v194, s46, v11
    v_dot2_f32_bf16 v85, v194, s47, v11
    v_dot2_f32_bf16 v86, v195, s46, v11
    v_dot2_f32_bf16 v87, v195, s47, v11
    v_cvt_pk_bf16_f32 v188, v88, v89
    v_cvt_pk_bf16_f32 v189, v90, v91
    v_cvt_pk_bf16_f32 v190, v92, v93
    v_cvt_pk_bf16_f32 v191, v94, v95
    v_dot2_f32_bf16 v88, v196, s46, v11
    v_dot2_f32_bf16 v89, v196, s47, v11
    v_dot2_f32_bf16 v90, v197, s46, v11
    v_dot2_f32_bf16 v91, v197, s47, v11
    v_dot2_f32_bf16 v92, v198, s46, v11
    v_dot2_f32_bf16 v93, v198, s47, v11
    v_dot2_f32_bf16 v94, v199, s46, v11
    v_dot2_f32_bf16 v95, v199, s47, v11
    v_cvt_pk_bf16_f32 v192, v80, v81
    v_cvt_pk_bf16_f32 v193, v82, v83
    v_cvt_pk_bf16_f32 v194, v84, v85
    v_cvt_pk_bf16_f32 v195, v86, v87
    v_dot2_f32_bf16 v80, v200, s46, v11
    v_dot2_f32_bf16 v81, v200, s47, v11
    v_dot2_f32_bf16 v82, v201, s46, v11
    v_dot2_f32_bf16 v83, v201, s47, v11
    v_dot2_f32_bf16 v84, v202, s46, v11
    v_dot2_f32_bf16 v85, v202, s47, v11
    v_dot2_f32_bf16 v86, v203, s46, v11
    v_dot2_f32_bf16 v87, v203, s47, v11
    v_cvt_pk_bf16_f32 v196, v88, v89
    v_cvt_pk_bf16_f32 v197, v90, v91
    v_cvt_pk_bf16_f32 v198, v92, v93
    v_cvt_pk_bf16_f32 v199, v94, v95
    v_dot2_f32_bf16 v88, v204, s46, v11
    v_dot2_f32_bf16 v89, v204, s47, v11
    v_dot2_f32_bf16 v90, v205, s46, v11
    v_dot2_f32_bf16 v91, v205, s47, v11
    v_dot2_f32_bf16 v92, v206, s46, v11
    v_dot2_f32_bf16 v93, v206, s47, v11
    v_dot2_f32_bf16 v94, v207, s46, v11
    v_dot2_f32_bf16 v95, v207, s47, v11
    v_cvt_pk_bf16_f32 v200, v80, v81
    v_cvt_pk_bf16_f32 v201, v82, v83
    v_cvt_pk_bf16_f32 v202, v84, v85
    v_cvt_pk_bf16_f32 v203, v86, v87
    v_dot2_f32_bf16 v80, v208, s46, v11
    v_dot2_f32_bf16 v81, v208, s47, v11
    v_dot2_f32_bf16 v82, v209, s46, v11
    v_dot2_f32_bf16 v83, v209, s47, v11
    v_dot2_f32_bf16 v84, v210, s46, v11
    v_dot2_f32_bf16 v85, v210, s47, v11
    v_dot2_f32_bf16 v86, v211, s46, v11
    v_dot2_f32_bf16 v87, v211, s47, v11
    v_cvt_pk_bf16_f32 v204, v88, v89
    v_cvt_pk_bf16_f32 v205, v90, v91
    v_cvt_pk_bf16_f32 v206, v92, v93
    v_cvt_pk_bf16_f32 v207, v94, v95
    v_dot2_f32_bf16 v88, v212, s46, v11
    v_dot2_f32_bf16 v89, v212, s47, v11
    v_dot2_f32_bf16 v90, v213, s46, v11
    v_dot2_f32_bf16 v91, v213, s47, v11
    v_dot2_f32_bf16 v92, v214, s46, v11
    v_dot2_f32_bf16 v93, v214, s47, v11
    v_dot2_f32_bf16 v94, v215, s46, v11
    v_dot2_f32_bf16 v95, v215, s47, v11
    v_cvt_pk_bf16_f32 v208, v80, v81
    v_cvt_pk_bf16_f32 v209, v82, v83
    v_cvt_pk_bf16_f32 v210, v84, v85
    v_cvt_pk_bf16_f32 v211, v86, v87
    v_dot2_f32_bf16 v80, v216, s46, v11
    v_dot2_f32_bf16 v81, v216, s47, v11
    v_dot2_f32_bf16 v82, v217, s46, v11
    v_dot2_f32_bf16 v83, v217, s47, v11
    v_dot2_f32_bf16 v84, v218, s46, v11
    v_dot2_f32_bf16 v85, v218, s47, v11
    v_dot2_f32_bf16 v86, v219, s46, v11
    v_dot2_f32_bf16 v87, v219, s47, v11
    v_cvt_pk_bf16_f32 v212, v88, v89
    v_cvt_pk_bf16_f32 v213, v90, v91
    v_cvt_pk_bf16_f32 v214, v92, v93
    v_cvt_pk_bf16_f32 v215, v94, v95
    v_dot2_f32_bf16 v88, v220, s46, v11
    v_dot2_f32_bf16 v89, v220, s47, v11
    v_dot2_f32_bf16 v90, v221, s46, v11
    v_dot2_f32_bf16 v91, v221, s47, v11
    v_dot2_f32_bf16 v92, v222, s46, v11
    v_dot2_f32_bf16 v93, v222, s47, v11
    v_dot2_f32_bf16 v94, v223, s46, v11
    v_dot2_f32_bf16 v95, v223, s47, v11
    v_cvt_pk_bf16_f32 v216, v80, v81
    v_cvt_pk_bf16_f32 v217, v82, v83
    v_cvt_pk_bf16_f32 v218, v84, v85
    v_cvt_pk_bf16_f32 v219, v86, v87
    v_dot2_f32_bf16 v80, v224, s46, v11
    v_dot2_f32_bf16 v81, v224, s47, v11
    v_dot2_f32_bf16 v82, v225, s46, v11
    v_dot2_f32_bf16 v83, v225, s47, v11
    v_dot2_f32_bf16 v84, v226, s46, v11
    v_dot2_f32_bf16 v85, v226, s47, v11
    v_dot2_f32_bf16 v86, v227, s46, v11
    v_dot2_f32_bf16 v87, v227, s47, v11
    v_cvt_pk_bf16_f32 v220, v88, v89
    v_cvt_pk_bf16_f32 v221, v90, v91
    v_cvt_pk_bf16_f32 v222, v92, v93
    v_cvt_pk_bf16_f32 v223, v94, v95
    v_dot2_f32_bf16 v88, v228, s46, v11
    v_dot2_f32_bf16 v89, v228, s47, v11
    v_dot2_f32_bf16 v90, v229, s46, v11
    v_dot2_f32_bf16 v91, v229, s47, v11
    v_dot2_f32_bf16 v92, v230, s46, v11
    v_dot2_f32_bf16 v93, v230, s47, v11
    v_dot2_f32_bf16 v94, v231, s46, v11
    v_dot2_f32_bf16 v95, v231, s47, v11
    v_cvt_pk_bf16_f32 v224, v80, v81
    v_cvt_pk_bf16_f32 v225, v82, v83
    v_cvt_pk_bf16_f32 v226, v84, v85
    v_cvt_pk_bf16_f32 v227, v86, v87
    v_dot2_f32_bf16 v80, v232, s46, v11
    v_dot2_f32_bf16 v81, v232, s47, v11
    v_dot2_f32_bf16 v82, v233, s46, v11
    v_dot2_f32_bf16 v83, v233, s47, v11
    v_dot2_f32_bf16 v84, v234, s46, v11
    v_dot2_f32_bf16 v85, v234, s47, v11
    v_dot2_f32_bf16 v86, v235, s46, v11
    v_dot2_f32_bf16 v87, v235, s47, v11
    v_cvt_pk_bf16_f32 v228, v88, v89
    v_cvt_pk_bf16_f32 v229, v90, v91
    v_cvt_pk_bf16_f32 v230, v92, v93
    v_cvt_pk_bf16_f32 v231, v94, v95
    v_dot2_f32_bf16 v88, v236, s46, v11
    v_dot2_f32_bf16 v89, v236, s47, v11
    v_dot2_f32_bf16 v90, v237, s46, v11
    v_dot2_f32_bf16 v91, v237, s47, v11
    v_dot2_f32_bf16 v92, v238, s46, v11
    v_dot2_f32_bf16 v93, v238, s47, v11
    v_dot2_f32_bf16 v94, v239, s46, v11
    v_dot2_f32_bf16 v95, v239, s47, v11
    v_cvt_pk_bf16_f32 v232, v80, v81
    v_cvt_pk_bf16_f32 v233, v82, v83
    v_cvt_pk_bf16_f32 v234, v84, v85
    v_cvt_pk_bf16_f32 v235, v86, v87
    v_cvt_pk_bf16_f32 v236, v88, v89
    v_cvt_pk_bf16_f32 v237, v90, v91
    v_cvt_pk_bf16_f32 v238, v92, v93
    v_cvt_pk_bf16_f32 v239, v94, v95
    s_bitcmp0_b32 s77, 0
    s_cselect_b32 exec_lo, 0x01010101, s0
    s_cselect_b32 exec_lo, exec_lo, 0x10101010
    s_cmp_lt_u32 s78, 202
    s_cselect_b32 exec_hi, exec_lo, 0
    s_cselect_b32 exec_lo, exec_lo, 1
    buffer_load_dword a254, v249, s[84:87], s70 offen
    buffer_load_dword a254, v249, s[84:87], s71 offen
    buffer_load_dword a254, v249, s[84:87], s72 offen
    buffer_load_dword a254, v249, s[84:87], s73 offen
    buffer_load_dword a254, v249, s[84:87], s74 offen
    buffer_load_dword a254, v249, s[84:87], s75 offen
    buffer_load_dword a254, v249, s[84:87], s76 offen
    s_mov_b64 exec, -1
    s_and_b32 s28, s14, 7
    s_min_u32 s28, s28, 6
    s_lshl_b32 s28, s28, 7
    s_lshr_b32 s29, s14, 3
    s_lshl_b32 s35, s13, 2
    s_add_u32 s29, s29, s35
    s_lshl_b32 s29, s29, 2
    s_add_u32 s29, s29, s12
    s_mul_i32 s29, s29, 14336
    s_add_u32 s66, s28, s29
    v_and_b32 v10, 15, v0
    v_mul_u32_u24 v10, 896, v10
    v_lshrrev_b32 v2, 4, v0
    v_lshl_add_u32 v2, v2, 4, v10
    s_waitcnt vmcnt(16)
    s_barrier
    s_lshl_b32 s28, s12, 8
    s_sub_u32 s28, s2, s28
    s_cmp_lt_i32 s28, 208
    s_cbranch_scc1 Lf_noarr
    s_mov_b64 exec, 1
    v_mov_b32 v30, 1
    buffer_atomic_add v30, off, s[80:83], 0 offset:128 sc1
    s_mov_b64 exec, -1
Lf_noarr:
    ds_read_b64_tr_b16 a[0:1], v254 offset:0
    ds_read_b64_tr_b16 a[2:3], v254 offset:256
    ds_read_b64_tr_b16 a[4:5], v252 offset:1024
    ds_read_b64_tr_b16 a[6:7], v252 offset:1280
    ds_read_b64_tr_b16 a[8:9], v254 offset:2048
    ds_read_b64_tr_b16 a[10:11], v254 offset:2304
    ds_read_b64_tr_b16 a[12:13], v252 offset:3072
    ds_read_b64_tr_b16 a[14:15], v252 offset:3328
    s_waitcnt lgkmcnt(6)
    v_mfma_f32_32x32x16_bf16 v[64:79], v[128:131], a[0:3], 0
    s_add_u32 m0, s34, 77824
    s_add_u32 s37, s32, s18
    s_add_u32 s18, s18, 172032
    s_cmp_eq_u32 s18, 1204224
    s_cselect_b32 s18, 0, s18
    buffer_load_dwordx4 v251, s[24:27], s37 offen lds
    ds_read_b64_tr_b16 a[16:17], v254 offset:4096
    ds_read_b64_tr_b16 a[18:19], v254 offset:4352
    ds_write_b32 v8, v14
    s_waitcnt lgkmcnt(7)
    v_mfma_f32_32x32x16_bf16 v[48:63], a[4:7], v[128:131], 0
    s_waitcnt lgkmcnt(5)
    s_add_u32 m0, s34, 81920
    s_add_u32 s37, s37, 86016
    buffer_load_dwordx4 v251, s[24:27], s37 offen lds
    ds_read_b64_tr_b16 a[20:21], v252 offset:5120
    ds_read_b64_tr_b16 a[22:23], v252 offset:5376
    v_mul_f32 v12, 0x3e8b97f6, v14
    v_mfma_f32_32x32x16_bf16 v[64:79], v[132:135], a[8:11], v[64:79]
    s_add_u32 m0, s34, 86016
    s_add_u32 s37, s33, s18
    s_add_u32 s18, s18, 172032
    s_cmp_eq_u32 s18, 1204224
    s_cselect_b32 s18, 0, s18
    buffer_load_dwordx4 v251, s[24:27], s37 offen lds
    ds_read_b64_tr_b16 a[24:25], v254 offset:6144
    ds_read_b64_tr_b16 a[26:27], v254 offset:6400
    ds_read_b128 v[96:99], v9 offset:0
    s_waitcnt lgkmcnt(8)
    v_mfma_f32_32x32x16_bf16 v[48:63], a[12:15], v[132:135], v[48:63]
    s_add_u32 m0, s34, 90112
    s_add_u32 s37, s33, s18
    s_add_u32 s18, s18, 172032
    s_cmp_eq_u32 s18, 1204224
    s_cselect_b32 s18, 0, s18
    buffer_load_dwordx4 v251, s[24:27], s37 offen lds
    ds_read_b64_tr_b16 a[28:29], v252 offset:7168
    ds_read_b64_tr_b16 a[30:31], v252 offset:7424
    ds_read_b128 v[100:103], v9 offset:32
    s_waitcnt lgkmcnt(9)
    v_mfma_f32_32x32x16_bf16 v[64:79], v[136:139], a[16:19], v[64:79]
    s_waitcnt lgkmcnt(6)
    ds_read_b64_tr_b16 a[0:1], v254 offset:8192
    ds_read_b64_tr_b16 a[2:3], v254 offset:8448
    ds_read_b128 v[104:107], v9 offset:64
    v_mfma_f32_32x32x16_bf16 v[48:63], a[20:23], v[136:139], v[48:63]
    s_waitcnt lgkmcnt(7)
    ds_read_b64_tr_b16 a[4:5], v252 offset:9216
    ds_read_b64_tr_b16 a[6:7], v252 offset:9472
    ds_read_b128 v[108:111], v9 offset:96
    v_mfma_f32_32x32x16_bf16 v[64:79], v[140:143], a[24:27], v[64:79]
    s_add_u32 m0, s34, 94208
    s_add_u32 s37, s33, s18
    s_add_u32 s18, s18, 172032
    s_cmp_eq_u32 s18, 1204224
    s_cselect_b32 s18, 0, s18
    buffer_load_dwordx4 v251, s[24:27], s37 offen lds
    ds_read_b64_tr_b16 a[8:9], v254 offset:10240
    ds_read_b64_tr_b16 a[10:11], v254 offset:10496
    s_waitcnt lgkmcnt(9)
    v_mfma_f32_32x32x16_bf16 v[48:63], a[28:31], v[140:143], v[48:63]
    s_waitcnt lgkmcnt(6)
    ds_read_b64_tr_b16 a[12:13], v252 offset:11264
    ds_read_b64_tr_b16 a[14:15], v252 offset:11520
    v_mfma_f32_32x32x16_bf16 v[64:79], v[144:147], a[0:3], v[64:79]
    s_waitcnt vmcnt(18)
    s_barrier
    ds_read_b64_tr_b16 a[16:17], v254 offset:12288
    ds_read_b64_tr_b16 a[18:19], v254 offset:12544
    s_waitcnt lgkmcnt(7)
    v_mfma_f32_32x32x16_bf16 v[48:63], a[4:7], v[144:147], v[48:63]
    s_waitcnt lgkmcnt(4)
    ds_read_b64_tr_b16 a[20:21], v252 offset:13312
    ds_read_b64_tr_b16 a[22:23], v252 offset:13568
    v_mfma_f32_32x32x16_bf16 v[64:79], v[148:151], a[8:11], v[64:79]
    s_add_u32 m0, s34, 98304
    s_add_u32 s37, s33, s18
    s_add_u32 s18, s18, 172032
    s_cmp_eq_u32 s18, 1204224
    s_cselect_b32 s18, 0, s18
    buffer_load_dwordx4 v251, s[24:27], s37 offen lds
    ds_read_b64_tr_b16 a[24:25], v254 offset:14336
    ds_read_b64_tr_b16 a[26:27], v254 offset:14592
    s_waitcnt lgkmcnt(6)
    v_mfma_f32_32x32x16_bf16 v[48:63], a[12:15], v[148:151], v[48:63]
    s_waitcnt lgkmcnt(4)
    ds_read_b64_tr_b16 a[28:29], v252 offset:15360
    ds_read_b64_tr_b16 a[30:31], v252 offset:15616
    v_mfma_f32_32x32x16_bf16 v[64:79], v[152:155], a[16:19], v[64:79]
    s_waitcnt lgkmcnt(4)
    ds_read_b64_tr_b16 a[0:1], v254 offset:16384
    ds_read_b64_tr_b16 a[2:3], v254 offset:16640
    v_mfma_f32_32x32x16_bf16 v[48:63], a[20:23], v[152:155], v[48:63]
    s_add_u32 m0, s34, 102400
    s_add_u32 s37, s33, s18
    s_add_u32 s18, s18, 172032
    s_cmp_eq_u32 s18, 1204224
    s_cselect_b32 s18, 0, s18
    buffer_load_dwordx4 v251, s[24:27], s37 offen lds
    ds_read_b64_tr_b16 a[4:5], v252 offset:17408
    ds_read_b64_tr_b16 a[6:7], v252 offset:17664
    s_waitcnt lgkmcnt(6)
    v_mfma_f32_32x32x16_bf16 v[64:79], v[156:159], a[24:27], v[64:79]
    s_waitcnt lgkmcnt(4)
    ds_read_b64_tr_b16 a[8:9], v254 offset:18432
    ds_read_b64_tr_b16 a[10:11], v254 offset:18688
    v_mfma_f32_32x32x16_bf16 v[48:63], a[28:31], v[156:159], v[48:63]
    s_waitcnt lgkmcnt(4)
    ds_read_b64_tr_b16 a[12:13], v252 offset:19456
    ds_read_b64_tr_b16 a[14:15], v252 offset:19712
    v_mfma_f32_32x32x16_bf16 v[64:79], v[160:163], a[0:3], v[64:79]
    s_add_u32 m0, s34, 106496
    s_add_u32 s37, s33, s18
    s_add_u32 s18, s18, 172032
    s_cmp_eq_u32 s18, 1204224
    s_cselect_b32 s18, 0, s18
    buffer_load_dwordx4 v251, s[24:27], s37 offen lds
    ds_read_b64_tr_b16 a[16:17], v254 offset:20480
    ds_read_b64_tr_b16 a[18:19], v254 offset:20736
    s_waitcnt lgkmcnt(6)
    v_mfma_f32_32x32x16_bf16 v[48:63], a[4:7], v[160:163], v[48:63]
    s_waitcnt lgkmcnt(4)
    ds_read_b64_tr_b16 a[20:21], v252 offset:21504
    ds_read_b64_tr_b16 a[22:23], v252 offset:21760
    v_mfma_f32_32x32x16_bf16 v[64:79], v[164:167], a[8:11], v[64:79]
    s_waitcnt lgkmcnt(4)
    ds_read_b64_tr_b16 a[24:25], v254 offset:22528
    ds_read_b64_tr_b16 a[26:27], v254 offset:22784
    v_mfma_f32_32x32x16_bf16 v[48:63], a[12:15], v[164:167], v[48:63]
    s_add_u32 m0, s34, 110592
    s_add_u32 s37, s33, s18
    s_add_u32 s18, s18, 172032
    s_cmp_eq_u32 s18, 1204224
    s_cselect_b32 s18, 0, s18
    buffer_load_dwordx4 v251, s[24:27], s37 offen lds
    ds_read_b64_tr_b16 a[28:29], v252 offset:23552
    ds_read_b64_tr_b16 a[30:31], v252 offset:23808
    s_waitcnt lgkmcnt(6)
    v_mfma_f32_32x32x16_bf16 v[64:79], v[168:171], a[16:19], v[64:79]
    s_waitcnt vmcnt(19)
    s_barrier
    ds_read_b64_tr_b16 a[0:1], v254 offset:24576
    ds_read_b64_tr_b16 a[2:3], v254 offset:24832
    s_waitcnt lgkmcnt(6)
    v_mfma_f32_32x32x16_bf16 v[48:63], a[20:23], v[168:171], v[48:63]
    s_waitcnt lgkmcnt(4)
    ds_read_b64_tr_b16 a[4:5], v252 offset:25600
    ds_read_b64_tr_b16 a[6:7], v252 offset:25856
    v_mfma_f32_32x32x16_bf16 v[64:79], v[172:175], a[24:27], v[64:79]
    s_waitcnt lgkmcnt(4)
    ds_read_b64_tr_b16 a[8:9], v254 offset:26624
    ds_read_b64_tr_b16 a[10:11], v254 offset:26880
    v_mfma_f32_32x32x16_bf16 v[48:63], a[28:31], v[172:175], v[48:63]
    s_waitcnt lgkmcnt(4)
    ds_read_b64_tr_b16 a[12:13], v252 offset:27648
    ds_read_b64_tr_b16 a[14:15], v252 offset:27904
    v_mfma_f32_32x32x16_bf16 v[64:79], v[176:179], a[0:3], v[64:79]
    s_waitcnt lgkmcnt(4)
    ds_read_b64_tr_b16 a[16:17], v254 offset:28672
    ds_read_b64_tr_b16 a[18:19], v254 offset:28928
    v_mfma_f32_32x32x16_bf16 v[48:63], a[4:7], v[176:179], v[48:63]
    s_waitcnt lgkmcnt(4)
    ds_read_b64_tr_b16 a[20:21], v252 offset:29696
    ds_read_b64_tr_b16 a[22:23], v252 offset:29952
    v_mfma_f32_32x32x16_bf16 v[64:79], v[180:183], a[8:11], v[64:79]
    s_waitcnt lgkmcnt(4)
    ds_read_b64_tr_b16 a[24:25], v254 offset:30720
    ds_read_b64_tr_b16 a[26:27], v254 offset:30976
    v_mfma_f32_32x32x16_bf16 v[48:63], a[12:15], v[180:183], v[48:63]
    s_waitcnt lgkmcnt(4)
    ds_read_b64_tr_b16 a[28:29], v252 offset:31744
    ds_read_b64_tr_b16 a[30:31], v252 offset:32000
    v_mfma_f32_32x32x16_bf16 v[64:79], v[184:187], a[16:19], v[64:79]
    s_waitcnt lgkmcnt(4)
    ds_read_b64_tr_b16 a[0:1], v254 offset:32768
    ds_read_b64_tr_b16 a[2:3], v254 offset:33024
    v_mfma_f32_32x32x16_bf16 v[48:63], a[20:23], v[184:187], v[48:63]
    s_waitcnt lgkmcnt(4)
    ds_read_b64_tr_b16 a[4:5], v252 offset:33792
    ds_read_b64_tr_b16 a[6:7], v252 offset:34048
    v_mfma_f32_32x32x16_bf16 v[64:79], v[188:191], a[24:27], v[64:79]
    s_waitcnt lgkmcnt(4)
    ds_read_b64_tr_b16 a[8:9], v254 offset:34816
    ds_read_b64_tr_b16 a[10:11], v254 offset:35072
    v_mfma_f32_32x32x16_bf16 v[48:63], a[28:31], v[188:191], v[48:63]
    s_waitcnt lgkmcnt(4)
    ds_read_b64_tr_b16 a[12:13], v252 offset:35840
    ds_read_b64_tr_b16 a[14:15], v252 offset:36096
    v_mfma_f32_32x32x16_bf16 v[64:79], v[192:195], a[0:3], v[64:79]
    s_waitcnt vmcnt(16)
    s_barrier
    ds_read_b64_tr_b16 a[16:17], v254 offset:36864
    ds_read_b64_tr_b16 a[18:19], v254 offset:37120
    s_waitcnt lgkmcnt(6)
    v_mfma_f32_32x32x16_bf16 v[48:63], a[4:7], v[192:195], v[48:63]
    s_waitcnt lgkmcnt(4)
    ds_read_b64_tr_b16 a[20:21], v252 offset:37888
    ds_read_b64_tr_b16 a[22:23], v252 offset:38144
    v_mfma_f32_32x32x16_bf16 v[64:79], v[196:199], a[8:11], v[64:79]
    s_waitcnt lgkmcnt(4)
    ds_read_b64_tr_b16 a[24:25], v254 offset:38912
    ds_read_b64_tr_b16 a[26:27], v254 offset:39168
    v_mfma_f32_32x32x16_bf16 v[48:63], a[12:15], v[196:199], v[48:63]
    s_waitcnt lgkmcnt(4)
    ds_read_b64_tr_b16 a[28:29], v252 offset:39936
    ds_read_b64_tr_b16 a[30:31], v252 offset:40192
    v_mfma_f32_32x32x16_bf16 v[64:79], v[200:203], a[16:19], v[64:79]
    s_waitcnt lgkmcnt(4)
    ds_read_b64_tr_b16 a[0:1], v254 offset:40960
    ds_read_b64_tr_b16 a[2:3], v254 offset:41216
    v_mfma_f32_32x32x16_bf16 v[48:63], a[20:23], v[200:203], v[48:63]
    s_waitcnt lgkmcnt(4)
    ds_read_b64_tr_b16 a[4:5], v252 offset:41984
    ds_read_b64_tr_b16 a[6:7], v252 offset:42240
    v_mfma_f32_32x32x16_bf16 v[64:79], v[204:207], a[24:27], v[64:79]
    s_waitcnt lgkmcnt(4)
    ds_read_b64_tr_b16 a[8:9], v254 offset:43008
    ds_read_b64_tr_b16 a[10:11], v254 offset:43264
    v_mfma_f32_32x32x16_bf16 v[48:63], a[28:31], v[204:207], v[48:63]
    s_waitcnt lgkmcnt(4)
    ds_read_b64_tr_b16 a[12:13], v252 offset:44032
    ds_read_b64_tr_b16 a[14:15], v252 offset:44288
    v_mfma_f32_32x32x16_bf16 v[64:79], v[208:211], a[0:3], v[64:79]
    s_waitcnt lgkmcnt(4)
    ds_read_b64_tr_b16 a[16:17], v254 offset:45056
    ds_read_b64_tr_b16 a[18:19], v254 offset:45312
    v_mfma_f32_32x32x16_bf16 v[48:63], a[4:7], v[208:211], v[48:63]
    s_waitcnt lgkmcnt(4)
    ds_read_b64_tr_b16 a[20:21], v252 offset:46080
    ds_read_b64_tr_b16 a[22:23], v252 offset:46336
    v_mfma_f32_32x32x16_bf16 v[64:79], v[212:215], a[8:11], v[64:79]
    s_waitcnt lgkmcnt(4)
    ds_read_b64_tr_b16 a[24:25], v254 offset:47104
    ds_read_b64_tr_b16 a[26:27], v254 offset:47360
    v_mfma_f32_32x32x16_bf16 v[48:63], a[12:15], v[212:215], v[48:63]
    s_waitcnt lgkmcnt(4)
    ds_read_b64_tr_b16 a[28:29], v252 offset:48128
    ds_read_b64_tr_b16 a[30:31], v252 offset:48384
    v_mfma_f32_32x32x16_bf16 v[64:79], v[216:219], a[16:19], v[64:79]
    s_waitcnt vmcnt(6)
    s_barrier
    ds_read_b64_tr_b16 a[0:1], v13 offset:0
    ds_read_b64_tr_b16 a[2:3], v13 offset:256
    s_waitcnt lgkmcnt(6)
    v_mfma_f32_32x32x16_bf16 v[48:63], a[20:23], v[216:219], v[48:63]
    s_waitcnt lgkmcnt(4)
    ds_read_b64_tr_b16 a[4:5], v253 offset:1024
    ds_read_b64_tr_b16 a[6:7], v253 offset:1280
    v_mfma_f32_32x32x16_bf16 v[64:79], v[220:223], a[24:27], v[64:79]
    s_waitcnt lgkmcnt(4)
    ds_read_b64_tr_b16 a[8:9], v13 offset:2048
    ds_read_b64_tr_b16 a[10:11], v13 offset:2304
    v_mfma_f32_32x32x16_bf16 v[48:63], a[28:31], v[220:223], v[48:63]
    s_waitcnt lgkmcnt(4)
    ds_read_b64_tr_b16 a[12:13], v253 offset:3072
    ds_read_b64_tr_b16 a[14:15], v253 offset:3328
    v_mfma_f32_32x32x16_bf16 v[64:79], v[224:227], a[0:3], v[64:79]
    s_waitcnt lgkmcnt(4)
    ds_read_b64_tr_b16 a[16:17], v13 offset:4096
    ds_read_b64_tr_b16 a[18:19], v13 offset:4352
    v_mfma_f32_32x32x16_bf16 v[48:63], a[4:7], v[224:227], v[48:63]
    s_waitcnt lgkmcnt(4)
    ds_read_b64_tr_b16 a[20:21], v253 offset:5120
    ds_read_b64_tr_b16 a[22:23], v253 offset:5376
    v_mfma_f32_32x32x16_bf16 v[64:79], v[228:231], a[8:11], v[64:79]
    s_waitcnt lgkmcnt(4)
    ds_read_b64_tr_b16 a[24:25], v13 offset:6144
    ds_read_b64_tr_b16 a[26:27], v13 offset:6400
    v_mfma_f32_32x32x16_bf16 v[48:63], a[12:15], v[228:231], v[48:63]
    s_waitcnt lgkmcnt(4)
    ds_read_b64_tr_b16 a[28:29], v253 offset:7168
    ds_read_b64_tr_b16 a[30:31], v253 offset:7424
    v_mfma_f32_32x32x16_bf16 v[64:79], v[232:235], a[16:19], v[64:79]
    s_waitcnt lgkmcnt(4)
    ds_read_b64_tr_b16 a[0:1], v253 offset:8192
    ds_read_b64_tr_b16 a[2:3], v253 offset:8448
    v_mfma_f32_32x32x16_bf16 v[48:63], a[20:23], v[232:235], v[48:63]
    s_waitcnt lgkmcnt(4)
    ds_read_b64_tr_b16 a[4:5], v253 offset:9216
    ds_read_b64_tr_b16 a[6:7], v253 offset:9472
    v_mfma_f32_32x32x16_bf16 v[64:79], v[236:239], a[24:27], v[64:79]
    s_waitcnt lgkmcnt(4)
    ds_read_b64_tr_b16 a[8:9], v253 offset:10240
    ds_read_b64_tr_b16 a[10:11], v253 offset:10496
    v_mfma_f32_32x32x16_bf16 v[48:63], a[28:31], v[236:239], v[48:63]
    s_waitcnt lgkmcnt(4)
    ds_read_b64_tr_b16 a[12:13], v253 offset:11264
    ds_read_b64_tr_b16 a[14:15], v253 offset:11520
    v_mfma_f32_32x32x16_bf16 v[32:47], a[0:3], v[128:131], 0
    s_waitcnt vmcnt(3)
    s_barrier
    ds_read_b64_tr_b16 a[16:17], v253 offset:12288
    ds_read_b64_tr_b16 a[18:19], v253 offset:12544
    s_waitcnt lgkmcnt(6)
    v_mfma_f32_32x32x16_bf16 v[32:47], a[4:7], v[132:135], v[32:47]
    s_waitcnt lgkmcnt(4)
    ds_read_b64_tr_b16 a[20:21], v253 offset:13312
    ds_read_b64_tr_b16 a[22:23], v253 offset:13568
    v_mfma_f32_32x32x16_bf16 v[32:47], a[8:11], v[136:139], v[32:47]
    s_waitcnt lgkmcnt(4)
    s_add_u32 m0, s67, 0
    s_nop 0
    buffer_load_dwordx4 v249, s[84:87], s70 offen lds
    ds_read_b64_tr_b16 a[24:25], v253 offset:14336
    ds_read_b64_tr_b16 a[26:27], v253 offset:14592
    v_mfma_f32_32x32x16_bf16 v[32:47], a[12:15], v[140:143], v[32:47]
    s_waitcnt lgkmcnt(4)
    s_add_u32 m0, s67, 1024
    s_nop 0
    buffer_load_dwordx4 v249, s[84:87], s71 offen lds
    ds_read_b64_tr_b16 a[28:29], v253 offset:15360
    ds_read_b64_tr_b16 a[30:31], v253 offset:15616
    v_mfma_f32_32x32x16_bf16 v[32:47], a[16:19], v[144:147], v[32:47]
    s_waitcnt lgkmcnt(4)
    s_add_u32 m0, s67, 2048
    s_nop 0
    buffer_load_dwordx4 v249, s[84:87], s72 offen lds
    ds_read_b64_tr_b16 a[0:1], v253 offset:16384
    ds_read_b64_tr_b16 a[2:3], v253 offset:16640
    v_mul_f32 v48, v48, v14
    v_mul_f32 v49, v49, v14
    v_mul_f32 v50, v50, v14
    v_mul_f32 v51, v51, v14
    v_mfma_f32_32x32x16_bf16 v[32:47], a[20:23], v[148:151], v[32:47]
    s_waitcnt lgkmcnt(4)
    s_add_u32 m0, s67, 3072
    s_nop 0
    buffer_load_dwordx4 v249, s[84:87], s73 offen lds
    ds_read_b64_tr_b16 a[4:5], v253 offset:17408
    ds_read_b64_tr_b16 a[6:7], v253 offset:17664
    v_mul_f32 v52, v52, v14
    v_mul_f32 v53, v53, v14
    v_mul_f32 v54, v54, v14
    v_mfma_f32_32x32x16_bf16 v[32:47], a[24:27], v[152:155], v[32:47]
    s_waitcnt lgkmcnt(4)
    s_add_u32 m0, s67, 4096
    s_nop 0
    buffer_load_dwordx4 v249, s[84:87], s74 offen lds
    ds_read_b64_tr_b16 a[8:9], v253 offset:18432
    ds_read_b64_tr_b16 a[10:11], v253 offset:18688
    v_mul_f32 v55, v55, v14
    v_mul_f32 v56, v56, v14
    v_mul_f32 v57, v57, v14
    v_mul_f32 v58, v58, v14
    v_mfma_f32_32x32x16_bf16 v[32:47], a[28:31], v[156:159], v[32:47]
    s_waitcnt lgkmcnt(4)
    s_add_u32 m0, s67, 5120
    s_nop 0
    buffer_load_dwordx4 v249, s[84:87], s75 offen lds
    ds_read_b64_tr_b16 a[12:13], v253 offset:19456
    ds_read_b64_tr_b16 a[14:15], v253 offset:19712
    v_mul_f32 v59, v59, v14
    v_mul_f32 v60, v60, v14
    v_mul_f32 v61, v61, v14
    v_mfma_f32_32x32x16_bf16 v[32:47], a[0:3], v[160:163], v[32:47]
    s_waitcnt lgkmcnt(4)
    s_add_u32 m0, s67, 6144
    s_nop 0
    buffer_load_dwordx4 v249, s[84:87], s76 offen lds
    ds_read_b64_tr_b16 a[16:17], v253 offset:20480
    ds_read_b64_tr_b16 a[18:19], v253 offset:20736
    v_mul_f32 v62, v62, v14
    v_mul_f32 v63, v63, v14
    v_cvt_pk_bf16_f32 v120, v48, v49
    v_cvt_pk_bf16_f32 v121, v50, v51
    v_mfma_f32_32x32x16_bf16 v[32:47], a[4:7], v[164:167], v[32:47]
    s_waitcnt lgkmcnt(4)
    ds_read_b64_tr_b16 a[20:21], v253 offset:21504
    ds_read_b64_tr_b16 a[22:23], v253 offset:21760
    v_cvt_pk_bf16_f32 v122, v52, v53
    v_cvt_pk_bf16_f32 v123, v54, v55
    v_cvt_pk_bf16_f32 v124, v56, v57
    v_mfma_f32_32x32x16_bf16 v[32:47], a[8:11], v[168:171], v[32:47]
    ds_read_b64_tr_b16 a[24:25], v253 offset:22528
    ds_read_b64_tr_b16 a[26:27], v253 offset:22784
    v_cvt_pk_bf16_f32 v125, v58, v59
    v_cvt_pk_bf16_f32 v126, v60, v61
    v_cvt_pk_bf16_f32 v127, v62, v63
    s_mov_b32 exec_lo, 0
    v_mov_b32 v126, 0x3f803f80
    v_mov_b32 v127, 0x3f80
    s_mov_b32 exec_lo, -1
    buffer_store_dwordx4 v[120:123], v1, s[4:7], s42 offen offset:0 sc1
    s_waitcnt lgkmcnt(6)
    v_mfma_f32_32x32x16_bf16 v[32:47], a[12:15], v[172:175], v[32:47]
    s_waitcnt lgkmcnt(4)
    ds_read_b64_tr_b16 a[28:29], v253 offset:23552
    ds_read_b64_tr_b16 a[30:31], v253 offset:23808
    buffer_store_dwordx4 v[124:127], v1, s[4:7], s42 offen offset:1024 sc1
    v_mul_f32 v64, v64, v96
    v_mul_f32 v65, v65, v97
    v_mfma_f32_32x32x16_bf16 v[32:47], a[16:19], v[176:179], v[32:47]
    s_waitcnt vmcnt(9)
    s_barrier
    ds_read_b64_tr_b16 a[0:1], v253 offset:24576
    ds_read_b64_tr_b16 a[2:3], v253 offset:24832
    v_mul_f32 v66, v66, v98
    v_mul_f32 v67, v67, v99
    v_mul_f32 v68, v68, v100
    v_mul_f32 v69, v69, v101
    s_waitcnt lgkmcnt(6)
    v_mfma_f32_32x32x16_bf16 v[32:47], a[20:23], v[180:183], v[32:47]
    s_waitcnt lgkmcnt(4)
    ds_read_b64_tr_b16 a[4:5], v253 offset:25600
    ds_read_b64_tr_b16 a[6:7], v253 offset:25856
    v_mul_f32 v70, v70, v102
    v_mul_f32 v71, v71, v103
    v_mul_f32 v72, v72, v104
    v_mfma_f32_32x32x16_bf16 v[32:47], a[24:27], v[184:187], v[32:47]
    s_waitcnt lgkmcnt(4)
    ds_read_b64_tr_b16 a[8:9], v253 offset:26624
    ds_read_b64_tr_b16 a[10:11], v253 offset:26880
    v_mul_f32 v73, v73, v105
    v_mul_f32 v74, v74, v106
    v_mul_f32 v75, v75, v107
    v_mul_f32 v76, v76, v108
    v_mfma_f32_32x32x16_bf16 v[32:47], a[28:31], v[188:191], v[32:47]
    s_waitcnt lgkmcnt(4)
    ds_read_b64_tr_b16 a[12:13], v253 offset:27648
    ds_read_b64_tr_b16 a[14:15], v253 offset:27904
    v_mul_f32 v77, v77, v109
    v_mul_f32 v78, v78, v110
    v_mul_f32 v79, v79, v111
    v_mfma_f32_32x32x16_bf16 v[32:47], a[0:3], v[192:195], v[32:47]
    s_waitcnt lgkmcnt(4)
    ds_read_b64_tr_b16 a[16:17], v253 offset:28672
    ds_read_b64_tr_b16 a[18:19], v253 offset:28928
    v_cvt_pk_bf16_f32 v112, v64, v65
    v_cvt_pk_bf16_f32 v113, v66, v67
    v_cvt_pk_bf16_f32 v114, v68, v69
    v_cvt_pk_bf16_f32 v115, v70, v71
    v_mfma_f32_32x32x16_bf16 v[32:47], a[4:7], v[196:199], v[32:47]
    s_waitcnt lgkmcnt(4)
    ds_read_b64_tr_b16 a[20:21], v253 offset:29696
    ds_read_b64_tr_b16 a[22:23], v253 offset:29952
    v_cvt_pk_bf16_f32 v116, v72, v73
    v_cvt_pk_bf16_f32 v117, v74, v75
    v_cvt_pk_bf16_f32 v118, v76, v77
    v_mfma_f32_32x32x16_bf16 v[32:47], a[8:11], v[200:203], v[32:47]
    ds_read_b64_tr_b16 a[24:25], v253 offset:30720
    ds_read_b64_tr_b16 a[26:27], v253 offset:30976
    v_cvt_pk_bf16_f32 v119, v78, v79
    v_mov_b32 v10, 0
    v_writelane_b32 v10, s45, 28
    v_writelane_b32 v10, s45, 60
    s_mov_b32 exec_lo, 0xf0000000
    s_mov_b32 exec_hi, 0xf0000000
    v_mov_b32 v112, v10
    v_mov_b32 v113, v10
    v_mov_b32 v114, v10
    v_mov_b32 v115, v10
    v_mov_b32 v116, v10
    v_mov_b32 v117, v10
    v_mov_b32 v118, v10
    v_mov_b32 v119, v10
    s_mov_b64 exec, -1
    buffer_store_dwordx4 v[112:115], v1, s[4:7], s43 offen offset:2048 sc1
    buffer_store_dwordx4 v[116:119], v1, s[4:7], s43 offen offset:3072 sc1
    s_waitcnt lgkmcnt(6)
    v_mfma_f32_32x32x16_bf16 v[32:47], a[12:15], v[204:207], v[32:47]
    s_waitcnt lgkmcnt(4)
    ds_read_b64_tr_b16 a[28:29], v253 offset:31744
    ds_read_b64_tr_b16 a[30:31], v253 offset:32000
    v_mfma_f32_32x32x16_bf16 v[32:47], a[16:19], v[208:211], v[32:47]
    s_waitcnt lgkmcnt(4)
    ds_read_b64_tr_b16 a[0:1], v253 offset:32768
    ds_read_b64_tr_b16 a[2:3], v253 offset:33024
    v_mfma_f32_32x32x16_bf16 v[32:47], a[20:23], v[212:215], v[32:47]
    s_waitcnt lgkmcnt(4)
    ds_read_b64_tr_b16 a[4:5], v253 offset:33792
    ds_read_b64_tr_b16 a[6:7], v253 offset:34048
    v_mfma_f32_32x32x16_bf16 v[32:47], a[24:27], v[216:219], v[32:47]
    s_waitcnt lgkmcnt(4)
    ds_read_b64_tr_b16 a[8:9], v253 offset:34816
    ds_read_b64_tr_b16 a[10:11], v253 offset:35072
    v_mfma_f32_32x32x16_bf16 v[32:47], a[28:31], v[220:223], v[32:47]
    s_waitcnt lgkmcnt(4)
    ds_read_b64_tr_b16 a[12:13], v253 offset:35840
    ds_read_b64_tr_b16 a[14:15], v253 offset:36096
    v_mfma_f32_32x32x16_bf16 v[32:47], a[0:3], v[224:227], v[32:47]
    s_waitcnt lgkmcnt(4)
    v_mfma_f32_32x32x16_bf16 v[32:47], a[4:7], v[228:231], v[32:47]
    s_waitcnt lgkmcnt(2)
    v_mfma_f32_32x32x16_bf16 v[32:47], a[8:11], v[232:235], v[32:47]
    s_waitcnt lgkmcnt(0)
    v_mfma_f32_32x32x16_bf16 v[32:47], a[12:15], v[236:239], v[32:47]
    s_mov_b32 exec_lo, 0
    s_nop 10
    v_mov_b32 v44, 0
    v_mov_b32 v45, 0
    v_mov_b32 v46, 0
    v_mov_b32 v47, 0
    s_mov_b32 exec_lo, -1
    v_pk_mul_f32 v[32:33], v[32:33], v[12:13] op_sel_hi:[1,0]
    v_pk_mul_f32 v[34:35], v[34:35], v[12:13] op_sel_hi:[1,0]
    v_pk_mul_f32 v[36:37], v[36:37], v[12:13] op_sel_hi:[1,0]
    v_pk_mul_f32 v[38:39], v[38:39], v[12:13] op_sel_hi:[1,0]
    v_pk_mul_f32 v[40:41], v[40:41], v[12:13] op_sel_hi:[1,0]
    v_pk_mul_f32 v[42:43], v[42:43], v[12:13] op_sel_hi:[1,0]
    v_pk_mul_f32 v[44:45], v[44:45], v[12:13] op_sel_hi:[1,0]
    v_pk_mul_f32 v[46:47], v[46:47], v[12:13] op_sel_hi:[1,0]
    v_cvt_pk_bf16_f32 v16, v32, v33
    v_cvt_pk_bf16_f32 v17, v34, v35
    v_cvt_pk_bf16_f32 v18, v36, v37
    v_cvt_pk_bf16_f32 v19, v38, v39
    buffer_store_dwordx4 v[16:19], v1, s[4:7], s41 offen sc1
    v_pk_mul_f32 v[10:11], v[32:33], v[48:49]
    v_pk_mul_f32 v[12:13], v[34:35], v[50:51]
    v_pk_fma_f32 v[10:11], v[36:37], v[52:53], v[10:11]
    v_pk_fma_f32 v[12:13], v[38:39], v[54:55], v[12:13]
    v_pk_fma_f32 v[10:11], v[40:41], v[56:57], v[10:11]
    v_pk_fma_f32 v[12:13], v[42:43], v[58:59], v[12:13]
    v_pk_fma_f32 v[10:11], v[44:45], v[60:61], v[10:11]
    v_pk_fma_f32 v[12:13], v[46:47], v[62:63], v[12:13]
    v_pk_add_f32 v[10:11], v[10:11], v[12:13]
    v_add_f32 v10, v10, v11
    v_mov_b32 v11, v10
    v_cvt_pk_bf16_f32 v20, v40, v41
    v_cvt_pk_bf16_f32 v21, v42, v43
    v_permlane32_swap_b32 v10, v11
    s_mov_b32 exec_lo, 0
    v_sub_f32 v44, -v10, v11
    s_mov_b32 exec_lo, -1
    v_cvt_pk_bf16_f32 v22, v44, v45
    v_cvt_pk_bf16_f32 v23, v46, v47
    buffer_store_dwordx4 v[20:23], v1, s[4:7], s41 offen offset:1024 sc1
    buffer_load_dword v3, off, s[80:83], 0 offset:128 sc1
    s_cmp_ge_u32 s78, 202
    s_cselect_b32 s28, 0x7fff0000, 0
    v_or_b32 v178, s28, v248
    s_and_b32 s28, s14, 15
    s_lshl_b32 s28, s28, 2
    s_add_u32 s28, s28, s12
    s_lshr_b32 s29, s28, 3
    s_add_u32 s29, s29, s28
    s_mul_i32 s29, s29, 32256
    s_lshr_b32 s28, s14, 4
    s_mul_i32 s28, s28, 16128
    s_add_u32 s29, s29, s28
    s_add_u32 s39, s29, 14065408
    s_mul_i32 s28, s13, 6
    s_add_u32 s29, s13, 48
    v_and_b32 v24, 15, v0
    v_lshrrev_b32 v25, 4, v0
    v_add3_u32 v26, v25, s28, 0
    v_lshrrev_b32 v27, 3, v26
    v_mul_u32_u24 v27, 2304, v27
    v_and_b32 v26, 7, v26
    v_lshl_add_u32 v27, v26, 8, v27
    v_lshl_add_u32 v28, v24, 4, v27
    v_add_u32 v183, s39, v28
    v_add_u32 v185, 16128, v183
    v_add3_u32 v26, v25, s28, 4
    s_mov_b32 exec_lo, 0
    v_mov_b32 v26, s29
    s_mov_b32 exec_lo, -1
    v_lshrrev_b32 v27, 3, v26
    v_mul_u32_u24 v27, 2304, v27
    v_and_b32 v26, 7, v26
    v_lshl_add_u32 v27, v26, 8, v27
    v_lshl_add_u32 v29, v24, 4, v27
    v_add_u32 v184, s39, v29
    v_add_u32 v186, 16128, v184
    v_mov_b32 v220, -1
    v_mov_b32 v221, -1
    v_mov_b32 v222, -1
    v_mov_b32 v223, -1
    s_add_u32 s36, s36, s79
    s_lshr_b32 s28, s40, 4
    s_lshl_b32 s28, s28, 2
    v_and_b32 v10, 15, v0
    v_lshl_add_u32 v182, v10, 7, s28
    s_lshr_b32 s28, s40, 2
    s_lshl_b32 s28, s28, 7
    s_mov_b32 exec_lo, 0
    v_lshl_add_u32 v182, v10, 2, s28
    s_mov_b32 exec_lo, 0xffff
    s_lshl_b32 s28, s79, 11
    v_add_u32 v182, s28, v182
    s_mov_b32 exec_lo, 0xffff0000
    s_mov_b32 exec_hi, 0
    s_lshl_b32 s28, s36, 11
    v_add_u32 v182, s28, v182
    s_mov_b64 exec, -1
    v_mov_b32 v180, 1
    s_waitcnt vmcnt(7)
    s_sub_u32 s96, s77, 48
    s_cmp_ge_u32 s96, 14
    s_cbranch_scc1 Lp_plain
    v_and_b32 v9, 32, v0
    v_lshl_add_u32 v8, v9, 4, v31
    v_mul_u32_u24 v9, 96, v9
    v_add_u32 v9, v9, v31
    ds_read_b64_tr_b16 v[192:193], v31 offset:0
    ds_read_b64_tr_b16 v[194:195], v31 offset:256
    ds_read_b64_tr_b16 v[196:197], v8 offset:1024
    ds_read_b64_tr_b16 v[198:199], v8 offset:1280
    ds_read_b64_tr_b16 v[200:201], v31 offset:2560
    ds_read_b64_tr_b16 v[202:203], v31 offset:2816
    ds_read_b64_tr_b16 v[204:205], v31 offset:3584
    ds_read_b64_tr_b16 v[206:207], v31 offset:3840
    ds_read_b64_tr_b16 v[208:209], v8 offset:4608
    ds_read_b64_tr_b16 v[210:211], v8 offset:4864
    ds_read_b64_tr_b16 v[212:213], v31 offset:6144
    ds_read_b64_tr_b16 v[214:215], v31 offset:6400
    ds_read_b64_tr_b16 v[216:217], v9 offset:1536
    ds_read_b64_tr_b16 v[218:219], v9 offset:1792
    s_waitcnt lgkmcnt(0)
    s_branch Lp_a
Lp_plain:
    ds_read_b64_tr_b16 v[192:193], v31 offset:0
    ds_read_b64_tr_b16 v[194:195], v31 offset:256
    ds_read_b64_tr_b16 v[196:197], v31 offset:1024
    ds_read_b64_tr_b16 v[198:199], v31 offset:1280
    ds_read_b64_tr_b16 v[200:201], v31 offset:2048
    ds_read_b64_tr_b16 v[202:203], v31 offset:2304
    ds_read_b64_tr_b16 v[204:205], v31 offset:3072
    ds_read_b64_tr_b16 v[206:207], v31 offset:3328
    ds_read_b64_tr_b16 v[208:209], v31 offset:4096
    ds_read_b64_tr_b16 v[210:211], v31 offset:4352
    ds_read_b64_tr_b16 v[212:213], v31 offset:5120
    ds_read_b64_tr_b16 v[214:215], v31 offset:5376
    ds_read_b64_tr_b16 v[216:217], v31 offset:6144
    ds_read_b64_tr_b16 v[218:219], v31 offset:6400
    s_waitcnt lgkmcnt(0)
    s_cmp_eq_u32 s89, 0
    s_cbranch_scc1 Lp_a
    v_lshlrev_b32 v48, 16, v192
    v_and_b32 v49, 0xffff0000, v192
    v_lshlrev_b32 v50, 16, v193
    v_and_b32 v51, 0xffff0000, v193
    v_lshlrev_b32 v52, 16, v194
    v_and_b32 v53, 0xffff0000, v194
    v_lshlrev_b32 v54, 16, v195
    v_and_b32 v55, 0xffff0000, v195
    v_lshlrev_b32 v56, 16, v196
    v_and_b32 v57, 0xffff0000, v196
    v_lshlrev_b32 v58, 16, v197
    v_and_b32 v59, 0xffff0000, v197
    v_lshlrev_b32 v60, 16, v198
    v_and_b32 v61, 0xffff0000, v198
    v_lshlrev_b32 v62, 16, v199
    v_and_b32 v63, 0xffff0000, v199
    v_lshlrev_b32 v64, 16, v200
    v_and_b32 v65, 0xffff0000, v200
    v_lshlrev_b32 v66, 16, v201
    v_and_b32 v67, 0xffff0000, v201
    v_lshlrev_b32 v68, 16, v202
    v_and_b32 v69, 0xffff0000, v202
    v_lshlrev_b32 v70, 16, v203
    v_and_b32 v71, 0xffff0000, v203
    v_lshlrev_b32 v72, 16, v204
    v_and_b32 v73, 0xffff0000, v204
    v_lshlrev_b32 v74, 16, v205
    v_and_b32 v75, 0xffff0000, v205
    v_lshlrev_b32 v76, 16, v206
    v_and_b32 v77, 0xffff0000, v206
    v_lshlrev_b32 v78, 16, v207
    v_and_b32 v79, 0xffff0000, v207
    v_lshlrev_b32 v80, 16, v208
    v_and_b32 v81, 0xffff0000, v208
    v_lshlrev_b32 v82, 16, v209
    v_and_b32 v83, 0xffff0000, v209
    v_lshlrev_b32 v84, 16, v210
    v_and_b32 v85, 0xffff0000, v210
    v_lshlrev_b32 v86, 16, v211
    v_and_b32 v87, 0xffff0000, v211
    v_lshlrev_b32 v88, 16, v212
    v_and_b32 v89, 0xffff0000, v212
    v_lshlrev_b32 v90, 16, v213
    v_and_b32 v91, 0xffff0000, v213
    v_lshlrev_b32 v92, 16, v214
    v_and_b32 v93, 0xffff0000, v214
    v_lshlrev_b32 v94, 16, v215
    v_and_b32 v95, 0xffff0000, v215
    v_lshlrev_b32 v96, 16, v216
    v_and_b32 v97, 0xffff0000, v216
    v_lshlrev_b32 v98, 16, v217
    v_and_b32 v99, 0xffff0000, v217
    v_lshlrev_b32 v100, 16, v218
    v_and_b32 v101, 0xffff0000, v218
    v_lshlrev_b32 v102, 16, v219
    v_and_b32 v103, 0xffff0000, v219
    v_pk_add_f32 v[8:9], v[48:49], v[50:51]
    v_pk_add_f32 v[10:11], v[52:53], v[54:55]
    v_pk_add_f32 v[8:9], v[8:9], v[56:57]
    v_pk_add_f32 v[10:11], v[10:11], v[58:59]
    v_pk_add_f32 v[8:9], v[8:9], v[60:61]
    v_pk_add_f32 v[10:11], v[10:11], v[62:63]
    v_pk_add_f32 v[8:9], v[8:9], v[64:65]
    v_pk_add_f32 v[10:11], v[10:11], v[66:67]
    v_pk_add_f32 v[8:9], v[8:9], v[68:69]
    v_pk_add_f32 v[10:11], v[10:11], v[70:71]
    v_pk_add_f32 v[8:9], v[8:9], v[72:73]
    v_pk_add_f32 v[10:11], v[10:11], v[74:75]
    v_pk_add_f32 v[8:9], v[8:9], v[76:77]
    v_pk_add_f32 v[10:11], v[10:11], v[78:79]
    v_pk_add_f32 v[8:9], v[8:9], v[80:81]
    v_pk_add_f32 v[10:11], v[10:11], v[82:83]
    v_pk_add_f32 v[8:9], v[8:9], v[84:85]
    v_pk_add_f32 v[10:11], v[10:11], v[86:87]
    v_pk_add_f32 v[8:9], v[8:9], v[88:89]
    v_pk_add_f32 v[10:11], v[10:11], v[90:91]
    v_pk_add_f32 v[8:9], v[8:9], v[92:93]
    v_pk_add_f32 v[10:11], v[10:11], v[94:95]
    v_pk_add_f32 v[8:9], v[8:9], v[96:97]
    v_pk_add_f32 v[10:11], v[10:11], v[98:99]
    v_pk_add_f32 v[8:9], v[8:9], v[100:101]
    v_pk_add_f32 v[10:11], v[10:11], v[102:103]
    v_pk_add_f32 v[8:9], v[8:9], v[10:11]
    v_add_f32 v8, v8, v9
    s_lshl_b32 s96, s12, 8
    v_lshl_add_u32 v9, v0, 2, s96
    ds_write_b32 v9, v8 offset:29696
    s_waitcnt lgkmcnt(0)
Lp_a:
    s_waitcnt vmcnt(0)
    v_cmp_gt_u32 vcc, 48, v3
    s_nop 0
    s_cbranch_vccz Lf_inited
    s_mov_b32 s39, 0
Lf_iwait:
    buffer_load_dword v3, off, s[80:83], 0 offset:128 sc1
    s_waitcnt vmcnt(0)
    v_cmp_gt_u32 vcc, 48, v3
    s_nop 0
    s_cbranch_vccz Lf_inited
    s_add_u32 s39, s39, 1
    s_cmp_lt_u32 s39, 200000
    s_cbranch_scc1 Lf_iwait
Lf_inited:
    s_mov_b32 s28, 54312960
    s_barrier
    s_cmp_lg_u32 s12, 0
    s_cbranch_scc1 Lmail0
    s_mov_b32 exec_hi, 15
    buffer_atomic_add v180, v182, s[4:7], s28 offen sc1
    s_mov_b32 exec_hi, -1
Lmail0:
    buffer_load_dwordx4 v[240:243], v2, s[20:23], s66 offen offset:0
    buffer_load_dwordx4 v[244:247], v2, s[20:23], s66 offen offset:64
    s_cmp_eq_u32 s89, 0
    s_cbranch_scc1 Lp_store
    v_and_b32 v9, 31, v0
    v_lshlrev_b32 v9, 2, v9
    ds_read_b32 v104, v9 offset:29696
    ds_read_b32 v105, v9 offset:29824
    ds_read_b32 v106, v9 offset:29952
    ds_read_b32 v107, v9 offset:30080
    ds_read_b32 v108, v9 offset:30208
    ds_read_b32 v109, v9 offset:30336
    ds_read_b32 v110, v9 offset:30464
    ds_read_b32 v111, v9 offset:30592
    s_waitcnt lgkmcnt(4)
    v_pk_add_f32 v[104:105], v[104:105], v[106:107]
    s_waitcnt lgkmcnt(0)
    v_pk_add_f32 v[108:109], v[108:109], v[110:111]
    v_pk_add_f32 v[104:105], v[104:105], v[108:109]
    v_add_f32 v8, v104, v105
    v_mul_f32 v8, 0xbb124925, v8
    v_pk_add_f32 v[48:49], v[48:49], v[8:9] op_sel_hi:[1,0]
    v_pk_add_f32 v[50:51], v[50:51], v[8:9] op_sel_hi:[1,0]
    v_pk_add_f32 v[52:53], v[52:53], v[8:9] op_sel_hi:[1,0]
    v_pk_add_f32 v[54:55], v[54:55], v[8:9] op_sel_hi:[1,0]
    v_pk_add_f32 v[56:57], v[56:57], v[8:9] op_sel_hi:[1,0]
    v_pk_add_f32 v[58:59], v[58:59], v[8:9] op_sel_hi:[1,0]
    v_pk_add_f32 v[60:61], v[60:61], v[8:9] op_sel_hi:[1,0]
    v_pk_add_f32 v[62:63], v[62:63], v[8:9] op_sel_hi:[1,0]
    v_pk_add_f32 v[64:65], v[64:65], v[8:9] op_sel_hi:[1,0]
    v_pk_add_f32 v[66:67], v[66:67], v[8:9] op_sel_hi:[1,0]
    v_pk_add_f32 v[68:69], v[68:69], v[8:9] op_sel_hi:[1,0]
    v_pk_add_f32 v[70:71], v[70:71], v[8:9] op_sel_hi:[1,0]
    v_pk_add_f32 v[72:73], v[72:73], v[8:9] op_sel_hi:[1,0]
    v_pk_add_f32 v[74:75], v[74:75], v[8:9] op_sel_hi:[1,0]
    v_pk_add_f32 v[76:77], v[76:77], v[8:9] op_sel_hi:[1,0]
    v_pk_add_f32 v[78:79], v[78:79], v[8:9] op_sel_hi:[1,0]
    v_pk_add_f32 v[80:81], v[80:81], v[8:9] op_sel_hi:[1,0]
    v_pk_add_f32 v[82:83], v[82:83], v[8:9] op_sel_hi:[1,0]
    v_pk_add_f32 v[84:85], v[84:85], v[8:9] op_sel_hi:[1,0]
    v_pk_add_f32 v[86:87], v[86:87], v[8:9] op_sel_hi:[1,0]
    v_pk_add_f32 v[88:89], v[88:89], v[8:9] op_sel_hi:[1,0]
    v_pk_add_f32 v[90:91], v[90:91], v[8:9] op_sel_hi:[1,0]
    v_pk_add_f32 v[92:93], v[92:93], v[8:9] op_sel_hi:[1,0]
    v_pk_add_f32 v[94:95], v[94:95], v[8:9] op_sel_hi:[1,0]
    v_pk_add_f32 v[96:97], v[96:97], v[8:9] op_sel_hi:[1,0]
    v_pk_add_f32 v[98:99], v[98:99], v[8:9] op_sel_hi:[1,0]
    v_pk_add_f32 v[100:101], v[100:101], v[8:9] op_sel_hi:[1,0]
    v_pk_add_f32 v[102:103], v[102:103], v[8:9] op_sel_hi:[1,0]
    v_cvt_pk_bf16_f32 v192, v48, v49
    v_cvt_pk_bf16_f32 v193, v50, v51
    v_cvt_pk_bf16_f32 v194, v52, v53
    v_cvt_pk_bf16_f32 v195, v54, v55
    v_cvt_pk_bf16_f32 v196, v56, v57
    v_cvt_pk_bf16_f32 v197, v58, v59
    v_cvt_pk_bf16_f32 v198, v60, v61
    v_cvt_pk_bf16_f32 v199, v62, v63
    v_cvt_pk_bf16_f32 v200, v64, v65
    v_cvt_pk_bf16_f32 v201, v66, v67
    v_cvt_pk_bf16_f32 v202, v68, v69
    v_cvt_pk_bf16_f32 v203, v70, v71
    v_cvt_pk_bf16_f32 v204, v72, v73
    v_cvt_pk_bf16_f32 v205, v74, v75
    v_cvt_pk_bf16_f32 v206, v76, v77
    v_cvt_pk_bf16_f32 v207, v78, v79
    v_cvt_pk_bf16_f32 v208, v80, v81
    v_cvt_pk_bf16_f32 v209, v82, v83
    v_cvt_pk_bf16_f32 v210, v84, v85
    v_cvt_pk_bf16_f32 v211, v86, v87
    v_cvt_pk_bf16_f32 v212, v88, v89
    v_cvt_pk_bf16_f32 v213, v90, v91
    v_cvt_pk_bf16_f32 v214, v92, v93
    v_cvt_pk_bf16_f32 v215, v94, v95
    v_cvt_pk_bf16_f32 v216, v96, v97
    v_cvt_pk_bf16_f32 v217, v98, v99
    v_cvt_pk_bf16_f32 v218, v100, v101
    v_cvt_pk_bf16_f32 v219, v102, v103
    s_cmp_eq_u32 s91, 0
    s_cbranch_scc1 Lp_store
    s_mov_b32 exec_lo, 0xf0000000
    s_mov_b32 exec_hi, 0xf0000000
    v_mov_b32 v192, 0
    v_mov_b32 v193, 0
    v_mov_b32 v194, 0
    v_mov_b32 v195, 0
    v_mov_b32 v196, 0
    v_mov_b32 v197, 0
    v_mov_b32 v198, 0
    v_mov_b32 v199, 0
    v_mov_b32 v200, 0
    v_mov_b32 v201, 0
    v_mov_b32 v202, 0
    v_mov_b32 v203, 0
    v_mov_b32 v204, 0
    v_mov_b32 v205, 0
    v_mov_b32 v206, 0
    v_mov_b32 v207, 0
    v_mov_b32 v208, 0
    v_mov_b32 v209, 0
    v_mov_b32 v210, 0
    v_mov_b32 v211, 0
    v_mov_b32 v212, 0
    v_mov_b32 v213, 0
    v_mov_b32 v214, 0
    v_mov_b32 v215, 0
    v_mov_b32 v216, 0
    v_mov_b32 v217, 0
    v_mov_b32 v218, 0
    v_mov_b32 v219, 0
    s_mov_b64 exec, -1
Lp_store:
    s_mov_b32 s89, 0
    s_mov_b32 s91, 0
    s_nop 1
    buffer_store_dwordx4 v[192:195], v178, s[4:7], s3 offen sc1
    buffer_store_dwordx4 v[196:199], v178, s[4:7], s56 offen sc1
    s_mov_b32 s18, 0
    s_and_b32 s15, s14, 7
    s_lshr_b32 s16, s14, 3
    s_lshl_b32 s28, s13, 2
    s_add_u32 s16, s16, s28
    s_lshl_b32 s17, s16, 2
    s_add_u32 s17, s17, s12
    s_and_b32 s28, s14, 15
    s_mul_i32 s28, s28, 84
    s_mul_i32 s29, s12, 21
    s_add_u32 s28, s28, s29
    s_lshl_b32 s28, s28, 10
    s_add_u32 s66, s28, 4415488
    s_lshl_b32 s29, s29, 10
    s_add_u32 s67, s29, 65536
    s_min_u32 s36, s15, 6
    s_mul_i32 s28, s36, 57344
    s_mul_i32 s29, s12, 14336
    s_add_u32 s28, s28, s29
    s_add_u32 s30, s28, 0
    s_add_u32 s31, s28, 401408
    s_mul_i32 s100, s12, 12288
    s_mul_i32 s32, s36, 57344
    s_lshl_b32 s35, s12, 13
    s_add_u32 s32, s32, s35
    s_add_u32 s32, s32, 802816
    s_add_u32 s100, s100, 114688
    s_add_u32 s33, s29, 57344
    s_add_u32 s34, s29, 0
    s_lshl_b32 s35, s36, 2
    buffer_store_dwordx4 v[200:203], v178, s[4:7], s57 offen sc1
    s_add_u32 s35, s35, s12
    s_mul_i32 s35, s35, 57344
    s_add_u32 s46, s35, 1204224
    s_add_u32 s47, s35, 2809856
    s_cmp_lg_u32 s15, 7
    s_cbranch_scc1 Lk_nospare
    s_and_b32 s28, s17, 15
    s_min_u32 s29, s28, 13
    s_mul_i32 s29, s29, 114688
    s_add_u32 s30, s29, 2809856
    s_add_u32 s31, s29, 2867200
    s_add_u32 s47, s29, 1236992
    s_add_u32 s32, s29, 1310720
    s_lshr_b32 s29, s28, 1
    s_min_u32 s35, s29, 6
    s_mul_i32 s35, s35, 57344
    s_add_u32 s46, s35, 835584
Lk_nospare:
    s_add_u32 s20, s36, 0
    s_cmp_ge_u32 s20, 7
    s_cselect_b32 s99, 7, 0
    s_sub_u32 s20, s20, s99
    s_mul_i32 s20, s20, 2304
    s_add_u32 s21, s36, 1
    s_cmp_ge_u32 s21, 7
    s_cselect_b32 s99, 7, 0
    s_sub_u32 s21, s21, s99
    s_mul_i32 s21, s21, 2304
    s_add_u32 s22, s36, 2
    s_cmp_ge_u32 s22, 7
    s_cselect_b32 s99, 7, 0
    s_sub_u32 s22, s22, s99
    s_mul_i32 s22, s22, 2304
    s_add_u32 s23, s36, 3
    s_cmp_ge_u32 s23, 7
    s_cselect_b32 s99, 7, 0
    s_sub_u32 s23, s23, s99
    s_mul_i32 s23, s23, 2304
    s_add_u32 s24, s36, 4
    s_cmp_ge_u32 s24, 7
    s_cselect_b32 s99, 7, 0
    s_sub_u32 s24, s24, s99
    s_mul_i32 s24, s24, 2304
    s_add_u32 s25, s36, 5
    buffer_store_dwordx4 v[204:207], v178, s[4:7], s58 offen sc1
    s_cmp_ge_u32 s25, 7
    s_cselect_b32 s99, 7, 0
    s_sub_u32 s25, s25, s99
    s_mul_i32 s25, s25, 2304
    s_add_u32 s26, s36, 6
    s_cmp_ge_u32 s26, 7
    s_cselect_b32 s99, 7, 0
    s_sub_u32 s26, s26, s99
    s_mul_i32 s26, s26, 2304
    s_and_b32 s35, s17, 15
    s_cmp_eq_u32 s35, 0
    s_cselect_b32 s69, 0x00030003, 0
    s_cselect_b32 s68, 4294935040, 0
    s_cmp_eq_u32 s35, 15
    s_cselect_b32 s69, 0xc000c000, s69
    s_cselect_b32 s68, 32256, s68
    s_add_u32 s29, s17, 1
    s_and_b32 s29, s29, 126
    s_cselect_b32 s68, s68, 0
    s_lshr_b32 s28, s14, 4
    s_lshl_b32 s55, s13, 1
    s_add_u32 s55, s55, s28
    s_and_b32 s35, s14, 15
    s_mul_i32 s36, s18, 22147072
    s_add_u32 s36, s36, 9920512
    s_lshl_b32 s28, s55, 2
    s_add_u32 s28, s28, s12
    s_lshl_b32 s28, s28, 16
    s_add_u32 s28, s28, s36
    s_add_u32 s48, s28, 17952768
    buffer_store_dwordx4 v[208:211], v178, s[4:7], s59 offen sc1
    s_lshl_b32 s28, s55, 4
    s_add_u32 s28, s28, s35
    s_lshl_b32 s28, s28, 13
    s_add_u32 s28, s28, s36
    s_add_u32 s28, s28, 15855616
    s_add_u32 s40, s12, 1
    s_and_b32 s40, s40, 3
    s_lshl_b32 s49, s40, 11
    s_add_u32 s49, s49, s28
    s_add_u32 s41, s12, 2
    s_and_b32 s41, s41, 3
    s_lshl_b32 s50, s41, 11
    s_add_u32 s50, s50, s28
    s_add_u32 s42, s12, 3
    s_and_b32 s42, s42, 3
    s_lshl_b32 s51, s42, 11
    s_add_u32 s51, s51, s28
    s_add_u32 s43, s12, 4
    s_and_b32 s43, s43, 3
    s_lshl_b32 s52, s43, 11
    s_add_u32 s52, s52, s28
    s_lshl_b32 s28, s35, 2
    s_add_u32 s28, s28, s12
    s_lshr_b32 s29, s28, 3
    s_add_u32 s29, s29, s28
    s_mul_i32 s53, s29, 32256
    s_add_u32 s53, s53, s36
    s_add_u32 s53, s53, 4144896
    s_mul_i32 s63, s17, 16128
    s_add_u32 s63, s63, s20
    buffer_store_dwordx4 v[212:215], v178, s[4:7], s61 offen sc1
    s_add_u32 s63, s63, 7856128
    s_mul_i32 s45, s18, 49152
    s_add_u32 s45, s45, 54214656
    s_mov_b32 s54, 0
    s_lshl_b32 s27, s55, 1
    s_lshr_b32 s27, 0x77771ddc, s27
    s_bfe_i32 s27, s27, 0x20000
    s_sub_u32 s27, s55, s27
    s_lshl_b32 s62, s55, 4
    s_and_b32 s28, s14, 15
    s_add_u32 s62, s62, s28
    s_lshl_b32 s62, s62, 5
    s_add_u32 s62, s62, s12
    s_lshl_b32 s62, s62, 2
    s_mul_i32 s28, s18, 32768
    s_add_u32 s62, s62, s28
    s_add_u32 s62, s62, 54312960
    s_min_u32 s36, s15, 6
    s_lshl_b32 s28, s36, 1
    v_mov_b32 v176, 0
    s_add_u32 s29, s28, 48
    v_writelane_b32 v176, s29, 0
    s_add_u32 s29, s29, 1
    v_writelane_b32 v176, s29, 1
    s_add_u32 s29, s28, 62
    v_writelane_b32 v176, s29, 2
    s_add_u32 s29, s29, 1
    v_writelane_b32 v176, s29, 3
    s_add_u32 s29, s28, 76
    v_writelane_b32 v176, s29, 4
    buffer_store_dwordx4 v[216:219], v178, s[4:7], s65 offen sc1
    s_add_u32 s29, s29, 1
    v_writelane_b32 v176, s29, 5
    s_mul_i32 s29, s12, 14
    s_add_u32 s29, s29, s28
    s_add_u32 s29, s29, 146
    v_writelane_b32 v176, s29, 6
    s_add_u32 s29, s29, 1
    v_writelane_b32 v176, s29, 7
    s_lshl_b32 s28, s36, 2
    s_add_u32 s28, s28, s12
    s_lshl_b32 s28, s28, 1
    s_add_u32 s29, s28, 90
    v_writelane_b32 v176, s29, 8
    s_add_u32 s29, s29, 1
    v_writelane_b32 v176, s29, 9
    s_and_b32 s29, s14, 15
    v_writelane_b32 v176, s29, 10
    s_add_u32 s29, s29, 16
    v_writelane_b32 v176, s29, 11
    s_add_u32 s29, s29, 16
    v_writelane_b32 v176, s29, 12
    s_add_u32 s29, s29, 16
    v_mul_u32_u24 v10, 2521, v176
    v_lshrrev_b32 v10, 16, v10
    v_mul_u32_u24 v10, 6, v10
    v_add_u32 v176, v176, v10
    s_lshr_b32 s28, s17, 3
    v_and_b32 v10, 15, v0
    s_lshl_b32 s29, s13, 5
    s_sub_u32 s29, s29, 32
    buffer_store_dwordx4 v[220:223], v183, s[4:7], 0 offen sc1
    s_mov_b64 exec, 0xffff0000
    v_lshl_add_u32 v176, v10, 4, s28
    s_mov_b64 exec, -1
    s_mov_b32 exec_lo, 0
    v_add_u32 v176, s29, v0
    s_mov_b32 exec_lo, -1
    v_lshlrev_b32 v176, 7, v176
    s_lshl_b32 s44, s13, 5
    s_add_u32 s44, s44, s14
    s_lshl_b32 s44, s44, 7
    s_add_u32 s44, s44, 54378496
    s_mul_i32 s28, s12, 12
    s_add_u32 s28, s28, 16
    s_lshl_b64 s[0:1], 0xfff, s28
    s_waitcnt vmcnt(9)
    v_lshlrev_b32 v160, 16, v240
    v_and_b32 v161, 0xffff0000, v240
    v_lshlrev_b32 v162, 16, v241
    v_and_b32 v163, 0xffff0000, v241
    v_lshlrev_b32 v164, 16, v242
    v_and_b32 v165, 0xffff0000, v242
    v_lshlrev_b32 v166, 16, v243
    v_and_b32 v167, 0xffff0000, v243
    s_waitcnt vmcnt(8)
    v_lshlrev_b32 v168, 16, v244
    v_and_b32 v169, 0xffff0000, v244
    v_lshlrev_b32 v170, 16, v245
    v_and_b32 v171, 0xffff0000, v245
    v_lshlrev_b32 v172, 16, v246
    v_and_b32 v173, 0xffff0000, v246
    v_lshlrev_b32 v174, 16, v247
    v_and_b32 v175, 0xffff0000, v247
    buffer_store_dwordx4 v[220:223], v184, s[4:7], 0 offen sc1
    v_mov_b32 v181, 0
    s_mov_b64 exec, 1
    buffer_atomic_or v181, off, s[4:7], s62 sc0 sc1
    s_mov_b64 exec, -1
    s_waitcnt vmcnt(0)
    s_barrier
    s_cmp_lg_u32 s12, 0
    s_cbranch_scc1 Larr1
    s_mov_b64 exec, 1
    buffer_store_dword v15, off, s[4:7], s44 sc1
    s_mov_b64 exec, -1
Larr1:
    v_cmp_eq_u32 vcc, 9, v181
    s_nop 0
    s_cbranch_vccnz Lk_got
Lk_wait:
    s_mov_b64 exec, 1
    s_mov_b32 s39, 0
Lk_spin:
    v_mov_b32 v10, 0
    buffer_atomic_or v10, off, s[4:7], s62 sc0 sc1
    s_waitcnt vmcnt(0)
    v_cmp_ne_u32 vcc, 9, v10
    s_nop 0
    s_cbranch_vccz Lk_seen
    s_add_u32 s39, s39, 1
    s_cmp_lt_u32 s39, 200000
    s_cbranch_scc1 Lk_spin
Lk_seen:
    s_mov_b64 exec, -1
Lk_got:
Lk_layer:
    buffer_load_dwordx4 v[16:19], v1, s[4:7], s49 offen offset:0 sc1
    buffer_load_dwordx4 v[20:23], v1, s[4:7], s49 offen offset:1024 sc1
    s_add_u32 s37, s48, 0
    buffer_load_dwordx4 a[0:3], v1, s[4:7], s37 offen offset:0 sc1
    buffer_load_dwordx4 a[4:7], v1, s[4:7], s37 offen offset:1024 sc1
    buffer_load_dwordx4 v[24:27], v1, s[4:7], s50 offen offset:0 sc1
    buffer_load_dwordx4 v[28:31], v1, s[4:7], s50 offen offset:1024 sc1
    buffer_load_dwordx4 a[8:11], v1, s[4:7], s37 offen offset:2048 sc1
    buffer_load_dwordx4 a[12:15], v1, s[4:7], s37 offen offset:3072 sc1
    s_add_u32 s37, s48, 4096
    buffer_load_dwordx4 a[16:19], v1, s[4:7], s37 offen offset:0 sc1
    buffer_load_dwordx4 a[20:23], v1, s[4:7], s37 offen offset:1024 sc1
    buffer_load_dwordx4 a[24:27], v1, s[4:7], s37 offen offset:2048 sc1
    buffer_load_dwordx4 a[28:31], v1, s[4:7], s37 offen offset:3072 sc1
    s_mul_i32 s28, s40, 12288
    s_add_u32 s28, s28, 114688
    v_add_u32 v6, s28, v1
    s_mul_i32 s28, s41, 12288
    s_add_u32 s28, s28, 118784
    v_add_u32 v7, s28, v1
    s_mul_i32 s28, s42, 12288
    s_add_u32 s28, s28, 122880
    v_add_u32 v8, s28, v1
    s_mul_i32 s28, s12, 12288
    s_add_u32 s28, s28, 114688
    v_add_u32 v9, s28, v1
    s_mul_i32 s35, s55, 3
    s_add_u32 s36, s35, 2
    s_lshl_b32 s28, s55, 7
    s_add_u32 s28, s28, 13824
    v_lshrrev_b32 v4, 5, v0
    v_add_u32 v12, s35, v4
    v_mov_b32 v13, s36
    v_bfe_u32 v14, v0, 4, 1
    v_mul_u32_u24 v14, 16128, v14
    v_and_b32 v5, 15, v0
    v_lshl_add_u32 v4, v5, 4, v14
    v_lshl_add_u32 v14, v5, 3, v14
    v_lshrrev_b32 v5, 3, v12
    v_mul_u32_u24 v5, 2304, v5
    v_and_b32 v12, 7, v12
    v_lshl_add_u32 v5, v12, 8, v5
    v_add_u32 v10, v5, v4
    v_lshrrev_b32 v5, 3, v13
    v_mul_u32_u24 v5, 2304, v5
    v_and_b32 v13, 7, v13
    v_lshl_add_u32 v5, v13, 8, v5
    v_add_u32 v11, v5, v4
    s_mov_b32 exec_lo, 0
    v_add_u32 v11, s28, v14
    s_mov_b32 exec_lo, -1
    v_lshlrev_b32 v3, 7, v0
    v_min_u32 v3, 0x880, v3
    s_mov_b32 s64, 54378496
    s_lshl_b32 s28, s14, 2
    s_add_u32 s28, s28, s12
    s_lshl_b32 s28, s28, 8
    v_lshl_add_u32 v187, v0, 7, s28
    buffer_load_dwordx4 v[32:35], v1, s[4:7], s51 offen offset:0 sc1
    buffer_load_dwordx4 v[36:39], v1, s[4:7], s51 offen offset:1024 sc1
    buffer_load_dwordx4 v[40:43], v1, s[4:7], s52 offen offset:0 sc1
    buffer_load_dwordx4 v[44:47], v1, s[4:7], s52 offen offset:1024 sc1
La_main:
    s_waitcnt vmcnt(13)
    v_mfma_f32_32x32x16_bf16 v[112:127], a[0:3], v[16:19], 0
    s_waitcnt vmcnt(12)
    v_mfma_f32_32x32x16_bf16 v[112:127], a[4:7], v[20:23], v[112:127]
    s_waitcnt vmcnt(11)
    v_mfma_f32_32x32x16_bf16 v[128:143], a[0:3], v[24:27], 0
    s_waitcnt vmcnt(10)
    s_add_u32 s37, s48, 8192
    s_nop 8
    v_exp_f32 v112, v112
    v_exp_f32 v113, v113
    v_exp_f32 v114, v114
    v_exp_f32 v115, v115
    v_cvt_pk_bf16_f32 v144, v112, v113
    v_mfma_f32_32x32x16_bf16 v[128:143], a[4:7], v[28:31], v[128:143]
    buffer_load_dwordx4 a[32:35], v1, s[4:7], s37 offen offset:0 sc1
    buffer_load_dwordx4 a[36:39], v1, s[4:7], s37 offen offset:1024 sc1
    v_exp_f32 v116, v116
    v_exp_f32 v117, v117
    v_exp_f32 v118, v118
    v_exp_f32 v119, v119
    v_cvt_pk_bf16_f32 v145, v114, v115
    v_cvt_pk_bf16_f32 v146, v116, v117
    s_add_u32 s38, s48, 12288
    v_exp_f32 v120, v120
    v_exp_f32 v121, v121
    v_exp_f32 v122, v122
    v_exp_f32 v123, v123
    v_cvt_pk_bf16_f32 v147, v118, v119
    v_cvt_pk_bf16_f32 v148, v120, v121
    buffer_load_dwordx4 a[40:43], v1, s[4:7], s37 offen offset:2048 sc1
    v_exp_f32 v124, v124
    v_exp_f32 v125, v125
    v_exp_f32 v126, v126
    v_exp_f32 v127, v127
    v_cvt_pk_bf16_f32 v149, v122, v123
    v_cvt_pk_bf16_f32 v150, v124, v125
    v_cvt_pk_bf16_f32 v151, v126, v127
    s_waitcnt vmcnt(9)
    v_mfma_f32_32x32x16_bf16 v[112:127], a[16:19], v[16:19], 0
    v_exp_f32 v128, v128
    v_exp_f32 v129, v129
    v_exp_f32 v130, v130
    v_exp_f32 v131, v131
    v_cvt_pk_bf16_f32 v152, v128, v129
    v_mfma_f32_32x32x16_bf16 v[112:127], a[20:23], v[20:23], v[112:127]
    buffer_load_dwordx4 a[44:47], v1, s[4:7], s37 offen offset:3072 sc1
    buffer_load_dwordx4 a[48:51], v1, s[4:7], s38 offen offset:0 sc1
    v_exp_f32 v132, v132
    v_exp_f32 v133, v133
    v_exp_f32 v134, v134
    v_exp_f32 v135, v135
    v_cvt_pk_bf16_f32 v153, v130, v131
    v_cvt_pk_bf16_f32 v154, v132, v133
    v_mfma_f32_32x32x16_bf16 v[48:63], a[8:11], v[144:147], 0
    s_add_u32 s37, s48, 16384
    v_exp_f32 v136, v136
    v_exp_f32 v137, v137
    v_exp_f32 v138, v138
    v_exp_f32 v139, v139
    v_cvt_pk_bf16_f32 v155, v134, v135
    v_cvt_pk_bf16_f32 v156, v136, v137
    v_mfma_f32_32x32x16_bf16 v[48:63], a[12:15], v[148:151], v[48:63]
    buffer_load_dwordx4 a[52:55], v1, s[4:7], s38 offen offset:1024 sc1
    v_exp_f32 v140, v140
    v_exp_f32 v141, v141
    v_exp_f32 v142, v142
    v_exp_f32 v143, v143
    v_cvt_pk_bf16_f32 v157, v138, v139
    v_cvt_pk_bf16_f32 v158, v140, v141
    v_cvt_pk_bf16_f32 v159, v142, v143
    v_mfma_f32_32x32x16_bf16 v[128:143], a[16:19], v[24:27], 0
    v_exp_f32 v112, v112
    v_exp_f32 v113, v113
    v_exp_f32 v114, v114
    v_exp_f32 v115, v115
    v_cvt_pk_bf16_f32 v144, v112, v113
    v_mfma_f32_32x32x16_bf16 v[128:143], a[20:23], v[28:31], v[128:143]
    buffer_load_dwordx4 a[56:59], v1, s[4:7], s38 offen offset:2048 sc1
    buffer_load_dwordx4 a[60:63], v1, s[4:7], s38 offen offset:3072 sc1
    v_exp_f32 v116, v116
    v_exp_f32 v117, v117
    v_exp_f32 v118, v118
    v_exp_f32 v119, v119
    v_cvt_pk_bf16_f32 v145, v114, v115
    v_cvt_pk_bf16_f32 v146, v116, v117
    v_mfma_f32_32x32x16_bf16 v[64:79], a[8:11], v[152:155], 0
    s_add_u32 s38, s48, 20480
    v_exp_f32 v120, v120
    v_exp_f32 v121, v121
    v_exp_f32 v122, v122
    v_exp_f32 v123, v123
    v_cvt_pk_bf16_f32 v147, v118, v119
    v_cvt_pk_bf16_f32 v148, v120, v121
    v_mfma_f32_32x32x16_bf16 v[64:79], a[12:15], v[156:159], v[64:79]
    s_waitcnt vmcnt(6)
    buffer_load_dwordx4 a[64:67], v1, s[4:7], s37 offen offset:0 sc1
    v_exp_f32 v124, v124
    v_exp_f32 v125, v125
    v_exp_f32 v126, v126
    v_exp_f32 v127, v127
    v_cvt_pk_bf16_f32 v149, v122, v123
    v_cvt_pk_bf16_f32 v150, v124, v125
    v_cvt_pk_bf16_f32 v151, v126, v127
    v_mfma_f32_32x32x16_bf16 v[112:127], a[32:35], v[16:19], 0
    v_exp_f32 v128, v128
    v_exp_f32 v129, v129
    v_exp_f32 v130, v130
    v_exp_f32 v131, v131
    v_cvt_pk_bf16_f32 v152, v128, v129
    v_mfma_f32_32x32x16_bf16 v[112:127], a[36:39], v[20:23], v[112:127]
    buffer_load_dwordx4 a[68:71], v1, s[4:7], s37 offen offset:1024 sc1
    buffer_load_dwordx4 a[72:75], v1, s[4:7], s37 offen offset:2048 sc1
    v_exp_f32 v132, v132
    v_exp_f32 v133, v133
    v_exp_f32 v134, v134
    v_exp_f32 v135, v135
    v_cvt_pk_bf16_f32 v153, v130, v131
    v_cvt_pk_bf16_f32 v154, v132, v133
    v_mfma_f32_32x32x16_bf16 v[48:63], a[24:27], v[144:147], v[48:63]
    v_exp_f32 v136, v136
    v_exp_f32 v137, v137
    v_exp_f32 v138, v138
    v_exp_f32 v139, v139
    v_cvt_pk_bf16_f32 v155, v134, v135
    v_cvt_pk_bf16_f32 v156, v136, v137
    v_mfma_f32_32x32x16_bf16 v[48:63], a[28:31], v[148:151], v[48:63]
    buffer_load_dwordx4 a[76:79], v1, s[4:7], s37 offen offset:3072 sc1
    v_exp_f32 v140, v140
    v_exp_f32 v141, v141
    v_exp_f32 v142, v142
    v_exp_f32 v143, v143
    v_cvt_pk_bf16_f32 v157, v138, v139
    v_cvt_pk_bf16_f32 v158, v140, v141
    v_cvt_pk_bf16_f32 v159, v142, v143
    v_mfma_f32_32x32x16_bf16 v[128:143], a[32:35], v[24:27], 0
    s_add_u32 s37, s48, 24576
    v_exp_f32 v112, v112
    v_exp_f32 v113, v113
    v_exp_f32 v114, v114
    v_exp_f32 v115, v115
    v_cvt_pk_bf16_f32 v144, v112, v113
    v_mfma_f32_32x32x16_bf16 v[128:143], a[36:39], v[28:31], v[128:143]
    buffer_load_dwordx4 a[80:83], v1, s[4:7], s38 offen offset:0 sc1
    buffer_load_dwordx4 a[84:87], v1, s[4:7], s38 offen offset:1024 sc1
    v_exp_f32 v116, v116
    v_exp_f32 v117, v117
    v_exp_f32 v118, v118
    v_exp_f32 v119, v119
    v_cvt_pk_bf16_f32 v145, v114, v115
    v_cvt_pk_bf16_f32 v146, v116, v117
    v_mfma_f32_32x32x16_bf16 v[64:79], a[24:27], v[152:155], v[64:79]
    v_exp_f32 v120, v120
    v_exp_f32 v121, v121
    v_exp_f32 v122, v122
    v_exp_f32 v123, v123
    v_cvt_pk_bf16_f32 v147, v118, v119
    v_cvt_pk_bf16_f32 v148, v120, v121
    v_mfma_f32_32x32x16_bf16 v[64:79], a[28:31], v[156:159], v[64:79]
    s_waitcnt vmcnt(8)
    buffer_load_dwordx4 a[88:91], v1, s[4:7], s38 offen offset:2048 sc1
    v_exp_f32 v124, v124
    v_exp_f32 v125, v125
    v_exp_f32 v126, v126
    v_exp_f32 v127, v127
    v_cvt_pk_bf16_f32 v149, v122, v123
    v_cvt_pk_bf16_f32 v150, v124, v125
    v_cvt_pk_bf16_f32 v151, v126, v127
    v_mfma_f32_32x32x16_bf16 v[112:127], a[48:51], v[16:19], 0
    v_exp_f32 v128, v128
    v_exp_f32 v129, v129
    v_exp_f32 v130, v130
    v_exp_f32 v131, v131
    v_cvt_pk_bf16_f32 v152, v128, v129
    v_mfma_f32_32x32x16_bf16 v[112:127], a[52:55], v[20:23], v[112:127]
    buffer_load_dwordx4 a[92:95], v1, s[4:7], s38 offen offset:3072 sc1
    buffer_load_dwordx4 a[96:99], v1, s[4:7], s37 offen offset:0 sc1
    v_exp_f32 v132, v132
    v_exp_f32 v133, v133
    v_exp_f32 v134, v134
    v_exp_f32 v135, v135
    v_cvt_pk_bf16_f32 v153, v130, v131
    v_cvt_pk_bf16_f32 v154, v132, v133
    v_mfma_f32_32x32x16_bf16 v[48:63], a[40:43], v[144:147], v[48:63]
    s_add_u32 s38, s48, 28672
    v_exp_f32 v136, v136
    v_exp_f32 v137, v137
    v_exp_f32 v138, v138
    v_exp_f32 v139, v139
    v_cvt_pk_bf16_f32 v155, v134, v135
    v_cvt_pk_bf16_f32 v156, v136, v137
    v_mfma_f32_32x32x16_bf16 v[48:63], a[44:47], v[148:151], v[48:63]
    buffer_load_dwordx4 a[100:103], v1, s[4:7], s37 offen offset:1024 sc1
    v_exp_f32 v140, v140
    v_exp_f32 v141, v141
    v_exp_f32 v142, v142
    v_exp_f32 v143, v143
    v_cvt_pk_bf16_f32 v157, v138, v139
    v_cvt_pk_bf16_f32 v158, v140, v141
    v_cvt_pk_bf16_f32 v159, v142, v143
    v_mfma_f32_32x32x16_bf16 v[128:143], a[48:51], v[24:27], 0
    v_exp_f32 v112, v112
    v_exp_f32 v113, v113
    v_exp_f32 v114, v114
    v_exp_f32 v115, v115
    v_cvt_pk_bf16_f32 v144, v112, v113
    v_mfma_f32_32x32x16_bf16 v[128:143], a[52:55], v[28:31], v[128:143]
    buffer_load_dwordx4 a[104:107], v1, s[4:7], s37 offen offset:2048 sc1
    buffer_load_dwordx4 a[108:111], v1, s[4:7], s37 offen offset:3072 sc1
    v_exp_f32 v116, v116
    v_exp_f32 v117, v117
    v_exp_f32 v118, v118
    v_exp_f32 v119, v119
    v_cvt_pk_bf16_f32 v145, v114, v115
    v_cvt_pk_bf16_f32 v146, v116, v117
    v_mfma_f32_32x32x16_bf16 v[64:79], a[40:43], v[152:155], v[64:79]
    s_add_u32 s37, s48, 32768
    v_exp_f32 v120, v120
    v_exp_f32 v121, v121
    v_exp_f32 v122, v122
    v_exp_f32 v123, v123
    v_cvt_pk_bf16_f32 v147, v118, v119
    v_cvt_pk_bf16_f32 v148, v120, v121
    v_mfma_f32_32x32x16_bf16 v[64:79], a[44:47], v[156:159], v[64:79]
    s_waitcnt vmcnt(10)
    buffer_load_dwordx4 a[112:115], v1, s[4:7], s38 offen offset:0 sc1
    v_exp_f32 v124, v124
    v_exp_f32 v125, v125
    v_exp_f32 v126, v126
    v_exp_f32 v127, v127
    v_cvt_pk_bf16_f32 v149, v122, v123
    v_cvt_pk_bf16_f32 v150, v124, v125
    v_cvt_pk_bf16_f32 v151, v126, v127
    v_mfma_f32_32x32x16_bf16 v[112:127], a[64:67], v[16:19], 0
    v_exp_f32 v128, v128
    v_exp_f32 v129, v129
    v_exp_f32 v130, v130
    v_exp_f32 v131, v131
    v_cvt_pk_bf16_f32 v152, v128, v129
    v_mfma_f32_32x32x16_bf16 v[112:127], a[68:71], v[20:23], v[112:127]
    buffer_load_dwordx4 a[116:119], v1, s[4:7], s38 offen offset:1024 sc1
    buffer_load_dwordx4 a[120:123], v1, s[4:7], s38 offen offset:2048 sc1
    v_exp_f32 v132, v132
    v_exp_f32 v133, v133
    v_exp_f32 v134, v134
    v_exp_f32 v135, v135
    v_cvt_pk_bf16_f32 v153, v130, v131
    v_cvt_pk_bf16_f32 v154, v132, v133
    v_mfma_f32_32x32x16_bf16 v[48:63], a[56:59], v[144:147], v[48:63]
    v_exp_f32 v136, v136
    v_exp_f32 v137, v137
    v_exp_f32 v138, v138
    v_exp_f32 v139, v139
    v_cvt_pk_bf16_f32 v155, v134, v135
    v_cvt_pk_bf16_f32 v156, v136, v137
    v_mfma_f32_32x32x16_bf16 v[48:63], a[60:63], v[148:151], v[48:63]
    buffer_load_dwordx4 a[124:127], v1, s[4:7], s38 offen offset:3072 sc1
    v_exp_f32 v140, v140
    v_exp_f32 v141, v141
    v_exp_f32 v142, v142
    v_exp_f32 v143, v143
    v_cvt_pk_bf16_f32 v157, v138, v139
    v_cvt_pk_bf16_f32 v158, v140, v141
    v_cvt_pk_bf16_f32 v159, v142, v143
    v_mfma_f32_32x32x16_bf16 v[128:143], a[64:67], v[24:27], 0
    s_add_u32 s38, s48, 36864
    v_exp_f32 v112, v112
    v_exp_f32 v113, v113
    v_exp_f32 v114, v114
    v_exp_f32 v115, v115
    v_cvt_pk_bf16_f32 v144, v112, v113
    v_mfma_f32_32x32x16_bf16 v[128:143], a[68:71], v[28:31], v[128:143]
    buffer_load_dwordx4 a[128:131], v1, s[4:7], s37 offen offset:0 sc1
    buffer_load_dwordx4 a[132:135], v1, s[4:7], s37 offen offset:1024 sc1
    v_exp_f32 v116, v116
    v_exp_f32 v117, v117
    v_exp_f32 v118, v118
    v_exp_f32 v119, v119
    v_cvt_pk_bf16_f32 v145, v114, v115
    v_cvt_pk_bf16_f32 v146, v116, v117
    v_mfma_f32_32x32x16_bf16 v[64:79], a[56:59], v[152:155], v[64:79]
    v_exp_f32 v120, v120
    v_exp_f32 v121, v121
    v_exp_f32 v122, v122
    v_exp_f32 v123, v123
    v_cvt_pk_bf16_f32 v147, v118, v119
    v_cvt_pk_bf16_f32 v148, v120, v121
    v_mfma_f32_32x32x16_bf16 v[64:79], a[60:63], v[156:159], v[64:79]
    s_waitcnt vmcnt(10)
    buffer_load_dwordx4 a[136:139], v1, s[4:7], s37 offen offset:2048 sc1
    v_exp_f32 v124, v124
    v_exp_f32 v125, v125
    v_exp_f32 v126, v126
    v_exp_f32 v127, v127
    v_cvt_pk_bf16_f32 v149, v122, v123
    v_cvt_pk_bf16_f32 v150, v124, v125
    v_cvt_pk_bf16_f32 v151, v126, v127
    v_mfma_f32_32x32x16_bf16 v[112:127], a[80:83], v[16:19], 0
    v_exp_f32 v128, v128
    v_exp_f32 v129, v129
    v_exp_f32 v130, v130
    v_exp_f32 v131, v131
    v_cvt_pk_bf16_f32 v152, v128, v129
    v_mfma_f32_32x32x16_bf16 v[112:127], a[84:87], v[20:23], v[112:127]
    buffer_load_dwordx4 a[140:143], v1, s[4:7], s37 offen offset:3072 sc1
    buffer_load_dwordx4 a[144:147], v1, s[4:7], s38 offen offset:0 sc1
    v_exp_f32 v132, v132
    v_exp_f32 v133, v133
    v_exp_f32 v134, v134
    v_exp_f32 v135, v135
    v_cvt_pk_bf16_f32 v153, v130, v131
    v_cvt_pk_bf16_f32 v154, v132, v133
    v_mfma_f32_32x32x16_bf16 v[48:63], a[72:75], v[144:147], v[48:63]
    s_add_u32 s37, s48, 40960
    v_exp_f32 v136, v136
    v_exp_f32 v137, v137
    v_exp_f32 v138, v138
    v_exp_f32 v139, v139
    v_cvt_pk_bf16_f32 v155, v134, v135
    v_cvt_pk_bf16_f32 v156, v136, v137
    v_mfma_f32_32x32x16_bf16 v[48:63], a[76:79], v[148:151], v[48:63]
    buffer_load_dwordx4 a[148:151], v1, s[4:7], s38 offen offset:1024 sc1
    v_exp_f32 v140, v140
    v_exp_f32 v141, v141
    v_exp_f32 v142, v142
    v_exp_f32 v143, v143
    v_cvt_pk_bf16_f32 v157, v138, v139
    v_cvt_pk_bf16_f32 v158, v140, v141
    v_cvt_pk_bf16_f32 v159, v142, v143
    v_mfma_f32_32x32x16_bf16 v[128:143], a[80:83], v[24:27], 0
    v_exp_f32 v112, v112
    v_exp_f32 v113, v113
    v_exp_f32 v114, v114
    v_exp_f32 v115, v115
    v_cvt_pk_bf16_f32 v144, v112, v113
    v_mfma_f32_32x32x16_bf16 v[128:143], a[84:87], v[28:31], v[128:143]
    buffer_load_dwordx4 a[152:155], v1, s[4:7], s38 offen offset:2048 sc1
    buffer_load_dwordx4 a[156:159], v1, s[4:7], s38 offen offset:3072 sc1
    v_exp_f32 v116, v116
    v_exp_f32 v117, v117
    v_exp_f32 v118, v118
    v_exp_f32 v119, v119
    v_cvt_pk_bf16_f32 v145, v114, v115
    v_cvt_pk_bf16_f32 v146, v116, v117
    v_mfma_f32_32x32x16_bf16 v[64:79], a[72:75], v[152:155], v[64:79]
    s_add_u32 s38, s48, 45056
    v_exp_f32 v120, v120
    v_exp_f32 v121, v121
    v_exp_f32 v122, v122
    v_exp_f32 v123, v123
    v_cvt_pk_bf16_f32 v147, v118, v119
    v_cvt_pk_bf16_f32 v148, v120, v121
    v_mfma_f32_32x32x16_bf16 v[64:79], a[76:79], v[156:159], v[64:79]
    s_waitcnt vmcnt(12)
    buffer_load_dwordx4 a[160:163], v1, s[4:7], s37 offen offset:0 sc1
    v_exp_f32 v124, v124
    v_exp_f32 v125, v125
    v_exp_f32 v126, v126
    v_exp_f32 v127, v127
    v_cvt_pk_bf16_f32 v149, v122, v123
    v_cvt_pk_bf16_f32 v150, v124, v125
    v_cvt_pk_bf16_f32 v151, v126, v127
    v_mfma_f32_32x32x16_bf16 v[112:127], a[96:99], v[16:19], 0
    v_exp_f32 v128, v128
    v_exp_f32 v129, v129
    v_exp_f32 v130, v130
    v_exp_f32 v131, v131
    v_cvt_pk_bf16_f32 v152, v128, v129
    v_mfma_f32_32x32x16_bf16 v[112:127], a[100:103], v[20:23], v[112:127]
    buffer_load_dwordx4 a[164:167], v1, s[4:7], s37 offen offset:1024 sc1
    buffer_load_dwordx4 a[168:171], v1, s[4:7], s37 offen offset:2048 sc1
    v_exp_f32 v132, v132
    v_exp_f32 v133, v133
    v_exp_f32 v134, v134
    v_exp_f32 v135, v135
    v_cvt_pk_bf16_f32 v153, v130, v131
    v_cvt_pk_bf16_f32 v154, v132, v133
    v_mfma_f32_32x32x16_bf16 v[48:63], a[88:91], v[144:147], v[48:63]
    v_exp_f32 v136, v136
    v_exp_f32 v137, v137
    v_exp_f32 v138, v138
    v_exp_f32 v139, v139
    v_cvt_pk_bf16_f32 v155, v134, v135
    v_cvt_pk_bf16_f32 v156, v136, v137
    v_mfma_f32_32x32x16_bf16 v[48:63], a[92:95], v[148:151], v[48:63]
    buffer_load_dwordx4 a[172:175], v1, s[4:7], s37 offen offset:3072 sc1
    v_exp_f32 v140, v140
    v_exp_f32 v141, v141
    v_exp_f32 v142, v142
    v_exp_f32 v143, v143
    v_cvt_pk_bf16_f32 v157, v138, v139
    v_cvt_pk_bf16_f32 v158, v140, v141
    v_cvt_pk_bf16_f32 v159, v142, v143
    v_mfma_f32_32x32x16_bf16 v[128:143], a[96:99], v[24:27], 0
    s_add_u32 s37, s48, 49152
    v_exp_f32 v112, v112
    v_exp_f32 v113, v113
    v_exp_f32 v114, v114
    v_exp_f32 v115, v115
    v_cvt_pk_bf16_f32 v144, v112, v113
    v_mfma_f32_32x32x16_bf16 v[128:143], a[100:103], v[28:31], v[128:143]
    buffer_load_dwordx4 a[176:179], v1, s[4:7], s38 offen offset:0 sc1
    buffer_load_dwordx4 a[180:183], v1, s[4:7], s38 offen offset:1024 sc1
    v_exp_f32 v116, v116
    v_exp_f32 v117, v117
    v_exp_f32 v118, v118
    v_exp_f32 v119, v119
    v_cvt_pk_bf16_f32 v145, v114, v115
    v_cvt_pk_bf16_f32 v146, v116, v117
    v_mfma_f32_32x32x16_bf16 v[64:79], a[88:91], v[152:155], v[64:79]
    v_exp_f32 v120, v120
    v_exp_f32 v121, v121
    v_exp_f32 v122, v122
    v_exp_f32 v123, v123
    v_cvt_pk_bf16_f32 v147, v118, v119
    v_cvt_pk_bf16_f32 v148, v120, v121
    v_mfma_f32_32x32x16_bf16 v[64:79], a[92:95], v[156:159], v[64:79]
    s_waitcnt vmcnt(14)
    buffer_load_dwordx4 a[184:187], v1, s[4:7], s38 offen offset:2048 sc1
    v_exp_f32 v124, v124
    v_exp_f32 v125, v125
    v_exp_f32 v126, v126
    v_exp_f32 v127, v127
    v_cvt_pk_bf16_f32 v149, v122, v123
    v_cvt_pk_bf16_f32 v150, v124, v125
    v_cvt_pk_bf16_f32 v151, v126, v127
    v_mfma_f32_32x32x16_bf16 v[112:127], a[112:115], v[16:19], 0
    v_exp_f32 v128, v128
    v_exp_f32 v129, v129
    v_exp_f32 v130, v130
    v_exp_f32 v131, v131
    v_cvt_pk_bf16_f32 v152, v128, v129
    v_mfma_f32_32x32x16_bf16 v[112:127], a[116:119], v[20:23], v[112:127]
    buffer_load_dwordx4 a[188:191], v1, s[4:7], s38 offen offset:3072 sc1
    buffer_load_dwordx4 a[192:195], v1, s[4:7], s37 offen offset:0 sc1
    v_exp_f32 v132, v132
    v_exp_f32 v133, v133
    v_exp_f32 v134, v134
    v_exp_f32 v135, v135
    v_cvt_pk_bf16_f32 v153, v130, v131
    v_cvt_pk_bf16_f32 v154, v132, v133
    v_mfma_f32_32x32x16_bf16 v[48:63], a[104:107], v[144:147], v[48:63]
    s_add_u32 s38, s48, 53248
    v_exp_f32 v136, v136
    v_exp_f32 v137, v137
    v_exp_f32 v138, v138
    v_exp_f32 v139, v139
    v_cvt_pk_bf16_f32 v155, v134, v135
    v_cvt_pk_bf16_f32 v156, v136, v137
    v_mfma_f32_32x32x16_bf16 v[48:63], a[108:111], v[148:151], v[48:63]
    buffer_load_dwordx4 a[196:199], v1, s[4:7], s37 offen offset:1024 sc1
    v_exp_f32 v140, v140
    v_exp_f32 v141, v141
    v_exp_f32 v142, v142
    v_exp_f32 v143, v143
    v_cvt_pk_bf16_f32 v157, v138, v139
    v_cvt_pk_bf16_f32 v158, v140, v141
    v_cvt_pk_bf16_f32 v159, v142, v143
    v_mfma_f32_32x32x16_bf16 v[128:143], a[112:115], v[24:27], 0
    s_cmp_lg_u32 s18, 0
    s_cbranch_scc1 La_nopi0
    s_mov_b64 exec, 0xffff
    buffer_load_dword v177, v176, s[4:7], s64 offen sc1
    s_mov_b64 exec, -1
La_nopi0:
    v_exp_f32 v112, v112
    v_exp_f32 v113, v113
    v_exp_f32 v114, v114
    v_exp_f32 v115, v115
    v_cvt_pk_bf16_f32 v144, v112, v113
    v_mfma_f32_32x32x16_bf16 v[128:143], a[116:119], v[28:31], v[128:143]
    buffer_load_dwordx4 a[200:203], v1, s[4:7], s37 offen offset:2048 sc1
    buffer_load_dwordx4 a[204:207], v1, s[4:7], s37 offen offset:3072 sc1
    v_exp_f32 v116, v116
    v_exp_f32 v117, v117
    v_exp_f32 v118, v118
    v_exp_f32 v119, v119
    v_cvt_pk_bf16_f32 v145, v114, v115
    v_cvt_pk_bf16_f32 v146, v116, v117
    v_mfma_f32_32x32x16_bf16 v[64:79], a[104:107], v[152:155], v[64:79]
    s_add_u32 s37, s48, 57344
    v_exp_f32 v120, v120
    v_exp_f32 v121, v121
    v_exp_f32 v122, v122
    v_exp_f32 v123, v123
    v_cvt_pk_bf16_f32 v147, v118, v119
    v_cvt_pk_bf16_f32 v148, v120, v121
    v_mfma_f32_32x32x16_bf16 v[64:79], a[108:111], v[156:159], v[64:79]
    s_waitcnt vmcnt(16)
    buffer_load_dwordx4 a[208:211], v1, s[4:7], s38 offen offset:0 sc1
    v_exp_f32 v124, v124
    v_exp_f32 v125, v125
    v_exp_f32 v126, v126
    v_exp_f32 v127, v127
    v_cvt_pk_bf16_f32 v149, v122, v123
    v_cvt_pk_bf16_f32 v150, v124, v125
    v_cvt_pk_bf16_f32 v151, v126, v127
    v_mfma_f32_32x32x16_bf16 v[112:127], a[128:131], v[16:19], 0
    v_exp_f32 v128, v128
    v_exp_f32 v129, v129
    v_exp_f32 v130, v130
    v_exp_f32 v131, v131
    v_cvt_pk_bf16_f32 v152, v128, v129
    v_mfma_f32_32x32x16_bf16 v[112:127], a[132:135], v[20:23], v[112:127]
    buffer_load_dwordx4 a[212:215], v1, s[4:7], s38 offen offset:1024 sc1
    buffer_load_dwordx4 a[216:219], v1, s[4:7], s38 offen offset:2048 sc1
    v_exp_f32 v132, v132
    v_exp_f32 v133, v133
    v_exp_f32 v134, v134
    v_exp_f32 v135, v135
    v_cvt_pk_bf16_f32 v153, v130, v131
    v_cvt_pk_bf16_f32 v154, v132, v133
    v_mfma_f32_32x32x16_bf16 v[48:63], a[120:123], v[144:147], v[48:63]
    v_exp_f32 v136, v136
    v_exp_f32 v137, v137
    v_exp_f32 v138, v138
    v_exp_f32 v139, v139
    v_cvt_pk_bf16_f32 v155, v134, v135
    v_cvt_pk_bf16_f32 v156, v136, v137
    v_mfma_f32_32x32x16_bf16 v[48:63], a[124:127], v[148:151], v[48:63]
    buffer_load_dwordx4 a[220:223], v1, s[4:7], s38 offen offset:3072 sc1
    v_exp_f32 v140, v140
    v_exp_f32 v141, v141
    v_exp_f32 v142, v142
    v_exp_f32 v143, v143
    v_cvt_pk_bf16_f32 v157, v138, v139
    v_cvt_pk_bf16_f32 v158, v140, v141
    v_cvt_pk_bf16_f32 v159, v142, v143
    v_mfma_f32_32x32x16_bf16 v[128:143], a[128:131], v[24:27], 0
    s_add_u32 s38, s48, 61440
    v_exp_f32 v112, v112
    v_exp_f32 v113, v113
    v_exp_f32 v114, v114
    v_exp_f32 v115, v115
    v_cvt_pk_bf16_f32 v144, v112, v113
    v_mfma_f32_32x32x16_bf16 v[128:143], a[132:135], v[28:31], v[128:143]
    buffer_load_dwordx4 a[224:227], v1, s[4:7], s37 offen offset:0 sc1
    buffer_load_dwordx4 a[228:231], v1, s[4:7], s37 offen offset:1024 sc1
    v_exp_f32 v116, v116
    v_exp_f32 v117, v117
    v_exp_f32 v118, v118
    v_exp_f32 v119, v119
    v_cvt_pk_bf16_f32 v145, v114, v115
    v_cvt_pk_bf16_f32 v146, v116, v117
    v_mfma_f32_32x32x16_bf16 v[64:79], a[120:123], v[152:155], v[64:79]
    v_exp_f32 v120, v120
    v_exp_f32 v121, v121
    v_exp_f32 v122, v122
    v_exp_f32 v123, v123
    v_cvt_pk_bf16_f32 v147, v118, v119
    v_cvt_pk_bf16_f32 v148, v120, v121
    v_mfma_f32_32x32x16_bf16 v[64:79], a[124:127], v[156:159], v[64:79]
    s_waitcnt vmcnt(18)
    buffer_load_dwordx4 a[232:235], v1, s[4:7], s37 offen offset:2048 sc1
    v_exp_f32 v124, v124
    v_exp_f32 v125, v125
    v_exp_f32 v126, v126
    v_exp_f32 v127, v127
    v_cvt_pk_bf16_f32 v149, v122, v123
    v_cvt_pk_bf16_f32 v150, v124, v125
    v_cvt_pk_bf16_f32 v151, v126, v127
    v_mfma_f32_32x32x16_bf16 v[112:127], a[144:147], v[16:19], 0
    s_add_u32 m0, s33, 0
    v_exp_f32 v128, v128
    v_exp_f32 v129, v129
    v_exp_f32 v130, v130
    v_exp_f32 v131, v131
    v_cvt_pk_bf16_f32 v152, v128, v129
    v_mfma_f32_32x32x16_bf16 v[112:127], a[148:151], v[20:23], v[112:127]
    buffer_load_dwordx4 a[236:239], v1, s[4:7], s37 offen offset:3072 sc1
    buffer_load_dwordx4 a[240:243], v1, s[4:7], s38 offen offset:0 sc1
    v_exp_f32 v132, v132
    v_exp_f32 v133, v133
    v_exp_f32 v134, v134
    v_exp_f32 v135, v135
    v_cvt_pk_bf16_f32 v153, v130, v131
    v_cvt_pk_bf16_f32 v154, v132, v133
    v_mfma_f32_32x32x16_bf16 v[48:63], a[136:139], v[144:147], v[48:63]
    s_add_u32 s37, s30, 0
    v_exp_f32 v136, v136
    v_exp_f32 v137, v137
    v_exp_f32 v138, v138
    v_exp_f32 v139, v139
    v_cvt_pk_bf16_f32 v155, v134, v135
    v_cvt_pk_bf16_f32 v156, v136, v137
    v_mfma_f32_32x32x16_bf16 v[48:63], a[140:143], v[148:151], v[48:63]
    buffer_load_dwordx4 a[244:247], v1, s[4:7], s38 offen offset:1024 sc1
    s_cmp_lg_u32 s18, 0
    s_cbranch_scc1 La_nopc0
    s_mov_b64 exec, 0xffff
    s_waitcnt vmcnt(11)
    v_cmp_eq_u32 vcc, 0, v177
    s_nop 0
    s_cbranch_vccz Lpolld2
    s_mov_b32 s39, 0
Lpoll2:
    buffer_load_dword v177, v176, s[4:7], s64 offen sc1
    s_waitcnt vmcnt(0)
    v_cmp_eq_u32 vcc, 0, v177
    s_nop 0
    s_cbranch_vccz Lpolld2
    s_add_u32 s39, s39, 1
    s_cmp_lt_u32 s39, 200000
    s_cbranch_scc1 Lpoll2
Lpolld2:
    s_nop 0
    s_mov_b64 exec, -1
La_nopc0:
    v_exp_f32 v140, v140
    v_exp_f32 v141, v141
    v_exp_f32 v142, v142
    v_exp_f32 v143, v143
    v_cvt_pk_bf16_f32 v157, v138, v139
    v_cvt_pk_bf16_f32 v158, v140, v141
    v_cvt_pk_bf16_f32 v159, v142, v143
    v_mfma_f32_32x32x16_bf16 v[128:143], a[144:147], v[24:27], 0
    v_exp_f32 v112, v112
    v_exp_f32 v113, v113
    v_exp_f32 v114, v114
    v_exp_f32 v115, v115
    v_cvt_pk_bf16_f32 v144, v112, v113
    v_mfma_f32_32x32x16_bf16 v[128:143], a[148:151], v[28:31], v[128:143]
    buffer_load_dwordx4 a[248:251], v1, s[4:7], s38 offen offset:2048 sc1
    buffer_load_dwordx4 a[252:255], v1, s[4:7], s38 offen offset:3072 sc1
    v_exp_f32 v116, v116
    v_exp_f32 v117, v117
    v_exp_f32 v118, v118
    v_exp_f32 v119, v119
    v_cvt_pk_bf16_f32 v145, v114, v115
    v_cvt_pk_bf16_f32 v146, v116, v117
    v_mfma_f32_32x32x16_bf16 v[64:79], a[136:139], v[152:155], v[64:79]
    s_add_u32 s38, s30, 4096
    v_exp_f32 v120, v120
    v_exp_f32 v121, v121
    v_exp_f32 v122, v122
    v_exp_f32 v123, v123
    v_cvt_pk_bf16_f32 v147, v118, v119
    v_cvt_pk_bf16_f32 v148, v120, v121
    v_mfma_f32_32x32x16_bf16 v[64:79], a[140:143], v[156:159], v[64:79]
    s_waitcnt vmcnt(20)
    buffer_load_dwordx4 v1, s[4:7], s37 offen offset:0 lds
    v_exp_f32 v124, v124
    v_exp_f32 v125, v125
    v_exp_f32 v126, v126
    v_exp_f32 v127, v127
    v_cvt_pk_bf16_f32 v149, v122, v123
    v_cvt_pk_bf16_f32 v150, v124, v125
    v_cvt_pk_bf16_f32 v151, v126, v127
    v_mfma_f32_32x32x16_bf16 v[112:127], a[160:163], v[16:19], 0
    v_exp_f32 v128, v128
    v_exp_f32 v129, v129
    v_exp_f32 v130, v130
    v_exp_f32 v131, v131
    v_cvt_pk_bf16_f32 v152, v128, v129
    v_mfma_f32_32x32x16_bf16 v[112:127], a[164:167], v[20:23], v[112:127]
    buffer_load_dwordx4 v1, s[4:7], s37 offen offset:1024 lds
    buffer_load_dwordx4 v1, s[4:7], s37 offen offset:2048 lds
    v_exp_f32 v132, v132
    v_exp_f32 v133, v133
    v_exp_f32 v134, v134
    v_exp_f32 v135, v135
    v_cvt_pk_bf16_f32 v153, v130, v131
    v_cvt_pk_bf16_f32 v154, v132, v133
    v_mfma_f32_32x32x16_bf16 v[48:63], a[152:155], v[144:147], v[48:63]
    v_exp_f32 v136, v136
    v_exp_f32 v137, v137
    v_exp_f32 v138, v138
    v_exp_f32 v139, v139
    v_cvt_pk_bf16_f32 v155, v134, v135
    v_cvt_pk_bf16_f32 v156, v136, v137
    v_mfma_f32_32x32x16_bf16 v[48:63], a[156:159], v[148:151], v[48:63]
    buffer_load_dwordx4 v1, s[4:7], s37 offen offset:3072 lds
    v_exp_f32 v140, v140
    v_exp_f32 v141, v141
    v_exp_f32 v142, v142
    v_exp_f32 v143, v143
    v_cvt_pk_bf16_f32 v157, v138, v139
    v_cvt_pk_bf16_f32 v158, v140, v141
    v_cvt_pk_bf16_f32 v159, v142, v143
    v_mfma_f32_32x32x16_bf16 v[128:143], a[160:163], v[24:27], 0
    s_add_u32 m0, s33, 4096
    v_exp_f32 v112, v112
    v_exp_f32 v113, v113
    v_exp_f32 v114, v114
    v_exp_f32 v115, v115
    v_cvt_pk_bf16_f32 v144, v112, v113
    v_mfma_f32_32x32x16_bf16 v[128:143], a[164:167], v[28:31], v[128:143]
    buffer_load_dwordx4 v1, s[4:7], s38 offen offset:0 lds
    buffer_load_dwordx4 v1, s[4:7], s38 offen offset:1024 lds
    v_exp_f32 v116, v116
    v_exp_f32 v117, v117
    v_exp_f32 v118, v118
    v_exp_f32 v119, v119
    v_cvt_pk_bf16_f32 v145, v114, v115
    v_cvt_pk_bf16_f32 v146, v116, v117
    v_mfma_f32_32x32x16_bf16 v[64:79], a[152:155], v[152:155], v[64:79]
    s_add_u32 s37, s30, 8192
    v_exp_f32 v120, v120
    v_exp_f32 v121, v121
    v_exp_f32 v122, v122
    v_exp_f32 v123, v123
    v_cvt_pk_bf16_f32 v147, v118, v119
    v_cvt_pk_bf16_f32 v148, v120, v121
    v_mfma_f32_32x32x16_bf16 v[64:79], a[156:159], v[156:159], v[64:79]
    s_waitcnt vmcnt(22)
    buffer_load_dwordx4 v1, s[4:7], s38 offen offset:2048 lds
    v_exp_f32 v124, v124
    v_exp_f32 v125, v125
    v_exp_f32 v126, v126
    v_exp_f32 v127, v127
    v_cvt_pk_bf16_f32 v149, v122, v123
    v_cvt_pk_bf16_f32 v150, v124, v125
    v_cvt_pk_bf16_f32 v151, v126, v127
    v_mfma_f32_32x32x16_bf16 v[112:127], a[176:179], v[16:19], 0
    v_exp_f32 v128, v128
    v_exp_f32 v129, v129
    v_exp_f32 v130, v130
    v_exp_f32 v131, v131
    v_cvt_pk_bf16_f32 v152, v128, v129
    v_mfma_f32_32x32x16_bf16 v[112:127], a[180:183], v[20:23], v[112:127]
    buffer_load_dwordx4 v1, s[4:7], s38 offen offset:3072 lds
    s_add_u32 m0, s33, 8192
    s_nop 0
    buffer_load_dwordx4 v1, s[4:7], s37 offen offset:0 lds
    v_exp_f32 v132, v132
    v_exp_f32 v133, v133
    v_exp_f32 v134, v134
    v_exp_f32 v135, v135
    v_cvt_pk_bf16_f32 v153, v130, v131
    v_cvt_pk_bf16_f32 v154, v132, v133
    v_mfma_f32_32x32x16_bf16 v[48:63], a[168:171], v[144:147], v[48:63]
    s_add_u32 s38, s30, 12288
    v_exp_f32 v136, v136
    v_exp_f32 v137, v137
    v_exp_f32 v138, v138
    v_exp_f32 v139, v139
    v_cvt_pk_bf16_f32 v155, v134, v135
    v_cvt_pk_bf16_f32 v156, v136, v137
    v_mfma_f32_32x32x16_bf16 v[48:63], a[172:175], v[148:151], v[48:63]
    buffer_load_dwordx4 v1, s[4:7], s37 offen offset:1024 lds
    v_exp_f32 v140, v140
    v_exp_f32 v141, v141
    v_exp_f32 v142, v142
    v_exp_f32 v143, v143
    v_cvt_pk_bf16_f32 v157, v138, v139
    v_cvt_pk_bf16_f32 v158, v140, v141
    v_cvt_pk_bf16_f32 v159, v142, v143
    v_mfma_f32_32x32x16_bf16 v[128:143], a[176:179], v[24:27], 0
    v_exp_f32 v112, v112
    v_exp_f32 v113, v113
    v_exp_f32 v114, v114
    v_exp_f32 v115, v115
    v_cvt_pk_bf16_f32 v144, v112, v113
    v_mfma_f32_32x32x16_bf16 v[128:143], a[180:183], v[28:31], v[128:143]
    buffer_load_dwordx4 v1, s[4:7], s37 offen offset:2048 lds
    buffer_load_dwordx4 v1, s[4:7], s37 offen offset:3072 lds
    v_exp_f32 v116, v116
    v_exp_f32 v117, v117
    v_exp_f32 v118, v118
    v_exp_f32 v119, v119
    v_cvt_pk_bf16_f32 v145, v114, v115
    v_cvt_pk_bf16_f32 v146, v116, v117
    v_mfma_f32_32x32x16_bf16 v[64:79], a[168:171], v[152:155], v[64:79]
    s_add_u32 m0, s33, 12288
    v_exp_f32 v120, v120
    v_exp_f32 v121, v121
    v_exp_f32 v122, v122
    v_exp_f32 v123, v123
    v_cvt_pk_bf16_f32 v147, v118, v119
    v_cvt_pk_bf16_f32 v148, v120, v121
    v_mfma_f32_32x32x16_bf16 v[64:79], a[172:175], v[156:159], v[64:79]
    s_waitcnt vmcnt(24)
    buffer_load_dwordx4 v1, s[4:7], s38 offen offset:0 lds
    v_exp_f32 v124, v124
    v_exp_f32 v125, v125
    v_exp_f32 v126, v126
    v_exp_f32 v127, v127
    v_cvt_pk_bf16_f32 v149, v122, v123
    v_cvt_pk_bf16_f32 v150, v124, v125
    v_cvt_pk_bf16_f32 v151, v126, v127
    v_mfma_f32_32x32x16_bf16 v[112:127], a[192:195], v[16:19], 0
    s_add_u32 s37, s31, 0
    v_exp_f32 v128, v128
    v_exp_f32 v129, v129
    v_exp_f32 v130, v130
    v_exp_f32 v131, v131
    v_cvt_pk_bf16_f32 v152, v128, v129
    v_mfma_f32_32x32x16_bf16 v[112:127], a[196:199], v[20:23], v[112:127]
    buffer_load_dwordx4 v1, s[4:7], s38 offen offset:1024 lds
    s_add_u32 m0, s34, 0
    s_nop 0
    buffer_load_dwordx4 v1, s[4:7], s37 offen offset:0 lds
    v_exp_f32 v132, v132
    v_exp_f32 v133, v133
    v_exp_f32 v134, v134
    v_exp_f32 v135, v135
    v_cvt_pk_bf16_f32 v153, v130, v131
    v_cvt_pk_bf16_f32 v154, v132, v133
    v_mfma_f32_32x32x16_bf16 v[48:63], a[184:187], v[144:147], v[48:63]
    s_add_u32 s38, s31, 4096
    v_exp_f32 v136, v136
    v_exp_f32 v137, v137
    v_exp_f32 v138, v138
    v_exp_f32 v139, v139
    v_cvt_pk_bf16_f32 v155, v134, v135
    v_cvt_pk_bf16_f32 v156, v136, v137
    v_mfma_f32_32x32x16_bf16 v[48:63], a[188:191], v[148:151], v[48:63]
    buffer_load_dwordx4 v1, s[4:7], s37 offen offset:1024 lds
    v_exp_f32 v140, v140
    v_exp_f32 v141, v141
    v_exp_f32 v142, v142
    v_exp_f32 v143, v143
    v_cvt_pk_bf16_f32 v157, v138, v139
    v_cvt_pk_bf16_f32 v158, v140, v141
    v_cvt_pk_bf16_f32 v159, v142, v143
    v_mfma_f32_32x32x16_bf16 v[128:143], a[192:195], v[24:27], 0
    v_exp_f32 v112, v112
    v_exp_f32 v113, v113
    v_exp_f32 v114, v114
    v_exp_f32 v115, v115
    v_cvt_pk_bf16_f32 v144, v112, v113
    v_mfma_f32_32x32x16_bf16 v[128:143], a[196:199], v[28:31], v[128:143]
    buffer_load_dwordx4 v1, s[4:7], s37 offen offset:2048 lds
    buffer_load_dwordx4 v1, s[4:7], s37 offen offset:3072 lds
    v_exp_f32 v116, v116
    v_exp_f32 v117, v117
    v_exp_f32 v118, v118
    v_exp_f32 v119, v119
    v_cvt_pk_bf16_f32 v145, v114, v115
    v_cvt_pk_bf16_f32 v146, v116, v117
    v_mfma_f32_32x32x16_bf16 v[64:79], a[184:187], v[152:155], v[64:79]
    s_add_u32 m0, s34, 4096
    v_exp_f32 v120, v120
    v_exp_f32 v121, v121
    v_exp_f32 v122, v122
    v_exp_f32 v123, v123
    v_cvt_pk_bf16_f32 v147, v118, v119
    v_cvt_pk_bf16_f32 v148, v120, v121
    v_mfma_f32_32x32x16_bf16 v[64:79], a[188:191], v[156:159], v[64:79]
    s_waitcnt vmcnt(26)
    buffer_load_dwordx4 v1, s[4:7], s38 offen offset:0 lds
    v_exp_f32 v124, v124
    v_exp_f32 v125, v125
    v_exp_f32 v126, v126
    v_exp_f32 v127, v127
    v_cvt_pk_bf16_f32 v149, v122, v123
    v_cvt_pk_bf16_f32 v150, v124, v125
    v_cvt_pk_bf16_f32 v151, v126, v127
    v_mfma_f32_32x32x16_bf16 v[112:127], a[208:211], v[16:19], 0
    s_add_u32 s37, s31, 8192
    v_exp_f32 v128, v128
    v_exp_f32 v129, v129
    v_exp_f32 v130, v130
    v_exp_f32 v131, v131
    v_cvt_pk_bf16_f32 v152, v128, v129
    v_mfma_f32_32x32x16_bf16 v[112:127], a[212:215], v[20:23], v[112:127]
    buffer_load_dwordx4 v1, s[4:7], s38 offen offset:1024 lds
    buffer_load_dwordx4 v1, s[4:7], s38 offen offset:2048 lds
    v_exp_f32 v132, v132
    v_exp_f32 v133, v133
    v_exp_f32 v134, v134
    v_exp_f32 v135, v135
    v_cvt_pk_bf16_f32 v153, v130, v131
    v_cvt_pk_bf16_f32 v154, v132, v133
    v_mfma_f32_32x32x16_bf16 v[48:63], a[200:203], v[144:147], v[48:63]
    v_exp_f32 v136, v136
    v_exp_f32 v137, v137
    v_exp_f32 v138, v138
    v_exp_f32 v139, v139
    v_cvt_pk_bf16_f32 v155, v134, v135
    v_cvt_pk_bf16_f32 v156, v136, v137
    v_mfma_f32_32x32x16_bf16 v[48:63], a[204:207], v[148:151], v[48:63]
    buffer_load_dwordx4 v1, s[4:7], s38 offen offset:3072 lds
    v_exp_f32 v140, v140
    v_exp_f32 v141, v141
    v_exp_f32 v142, v142
    v_exp_f32 v143, v143
    v_cvt_pk_bf16_f32 v157, v138, v139
    v_cvt_pk_bf16_f32 v158, v140, v141
    v_cvt_pk_bf16_f32 v159, v142, v143
    v_mfma_f32_32x32x16_bf16 v[128:143], a[208:211], v[24:27], 0
    s_add_u32 m0, s34, 8192
    v_exp_f32 v112, v112
    v_exp_f32 v113, v113
    v_exp_f32 v114, v114
    v_exp_f32 v115, v115
    v_cvt_pk_bf16_f32 v144, v112, v113
    v_mfma_f32_32x32x16_bf16 v[128:143], a[212:215], v[28:31], v[128:143]
    buffer_load_dwordx4 v1, s[4:7], s37 offen offset:0 lds
    buffer_load_dwordx4 v1, s[4:7], s37 offen offset:1024 lds
    v_exp_f32 v116, v116
    v_exp_f32 v117, v117
    v_exp_f32 v118, v118
    v_exp_f32 v119, v119
    v_cvt_pk_bf16_f32 v145, v114, v115
    v_cvt_pk_bf16_f32 v146, v116, v117
    v_mfma_f32_32x32x16_bf16 v[64:79], a[200:203], v[152:155], v[64:79]
    s_add_u32 s38, s31, 12288
    v_exp_f32 v120, v120
    v_exp_f32 v121, v121
    v_exp_f32 v122, v122
    v_exp_f32 v123, v123
    v_cvt_pk_bf16_f32 v147, v118, v119
    v_cvt_pk_bf16_f32 v148, v120, v121
    v_mfma_f32_32x32x16_bf16 v[64:79], a[204:207], v[156:159], v[64:79]
    s_waitcnt vmcnt(28)
    buffer_load_dwordx4 v1, s[4:7], s37 offen offset:2048 lds
    v_exp_f32 v124, v124
    v_exp_f32 v125, v125
    v_exp_f32 v126, v126
    v_exp_f32 v127, v127
    v_cvt_pk_bf16_f32 v149, v122, v123
    v_cvt_pk_bf16_f32 v150, v124, v125
    v_cvt_pk_bf16_f32 v151, v126, v127
    v_mfma_f32_32x32x16_bf16 v[112:127], a[224:227], v[16:19], 0
    v_exp_f32 v128, v128
    v_exp_f32 v129, v129
    v_exp_f32 v130, v130
    v_exp_f32 v131, v131
    v_cvt_pk_bf16_f32 v152, v128, v129
    v_mfma_f32_32x32x16_bf16 v[112:127], a[228:231], v[20:23], v[112:127]
    buffer_load_dwordx4 v1, s[4:7], s37 offen offset:3072 lds
    v_exp_f32 v132, v132
    v_exp_f32 v133, v133
    v_exp_f32 v134, v134
    v_exp_f32 v135, v135
    v_cvt_pk_bf16_f32 v153, v130, v131
    v_cvt_pk_bf16_f32 v154, v132, v133
    v_mfma_f32_32x32x16_bf16 v[48:63], a[216:219], v[144:147], v[48:63]
    s_add_u32 m0, s34, 12288
    v_exp_f32 v136, v136
    v_exp_f32 v137, v137
    v_exp_f32 v138, v138
    v_exp_f32 v139, v139
    v_cvt_pk_bf16_f32 v155, v134, v135
    v_cvt_pk_bf16_f32 v156, v136, v137
    v_mfma_f32_32x32x16_bf16 v[48:63], a[220:223], v[148:151], v[48:63]
    buffer_load_dwordx4 v1, s[4:7], s38 offen offset:0 lds
    v_exp_f32 v140, v140
    v_exp_f32 v141, v141
    v_exp_f32 v142, v142
    v_exp_f32 v143, v143
    v_cvt_pk_bf16_f32 v157, v138, v139
    v_cvt_pk_bf16_f32 v158, v140, v141
    v_cvt_pk_bf16_f32 v159, v142, v143
    v_mfma_f32_32x32x16_bf16 v[128:143], a[224:227], v[24:27], 0
    s_cmp_lg_u32 s18, 0
    s_cbranch_scc1 La_nopi1
    s_mov_b64 exec, s[0:1]
    buffer_load_dword v177, v176, s[4:7], s64 offen sc1
    s_mov_b64 exec, -1
La_nopi1:
    v_exp_f32 v112, v112
    v_exp_f32 v113, v113
    v_exp_f32 v114, v114
    v_exp_f32 v115, v115
    v_cvt_pk_bf16_f32 v144, v112, v113
    v_mfma_f32_32x32x16_bf16 v[128:143], a[228:231], v[28:31], v[128:143]
    buffer_load_dwordx4 v1, s[4:7], s38 offen offset:1024 lds
    v_exp_f32 v116, v116
    v_exp_f32 v117, v117
    v_exp_f32 v118, v118
    v_exp_f32 v119, v119
    v_cvt_pk_bf16_f32 v145, v114, v115
    v_cvt_pk_bf16_f32 v146, v116, v117
    v_mfma_f32_32x32x16_bf16 v[64:79], a[216:219], v[152:155], v[64:79]
    s_add_u32 s37, s47, 8192
    v_exp_f32 v120, v120
    v_exp_f32 v121, v121
    v_exp_f32 v122, v122
    v_exp_f32 v123, v123
    v_cvt_pk_bf16_f32 v147, v118, v119
    v_cvt_pk_bf16_f32 v148, v120, v121
    v_mfma_f32_32x32x16_bf16 v[64:79], a[220:223], v[156:159], v[64:79]
    s_waitcnt vmcnt(28)
    buffer_load_dwordx4 v[192:195], v1, s[4:7], s37 offen offset:0
    v_exp_f32 v124, v124
    v_exp_f32 v125, v125
    v_exp_f32 v126, v126
    v_exp_f32 v127, v127
    v_cvt_pk_bf16_f32 v149, v122, v123
    v_cvt_pk_bf16_f32 v150, v124, v125
    v_cvt_pk_bf16_f32 v151, v126, v127
    v_mfma_f32_32x32x16_bf16 v[112:127], a[240:243], v[16:19], 0
    s_add_u32 s38, s47, 12288
    v_exp_f32 v128, v128
    v_exp_f32 v129, v129
    v_exp_f32 v130, v130
    v_exp_f32 v131, v131
    v_cvt_pk_bf16_f32 v152, v128, v129
    v_mfma_f32_32x32x16_bf16 v[112:127], a[244:247], v[20:23], v[112:127]
    buffer_load_dwordx4 v[196:199], v1, s[4:7], s37 offen offset:1024
    v_exp_f32 v132, v132
    v_exp_f32 v133, v133
    v_exp_f32 v134, v134
    v_exp_f32 v135, v135
    v_cvt_pk_bf16_f32 v153, v130, v131
    v_cvt_pk_bf16_f32 v154, v132, v133
    v_mfma_f32_32x32x16_bf16 v[48:63], a[232:235], v[144:147], v[48:63]
    v_exp_f32 v136, v136
    v_exp_f32 v137, v137
    v_exp_f32 v138, v138
    v_exp_f32 v139, v139
    v_cvt_pk_bf16_f32 v155, v134, v135
    v_cvt_pk_bf16_f32 v156, v136, v137
    v_mfma_f32_32x32x16_bf16 v[48:63], a[236:239], v[148:151], v[48:63]
    buffer_load_dwordx4 v[200:203], v1, s[4:7], s37 offen offset:2048
    v_exp_f32 v140, v140
    v_exp_f32 v141, v141
    v_exp_f32 v142, v142
    v_exp_f32 v143, v143
    v_cvt_pk_bf16_f32 v157, v138, v139
    v_cvt_pk_bf16_f32 v158, v140, v141
    v_cvt_pk_bf16_f32 v159, v142, v143
    v_mfma_f32_32x32x16_bf16 v[128:143], a[240:243], v[24:27], 0
    v_exp_f32 v112, v112
    v_exp_f32 v113, v113
    v_exp_f32 v114, v114
    v_exp_f32 v115, v115
    v_cvt_pk_bf16_f32 v144, v112, v113
    v_mfma_f32_32x32x16_bf16 v[128:143], a[244:247], v[28:31], v[128:143]
    buffer_load_dwordx4 v[204:207], v1, s[4:7], s37 offen offset:3072
    v_exp_f32 v116, v116
    v_exp_f32 v117, v117
    v_exp_f32 v118, v118
    v_exp_f32 v119, v119
    v_cvt_pk_bf16_f32 v145, v114, v115
    v_cvt_pk_bf16_f32 v146, v116, v117
    v_mfma_f32_32x32x16_bf16 v[64:79], a[232:235], v[152:155], v[64:79]
    v_exp_f32 v120, v120
    v_exp_f32 v121, v121
    v_exp_f32 v122, v122
    v_exp_f32 v123, v123
    v_cvt_pk_bf16_f32 v147, v118, v119
    v_cvt_pk_bf16_f32 v148, v120, v121
    v_mfma_f32_32x32x16_bf16 v[64:79], a[236:239], v[156:159], v[64:79]
    buffer_load_dwordx4 v[208:211], v1, s[4:7], s38 offen offset:0
    v_exp_f32 v124, v124
    v_exp_f32 v125, v125
    v_exp_f32 v126, v126
    v_exp_f32 v127, v127
    v_cvt_pk_bf16_f32 v149, v122, v123
    v_cvt_pk_bf16_f32 v150, v124, v125
    v_cvt_pk_bf16_f32 v151, v126, v127
    v_mfma_f32_32x32x16_bf16 v[112:127], a[0:3], v[32:35], 0
    s_add_u32 s37, s47, 16384
    v_exp_f32 v128, v128
    v_exp_f32 v129, v129
    v_exp_f32 v130, v130
    v_exp_f32 v131, v131
    v_cvt_pk_bf16_f32 v152, v128, v129
    v_mfma_f32_32x32x16_bf16 v[112:127], a[4:7], v[36:39], v[112:127]
    buffer_load_dwordx4 v[212:215], v1, s[4:7], s38 offen offset:1024
    v_exp_f32 v132, v132
    v_exp_f32 v133, v133
    v_exp_f32 v134, v134
    v_exp_f32 v135, v135
    v_cvt_pk_bf16_f32 v153, v130, v131
    v_cvt_pk_bf16_f32 v154, v132, v133
    v_mfma_f32_32x32x16_bf16 v[48:63], a[248:251], v[144:147], v[48:63]
    v_exp_f32 v136, v136
    v_exp_f32 v137, v137
    v_exp_f32 v138, v138
    v_exp_f32 v139, v139
    v_cvt_pk_bf16_f32 v155, v134, v135
    v_cvt_pk_bf16_f32 v156, v136, v137
    v_mfma_f32_32x32x16_bf16 v[48:63], a[252:255], v[148:151], v[48:63]
    buffer_load_dwordx4 v[216:219], v1, s[4:7], s38 offen offset:2048
    v_exp_f32 v140, v140
    v_exp_f32 v141, v141
    v_exp_f32 v142, v142
    v_exp_f32 v143, v143
    v_cvt_pk_bf16_f32 v157, v138, v139
    v_cvt_pk_bf16_f32 v158, v140, v141
    v_cvt_pk_bf16_f32 v159, v142, v143
    v_mfma_f32_32x32x16_bf16 v[128:143], a[16:19], v[32:35], 0
    v_exp_f32 v112, v112
    v_exp_f32 v113, v113
    v_exp_f32 v114, v114
    v_exp_f32 v115, v115
    v_cvt_pk_bf16_f32 v144, v112, v113
    v_mfma_f32_32x32x16_bf16 v[128:143], a[20:23], v[36:39], v[128:143]
    buffer_load_dwordx4 v[220:223], v1, s[4:7], s38 offen offset:3072
    v_exp_f32 v116, v116
    v_exp_f32 v117, v117
    v_exp_f32 v118, v118
    v_exp_f32 v119, v119
    v_cvt_pk_bf16_f32 v145, v114, v115
    v_cvt_pk_bf16_f32 v146, v116, v117
    v_mfma_f32_32x32x16_bf16 v[64:79], a[248:251], v[152:155], v[64:79]
    v_exp_f32 v120, v120
    v_exp_f32 v121, v121
    v_exp_f32 v122, v122
    v_exp_f32 v123, v123
    v_cvt_pk_bf16_f32 v147, v118, v119
    v_cvt_pk_bf16_f32 v148, v120, v121
    v_mfma_f32_32x32x16_bf16 v[64:79], a[252:255], v[156:159], v[64:79]
    buffer_load_dwordx4 v[224:227], v1, s[4:7], s37 offen offset:0
    v_exp_f32 v124, v124
    v_exp_f32 v125, v125
    v_exp_f32 v126, v126
    v_exp_f32 v127, v127
    v_cvt_pk_bf16_f32 v149, v122, v123
    v_cvt_pk_bf16_f32 v150, v124, v125
    v_cvt_pk_bf16_f32 v151, v126, v127
    v_mfma_f32_32x32x16_bf16 v[112:127], a[32:35], v[32:35], 0
    ds_write_b128 v6, v[48:51] offset:0
    v_exp_f32 v128, v128
    v_exp_f32 v129, v129
    v_exp_f32 v130, v130
    v_exp_f32 v131, v131
    v_cvt_pk_bf16_f32 v152, v128, v129
    v_mfma_f32_32x32x16_bf16 v[112:127], a[36:39], v[36:39], v[112:127]
    buffer_load_dwordx4 v[228:231], v1, s[4:7], s37 offen offset:1024
    ds_write_b128 v6, v[52:55] offset:1024
    v_exp_f32 v132, v132
    v_exp_f32 v133, v133
    v_exp_f32 v134, v134
    v_exp_f32 v135, v135
    v_cvt_pk_bf16_f32 v153, v130, v131
    v_cvt_pk_bf16_f32 v154, v132, v133
    v_mfma_f32_32x32x16_bf16 v[80:95], a[8:11], v[144:147], 0
    s_cmp_lg_u32 s18, 0
    s_cbranch_scc1 La_nopc1
    s_mov_b64 exec, s[0:1]
    s_waitcnt vmcnt(10)
    v_cmp_eq_u32 vcc, 0, v177
    s_nop 0
    s_cbranch_vccz Lpolld3
    s_mov_b32 s39, 0
Lpoll3:
    buffer_load_dword v177, v176, s[4:7], s64 offen sc1
    s_waitcnt vmcnt(0)
    v_cmp_eq_u32 vcc, 0, v177
    s_nop 0
    s_cbranch_vccz Lpolld3
    s_add_u32 s39, s39, 1
    s_cmp_lt_u32 s39, 200000
    s_cbranch_scc1 Lpoll3
Lpolld3:
    s_nop 0
    v_cmp_ne_u32 vcc, s19, v177
    s_nop 0
    s_cmp_lg_u32 vcc_hi, 0
    s_cselect_b32 s60, 2, 0
    s_mov_b64 exec, -1
La_nopc1:
    ds_write_b128 v6, v[56:59] offset:2048
    v_exp_f32 v136, v136
    v_exp_f32 v137, v137
    v_exp_f32 v138, v138
    v_exp_f32 v139, v139
    v_cvt_pk_bf16_f32 v155, v134, v135
    v_cvt_pk_bf16_f32 v156, v136, v137
    v_mfma_f32_32x32x16_bf16 v[80:95], a[12:15], v[148:151], v[80:95]
    buffer_load_dwordx4 v[232:235], v1, s[4:7], s37 offen offset:2048
    ds_write_b128 v6, v[60:63] offset:3072
    v_exp_f32 v140, v140
    v_exp_f32 v141, v141
    v_exp_f32 v142, v142
    v_exp_f32 v143, v143
    v_cvt_pk_bf16_f32 v157, v138, v139
    v_cvt_pk_bf16_f32 v158, v140, v141
    v_cvt_pk_bf16_f32 v159, v142, v143
    v_mfma_f32_32x32x16_bf16 v[128:143], a[48:51], v[32:35], 0
    s_add_u32 s38, s47, 20480
    v_exp_f32 v112, v112
    v_exp_f32 v113, v113
    v_exp_f32 v114, v114
    v_exp_f32 v115, v115
    v_cvt_pk_bf16_f32 v144, v112, v113
    v_mfma_f32_32x32x16_bf16 v[128:143], a[52:55], v[36:39], v[128:143]
    buffer_load_dwordx4 v[236:239], v1, s[4:7], s37 offen offset:3072
    v_exp_f32 v116, v116
    v_exp_f32 v117, v117
    v_exp_f32 v118, v118
    v_exp_f32 v119, v119
    v_cvt_pk_bf16_f32 v145, v114, v115
    v_cvt_pk_bf16_f32 v146, v116, v117
    v_mfma_f32_32x32x16_bf16 v[80:95], a[24:27], v[152:155], v[80:95]
    ds_write_b128 v7, v[64:67] offset:0
    ds_write_b128 v7, v[68:71] offset:1024
    v_exp_f32 v120, v120
    v_exp_f32 v121, v121
    v_exp_f32 v122, v122
    v_exp_f32 v123, v123
    v_cvt_pk_bf16_f32 v147, v118, v119
    v_cvt_pk_bf16_f32 v148, v120, v121
    v_mfma_f32_32x32x16_bf16 v[80:95], a[28:31], v[156:159], v[80:95]
    buffer_load_dwordx4 v[240:243], v1, s[4:7], s38 offen offset:0
    ds_write_b128 v7, v[72:75] offset:2048
    ds_write_b128 v7, v[76:79] offset:3072
    v_exp_f32 v124, v124
    v_exp_f32 v125, v125
    v_exp_f32 v126, v126
    v_exp_f32 v127, v127
    v_cvt_pk_bf16_f32 v149, v122, v123
    v_cvt_pk_bf16_f32 v150, v124, v125
    v_cvt_pk_bf16_f32 v151, v126, v127
    v_mfma_f32_32x32x16_bf16 v[112:127], a[64:67], v[32:35], 0
    buffer_load_dword v179, v3, s[4:7], s63 offen sc1
    v_exp_f32 v128, v128
    v_exp_f32 v129, v129
    v_exp_f32 v130, v130
    v_exp_f32 v131, v131
    v_cvt_pk_bf16_f32 v152, v128, v129
    v_mfma_f32_32x32x16_bf16 v[112:127], a[68:71], v[36:39], v[112:127]
    buffer_load_dwordx4 v[244:247], v1, s[4:7], s38 offen offset:1024
    v_exp_f32 v132, v132
    v_exp_f32 v133, v133
    v_exp_f32 v134, v134
    v_exp_f32 v135, v135
    v_cvt_pk_bf16_f32 v153, v130, v131
    v_cvt_pk_bf16_f32 v154, v132, v133
    v_mfma_f32_32x32x16_bf16 v[80:95], a[40:43], v[144:147], v[80:95]
    v_exp_f32 v136, v136
    v_exp_f32 v137, v137
    v_exp_f32 v138, v138
    v_exp_f32 v139, v139
    v_cvt_pk_bf16_f32 v155, v134, v135
    v_cvt_pk_bf16_f32 v156, v136, v137
    v_mfma_f32_32x32x16_bf16 v[80:95], a[44:47], v[148:151], v[80:95]
    buffer_load_dwordx4 v[248:251], v1, s[4:7], s38 offen offset:2048
    v_exp_f32 v140, v140
    v_exp_f32 v141, v141
    v_exp_f32 v142, v142
    v_exp_f32 v143, v143
    v_cvt_pk_bf16_f32 v157, v138, v139
    v_cvt_pk_bf16_f32 v158, v140, v141
    v_cvt_pk_bf16_f32 v159, v142, v143
    v_mfma_f32_32x32x16_bf16 v[128:143], a[80:83], v[32:35], 0
    s_waitcnt lgkmcnt(0)
    s_barrier
    v_exp_f32 v112, v112
    v_exp_f32 v113, v113
    v_exp_f32 v114, v114
    v_exp_f32 v115, v115
    v_cvt_pk_bf16_f32 v144, v112, v113
    v_mfma_f32_32x32x16_bf16 v[128:143], a[84:87], v[36:39], v[128:143]
    buffer_load_dwordx4 v[252:255], v1, s[4:7], s38 offen offset:3072
    v_exp_f32 v116, v116
    v_exp_f32 v117, v117
    v_exp_f32 v118, v118
    v_exp_f32 v119, v119
    v_cvt_pk_bf16_f32 v145, v114, v115
    v_cvt_pk_bf16_f32 v146, v116, v117
    v_mfma_f32_32x32x16_bf16 v[80:95], a[56:59], v[152:155], v[80:95]
    v_exp_f32 v120, v120
    v_exp_f32 v121, v121
    v_exp_f32 v122, v122
    v_exp_f32 v123, v123
    v_cvt_pk_bf16_f32 v147, v118, v119
    v_cvt_pk_bf16_f32 v148, v120, v121
    v_mfma_f32_32x32x16_bf16 v[80:95], a[60:63], v[156:159], v[80:95]
    v_exp_f32 v124, v124
    v_exp_f32 v125, v125
    v_exp_f32 v126, v126
    v_exp_f32 v127, v127
    v_cvt_pk_bf16_f32 v149, v122, v123
    v_cvt_pk_bf16_f32 v150, v124, v125
    v_cvt_pk_bf16_f32 v151, v126, v127
    v_mfma_f32_32x32x16_bf16 v[112:127], a[0:3], v[40:43], 0
    ds_read_b128 v[48:51], v9 offset:0
    v_exp_f32 v128, v128
    v_exp_f32 v129, v129
    v_exp_f32 v130, v130
    v_exp_f32 v131, v131
    v_cvt_pk_bf16_f32 v152, v128, v129
    v_mfma_f32_32x32x16_bf16 v[112:127], a[4:7], v[44:47], v[112:127]
    ds_read_b128 v[52:55], v9 offset:1024
    v_exp_f32 v132, v132
    v_exp_f32 v133, v133
    v_exp_f32 v134, v134
    v_exp_f32 v135, v135
    v_cvt_pk_bf16_f32 v153, v130, v131
    v_cvt_pk_bf16_f32 v154, v132, v133
    v_mfma_f32_32x32x16_bf16 v[80:95], a[72:75], v[144:147], v[80:95]
    ds_read_b128 v[56:59], v9 offset:2048
    v_exp_f32 v136, v136
    v_exp_f32 v137, v137
    v_exp_f32 v138, v138
    v_exp_f32 v139, v139
    v_cvt_pk_bf16_f32 v155, v134, v135
    v_cvt_pk_bf16_f32 v156, v136, v137
    v_mfma_f32_32x32x16_bf16 v[80:95], a[76:79], v[148:151], v[80:95]
    ds_read_b128 v[60:63], v9 offset:3072
    v_exp_f32 v140, v140
    v_exp_f32 v141, v141
    v_exp_f32 v142, v142
    v_exp_f32 v143, v143
    v_cvt_pk_bf16_f32 v157, v138, v139
    v_cvt_pk_bf16_f32 v158, v140, v141
    v_cvt_pk_bf16_f32 v159, v142, v143
    v_mfma_f32_32x32x16_bf16 v[128:143], a[96:99], v[32:35], 0
    ds_read_b128 v[64:67], v9 offset:4096
    v_exp_f32 v112, v112
    v_exp_f32 v113, v113
    v_exp_f32 v114, v114
    v_exp_f32 v115, v115
    v_cvt_pk_bf16_f32 v144, v112, v113
    v_mfma_f32_32x32x16_bf16 v[128:143], a[100:103], v[36:39], v[128:143]
    ds_read_b128 v[68:71], v9 offset:5120
    v_exp_f32 v116, v116
    v_exp_f32 v117, v117
    v_exp_f32 v118, v118
    v_exp_f32 v119, v119
    v_cvt_pk_bf16_f32 v145, v114, v115
    v_cvt_pk_bf16_f32 v146, v116, v117
    v_mfma_f32_32x32x16_bf16 v[80:95], a[88:91], v[152:155], v[80:95]
    ds_read_b128 v[72:75], v9 offset:6144
    v_exp_f32 v120, v120
    v_exp_f32 v121, v121
    v_exp_f32 v122, v122
    v_exp_f32 v123, v123
    v_cvt_pk_bf16_f32 v147, v118, v119
    v_cvt_pk_bf16_f32 v148, v120, v121
    v_mfma_f32_32x32x16_bf16 v[80:95], a[92:95], v[156:159], v[80:95]
    ds_read_b128 v[76:79], v9 offset:7168
    v_exp_f32 v124, v124
    v_exp_f32 v125, v125
    v_exp_f32 v126, v126
    v_exp_f32 v127, v127
    v_cvt_pk_bf16_f32 v149, v122, v123
    v_cvt_pk_bf16_f32 v150, v124, v125
    v_cvt_pk_bf16_f32 v151, v126, v127
    v_mfma_f32_32x32x16_bf16 v[112:127], a[16:19], v[40:43], 0
    s_add_u32 s37, s46, 0
    v_exp_f32 v128, v128
    v_exp_f32 v129, v129
    v_exp_f32 v130, v130
    v_exp_f32 v131, v131
    v_cvt_pk_bf16_f32 v152, v128, v129
    v_mfma_f32_32x32x16_bf16 v[112:127], a[20:23], v[44:47], v[112:127]
    s_waitcnt lgkmcnt(4)
    v_exp_f32 v132, v132
    v_exp_f32 v133, v133
    v_exp_f32 v134, v134
    v_exp_f32 v135, v135
    v_cvt_pk_bf16_f32 v153, v130, v131
    v_cvt_pk_bf16_f32 v154, v132, v133
    v_mfma_f32_32x32x16_bf16 v[96:111], a[8:11], v[144:147], v[48:63]
    v_exp_f32 v136, v136
    v_exp_f32 v137, v137
    v_exp_f32 v138, v138
    v_exp_f32 v139, v139
    v_cvt_pk_bf16_f32 v155, v134, v135
    v_cvt_pk_bf16_f32 v156, v136, v137
    v_mfma_f32_32x32x16_bf16 v[96:111], a[12:15], v[148:151], v[96:111]
    buffer_load_dwordx4 a[0:3], v1, s[4:7], s37 offen offset:0
    v_exp_f32 v140, v140
    v_exp_f32 v141, v141
    v_exp_f32 v142, v142
    v_exp_f32 v143, v143
    v_cvt_pk_bf16_f32 v157, v138, v139
    v_cvt_pk_bf16_f32 v158, v140, v141
    v_cvt_pk_bf16_f32 v159, v142, v143
    v_mfma_f32_32x32x16_bf16 v[128:143], a[112:115], v[32:35], 0
    s_add_u32 s38, s46, 4096
    v_exp_f32 v112, v112
    v_exp_f32 v113, v113
    v_exp_f32 v114, v114
    v_exp_f32 v115, v115
    v_cvt_pk_bf16_f32 v144, v112, v113
    v_mfma_f32_32x32x16_bf16 v[128:143], a[116:119], v[36:39], v[128:143]
    buffer_load_dwordx4 a[4:7], v1, s[4:7], s37 offen offset:1024
    buffer_load_dwordx4 a[8:11], v1, s[4:7], s37 offen offset:2048
    v_exp_f32 v116, v116
    v_exp_f32 v117, v117
    v_exp_f32 v118, v118
    v_exp_f32 v119, v119
    v_cvt_pk_bf16_f32 v145, v114, v115
    v_cvt_pk_bf16_f32 v146, v116, v117
    v_mfma_f32_32x32x16_bf16 v[80:95], a[104:107], v[152:155], v[80:95]
    v_exp_f32 v120, v120
    v_exp_f32 v121, v121
    v_exp_f32 v122, v122
    v_exp_f32 v123, v123
    v_cvt_pk_bf16_f32 v147, v118, v119
    v_cvt_pk_bf16_f32 v148, v120, v121
    v_mfma_f32_32x32x16_bf16 v[80:95], a[108:111], v[156:159], v[80:95]
    buffer_load_dwordx4 a[12:15], v1, s[4:7], s37 offen offset:3072
    v_exp_f32 v124, v124
    v_exp_f32 v125, v125
    v_exp_f32 v126, v126
    v_exp_f32 v127, v127
    v_cvt_pk_bf16_f32 v149, v122, v123
    v_cvt_pk_bf16_f32 v150, v124, v125
    v_cvt_pk_bf16_f32 v151, v126, v127
    v_mfma_f32_32x32x16_bf16 v[112:127], a[32:35], v[40:43], 0
    s_waitcnt lgkmcnt(0)
    v_exp_f32 v128, v128
    v_exp_f32 v129, v129
    v_exp_f32 v130, v130
    v_exp_f32 v131, v131
    v_cvt_pk_bf16_f32 v152, v128, v129
    v_mfma_f32_32x32x16_bf16 v[112:127], a[36:39], v[44:47], v[112:127]
    s_add_u32 s37, s32, 0
    v_exp_f32 v132, v132
    v_exp_f32 v133, v133
    v_exp_f32 v134, v134
    v_exp_f32 v135, v135
    v_cvt_pk_bf16_f32 v153, v130, v131
    v_cvt_pk_bf16_f32 v154, v132, v133
    v_mfma_f32_32x32x16_bf16 v[96:111], a[24:27], v[144:147], v[96:111]
    s_add_u32 m0, s100, 0
    v_exp_f32 v136, v136
    v_exp_f32 v137, v137
    v_exp_f32 v138, v138
    v_exp_f32 v139, v139
    v_cvt_pk_bf16_f32 v155, v134, v135
    v_cvt_pk_bf16_f32 v156, v136, v137
    v_mfma_f32_32x32x16_bf16 v[96:111], a[28:31], v[148:151], v[96:111]
    buffer_load_dwordx4 a[16:19], v1, s[4:7], s38 offen offset:0
    v_exp_f32 v140, v140
    v_exp_f32 v141, v141
    v_exp_f32 v142, v142
    v_exp_f32 v143, v143
    v_cvt_pk_bf16_f32 v157, v138, v139
    v_cvt_pk_bf16_f32 v158, v140, v141
    v_cvt_pk_bf16_f32 v159, v142, v143
    v_mfma_f32_32x32x16_bf16 v[128:143], a[128:131], v[32:35], 0
    v_exp_f32 v112, v112
    v_exp_f32 v113, v113
    v_exp_f32 v114, v114
    v_exp_f32 v115, v115
    v_cvt_pk_bf16_f32 v144, v112, v113
    v_mfma_f32_32x32x16_bf16 v[128:143], a[132:135], v[36:39], v[128:143]
    buffer_load_dwordx4 a[20:23], v1, s[4:7], s38 offen offset:1024
    buffer_load_dwordx4 a[24:27], v1, s[4:7], s38 offen offset:2048
    v_exp_f32 v116, v116
    v_exp_f32 v117, v117
    v_exp_f32 v118, v118
    v_exp_f32 v119, v119
    v_cvt_pk_bf16_f32 v145, v114, v115
    v_cvt_pk_bf16_f32 v146, v116, v117
    v_mfma_f32_32x32x16_bf16 v[80:95], a[120:123], v[152:155], v[80:95]
    v_exp_f32 v120, v120
    v_exp_f32 v121, v121
    v_exp_f32 v122, v122
    v_exp_f32 v123, v123
    v_cvt_pk_bf16_f32 v147, v118, v119
    v_cvt_pk_bf16_f32 v148, v120, v121
    v_mfma_f32_32x32x16_bf16 v[80:95], a[124:127], v[156:159], v[80:95]
    buffer_load_dwordx4 a[28:31], v1, s[4:7], s38 offen offset:3072
    v_exp_f32 v124, v124
    v_exp_f32 v125, v125
    v_exp_f32 v126, v126
    v_exp_f32 v127, v127
    v_cvt_pk_bf16_f32 v149, v122, v123
    v_cvt_pk_bf16_f32 v150, v124, v125
    v_cvt_pk_bf16_f32 v151, v126, v127
    v_mfma_f32_32x32x16_bf16 v[112:127], a[48:51], v[40:43], 0
    s_add_u32 s38, s46, 8192
    v_exp_f32 v128, v128
    v_exp_f32 v129, v129
    v_exp_f32 v130, v130
    v_exp_f32 v131, v131
    v_cvt_pk_bf16_f32 v152, v128, v129
    v_mfma_f32_32x32x16_bf16 v[112:127], a[52:55], v[44:47], v[112:127]
    buffer_load_dwordx4 v1, s[4:7], s37 offen offset:0 lds
    buffer_load_dwordx4 v1, s[4:7], s37 offen offset:1024 lds
    v_exp_f32 v132, v132
    v_exp_f32 v133, v133
    v_exp_f32 v134, v134
    v_exp_f32 v135, v135
    v_cvt_pk_bf16_f32 v153, v130, v131
    v_cvt_pk_bf16_f32 v154, v132, v133
    v_mfma_f32_32x32x16_bf16 v[96:111], a[40:43], v[144:147], v[96:111]
    v_exp_f32 v136, v136
    v_exp_f32 v137, v137
    v_exp_f32 v138, v138
    v_exp_f32 v139, v139
    v_cvt_pk_bf16_f32 v155, v134, v135
    v_cvt_pk_bf16_f32 v156, v136, v137
    v_mfma_f32_32x32x16_bf16 v[96:111], a[44:47], v[148:151], v[96:111]
    buffer_load_dwordx4 v1, s[4:7], s37 offen offset:2048 lds
    v_exp_f32 v140, v140
    v_exp_f32 v141, v141
    v_exp_f32 v142, v142
    v_exp_f32 v143, v143
    v_cvt_pk_bf16_f32 v157, v138, v139
    v_cvt_pk_bf16_f32 v158, v140, v141
    v_cvt_pk_bf16_f32 v159, v142, v143
    v_mfma_f32_32x32x16_bf16 v[128:143], a[144:147], v[32:35], 0
    v_exp_f32 v112, v112
    v_exp_f32 v113, v113
    v_exp_f32 v114, v114
    v_exp_f32 v115, v115
    v_cvt_pk_bf16_f32 v144, v112, v113
    v_mfma_f32_32x32x16_bf16 v[128:143], a[148:151], v[36:39], v[128:143]
    buffer_load_dwordx4 v1, s[4:7], s37 offen offset:3072 lds
    buffer_load_dwordx4 a[32:35], v1, s[4:7], s38 offen offset:0
    v_exp_f32 v116, v116
    v_exp_f32 v117, v117
    v_exp_f32 v118, v118
    v_exp_f32 v119, v119
    v_cvt_pk_bf16_f32 v145, v114, v115
    v_cvt_pk_bf16_f32 v146, v116, v117
    v_mfma_f32_32x32x16_bf16 v[80:95], a[136:139], v[152:155], v[80:95]
    s_add_u32 s37, s46, 12288
    v_exp_f32 v120, v120
    v_exp_f32 v121, v121
    v_exp_f32 v122, v122
    v_exp_f32 v123, v123
    v_cvt_pk_bf16_f32 v147, v118, v119
    v_cvt_pk_bf16_f32 v148, v120, v121
    v_mfma_f32_32x32x16_bf16 v[80:95], a[140:143], v[156:159], v[80:95]
    buffer_load_dwordx4 a[36:39], v1, s[4:7], s38 offen offset:1024
    v_exp_f32 v124, v124
    v_exp_f32 v125, v125
    v_exp_f32 v126, v126
    v_exp_f32 v127, v127
    v_cvt_pk_bf16_f32 v149, v122, v123
    v_cvt_pk_bf16_f32 v150, v124, v125
    v_cvt_pk_bf16_f32 v151, v126, v127
    v_mfma_f32_32x32x16_bf16 v[112:127], a[64:67], v[40:43], 0
    v_exp_f32 v128, v128
    v_exp_f32 v129, v129
    v_exp_f32 v130, v130
    v_exp_f32 v131, v131
    v_cvt_pk_bf16_f32 v152, v128, v129
    v_mfma_f32_32x32x16_bf16 v[112:127], a[68:71], v[44:47], v[112:127]
    buffer_load_dwordx4 a[40:43], v1, s[4:7], s38 offen offset:2048
    buffer_load_dwordx4 a[44:47], v1, s[4:7], s38 offen offset:3072
    v_exp_f32 v132, v132
    v_exp_f32 v133, v133
    v_exp_f32 v134, v134
    v_exp_f32 v135, v135
    v_cvt_pk_bf16_f32 v153, v130, v131
    v_cvt_pk_bf16_f32 v154, v132, v133
    v_mfma_f32_32x32x16_bf16 v[96:111], a[56:59], v[144:147], v[96:111]
    s_add_u32 s38, s32, 4096
    v_exp_f32 v136, v136
    v_exp_f32 v137, v137
    v_exp_f32 v138, v138
    v_exp_f32 v139, v139
    v_cvt_pk_bf16_f32 v155, v134, v135
    v_cvt_pk_bf16_f32 v156, v136, v137
    v_mfma_f32_32x32x16_bf16 v[96:111], a[60:63], v[148:151], v[96:111]
    buffer_load_dwordx4 a[48:51], v1, s[4:7], s37 offen offset:0
    v_exp_f32 v140, v140
    v_exp_f32 v141, v141
    v_exp_f32 v142, v142
    v_exp_f32 v143, v143
    v_cvt_pk_bf16_f32 v157, v138, v139
    v_cvt_pk_bf16_f32 v158, v140, v141
    v_cvt_pk_bf16_f32 v159, v142, v143
    v_mfma_f32_32x32x16_bf16 v[128:143], a[160:163], v[32:35], 0
    s_add_u32 m0, s100, 4096
    v_exp_f32 v112, v112
    v_exp_f32 v113, v113
    v_exp_f32 v114, v114
    v_exp_f32 v115, v115
    v_cvt_pk_bf16_f32 v144, v112, v113
    v_mfma_f32_32x32x16_bf16 v[128:143], a[164:167], v[36:39], v[128:143]
    buffer_load_dwordx4 a[52:55], v1, s[4:7], s37 offen offset:1024
    buffer_load_dwordx4 a[56:59], v1, s[4:7], s37 offen offset:2048
    v_exp_f32 v116, v116
    v_exp_f32 v117, v117
    v_exp_f32 v118, v118
    v_exp_f32 v119, v119
    v_cvt_pk_bf16_f32 v145, v114, v115
    v_cvt_pk_bf16_f32 v146, v116, v117
    v_mfma_f32_32x32x16_bf16 v[80:95], a[152:155], v[152:155], v[80:95]
    v_exp_f32 v120, v120
    v_exp_f32 v121, v121
    v_exp_f32 v122, v122
    v_exp_f32 v123, v123
    v_cvt_pk_bf16_f32 v147, v118, v119
    v_cvt_pk_bf16_f32 v148, v120, v121
    v_mfma_f32_32x32x16_bf16 v[80:95], a[156:159], v[156:159], v[80:95]
    buffer_load_dwordx4 a[60:63], v1, s[4:7], s37 offen offset:3072
    v_exp_f32 v124, v124
    v_exp_f32 v125, v125
    v_exp_f32 v126, v126
    v_exp_f32 v127, v127
    v_cvt_pk_bf16_f32 v149, v122, v123
    v_cvt_pk_bf16_f32 v150, v124, v125
    v_cvt_pk_bf16_f32 v151, v126, v127
    v_mfma_f32_32x32x16_bf16 v[112:127], a[80:83], v[40:43], 0
    s_add_u32 s37, s46, 16384
    v_exp_f32 v128, v128
    v_exp_f32 v129, v129
    v_exp_f32 v130, v130
    v_exp_f32 v131, v131
    v_cvt_pk_bf16_f32 v152, v128, v129
    v_mfma_f32_32x32x16_bf16 v[112:127], a[84:87], v[44:47], v[112:127]
    buffer_load_dwordx4 v1, s[4:7], s38 offen offset:0 lds
    buffer_load_dwordx4 v1, s[4:7], s38 offen offset:1024 lds
    v_exp_f32 v132, v132
    v_exp_f32 v133, v133
    v_exp_f32 v134, v134
    v_exp_f32 v135, v135
    v_cvt_pk_bf16_f32 v153, v130, v131
    v_cvt_pk_bf16_f32 v154, v132, v133
    v_mfma_f32_32x32x16_bf16 v[96:111], a[72:75], v[144:147], v[96:111]
    v_exp_f32 v136, v136
    v_exp_f32 v137, v137
    v_exp_f32 v138, v138
    v_exp_f32 v139, v139
    v_cvt_pk_bf16_f32 v155, v134, v135
    v_cvt_pk_bf16_f32 v156, v136, v137
    v_mfma_f32_32x32x16_bf16 v[96:111], a[76:79], v[148:151], v[96:111]
    buffer_load_dwordx4 v1, s[4:7], s38 offen offset:2048 lds
    v_exp_f32 v140, v140
    v_exp_f32 v141, v141
    v_exp_f32 v142, v142
    v_exp_f32 v143, v143
    v_cvt_pk_bf16_f32 v157, v138, v139
    v_cvt_pk_bf16_f32 v158, v140, v141
    v_cvt_pk_bf16_f32 v159, v142, v143
    v_mfma_f32_32x32x16_bf16 v[128:143], a[176:179], v[32:35], 0
    v_exp_f32 v112, v112
    v_exp_f32 v113, v113
    v_exp_f32 v114, v114
    v_exp_f32 v115, v115
    v_cvt_pk_bf16_f32 v144, v112, v113
    v_mfma_f32_32x32x16_bf16 v[128:143], a[180:183], v[36:39], v[128:143]
    buffer_load_dwordx4 v1, s[4:7], s38 offen offset:3072 lds
    buffer_load_dwordx4 a[64:67], v1, s[4:7], s37 offen offset:0
    v_exp_f32 v116, v116
    v_exp_f32 v117, v117
    v_exp_f32 v118, v118
    v_exp_f32 v119, v119
    v_cvt_pk_bf16_f32 v145, v114, v115
    v_cvt_pk_bf16_f32 v146, v116, v117
    v_mfma_f32_32x32x16_bf16 v[80:95], a[168:171], v[152:155], v[80:95]
    s_add_u32 s38, s46, 20480
    v_exp_f32 v120, v120
    v_exp_f32 v121, v121
    v_exp_f32 v122, v122
    v_exp_f32 v123, v123
    v_cvt_pk_bf16_f32 v147, v118, v119
    v_cvt_pk_bf16_f32 v148, v120, v121
    v_mfma_f32_32x32x16_bf16 v[80:95], a[172:175], v[156:159], v[80:95]
    buffer_load_dwordx4 a[68:71], v1, s[4:7], s37 offen offset:1024
    v_exp_f32 v124, v124
    v_exp_f32 v125, v125
    v_exp_f32 v126, v126
    v_exp_f32 v127, v127
    v_cvt_pk_bf16_f32 v149, v122, v123
    v_cvt_pk_bf16_f32 v150, v124, v125
    v_cvt_pk_bf16_f32 v151, v126, v127
    v_mfma_f32_32x32x16_bf16 v[112:127], a[96:99], v[40:43], 0
    v_exp_f32 v128, v128
    v_exp_f32 v129, v129
    v_exp_f32 v130, v130
    v_exp_f32 v131, v131
    v_cvt_pk_bf16_f32 v152, v128, v129
    v_mfma_f32_32x32x16_bf16 v[112:127], a[100:103], v[44:47], v[112:127]
    buffer_load_dwordx4 a[72:75], v1, s[4:7], s37 offen offset:2048
    buffer_load_dwordx4 a[76:79], v1, s[4:7], s37 offen offset:3072
    v_exp_f32 v132, v132
    v_exp_f32 v133, v133
    v_exp_f32 v134, v134
    v_exp_f32 v135, v135
    v_cvt_pk_bf16_f32 v153, v130, v131
    v_cvt_pk_bf16_f32 v154, v132, v133
    v_mfma_f32_32x32x16_bf16 v[96:111], a[88:91], v[144:147], v[96:111]
    v_exp_f32 v136, v136
    v_exp_f32 v137, v137
    v_exp_f32 v138, v138
    v_exp_f32 v139, v139
    v_cvt_pk_bf16_f32 v155, v134, v135
    v_cvt_pk_bf16_f32 v156, v136, v137
    v_mfma_f32_32x32x16_bf16 v[96:111], a[92:95], v[148:151], v[96:111]
    buffer_load_dwordx4 a[80:83], v1, s[4:7], s38 offen offset:0
    v_exp_f32 v140, v140
    v_exp_f32 v141, v141
    v_exp_f32 v142, v142
    v_exp_f32 v143, v143
    v_cvt_pk_bf16_f32 v157, v138, v139
    v_cvt_pk_bf16_f32 v158, v140, v141
    v_cvt_pk_bf16_f32 v159, v142, v143
    v_mfma_f32_32x32x16_bf16 v[128:143], a[192:195], v[32:35], 0
    s_getpc_b64 s[28:29]
Lpc_ct:
    s_add_u32 s28, s28, La_after-Lpc_ct
    s_addc_u32 s29, s29, 0
    s_mov_b64 exec, 3
    v_min_u32 v187, Lc_code_end-La_after-4, v187
    global_load_dword v181, v187, s[28:29]
    s_mov_b64 exec, -1
    v_exp_f32 v112, v112
    v_exp_f32 v113, v113
    v_exp_f32 v114, v114
    v_exp_f32 v115, v115
    v_cvt_pk_bf16_f32 v144, v112, v113
    v_mfma_f32_32x32x16_bf16 v[128:143], a[196:199], v[36:39], v[128:143]
    buffer_load_dwordx4 a[84:87], v1, s[4:7], s38 offen offset:1024
    buffer_load_dwordx4 a[88:91], v1, s[4:7], s38 offen offset:2048
    v_exp_f32 v116, v116
    v_exp_f32 v117, v117
    v_exp_f32 v118, v118
    v_exp_f32 v119, v119
    v_cvt_pk_bf16_f32 v145, v114, v115
    v_cvt_pk_bf16_f32 v146, v116, v117
    v_mfma_f32_32x32x16_bf16 v[80:95], a[184:187], v[152:155], v[80:95]
    s_add_u32 s37, s46, 24576
    v_exp_f32 v120, v120
    v_exp_f32 v121, v121
    v_exp_f32 v122, v122
    v_exp_f32 v123, v123
    v_cvt_pk_bf16_f32 v147, v118, v119
    v_cvt_pk_bf16_f32 v148, v120, v121
    v_mfma_f32_32x32x16_bf16 v[80:95], a[188:191], v[156:159], v[80:95]
    buffer_load_dwordx4 a[92:95], v1, s[4:7], s38 offen offset:3072
    v_exp_f32 v124, v124
    v_exp_f32 v125, v125
    v_exp_f32 v126, v126
    v_exp_f32 v127, v127
    v_cvt_pk_bf16_f32 v149, v122, v123
    v_cvt_pk_bf16_f32 v150, v124, v125
    v_cvt_pk_bf16_f32 v151, v126, v127
    v_mfma_f32_32x32x16_bf16 v[112:127], a[112:115], v[40:43], 0
    v_exp_f32 v128, v128
    v_exp_f32 v129, v129
    v_exp_f32 v130, v130
    v_exp_f32 v131, v131
    v_cvt_pk_bf16_f32 v152, v128, v129
    v_mfma_f32_32x32x16_bf16 v[112:127], a[116:119], v[44:47], v[112:127]
    v_exp_f32 v132, v132
    v_exp_f32 v133, v133
    v_exp_f32 v134, v134
    v_exp_f32 v135, v135
    v_cvt_pk_bf16_f32 v153, v130, v131
    v_cvt_pk_bf16_f32 v154, v132, v133
    v_mfma_f32_32x32x16_bf16 v[96:111], a[104:107], v[144:147], v[96:111]
    v_exp_f32 v136, v136
    v_exp_f32 v137, v137
    v_exp_f32 v138, v138
    v_exp_f32 v139, v139
    v_cvt_pk_bf16_f32 v155, v134, v135
    v_cvt_pk_bf16_f32 v156, v136, v137
    v_mfma_f32_32x32x16_bf16 v[96:111], a[108:111], v[148:151], v[96:111]
    buffer_load_dwordx4 a[96:99], v1, s[4:7], s37 offen offset:0
    v_exp_f32 v140, v140
    v_exp_f32 v141, v141
    v_exp_f32 v142, v142
    v_exp_f32 v143, v143
    v_cvt_pk_bf16_f32 v157, v138, v139
    v_cvt_pk_bf16_f32 v158, v140, v141
    v_cvt_pk_bf16_f32 v159, v142, v143
    v_mfma_f32_32x32x16_bf16 v[128:143], a[208:211], v[32:35], 0
    s_add_u32 s38, s46, 28672
    v_exp_f32 v112, v112
    v_exp_f32 v113, v113
    v_exp_f32 v114, v114
    v_exp_f32 v115, v115
    v_cvt_pk_bf16_f32 v144, v112, v113
    v_mfma_f32_32x32x16_bf16 v[128:143], a[212:215], v[36:39], v[128:143]
    buffer_load_dwordx4 a[100:103], v1, s[4:7], s37 offen offset:1024
    buffer_load_dwordx4 a[104:107], v1, s[4:7], s37 offen offset:2048
    v_exp_f32 v116, v116
    v_exp_f32 v117, v117
    v_exp_f32 v118, v118
    v_exp_f32 v119, v119
    v_cvt_pk_bf16_f32 v145, v114, v115
    v_cvt_pk_bf16_f32 v146, v116, v117
    v_mfma_f32_32x32x16_bf16 v[80:95], a[200:203], v[152:155], v[80:95]
    v_exp_f32 v120, v120
    v_exp_f32 v121, v121
    v_exp_f32 v122, v122
    v_exp_f32 v123, v123
    v_cvt_pk_bf16_f32 v147, v118, v119
    v_cvt_pk_bf16_f32 v148, v120, v121
    v_mfma_f32_32x32x16_bf16 v[80:95], a[204:207], v[156:159], v[80:95]
    buffer_load_dwordx4 a[108:111], v1, s[4:7], s37 offen offset:3072
    v_exp_f32 v124, v124
    v_exp_f32 v125, v125
    v_exp_f32 v126, v126
    v_exp_f32 v127, v127
    v_cvt_pk_bf16_f32 v149, v122, v123
    v_cvt_pk_bf16_f32 v150, v124, v125
    v_cvt_pk_bf16_f32 v151, v126, v127
    v_mfma_f32_32x32x16_bf16 v[112:127], a[128:131], v[40:43], 0
    v_exp_f32 v128, v128
    v_exp_f32 v129, v129
    v_exp_f32 v130, v130
    v_exp_f32 v131, v131
    v_cvt_pk_bf16_f32 v152, v128, v129
    v_mfma_f32_32x32x16_bf16 v[112:127], a[132:135], v[44:47], v[112:127]
    v_exp_f32 v132, v132
    v_exp_f32 v133, v133
    v_exp_f32 v134, v134
    v_exp_f32 v135, v135
    v_cvt_pk_bf16_f32 v153, v130, v131
    v_cvt_pk_bf16_f32 v154, v132, v133
    v_mfma_f32_32x32x16_bf16 v[96:111], a[120:123], v[144:147], v[96:111]
    v_exp_f32 v136, v136
    v_exp_f32 v137, v137
    v_exp_f32 v138, v138
    v_exp_f32 v139, v139
    v_cvt_pk_bf16_f32 v155, v134, v135
    v_cvt_pk_bf16_f32 v156, v136, v137
    v_mfma_f32_32x32x16_bf16 v[96:111], a[124:127], v[148:151], v[96:111]
    buffer_load_dwordx4 a[112:115], v1, s[4:7], s38 offen offset:0
    v_exp_f32 v140, v140
    v_exp_f32 v141, v141
    v_exp_f32 v142, v142
    v_exp_f32 v143, v143
    v_cvt_pk_bf16_f32 v157, v138, v139
    v_cvt_pk_bf16_f32 v158, v140, v141
    v_cvt_pk_bf16_f32 v159, v142, v143
    v_mfma_f32_32x32x16_bf16 v[128:143], a[224:227], v[32:35], 0
    s_add_u32 s37, s46, 32768
    v_exp_f32 v112, v112
    v_exp_f32 v113, v113
    v_exp_f32 v114, v114
    v_exp_f32 v115, v115
    v_cvt_pk_bf16_f32 v144, v112, v113
    v_mfma_f32_32x32x16_bf16 v[128:143], a[228:231], v[36:39], v[128:143]
    buffer_load_dwordx4 a[116:119], v1, s[4:7], s38 offen offset:1024
    buffer_load_dwordx4 a[120:123], v1, s[4:7], s38 offen offset:2048
    v_exp_f32 v116, v116
    v_exp_f32 v117, v117
    v_exp_f32 v118, v118
    v_exp_f32 v119, v119
    v_cvt_pk_bf16_f32 v145, v114, v115
    v_cvt_pk_bf16_f32 v146, v116, v117
    v_mfma_f32_32x32x16_bf16 v[80:95], a[216:219], v[152:155], v[80:95]
    v_exp_f32 v120, v120
    v_exp_f32 v121, v121
    v_exp_f32 v122, v122
    v_exp_f32 v123, v123
    v_cvt_pk_bf16_f32 v147, v118, v119
    v_cvt_pk_bf16_f32 v148, v120, v121
    v_mfma_f32_32x32x16_bf16 v[80:95], a[220:223], v[156:159], v[80:95]
    buffer_load_dwordx4 a[124:127], v1, s[4:7], s38 offen offset:3072
    v_exp_f32 v124, v124
    v_exp_f32 v125, v125
    v_exp_f32 v126, v126
    v_exp_f32 v127, v127
    v_cvt_pk_bf16_f32 v149, v122, v123
    v_cvt_pk_bf16_f32 v150, v124, v125
    v_cvt_pk_bf16_f32 v151, v126, v127
    v_mfma_f32_32x32x16_bf16 v[112:127], a[144:147], v[40:43], 0
    v_exp_f32 v128, v128
    v_exp_f32 v129, v129
    v_exp_f32 v130, v130
    v_exp_f32 v131, v131
    v_cvt_pk_bf16_f32 v152, v128, v129
    v_mfma_f32_32x32x16_bf16 v[112:127], a[148:151], v[44:47], v[112:127]
    v_exp_f32 v132, v132
    v_exp_f32 v133, v133
    v_exp_f32 v134, v134
    v_exp_f32 v135, v135
    v_cvt_pk_bf16_f32 v153, v130, v131
    v_cvt_pk_bf16_f32 v154, v132, v133
    v_mfma_f32_32x32x16_bf16 v[96:111], a[136:139], v[144:147], v[96:111]
    v_exp_f32 v136, v136
    v_exp_f32 v137, v137
    v_exp_f32 v138, v138
    v_exp_f32 v139, v139
    v_cvt_pk_bf16_f32 v155, v134, v135
    v_cvt_pk_bf16_f32 v156, v136, v137
    v_mfma_f32_32x32x16_bf16 v[96:111], a[140:143], v[148:151], v[96:111]
    buffer_load_dwordx4 a[128:131], v1, s[4:7], s37 offen offset:0
    v_exp_f32 v140, v140
    v_exp_f32 v141, v141
    v_exp_f32 v142, v142
    v_exp_f32 v143, v143
    v_cvt_pk_bf16_f32 v157, v138, v139
    v_cvt_pk_bf16_f32 v158, v140, v141
    v_cvt_pk_bf16_f32 v159, v142, v143
    v_mfma_f32_32x32x16_bf16 v[128:143], a[240:243], v[32:35], 0
    s_add_u32 s38, s46, 36864
    v_exp_f32 v112, v112
    v_exp_f32 v113, v113
    v_exp_f32 v114, v114
    v_exp_f32 v115, v115
    v_cvt_pk_bf16_f32 v144, v112, v113
    v_mfma_f32_32x32x16_bf16 v[128:143], a[244:247], v[36:39], v[128:143]
    buffer_load_dwordx4 a[132:135], v1, s[4:7], s37 offen offset:1024
    buffer_load_dwordx4 a[136:139], v1, s[4:7], s37 offen offset:2048
    v_exp_f32 v116, v116
    v_exp_f32 v117, v117
    v_exp_f32 v118, v118
    v_exp_f32 v119, v119
    v_cvt_pk_bf16_f32 v145, v114, v115
    v_cvt_pk_bf16_f32 v146, v116, v117
    v_mfma_f32_32x32x16_bf16 v[80:95], a[232:235], v[152:155], v[80:95]
    v_exp_f32 v120, v120
    v_exp_f32 v121, v121
    v_exp_f32 v122, v122
    v_exp_f32 v123, v123
    v_cvt_pk_bf16_f32 v147, v118, v119
    v_cvt_pk_bf16_f32 v148, v120, v121
    v_mfma_f32_32x32x16_bf16 v[80:95], a[236:239], v[156:159], v[80:95]
    buffer_load_dwordx4 a[140:143], v1, s[4:7], s37 offen offset:3072
    v_exp_f32 v124, v124
    v_exp_f32 v125, v125
    v_exp_f32 v126, v126
    v_exp_f32 v127, v127
    v_cvt_pk_bf16_f32 v149, v122, v123
    v_cvt_pk_bf16_f32 v150, v124, v125
    v_cvt_pk_bf16_f32 v151, v126, v127
    v_mfma_f32_32x32x16_bf16 v[112:127], a[160:163], v[40:43], 0
    v_exp_f32 v128, v128
    v_exp_f32 v129, v129
    v_exp_f32 v130, v130
    v_exp_f32 v131, v131
    v_cvt_pk_bf16_f32 v152, v128, v129
    v_mfma_f32_32x32x16_bf16 v[112:127], a[164:167], v[44:47], v[112:127]
    v_exp_f32 v132, v132
    v_exp_f32 v133, v133
    v_exp_f32 v134, v134
    v_exp_f32 v135, v135
    v_cvt_pk_bf16_f32 v153, v130, v131
    v_cvt_pk_bf16_f32 v154, v132, v133
    v_mfma_f32_32x32x16_bf16 v[96:111], a[152:155], v[144:147], v[96:111]
    v_exp_f32 v136, v136
    v_exp_f32 v137, v137
    v_exp_f32 v138, v138
    v_exp_f32 v139, v139
    v_cvt_pk_bf16_f32 v155, v134, v135
    v_cvt_pk_bf16_f32 v156, v136, v137
    v_mfma_f32_32x32x16_bf16 v[96:111], a[156:159], v[148:151], v[96:111]
    buffer_load_dwordx4 a[144:147], v1, s[4:7], s38 offen offset:0
    v_exp_f32 v140, v140
    v_exp_f32 v141, v141
    v_exp_f32 v142, v142
    v_exp_f32 v143, v143
    v_cvt_pk_bf16_f32 v157, v138, v139
    v_cvt_pk_bf16_f32 v158, v140, v141
    v_cvt_pk_bf16_f32 v159, v142, v143
    v_mfma_f32_32x32x16_bf16 v[128:143], a[176:179], v[40:43], 0
    s_add_u32 s37, s46, 40960
    v_exp_f32 v112, v112
    v_exp_f32 v113, v113
    v_exp_f32 v114, v114
    v_exp_f32 v115, v115
    v_cvt_pk_bf16_f32 v144, v112, v113
    v_mfma_f32_32x32x16_bf16 v[128:143], a[180:183], v[44:47], v[128:143]
    buffer_load_dwordx4 a[148:151], v1, s[4:7], s38 offen offset:1024
    buffer_load_dwordx4 a[152:155], v1, s[4:7], s38 offen offset:2048
    v_exp_f32 v116, v116
    v_exp_f32 v117, v117
    v_exp_f32 v118, v118
    v_exp_f32 v119, v119
    v_cvt_pk_bf16_f32 v145, v114, v115
    v_cvt_pk_bf16_f32 v146, v116, v117
    v_mfma_f32_32x32x16_bf16 v[80:95], a[248:251], v[152:155], v[80:95]
    v_exp_f32 v120, v120
    v_exp_f32 v121, v121
    v_exp_f32 v122, v122
    v_exp_f32 v123, v123
    v_cvt_pk_bf16_f32 v147, v118, v119
    v_cvt_pk_bf16_f32 v148, v120, v121
    v_mfma_f32_32x32x16_bf16 v[80:95], a[252:255], v[156:159], v[80:95]
    buffer_load_dwordx4 a[156:159], v1, s[4:7], s38 offen offset:3072
    v_exp_f32 v124, v124
    v_exp_f32 v125, v125
    v_exp_f32 v126, v126
    v_exp_f32 v127, v127
    v_cvt_pk_bf16_f32 v149, v122, v123
    v_cvt_pk_bf16_f32 v150, v124, v125
    v_cvt_pk_bf16_f32 v151, v126, v127
    v_mfma_f32_32x32x16_bf16 v[112:127], a[192:195], v[40:43], 0
    v_exp_f32 v128, v128
    v_exp_f32 v129, v129
    v_exp_f32 v130, v130
    v_exp_f32 v131, v131
    v_cvt_pk_bf16_f32 v152, v128, v129
    v_mfma_f32_32x32x16_bf16 v[112:127], a[196:199], v[44:47], v[112:127]
    s_add_u32 s38, s46, 45056
    v_exp_f32 v132, v132
    v_exp_f32 v133, v133
    v_exp_f32 v134, v134
    v_exp_f32 v135, v135
    v_cvt_pk_bf16_f32 v153, v130, v131
    v_cvt_pk_bf16_f32 v154, v132, v133
    v_mfma_f32_32x32x16_bf16 v[96:111], a[168:171], v[144:147], v[96:111]
    ds_write_b128 v8, v[80:83] offset:0
    ds_write_b128 v8, v[84:87] offset:1024
    v_exp_f32 v136, v136
    v_exp_f32 v137, v137
    v_exp_f32 v138, v138
    v_exp_f32 v139, v139
    v_cvt_pk_bf16_f32 v155, v134, v135
    v_cvt_pk_bf16_f32 v156, v136, v137
    v_mfma_f32_32x32x16_bf16 v[96:111], a[172:175], v[148:151], v[96:111]
    buffer_load_dwordx4 a[160:163], v1, s[4:7], s37 offen offset:0
    ds_write_b128 v8, v[88:91] offset:2048
    ds_write_b128 v8, v[92:95] offset:3072
    v_exp_f32 v140, v140
    v_exp_f32 v141, v141
    v_exp_f32 v142, v142
    v_exp_f32 v143, v143
    v_cvt_pk_bf16_f32 v157, v138, v139
    v_cvt_pk_bf16_f32 v158, v140, v141
    v_cvt_pk_bf16_f32 v159, v142, v143
    v_mfma_f32_32x32x16_bf16 v[128:143], a[208:211], v[40:43], 0
    v_exp_f32 v112, v112
    v_exp_f32 v113, v113
    v_exp_f32 v114, v114
    v_exp_f32 v115, v115
    v_cvt_pk_bf16_f32 v144, v112, v113
    v_mfma_f32_32x32x16_bf16 v[128:143], a[212:215], v[44:47], v[128:143]
    buffer_load_dwordx4 a[164:167], v1, s[4:7], s37 offen offset:1024
    buffer_load_dwordx4 a[168:171], v1, s[4:7], s37 offen offset:2048
    v_exp_f32 v116, v116
    v_exp_f32 v117, v117
    v_exp_f32 v118, v118
    v_exp_f32 v119, v119
    v_cvt_pk_bf16_f32 v145, v114, v115
    v_cvt_pk_bf16_f32 v146, v116, v117
    v_mfma_f32_32x32x16_bf16 v[96:111], a[184:187], v[152:155], v[96:111]
    v_exp_f32 v120, v120
    v_exp_f32 v121, v121
    v_exp_f32 v122, v122
    v_exp_f32 v123, v123
    v_cvt_pk_bf16_f32 v147, v118, v119
    v_cvt_pk_bf16_f32 v148, v120, v121
    v_mfma_f32_32x32x16_bf16 v[96:111], a[188:191], v[156:159], v[96:111]
    s_waitcnt lgkmcnt(0)
    buffer_load_dwordx4 a[172:175], v1, s[4:7], s37 offen offset:3072
    s_barrier
    v_exp_f32 v124, v124
    v_exp_f32 v125, v125
    v_exp_f32 v126, v126
    v_exp_f32 v127, v127
    v_cvt_pk_bf16_f32 v149, v122, v123
    v_cvt_pk_bf16_f32 v150, v124, v125
    v_cvt_pk_bf16_f32 v151, v126, v127
    v_mfma_f32_32x32x16_bf16 v[112:127], a[224:227], v[40:43], 0
    ds_read_b128 v[48:51], v9 offset:8192
    v_exp_f32 v128, v128
    v_exp_f32 v129, v129
    v_exp_f32 v130, v130
    v_exp_f32 v131, v131
    v_cvt_pk_bf16_f32 v152, v128, v129
    v_mfma_f32_32x32x16_bf16 v[112:127], a[228:231], v[44:47], v[112:127]
    buffer_load_dwordx4 a[176:179], v1, s[4:7], s38 offen offset:0
    buffer_load_dwordx4 a[180:183], v1, s[4:7], s38 offen offset:1024
    ds_read_b128 v[52:55], v9 offset:9216
    v_exp_f32 v132, v132
    v_exp_f32 v133, v133
    v_exp_f32 v134, v134
    v_exp_f32 v135, v135
    v_cvt_pk_bf16_f32 v153, v130, v131
    v_cvt_pk_bf16_f32 v154, v132, v133
    v_mfma_f32_32x32x16_bf16 v[96:111], a[200:203], v[144:147], v[96:111]
    ds_read_b128 v[56:59], v9 offset:10240
    v_exp_f32 v136, v136
    v_exp_f32 v137, v137
    v_exp_f32 v138, v138
    v_exp_f32 v139, v139
    v_cvt_pk_bf16_f32 v155, v134, v135
    v_cvt_pk_bf16_f32 v156, v136, v137
    v_mfma_f32_32x32x16_bf16 v[96:111], a[204:207], v[148:151], v[96:111]
    buffer_load_dwordx4 a[184:187], v1, s[4:7], s38 offen offset:2048
    ds_read_b128 v[60:63], v9 offset:11264
    v_exp_f32 v140, v140
    v_exp_f32 v141, v141
    v_exp_f32 v142, v142
    v_exp_f32 v143, v143
    v_cvt_pk_bf16_f32 v157, v138, v139
    v_cvt_pk_bf16_f32 v158, v140, v141
    v_cvt_pk_bf16_f32 v159, v142, v143
    v_mfma_f32_32x32x16_bf16 v[128:143], a[240:243], v[40:43], 0
    s_waitcnt lgkmcnt(3)
    s_add_u32 s37, s46, 49152
    v_add_f32 v64, v64, v48
    v_add_f32 v65, v65, v49
    v_exp_f32 v112, v112
    v_exp_f32 v113, v113
    v_exp_f32 v114, v114
    v_exp_f32 v115, v115
    v_cvt_pk_bf16_f32 v144, v112, v113
    v_mfma_f32_32x32x16_bf16 v[128:143], a[244:247], v[44:47], v[128:143]
    buffer_load_dwordx4 a[188:191], v1, s[4:7], s38 offen offset:3072
    buffer_load_dwordx4 a[192:195], v1, s[4:7], s37 offen offset:0
    v_add_f32 v66, v66, v50
    v_add_f32 v67, v67, v51
    v_exp_f32 v116, v116
    v_exp_f32 v117, v117
    v_exp_f32 v118, v118
    v_exp_f32 v119, v119
    v_cvt_pk_bf16_f32 v145, v114, v115
    v_cvt_pk_bf16_f32 v146, v116, v117
    v_mfma_f32_32x32x16_bf16 v[96:111], a[216:219], v[152:155], v[96:111]
    s_waitcnt lgkmcnt(2)
    s_add_u32 s38, s46, 53248
    v_add_f32 v68, v68, v52
    v_add_f32 v69, v69, v53
    v_exp_f32 v120, v120
    v_exp_f32 v121, v121
    v_exp_f32 v122, v122
    v_exp_f32 v123, v123
    v_cvt_pk_bf16_f32 v147, v118, v119
    v_cvt_pk_bf16_f32 v148, v120, v121
    v_mfma_f32_32x32x16_bf16 v[96:111], a[220:223], v[156:159], v[96:111]
    s_waitcnt lgkmcnt(1)
    buffer_load_dwordx4 a[196:199], v1, s[4:7], s37 offen offset:1024
    v_add_f32 v70, v70, v54
    v_add_f32 v71, v71, v55
    v_exp_f32 v124, v124
    v_exp_f32 v125, v125
    v_exp_f32 v126, v126
    v_exp_f32 v127, v127
    v_cvt_pk_bf16_f32 v149, v122, v123
    v_cvt_pk_bf16_f32 v150, v124, v125
    v_cvt_pk_bf16_f32 v151, v126, v127
    v_add_f32 v72, v72, v56
    v_add_f32 v73, v73, v57
    v_exp_f32 v128, v128
    v_exp_f32 v129, v129
    v_exp_f32 v130, v130
    v_exp_f32 v131, v131
    v_cvt_pk_bf16_f32 v152, v128, v129
    buffer_load_dwordx4 a[200:203], v1, s[4:7], s37 offen offset:2048
    buffer_load_dwordx4 a[204:207], v1, s[4:7], s37 offen offset:3072
    v_add_f32 v74, v74, v58
    v_add_f32 v75, v75, v59
    v_exp_f32 v132, v132
    v_exp_f32 v133, v133
    v_exp_f32 v134, v134
    v_exp_f32 v135, v135
    v_cvt_pk_bf16_f32 v153, v130, v131
    v_cvt_pk_bf16_f32 v154, v132, v133
    v_mfma_f32_32x32x16_bf16 v[96:111], a[232:235], v[144:147], v[96:111]
    s_waitcnt lgkmcnt(0)
    v_add_f32 v76, v76, v60
    v_add_f32 v77, v77, v61
    v_exp_f32 v136, v136
    v_exp_f32 v137, v137
    v_exp_f32 v138, v138
    v_exp_f32 v139, v139
    v_cvt_pk_bf16_f32 v155, v134, v135
    v_cvt_pk_bf16_f32 v156, v136, v137
    v_mfma_f32_32x32x16_bf16 v[96:111], a[236:239], v[148:151], v[96:111]
    buffer_load_dwordx4 a[208:211], v1, s[4:7], s38 offen offset:0
    v_add_f32 v78, v78, v62
    v_add_f32 v79, v79, v63
    v_exp_f32 v140, v140
    v_exp_f32 v141, v141
    v_exp_f32 v142, v142
    v_exp_f32 v143, v143
    v_cvt_pk_bf16_f32 v157, v138, v139
    v_cvt_pk_bf16_f32 v158, v140, v141
    v_cvt_pk_bf16_f32 v159, v142, v143
    v_mfma_f32_32x32x16_bf16 v[96:111], a[248:251], v[152:155], v[96:111]
    s_nop 0
    v_mfma_f32_32x32x16_bf16 v[96:111], a[252:255], v[156:159], v[96:111]
La_after:
    v_mov_b32 v4, 0x21800000
    v_mov_b32 v5, 0x5d800000
    v_and_b32 v180, 3, v0
    v_mul_u32_u24 v180, 12288, v180
    v_add_u32 v180, 122880, v180
    s_nop 6
    v_pk_add_f32 v[108:109], v[108:109], v[76:77]
    v_pk_add_f32 v[96:97], v[96:97], v[64:65]
    v_mov_b32 v12, v108
    v_mov_b32 v13, v108
    v_pk_add_f32 v[98:99], v[98:99], v[66:67]
    v_pk_add_f32 v[100:101], v[100:101], v[68:69]
    v_permlane32_swap_b32 v12, v13
    v_pk_add_f32 v[102:103], v[102:103], v[70:71]
    v_rcp_f32 v14, v13
    v_pk_add_f32 v[104:105], v[104:105], v[72:73]
    v_pk_add_f32 v[106:107], v[106:107], v[74:75]
    v_pk_add_f32 v[110:111], v[110:111], v[78:79]
    v_pk_mul_f32 v[112:113], v[96:97], 0 op_sel_hi:[1,0]
    v_pk_mul_f32 v[114:115], v[98:99], 0 op_sel_hi:[1,0]
    v_pk_fma_f32 v[112:113], v[100:101], 0, v[112:113] op_sel_hi:[1,0,1]
    v_pk_fma_f32 v[114:115], v[102:103], 0, v[114:115] op_sel_hi:[1,0,1]
    v_pk_fma_f32 v[112:113], v[104:105], 0, v[112:113] op_sel_hi:[1,0,1]
    v_pk_fma_f32 v[114:115], v[106:107], 0, v[114:115] op_sel_hi:[1,0,1]
    v_pk_fma_f32 v[112:113], v[108:109], 0, v[112:113] op_sel_hi:[1,0,1]
    v_pk_fma_f32 v[114:115], v[110:111], 0, v[114:115] op_sel_hi:[1,0,1]
    v_pk_add_f32 v[112:113], v[112:113], v[114:115]
    v_add_f32 v4, v4, v112
    v_add_f32 v5, v5, v113
    v_cmp_nge_f32 vcc, v13, v4
    v_cmp_nle_f32 s[28:29], v13, v5
    v_pk_mul_f32 v[104:105], v[104:105], v[14:15] op_sel_hi:[1,0]
    v_pk_mul_f32 v[106:107], v[106:107], v[14:15] op_sel_hi:[1,0]
    v_pk_mul_f32 v[108:109], v[108:109], v[14:15] op_sel_hi:[1,0]
    v_pk_mul_f32 v[110:111], v[110:111], v[14:15] op_sel_hi:[1,0]
    s_or_b64 vcc, vcc, s[28:29]
    s_cselect_b32 s28, 1, 0
    s_andn2_b32 s28, s28, s54
    s_cselect_b32 s101, 0x7ff00000, s53
    s_cselect_b32 s53, s53, 0x7ff00000
    v_cvt_pk_bf16_f32 v148, v104, v105
    v_cvt_pk_bf16_f32 v149, v106, v107
    v_cvt_pk_bf16_f32 v150, v108, v109
    v_cvt_pk_bf16_f32 v151, v110, v111
    s_mov_b32 exec_lo, 0
    buffer_store_dwordx2 v[148:149], v11, s[4:7], s101 offen sc1
    s_mov_b32 exec_lo, -1
    s_mov_b32 exec_hi, 0
    buffer_store_dwordx4 v[148:151], v11, s[4:7], s101 offen sc1
    s_mov_b32 exec_hi, -1
    v_pk_mul_f32 v[96:97], v[96:97], v[14:15] op_sel_hi:[1,0]
    v_pk_mul_f32 v[98:99], v[98:99], v[14:15] op_sel_hi:[1,0]
    v_pk_mul_f32 v[100:101], v[100:101], v[14:15] op_sel_hi:[1,0]
    v_pk_mul_f32 v[102:103], v[102:103], v[14:15] op_sel_hi:[1,0]
    v_cvt_pk_bf16_f32 v144, v96, v97
    v_cvt_pk_bf16_f32 v145, v98, v99
    v_cvt_pk_bf16_f32 v146, v100, v101
    v_cvt_pk_bf16_f32 v147, v102, v103
    buffer_store_dwordx4 v[144:147], v10, s[4:7], s101 offen sc1
    s_or_b32 s28, s28, s60
    v_mov_b32 v13, s28
    ds_write_b32 v9, v13 offset:8192
    s_waitcnt vmcnt(41)
    s_waitcnt lgkmcnt(0)
    s_barrier
    ds_read_b32 v12, v180
    s_waitcnt lgkmcnt(0)
    v_cmp_lt_u32 s[28:29], 1, v12
    v_and_b32 v12, 1, v12
    v_cmp_ne_u32 vcc, 0, v12
    s_and_b32 s61, s28, 15
    s_cbranch_vccnz La_slow
    s_cmp_eq_u32 s15, 7
    s_cbranch_scc1 Lc_spare
    s_mul_i32 s29, s18, 22147072
    s_add_u32 s29, s29, 9920512
    s_mul_i32 s28, s17, 16128
    s_add_u32 s40, s29, s28
    s_add_u32 s42, s40, 2064384
    s_mul_i32 s35, s13, 32256
    s_add_u32 s41, s40, s35
    s_add_u32 s41, s41, 4128768
    s_mul_i32 s35, s16, 229376
    s_lshl_b32 s36, s12, 13
    s_add_u32 s35, s35, s36
    s_add_u32 s44, s35, 16371712
    s_mov_b32 s43, 7856128
    s_lshl_b32 s58, s12, 12
    s_sub_u32 s58, s32, s58
    s_add_u32 s58, s58, 32768
    s_add_u32 s59, s100, 8192
    s_mul_i32 s56, s12, 6144
    s_sub_u32 s56, s32, s56
    s_add_u32 s56, s56, 49152
    s_lshl_b32 s57, s12, 11
    s_add_u32 s57, s57, 57344
    s_add_u32 s29, s41, 16128
    s_lshr_b32 s36, s15, 0
    s_add_u32 s48, s36, 0
    s_cmp_ge_u32 s48, 6
    s_cselect_b32 s99, 6, 0
    s_sub_u32 s48, s48, s99
    s_mul_i32 s48, s48, 2304
    s_add_u32 s48, s48, s29
    s_add_u32 s49, s36, 1
    s_cmp_ge_u32 s49, 6
    s_cselect_b32 s99, 6, 0
    s_sub_u32 s49, s49, s99
    s_mul_i32 s49, s49, 2304
    s_add_u32 s49, s49, s29
    s_add_u32 s50, s36, 2
    s_cmp_ge_u32 s50, 6
    s_cselect_b32 s99, 6, 0
    s_sub_u32 s50, s50, s99
    s_mul_i32 s50, s50, 2304
    s_add_u32 s50, s50, s29
    s_add_u32 s51, s36, 3
    s_cmp_ge_u32 s51, 6
    s_cselect_b32 s99, 6, 0
    s_sub_u32 s51, s51, s99
    s_mul_i32 s51, s51, 2304
    s_add_u32 s51, s51, s29
    s_add_u32 s52, s36, 4
    s_cmp_ge_u32 s52, 6
    s_cselect_b32 s99, 6, 0
    s_sub_u32 s52, s52, s99
    s_mul_i32 s52, s52, 2304
    s_add_u32 s52, s52, s29
    s_add_u32 s53, s36, 5
    s_cmp_ge_u32 s53, 6
    s_cselect_b32 s99, 6, 0
    s_sub_u32 s53, s53, s99
    s_mul_i32 s53, s53, 2304
    s_add_u32 s53, s53, s29
    s_add_u32 s54, s29, 13824
    s_add_u32 s40, s28, 7856128
    s_mov_b32 s42, s40
    s_lshl_b32 s62, s17, 6
    s_add_u32 s62, s62, s45
    s_lshl_b32 s35, s15, 2
    s_add_u32 s63, s62, s35
    s_lshl_b32 s64, s17, 7
    s_add_u32 s64, s64, s45
    s_add_u32 s64, s64, 32768
    s_add_u32 s65, s64, s35
    v_min_u32 v3, 6, v0
    v_lshlrev_b32 v3, 2, v3
    v_and_b32 v10, 3, v0
    v_mul_u32_u24 v10, 8192, v10
    buffer_load_dword v112, v10, s[4:7], s62 offen
    buffer_load_dword v113, off, s[4:7], s64
    buffer_load_dwordx4 a[212:215], v1, s[4:7], s38 offen offset:1024
    buffer_load_dwordx4 a[216:219], v1, s[4:7], s38 offen offset:2048
    buffer_load_dwordx4 a[220:223], v1, s[4:7], s38 offen offset:3072
    s_add_u32 s37, s47, 0
    buffer_load_dwordx4 a[224:227], v1, s[4:7], s37 offen offset:0
    buffer_load_dwordx4 a[228:231], v1, s[4:7], s37 offen offset:1024
    buffer_load_dwordx4 a[232:235], v1, s[4:7], s37 offen offset:2048
    buffer_load_dwordx4 a[236:239], v1, s[4:7], s37 offen offset:3072
    s_add_u32 s38, s47, 4096
    buffer_load_dwordx4 a[240:243], v1, s[4:7], s38 offen offset:0
    s_mov_b32 s101, 0x7ff00000
    v_lshrrev_b32 v114, 4, v0
    v_and_b32 v115, 15, v0
    v_lshlrev_b32 v115, 3, v115
    v_lshl_add_u32 v114, v114, 8, v115
    v_add_u32 v13, 57344, v1
    v_pk_mul_f32 v[16:17], v[160:161], 1.0 op_sel_hi:[1,0]
    v_pk_mul_f32 v[18:19], v[162:163], 1.0 op_sel_hi:[1,0]
    v_pk_mul_f32 v[20:21], v[164:165], 1.0 op_sel_hi:[1,0]
    v_pk_mul_f32 v[22:23], v[166:167], 1.0 op_sel_hi:[1,0]
    v_pk_mul_f32 v[24:25], v[168:169], 1.0 op_sel_hi:[1,0]
    v_pk_mul_f32 v[26:27], v[170:171], 1.0 op_sel_hi:[1,0]
    v_pk_mul_f32 v[28:29], v[172:173], 1.0 op_sel_hi:[1,0]
    v_pk_mul_f32 v[30:31], v[174:175], 1.0 op_sel_hi:[1,0]
    ds_read_b128 v[128:131], v13 offset:0
    ds_read_b128 v[132:135], v13 offset:1024
    ds_read_b128 v[136:139], v13 offset:2048
    ds_read_b128 v[140:143], v13 offset:3072
    ds_read_b128 v[144:147], v13 offset:4096
    ds_read_b128 v[148:151], v13 offset:5120
    ds_read_b128 v[152:155], v13 offset:6144
    ds_read_b128 v[156:159], v13 offset:7168
    ds_read_b128 v[160:163], v13 offset:8192
    ds_read_b128 v[164:167], v13 offset:9216
    ds_read_b128 v[168:171], v13 offset:10240
    ds_read_b128 v[172:175], v13 offset:11264
    ds_read_b128 v[176:179], v13 offset:12288
    s_waitcnt vmcnt(45)
    ds_read_b128 v[180:183], v13 offset:13312
    ds_read_b128 v[184:187], v13 offset:14336
    ds_read_b128 v[188:191], v13 offset:15360
    buffer_load_dwordx4 v[56:59], v1, s[4:7], s48 offen offset:0 sc1
    buffer_load_dwordx4 v[60:63], v1, s[4:7], s48 offen offset:1024 sc1
    buffer_load_dwordx4 v[64:67], v1, s[4:7], s49 offen offset:0 sc1
    buffer_load_dwordx4 v[68:71], v1, s[4:7], s49 offen offset:1024 sc1
    buffer_load_dwordx4 v[72:75], v1, s[4:7], s50 offen offset:0 sc1
    buffer_load_dwordx4 v[76:79], v1, s[4:7], s50 offen offset:1024 sc1
    buffer_load_dwordx4 v[80:83], v1, s[4:7], s51 offen offset:0 sc1
    s_and_b32 s35, s17, 15
    s_cmp_eq_u32 s35, 0
    s_cselect_b32 s28, 0, -1
    s_cselect_b32 s55, 0, 3
    s_cmp_eq_u32 s35, 15
    s_cselect_b32 s28, 2, s28
    s_cselect_b32 s36, 32256, 0
    v_lshrrev_b32 v2, 5, v0
    v_mul_u32_u24 v2, 4608, v2
    v_and_b32 v10, 15, v0
    v_lshl_add_u32 v2, v10, 4, v2
    s_lshr_b32 s99, s15, 2
    s_mul_i32 s99, s99, 2288
    v_add_u32 v2, s99, v2
    v_lshl_add_u32 v2, s15, 2, v2
    v_and_b32 v10, 15, v0
    v_lshrrev_b32 v11, 4, v0
    v_add_u32 v12, 15, v10
    v_lshrrev_b32 v4, 4, v12
    v_cmp_eq_u32 vcc, s28, v4
    v_mul_u32_u24 v4, 16128, v4
    v_and_b32 v8, 1, v12
    v_lshl_add_u32 v8, v11, 1, v8
    v_and_b32 v12, 15, v12
    v_lshl_add_u32 v12, v11, 4, v12
    v_cndmask_b32 v12, v12, v8, vcc
    v_lshl_add_u32 v4, v12, 4, v4
    v_add_u32 v12, 17, v10
    v_lshrrev_b32 v5, 4, v12
    v_cmp_eq_u32 vcc, s28, v5
    v_mul_u32_u24 v5, 16128, v5
    v_and_b32 v8, 1, v12
    v_lshl_add_u32 v8, v11, 1, v8
    v_and_b32 v12, 15, v12
    v_lshl_add_u32 v12, v11, 4, v12
    v_cndmask_b32 v12, v12, v8, vcc
    v_lshl_add_u32 v5, v12, 4, v5
    v_add_u32 v12, 14, v10
    v_lshrrev_b32 v6, 4, v12
    v_cmp_eq_u32 vcc, s28, v6
    v_mul_u32_u24 v6, 16128, v6
    v_and_b32 v8, 1, v12
    v_lshl_add_u32 v8, v11, 1, v8
    v_and_b32 v12, 15, v12
    v_lshl_add_u32 v12, v11, 4, v12
    v_cndmask_b32 v12, v12, v8, vcc
    v_lshl_add_u32 v6, v12, 4, v6
    v_add_u32 v12, 18, v10
    v_lshrrev_b32 v7, 4, v12
    v_cmp_eq_u32 vcc, s28, v7
    v_mul_u32_u24 v7, 16128, v7
    v_and_b32 v8, 1, v12
    v_lshl_add_u32 v8, v11, 1, v8
    v_and_b32 v12, 15, v12
    v_lshl_add_u32 v12, v11, 4, v12
    v_cndmask_b32 v12, v12, v8, vcc
    v_lshl_add_u32 v7, v12, 4, v7
    v_mov_b32 v8, v4
    v_mov_b32 v9, v6
    s_mov_b32 exec_lo, 0
    v_mov_b32 v8, v5
    v_mov_b32 v9, v7
    s_mov_b32 exec_lo, -1
    v_bfe_u32 v10, v0, 3, 2
    v_min_u32 v10, 2, v10
    v_add_u32 v10, s35, v10
    v_med3_u32 v10, v10, 1, 16
    v_subrev_u32 v10, s35, v10
    v_and_b32 v11, 7, v0
    v_min_u32 v11, 6, v11
    v_lshlrev_b32 v11, 2, v11
    v_lshl_add_u32 v14, v10, 6, v11
    v_lshrrev_b32 v11, 5, v0
    v_mul_u32_u24 v11, 3, v11
    v_lshrrev_b32 v10, 3, v0
    v_add3_u32 v11, v11, v10, s55
    v_lshrrev_b32 v12, 1, v11
    v_mul_u32_u24 v12, 2304, v12
    v_and_b32 v11, 1, v11
    v_lshl_add_u32 v12, v11, 10, v12
    v_and_b32 v10, 7, v0
    v_lshl_add_u32 v12, v10, 4, v12
    v_add_u32 v12, s36, v12
    v_lshrrev_b32 v11, 4, v0
    v_and_b32 v10, 1, v0
    v_lshl_add_u32 v11, v11, 1, v10
    v_lshlrev_b32 v11, 4, v11
    s_waitcnt vmcnt(6)
    v_max3_u32 v116, v56, v58, v59
    v_cmp_eq_u32 vcc, -1, v116
    s_nop 0
    s_cbranch_vccnz Lo_late0
Lo_back0:
    s_waitcnt lgkmcnt(12)
    v_mfma_f32_16x16x32_bf16 v[16:19], v[128:131], v[56:59], v[16:19]
    buffer_load_dwordx4 v[84:87], v1, s[4:7], s51 offen offset:1024 sc1
    ds_read_b128 v[128:131], v13 offset:16384
    v_mfma_f32_16x16x32_bf16 v[20:23], v[132:135], v[56:59], v[20:23]
    ds_read_b128 v[132:135], v13 offset:17408
    s_waitcnt vmcnt(6)
    v_max3_u32 v116, v60, v62, v63
    v_mfma_f32_16x16x32_bf16 v[24:27], v[136:139], v[56:59], v[24:27]
    ds_read_b128 v[136:139], v13 offset:18432
    v_cmp_eq_u32 vcc, -1, v116
    v_mfma_f32_16x16x32_bf16 v[28:31], v[140:143], v[56:59], v[28:31]
    ds_read_b128 v[140:143], v13 offset:19456
    s_cbranch_vccnz Lo_late1
Lo_back1:
    s_waitcnt lgkmcnt(12)
    v_mfma_f32_16x16x32_bf16 v[16:19], v[144:147], v[60:63], v[16:19]
    buffer_load_dwordx4 v[88:91], v1, s[4:7], s52 offen offset:0 sc1
    ds_read_b128 v[144:147], v13 offset:20480
    v_mfma_f32_16x16x32_bf16 v[20:23], v[148:151], v[60:63], v[20:23]
    ds_read_b128 v[148:151], v13 offset:21504
    s_waitcnt vmcnt(6)
    v_max3_u32 v116, v64, v66, v67
    v_mfma_f32_16x16x32_bf16 v[24:27], v[152:155], v[60:63], v[24:27]
    ds_read_b128 v[152:155], v13 offset:22528
    v_cmp_eq_u32 vcc, -1, v116
    v_mfma_f32_16x16x32_bf16 v[28:31], v[156:159], v[60:63], v[28:31]
    ds_read_b128 v[156:159], v13 offset:23552
    s_cbranch_vccnz Lo_late2
Lo_back2:
    s_waitcnt lgkmcnt(12)
    v_mfma_f32_16x16x32_bf16 v[16:19], v[160:163], v[64:67], v[16:19]
    buffer_load_dwordx4 v[92:95], v1, s[4:7], s52 offen offset:1024 sc1
    ds_read_b128 v[160:163], v13 offset:24576
    v_mfma_f32_16x16x32_bf16 v[20:23], v[164:167], v[64:67], v[20:23]
    ds_read_b128 v[164:167], v13 offset:25600
    s_waitcnt vmcnt(6)
    v_max3_u32 v116, v68, v70, v71
    v_mfma_f32_16x16x32_bf16 v[24:27], v[168:171], v[64:67], v[24:27]
    ds_read_b128 v[168:171], v13 offset:26624
    v_cmp_eq_u32 vcc, -1, v116
    v_mfma_f32_16x16x32_bf16 v[28:31], v[172:175], v[64:67], v[28:31]
    ds_read_b128 v[172:175], v13 offset:27648
    s_cbranch_vccnz Lo_late3
Lo_back3:
    s_waitcnt lgkmcnt(12)
    v_mfma_f32_16x16x32_bf16 v[16:19], v[176:179], v[68:71], v[16:19]
    buffer_load_dwordx4 v[96:99], v1, s[4:7], s53 offen offset:0 sc1
    ds_read_b128 v[176:179], v13 offset:28672
    v_mfma_f32_16x16x32_bf16 v[20:23], v[180:183], v[68:71], v[20:23]
    ds_read_b128 v[180:183], v13 offset:29696
    s_waitcnt vmcnt(6)
    v_max3_u32 v116, v72, v74, v75
    v_mfma_f32_16x16x32_bf16 v[24:27], v[184:187], v[68:71], v[24:27]
    ds_read_b128 v[184:187], v13 offset:30720
    v_cmp_eq_u32 vcc, -1, v116
    v_mfma_f32_16x16x32_bf16 v[28:31], v[188:191], v[68:71], v[28:31]
    ds_read_b128 v[188:191], v13 offset:31744
    s_cbranch_vccnz Lo_late4
Lo_back4:
    s_waitcnt lgkmcnt(12)
    v_mfma_f32_16x16x32_bf16 v[16:19], v[128:131], v[72:75], v[16:19]
    buffer_load_dwordx4 v[100:103], v1, s[4:7], s53 offen offset:1024 sc1
    ds_read_b128 v[128:131], v13 offset:32768
    v_mfma_f32_16x16x32_bf16 v[20:23], v[132:135], v[72:75], v[20:23]
    ds_read_b128 v[132:135], v13 offset:33792
    s_waitcnt vmcnt(6)
    v_max3_u32 v116, v76, v78, v79
    v_mfma_f32_16x16x32_bf16 v[24:27], v[136:139], v[72:75], v[24:27]
    ds_read_b128 v[136:139], v13 offset:34816
    v_cmp_eq_u32 vcc, -1, v116
    v_mfma_f32_16x16x32_bf16 v[28:31], v[140:143], v[72:75], v[28:31]
    ds_read_b128 v[140:143], v13 offset:35840
    s_cbranch_vccnz Lo_late5
Lo_back5:
    s_waitcnt lgkmcnt(12)
    v_mfma_f32_16x16x32_bf16 v[16:19], v[144:147], v[76:79], v[16:19]
    buffer_load_dwordx2 v[104:105], v114, s[4:7], s54 offen offset:0 sc1
    buffer_load_dwordx2 v[106:107], v114, s[4:7], s54 offen offset:128 sc1
    ds_read_b128 v[144:147], v13 offset:36864
    v_mfma_f32_16x16x32_bf16 v[20:23], v[148:151], v[76:79], v[20:23]
    ds_read_b128 v[148:151], v13 offset:37888
    s_waitcnt vmcnt(7)
    v_max3_u32 v116, v80, v82, v83
    v_mfma_f32_16x16x32_bf16 v[24:27], v[152:155], v[76:79], v[24:27]
    ds_read_b128 v[152:155], v13 offset:38912
    v_cmp_eq_u32 vcc, -1, v116
    v_mfma_f32_16x16x32_bf16 v[28:31], v[156:159], v[76:79], v[28:31]
    ds_read_b128 v[156:159], v13 offset:39936
    s_cbranch_vccnz Lo_late6
Lo_back6:
    s_waitcnt lgkmcnt(12)
    v_mfma_f32_16x16x32_bf16 v[16:19], v[160:163], v[80:83], v[16:19]
    buffer_load_dwordx2 v[108:109], v114, s[4:7], s54 offen offset:1024 sc1
    buffer_load_dwordx2 v[110:111], v114, s[4:7], s54 offen offset:1152 sc1
    ds_read_b128 v[160:163], v13 offset:40960
    v_mfma_f32_16x16x32_bf16 v[20:23], v[164:167], v[80:83], v[20:23]
    ds_read_b128 v[164:167], v13 offset:41984
    s_waitcnt vmcnt(8)
    v_max3_u32 v116, v84, v86, v87
    v_mfma_f32_16x16x32_bf16 v[24:27], v[168:171], v[80:83], v[24:27]
    ds_read_b128 v[168:171], v13 offset:43008
    v_cmp_eq_u32 vcc, -1, v116
    v_mfma_f32_16x16x32_bf16 v[28:31], v[172:175], v[80:83], v[28:31]
    ds_read_b128 v[172:175], v13 offset:44032
    s_cbranch_vccnz Lo_late7
Lo_back7:
    s_barrier
    s_waitcnt lgkmcnt(12)
    v_mfma_f32_16x16x32_bf16 v[16:19], v[176:179], v[84:87], v[16:19]
    s_add_u32 m0, s59, 0
    s_add_u32 s38, s58, 0
    buffer_load_dwordx4 v1, s[4:7], s38 offen offset:0 lds
    buffer_load_dwordx4 v1, s[4:7], s38 offen offset:1024 lds
    ds_read_b128 v[176:179], v13 offset:45056
    v_mfma_f32_16x16x32_bf16 v[20:23], v[180:183], v[84:87], v[20:23]
    ds_read_b128 v[180:183], v13 offset:46080
    s_waitcnt vmcnt(9)
    v_max3_u32 v116, v88, v90, v91
    v_mfma_f32_16x16x32_bf16 v[24:27], v[184:187], v[84:87], v[24:27]
    ds_read_b128 v[184:187], v13 offset:47104
    v_cmp_eq_u32 vcc, -1, v116
    v_mfma_f32_16x16x32_bf16 v[28:31], v[188:191], v[84:87], v[28:31]
    ds_read_b128 v[188:191], v13 offset:48128
    s_cbranch_vccnz Lo_late8
Lo_back8:
    s_waitcnt lgkmcnt(12)
    v_mfma_f32_16x16x32_bf16 v[16:19], v[128:131], v[88:91], v[16:19]
    buffer_load_dwordx4 v1, s[4:7], s38 offen offset:2048 lds
    buffer_load_dwordx4 v1, s[4:7], s38 offen offset:3072 lds
    ds_read_b128 v[128:131], v13 offset:49152
    v_mfma_f32_16x16x32_bf16 v[20:23], v[132:135], v[88:91], v[20:23]
    ds_read_b128 v[132:135], v13 offset:50176
    s_waitcnt vmcnt(10)
    v_max3_u32 v116, v92, v94, v95
    v_mfma_f32_16x16x32_bf16 v[24:27], v[136:139], v[88:91], v[24:27]
    ds_read_b128 v[136:139], v13 offset:51200
    v_cmp_eq_u32 vcc, -1, v116
    v_mfma_f32_16x16x32_bf16 v[28:31], v[140:143], v[88:91], v[28:31]
    ds_read_b128 v[140:143], v13 offset:52224
    s_cbranch_vccnz Lo_late9
Lo_back9:
    s_waitcnt lgkmcnt(12)
    v_mfma_f32_16x16x32_bf16 v[16:19], v[144:147], v[92:95], v[16:19]
    s_add_u32 m0, s57, 0
    s_add_u32 s38, s56, 0
    buffer_load_dwordx4 v1, s[4:7], s38 offen offset:0 lds
    buffer_load_dwordx4 v1, s[4:7], s38 offen offset:1024 lds
    ds_read_b128 v[144:147], v13 offset:53248
    v_mfma_f32_16x16x32_bf16 v[20:23], v[148:151], v[92:95], v[20:23]
    ds_read_b128 v[148:151], v13 offset:54272
    s_waitcnt vmcnt(11)
    v_max3_u32 v116, v96, v98, v99
    v_mfma_f32_16x16x32_bf16 v[24:27], v[152:155], v[92:95], v[24:27]
    ds_read_b128 v[152:155], v13 offset:55296
    v_cmp_eq_u32 vcc, -1, v116
    v_mfma_f32_16x16x32_bf16 v[28:31], v[156:159], v[92:95], v[28:31]
    ds_read_b128 v[156:159], v13 offset:56320
    s_cbranch_vccnz Lo_late10
Lo_back10:
    s_waitcnt lgkmcnt(12)
    v_mfma_f32_16x16x32_bf16 v[16:19], v[160:163], v[96:99], v[16:19]
    s_add_u32 s38, s47, 4096
    buffer_load_dwordx4 a[244:247], v1, s[4:7], s38 offen offset:1024
    buffer_load_dwordx4 a[248:251], v1, s[4:7], s38 offen offset:2048
    v_mfma_f32_16x16x32_bf16 v[20:23], v[164:167], v[96:99], v[20:23]
    s_waitcnt vmcnt(12)
    v_max3_u32 v116, v100, v102, v103
    v_cmp_eq_u32 vcc, -1, v116
    v_mfma_f32_16x16x32_bf16 v[24:27], v[168:171], v[96:99], v[24:27]
    v_mfma_f32_16x16x32_bf16 v[28:31], v[172:175], v[96:99], v[28:31]
    s_cbranch_vccnz Lo_late11
Lo_back11:
    s_waitcnt lgkmcnt(8)
    v_mfma_f32_16x16x32_bf16 v[16:19], v[176:179], v[100:103], v[16:19]
    buffer_load_dwordx4 a[252:255], v1, s[4:7], s38 offen offset:3072
    v_mfma_f32_16x16x32_bf16 v[20:23], v[180:183], v[100:103], v[20:23]
    s_waitcnt vmcnt(11)
    v_max3_u32 v116, v104, v106, v107
    v_cmp_eq_u32 vcc, -1, v116
    v_mfma_f32_16x16x32_bf16 v[24:27], v[184:187], v[100:103], v[24:27]
    v_mfma_f32_16x16x32_bf16 v[28:31], v[188:191], v[100:103], v[28:31]
    s_cbranch_vccnz Lo_late12
Lo_back12:
    s_waitcnt lgkmcnt(4)
    v_mfma_f32_16x16x32_bf16 v[16:19], v[128:131], v[104:107], v[16:19]
    v_mfma_f32_16x16x32_bf16 v[20:23], v[132:135], v[104:107], v[20:23]
    s_waitcnt vmcnt(9)
    v_max3_u32 v116, v108, v110, v111
    v_cmp_eq_u32 vcc, -1, v116
    v_mfma_f32_16x16x32_bf16 v[24:27], v[136:139], v[104:107], v[24:27]
    v_mfma_f32_16x16x32_bf16 v[28:31], v[140:143], v[104:107], v[28:31]
    s_cbranch_vccnz Lo_late13
Lo_back13:
    s_waitcnt lgkmcnt(0)
    v_mfma_f32_16x16x32_bf16 v[16:19], v[144:147], v[108:111], v[16:19]
    v_mfma_f32_16x16x32_bf16 v[20:23], v[148:151], v[108:111], v[20:23]
    v_mfma_f32_16x16x32_bf16 v[24:27], v[152:155], v[108:111], v[24:27]
    v_mfma_f32_16x16x32_bf16 v[28:31], v[156:159], v[108:111], v[28:31]
    s_cmp_lg_u32 s61, 0
    s_cbranch_scc1 Lc_slowbody
    s_add_u32 s29, s40, s20
    s_nop 1
    v_cvt_pk_bf16_f32 v48, v16, v17
    v_cvt_pk_bf16_f32 v49, v18, v19
    v_cvt_pk_bf16_f32 v50, v20, v21
    v_cvt_pk_bf16_f32 v51, v22, v23
    buffer_store_dwordx4 v[48:51], v1, s[4:7], s29 offen offset:0
    v_cvt_pk_bf16_f32 v52, v24, v25
    v_cvt_pk_bf16_f32 v53, v26, v27
    v_cvt_pk_bf16_f32 v54, v28, v29
    v_cvt_pk_bf16_f32 v55, v30, v31
    buffer_store_dwordx4 v[52:55], v1, s[4:7], s29 offen offset:1024
    v_pk_add_f32 v[112:113], v[16:17], v[18:19]
    v_pk_mul_f32 v[114:115], v[16:17], v[16:17]
    v_pk_add_f32 v[116:117], v[20:21], v[22:23]
    v_pk_mul_f32 v[118:119], v[18:19], v[18:19]
    v_pk_add_f32 v[112:113], v[112:113], v[24:25]
    v_pk_fma_f32 v[114:115], v[20:21], v[20:21], v[114:115]
    v_pk_add_f32 v[116:117], v[116:117], v[26:27]
    v_pk_fma_f32 v[118:119], v[22:23], v[22:23], v[118:119]
    v_pk_add_f32 v[112:113], v[112:113], v[28:29]
    v_pk_fma_f32 v[114:115], v[24:25], v[24:25], v[114:115]
    v_pk_add_f32 v[116:117], v[116:117], v[30:31]
    v_pk_fma_f32 v[118:119], v[26:27], v[26:27], v[118:119]
    v_pk_fma_f32 v[114:115], v[28:29], v[28:29], v[114:115]
    v_pk_fma_f32 v[118:119], v[30:31], v[30:31], v[118:119]
    v_pk_add_f32 v[112:113], v[112:113], v[116:117]
    v_pk_add_f32 v[114:115], v[114:115], v[118:119]
    v_add_f32 v112, v112, v113
    v_add_f32 v114, v114, v115
    s_nop 1
    v_permlane32_swap_b32 v112, v114
    v_add_f32 v112, v112, v114
    v_mov_b32 v113, v112
    s_nop 1
    v_permlane16_swap_b32 v112, v113
    s_mov_b32 exec_lo, 0xffff
    s_mov_b32 exec_hi, 0xffff
    v_add_f32 v112, v112, v113
    buffer_store_dword v112, v2, s[4:7], s40 offen offset:2048
    s_mov_b64 exec, -1
    ds_read_b128 v[128:131], v1 offset:0
    ds_read_b128 v[132:135], v1 offset:1024
    ds_read_b128 v[136:139], v1 offset:2048
    ds_read_b128 v[140:143], v1 offset:3072
    ds_read_b128 v[144:147], v1 offset:4096
    ds_read_b128 v[148:151], v1 offset:5120
    ds_read_b128 v[152:155], v1 offset:6144
    ds_read_b128 v[156:159], v1 offset:7168
    ds_read_b128 v[160:163], v1 offset:8192
    ds_read_b128 v[164:167], v1 offset:9216
    ds_read_b128 v[168:171], v1 offset:10240
    ds_read_b128 v[172:175], v1 offset:11264
    ds_read_b128 v[176:179], v1 offset:12288
    ds_read_b128 v[180:183], v1 offset:13312
    ds_read_b128 v[184:187], v1 offset:14336
    ds_read_b128 v[188:191], v1 offset:15360
    v_pk_mul_f32 v[32:33], v[16:17], 1.0 op_sel_hi:[1,0]
    v_pk_mul_f32 v[34:35], v[18:19], 1.0 op_sel_hi:[1,0]
    v_pk_mul_f32 v[36:37], v[20:21], 1.0 op_sel_hi:[1,0]
    v_pk_mul_f32 v[38:39], v[22:23], 1.0 op_sel_hi:[1,0]
    v_pk_mul_f32 v[40:41], v[24:25], 1.0 op_sel_hi:[1,0]
    v_pk_mul_f32 v[42:43], v[26:27], 1.0 op_sel_hi:[1,0]
    v_pk_mul_f32 v[44:45], v[28:29], 1.0 op_sel_hi:[1,0]
    v_pk_mul_f32 v[46:47], v[30:31], 1.0 op_sel_hi:[1,0]
    s_add_u32 s48, s40, s20
    s_add_u32 s49, s40, s21
    s_add_u32 s50, s40, s22
    s_add_u32 s51, s40, s23
    s_add_u32 s52, s40, s24
    s_add_u32 s53, s40, s25
    s_add_u32 s54, s40, s26
    v_lshrrev_b32 v116, 4, v0
    v_lshl_add_u32 v116, v116, 11, v1
    s_waitcnt vmcnt(0)
    s_mov_b64 exec, 1
    buffer_store_dword v15, off, s[4:7], s63 offset:0
    s_mov_b64 exec, -1
    buffer_load_dword v125, v3, s[4:7], s62 offen sc1
    s_waitcnt vmcnt(0)
    v_cmp_eq_u32 vcc, 0, v125
    s_nop 0
    s_cbranch_vccz Lpolld4
    s_mov_b32 s39, 0
Lpoll4:
    buffer_load_dword v125, v3, s[4:7], s62 offen sc1
    s_waitcnt vmcnt(0)
    v_cmp_eq_u32 vcc, 0, v125
    s_nop 0
    s_cbranch_vccz Lpolld4
    s_add_u32 s39, s39, 1
    s_cmp_lt_u32 s39, 200000
    s_cbranch_scc1 Lpoll4
Lpolld4:
    s_nop 0
    buffer_load_dwordx4 v[64:67], v1, s[4:7], s49 offen offset:0 sc1
    buffer_load_dwordx4 v[68:71], v1, s[4:7], s49 offen offset:1024 sc1
    buffer_load_dwordx4 v[72:75], v1, s[4:7], s50 offen offset:0 sc1
    buffer_load_dwordx4 v[76:79], v1, s[4:7], s50 offen offset:1024 sc1
    buffer_load_dwordx4 v[80:83], v1, s[4:7], s51 offen offset:0 sc1
    buffer_load_dwordx4 v[112:115], v116, s[4:7], s40 offen offset:2048 sc1
    s_waitcnt lgkmcnt(12)
    v_mfma_f32_16x16x32_bf16 v[16:19], v[128:131], v[48:51], 0
    ds_read_b128 v[128:131], v1 offset:16384
    v_mfma_f32_16x16x32_bf16 v[20:23], v[132:135], v[48:51], 0
    ds_read_b128 v[132:135], v1 offset:17408
    v_mfma_f32_16x16x32_bf16 v[24:27], v[136:139], v[48:51], 0
    ds_read_b128 v[136:139], v1 offset:18432
    v_mfma_f32_16x16x32_bf16 v[28:31], v[140:143], v[48:51], 0
    ds_read_b128 v[140:143], v1 offset:19456
    s_waitcnt lgkmcnt(12)
    v_mfma_f32_16x16x32_bf16 v[16:19], v[144:147], v[52:55], v[16:19]
    ds_read_b128 v[144:147], v1 offset:20480
    v_mfma_f32_16x16x32_bf16 v[20:23], v[148:151], v[52:55], v[20:23]
    ds_read_b128 v[148:151], v1 offset:21504
    v_mfma_f32_16x16x32_bf16 v[24:27], v[152:155], v[52:55], v[24:27]
    ds_read_b128 v[152:155], v1 offset:22528
    v_mfma_f32_16x16x32_bf16 v[28:31], v[156:159], v[52:55], v[28:31]
    ds_read_b128 v[156:159], v1 offset:23552
    s_waitcnt vmcnt(5) lgkmcnt(12)
    v_mfma_f32_16x16x32_bf16 v[16:19], v[160:163], v[64:67], v[16:19]
    buffer_load_dwordx4 v[84:87], v1, s[4:7], s51 offen offset:1024 sc1
    ds_read_b128 v[160:163], v1 offset:24576
    v_mfma_f32_16x16x32_bf16 v[20:23], v[164:167], v[64:67], v[20:23]
    ds_read_b128 v[164:167], v1 offset:25600
    v_mfma_f32_16x16x32_bf16 v[24:27], v[168:171], v[64:67], v[24:27]
    ds_read_b128 v[168:171], v1 offset:26624
    v_mfma_f32_16x16x32_bf16 v[28:31], v[172:175], v[64:67], v[28:31]
    ds_read_b128 v[172:175], v1 offset:27648
    s_waitcnt vmcnt(5) lgkmcnt(12)
    v_mfma_f32_16x16x32_bf16 v[16:19], v[176:179], v[68:71], v[16:19]
    buffer_load_dwordx4 v[88:91], v1, s[4:7], s52 offen offset:0 sc1
    ds_read_b128 v[176:179], v1 offset:28672
    v_mfma_f32_16x16x32_bf16 v[20:23], v[180:183], v[68:71], v[20:23]
    ds_read_b128 v[180:183], v1 offset:29696
    v_mfma_f32_16x16x32_bf16 v[24:27], v[184:187], v[68:71], v[24:27]
    ds_read_b128 v[184:187], v1 offset:30720
    v_mfma_f32_16x16x32_bf16 v[28:31], v[188:191], v[68:71], v[28:31]
    ds_read_b128 v[188:191], v1 offset:31744
    s_waitcnt vmcnt(5) lgkmcnt(12)
    v_mfma_f32_16x16x32_bf16 v[16:19], v[128:131], v[72:75], v[16:19]
    buffer_load_dwordx4 v[92:95], v1, s[4:7], s52 offen offset:1024 sc1
    ds_read_b128 v[128:131], v1 offset:32768
    v_mfma_f32_16x16x32_bf16 v[20:23], v[132:135], v[72:75], v[20:23]
    ds_read_b128 v[132:135], v1 offset:33792
    v_mfma_f32_16x16x32_bf16 v[24:27], v[136:139], v[72:75], v[24:27]
    ds_read_b128 v[136:139], v1 offset:34816
    v_mfma_f32_16x16x32_bf16 v[28:31], v[140:143], v[72:75], v[28:31]
    ds_read_b128 v[140:143], v1 offset:35840
    s_waitcnt vmcnt(5) lgkmcnt(12)
    v_mfma_f32_16x16x32_bf16 v[16:19], v[144:147], v[76:79], v[16:19]
    buffer_load_dwordx4 v[96:99], v1, s[4:7], s53 offen offset:0 sc1
    ds_read_b128 v[144:147], v1 offset:36864
    v_mfma_f32_16x16x32_bf16 v[20:23], v[148:151], v[76:79], v[20:23]
    ds_read_b128 v[148:151], v1 offset:37888
    v_mfma_f32_16x16x32_bf16 v[24:27], v[152:155], v[76:79], v[24:27]
    ds_read_b128 v[152:155], v1 offset:38912
    v_mfma_f32_16x16x32_bf16 v[28:31], v[156:159], v[76:79], v[28:31]
    ds_read_b128 v[156:159], v1 offset:39936
    s_waitcnt vmcnt(5) lgkmcnt(12)
    v_mfma_f32_16x16x32_bf16 v[16:19], v[160:163], v[80:83], v[16:19]
    buffer_load_dwordx4 v[100:103], v1, s[4:7], s53 offen offset:1024 sc1
    ds_read_b128 v[160:163], v1 offset:40960
    v_mfma_f32_16x16x32_bf16 v[20:23], v[164:167], v[80:83], v[20:23]
    ds_read_b128 v[164:167], v1 offset:41984
    v_mfma_f32_16x16x32_bf16 v[24:27], v[168:171], v[80:83], v[24:27]
    ds_read_b128 v[168:171], v1 offset:43008
    v_mfma_f32_16x16x32_bf16 v[28:31], v[172:175], v[80:83], v[28:31]
    ds_read_b128 v[172:175], v1 offset:44032
    s_waitcnt vmcnt(4) lgkmcnt(12)
    v_mfma_f32_16x16x32_bf16 v[16:19], v[176:179], v[84:87], v[16:19]
    buffer_load_dwordx4 v[104:107], v1, s[4:7], s54 offen offset:0 sc1
    ds_read_b128 v[176:179], v1 offset:45056
    v_mfma_f32_16x16x32_bf16 v[20:23], v[180:183], v[84:87], v[20:23]
    ds_read_b128 v[180:183], v1 offset:46080
    s_mov_b32 vcc_lo, 0xffff
    v_mfma_f32_16x16x32_bf16 v[24:27], v[184:187], v[84:87], v[24:27]
    ds_read_b128 v[184:187], v1 offset:47104
    s_mov_b32 vcc_hi, 0xffff
    v_mfma_f32_16x16x32_bf16 v[28:31], v[188:191], v[84:87], v[28:31]
    ds_read_b128 v[188:191], v1 offset:48128
    v_add_f32 v126, v112, v113
    s_waitcnt vmcnt(4) lgkmcnt(12)
    v_mfma_f32_16x16x32_bf16 v[16:19], v[128:131], v[88:91], v[16:19]
    buffer_load_dwordx4 v[108:111], v1, s[4:7], s54 offen offset:1024 sc1
    ds_read_b128 v[128:131], v1 offset:49152
    v_mfma_f32_16x16x32_bf16 v[20:23], v[132:135], v[88:91], v[20:23]
    ds_read_b128 v[132:135], v1 offset:50176
    v_cndmask_b32 v127, 0, v115, vcc
    v_mfma_f32_16x16x32_bf16 v[24:27], v[136:139], v[88:91], v[24:27]
    ds_read_b128 v[136:139], v1 offset:51200
    v_add_f32 v126, v126, v114
    v_mfma_f32_16x16x32_bf16 v[28:31], v[140:143], v[88:91], v[28:31]
    ds_read_b128 v[140:143], v1 offset:52224
    v_add_f32 v126, v126, v127
    s_waitcnt vmcnt(4) lgkmcnt(12)
    v_mfma_f32_16x16x32_bf16 v[16:19], v[144:147], v[92:95], v[16:19]
    ds_read_b128 v[144:147], v1 offset:53248
    v_mov_b32 v127, v126
    v_mfma_f32_16x16x32_bf16 v[20:23], v[148:151], v[92:95], v[20:23]
    ds_read_b128 v[148:151], v1 offset:54272
    v_permlane16_swap_b32 v126, v127
    v_mfma_f32_16x16x32_bf16 v[24:27], v[152:155], v[92:95], v[24:27]
    ds_read_b128 v[152:155], v1 offset:55296
    v_add_f32 v126, v126, v127
    v_mfma_f32_16x16x32_bf16 v[28:31], v[156:159], v[92:95], v[28:31]
    ds_read_b128 v[156:159], v1 offset:56320
    v_mov_b32 v127, v126
    s_waitcnt vmcnt(3) lgkmcnt(12)
    v_mfma_f32_16x16x32_bf16 v[16:19], v[160:163], v[96:99], v[16:19]
    v_permlane32_swap_b32 v126, v127
    v_mul_f32 v120, 0x3b124925, v126
    v_mfma_f32_16x16x32_bf16 v[20:23], v[164:167], v[96:99], v[20:23]
    v_mul_f32 v127, 0x3b124925, v127
    v_fma_f32 v127, -v120, v120, v127
    v_mfma_f32_16x16x32_bf16 v[24:27], v[168:171], v[96:99], v[24:27]
    v_max_f32 v127, 0, v127
    v_add_f32 v121, 0x3727c5ac, v127
    v_mfma_f32_16x16x32_bf16 v[28:31], v[172:175], v[96:99], v[28:31]
    v_rsq_f32 v121, v121
    s_nop 0
    v_mul_f32 v126, v121, v121
    s_waitcnt vmcnt(2) lgkmcnt(8)
    v_mfma_f32_16x16x32_bf16 v[16:19], v[176:179], v[100:103], v[16:19]
    v_mov_b32 v125, 0x3727c5ac
    v_fma_f32 v126, v126, v127, v125
    v_mfma_f32_16x16x32_bf16 v[20:23], v[180:183], v[100:103], v[20:23]
    v_rsq_f32 v126, v126
    s_nop 0
    v_mul_f32 v126, v126, v121
    v_mfma_f32_16x16x32_bf16 v[24:27], v[184:187], v[100:103], v[24:27]
    v_rcp_f32 v124, v126
    v_mul_f32 v123, v126, v126
    v_mfma_f32_16x16x32_bf16 v[28:31], v[188:191], v[100:103], v[28:31]
    v_mul_f32 v122, 0xc0135761, v126
    v_mul_f32 v123, v123, v122
    s_waitcnt vmcnt(1) lgkmcnt(4)
    v_mfma_f32_16x16x32_bf16 v[16:19], v[128:131], v[104:107], v[16:19]
    v_mul_f32 v123, 0x3d372713, v123
    v_mul_f32 v120, -v120, v121
    v_mfma_f32_16x16x32_bf16 v[20:23], v[132:135], v[104:107], v[20:23]
    v_add_u32 v119, 114688, v1
    v_mfma_f32_16x16x32_bf16 v[24:27], v[136:139], v[104:107], v[24:27]
    v_mfma_f32_16x16x32_bf16 v[28:31], v[140:143], v[104:107], v[28:31]
    s_waitcnt vmcnt(0) lgkmcnt(0)
    v_mfma_f32_16x16x32_bf16 v[16:19], v[144:147], v[108:111], v[16:19]
    v_mfma_f32_16x16x32_bf16 v[20:23], v[148:151], v[108:111], v[20:23]
    v_mfma_f32_16x16x32_bf16 v[24:27], v[152:155], v[108:111], v[24:27]
    v_mfma_f32_16x16x32_bf16 v[28:31], v[156:159], v[108:111], v[28:31]
    s_add_u32 s29, s41, s20
    s_add_u32 s29, s29, 16128
    s_add_u32 s28, s68, s29
    s_nop 1
    v_pk_mul_f32 v[128:129], v[16:17], v[16:17]
    v_pk_mul_f32 v[130:131], v[18:19], v[18:19]
    v_pk_mul_f32 v[132:133], v[20:21], v[20:21]
    v_pk_mul_f32 v[134:135], v[22:23], v[22:23]
    v_pk_fma_f32 v[128:129], v[128:129], v[122:123], v[122:123] op_sel:[0,1,0] op_sel_hi:[1,1,0]
    v_pk_fma_f32 v[130:131], v[130:131], v[122:123], v[122:123] op_sel:[0,1,0] op_sel_hi:[1,1,0]
    v_pk_fma_f32 v[132:133], v[132:133], v[122:123], v[122:123] op_sel:[0,1,0] op_sel_hi:[1,1,0]
    v_pk_fma_f32 v[134:135], v[134:135], v[122:123], v[122:123] op_sel:[0,1,0] op_sel_hi:[1,1,0]
    v_pk_mul_f32 v[128:129], v[128:129], v[16:17]
    v_pk_mul_f32 v[130:131], v[130:131], v[18:19]
    v_pk_mul_f32 v[132:133], v[132:133], v[20:21]
    v_pk_mul_f32 v[134:135], v[134:135], v[22:23]
    v_exp_f32 v128, v128
    v_exp_f32 v129, v129
    v_exp_f32 v130, v130
    v_exp_f32 v131, v131
    v_exp_f32 v132, v132
    v_exp_f32 v133, v133
    v_exp_f32 v134, v134
    v_exp_f32 v135, v135
    v_pk_fma_f32 v[128:129], v[128:129], v[124:125], v[124:125] op_sel_hi:[1,0,0]
    v_pk_fma_f32 v[130:131], v[130:131], v[124:125], v[124:125] op_sel_hi:[1,0,0]
    v_pk_fma_f32 v[132:133], v[132:133], v[124:125], v[124:125] op_sel_hi:[1,0,0]
    v_pk_fma_f32 v[134:135], v[134:135], v[124:125], v[124:125] op_sel_hi:[1,0,0]
    v_rcp_f32 v128, v128
    v_rcp_f32 v129, v129
    v_rcp_f32 v130, v130
    v_rcp_f32 v131, v131
    v_rcp_f32 v132, v132
    v_rcp_f32 v133, v133
    v_rcp_f32 v134, v134
    v_rcp_f32 v135, v135
    v_pk_mul_f32 v[128:129], v[128:129], v[16:17]
    v_pk_mul_f32 v[130:131], v[130:131], v[18:19]
    v_pk_mul_f32 v[132:133], v[132:133], v[20:21]
    v_pk_mul_f32 v[134:135], v[134:135], v[22:23]
    v_cvt_pk_bf16_f32 v48, v128, v129
    v_cvt_pk_bf16_f32 v49, v130, v131
    v_cvt_pk_bf16_f32 v50, v132, v133
    v_cvt_pk_bf16_f32 v51, v134, v135
    buffer_store_dwordx4 v[48:51], v1, s[4:7], s29 offen
    v_pk_mul_f32 v[128:129], v[24:25], v[24:25]
    v_pk_mul_f32 v[130:131], v[26:27], v[26:27]
    v_pk_mul_f32 v[132:133], v[28:29], v[28:29]
    v_pk_mul_f32 v[134:135], v[30:31], v[30:31]
    v_pk_fma_f32 v[128:129], v[128:129], v[122:123], v[122:123] op_sel:[0,1,0] op_sel_hi:[1,1,0]
    v_pk_fma_f32 v[130:131], v[130:131], v[122:123], v[122:123] op_sel:[0,1,0] op_sel_hi:[1,1,0]
    v_pk_fma_f32 v[132:133], v[132:133], v[122:123], v[122:123] op_sel:[0,1,0] op_sel_hi:[1,1,0]
    v_pk_fma_f32 v[134:135], v[134:135], v[122:123], v[122:123] op_sel:[0,1,0] op_sel_hi:[1,1,0]
    v_pk_mul_f32 v[128:129], v[128:129], v[24:25]
    v_pk_mul_f32 v[130:131], v[130:131], v[26:27]
    v_pk_mul_f32 v[132:133], v[132:133], v[28:29]
    v_pk_mul_f32 v[134:135], v[134:135], v[30:31]
    v_exp_f32 v128, v128
    v_exp_f32 v129, v129
    v_exp_f32 v130, v130
    v_exp_f32 v131, v131
    v_exp_f32 v132, v132
    v_exp_f32 v133, v133
    v_exp_f32 v134, v134
    v_exp_f32 v135, v135
    v_pk_fma_f32 v[128:129], v[128:129], v[124:125], v[124:125] op_sel_hi:[1,0,0]
    v_pk_fma_f32 v[130:131], v[130:131], v[124:125], v[124:125] op_sel_hi:[1,0,0]
    v_pk_fma_f32 v[132:133], v[132:133], v[124:125], v[124:125] op_sel_hi:[1,0,0]
    v_pk_fma_f32 v[134:135], v[134:135], v[124:125], v[124:125] op_sel_hi:[1,0,0]
    v_rcp_f32 v128, v128
    v_rcp_f32 v129, v129
    v_rcp_f32 v130, v130
    v_rcp_f32 v131, v131
    v_rcp_f32 v132, v132
    v_rcp_f32 v133, v133
    v_rcp_f32 v134, v134
    v_rcp_f32 v135, v135
    v_pk_mul_f32 v[128:129], v[128:129], v[24:25]
    v_pk_mul_f32 v[130:131], v[130:131], v[26:27]
    v_pk_mul_f32 v[132:133], v[132:133], v[28:29]
    v_pk_mul_f32 v[134:135], v[134:135], v[30:31]
    v_cvt_pk_bf16_f32 v52, v128, v129
    v_cvt_pk_bf16_f32 v53, v130, v131
    v_cvt_pk_bf16_f32 v54, v132, v133
    v_cvt_pk_bf16_f32 v55, v134, v135
    buffer_store_dwordx4 v[52:55], v1, s[4:7], s29 offen offset:1024
    s_add_u32 s35, s63, 8192
    s_add_u32 s36, s62, 8128
    s_cmp_eq_u32 s68, 0
    s_cbranch_scc1 Lc_nohalo
    s_mov_b32 exec_lo, s69
    s_mov_b32 exec_hi, s69
    buffer_store_dwordx4 v[48:51], v11, s[4:7], s28 offen sc1
    buffer_store_dwordx4 v[52:55], v11, s[4:7], s28 offen offset:1024 sc1
    s_mov_b64 exec, -1
    ds_read_b128 v[128:131], v119 offset:0
    ds_read_b128 v[132:135], v119 offset:1024
    ds_read_b128 v[136:139], v119 offset:2048
    ds_read_b128 v[140:143], v119 offset:3072
    ds_read_b128 v[144:147], v119 offset:4096
    ds_read_b128 v[148:151], v119 offset:5120
    ds_read_b128 v[152:155], v119 offset:6144
    ds_read_b128 v[156:159], v119 offset:7168
    ds_read_b128 v[160:163], v119 offset:12288
    ds_read_b128 v[164:167], v119 offset:13312
    ds_read_b128 v[168:171], v119 offset:14336
    ds_read_b128 v[172:175], v119 offset:15360
    ds_read_b128 v[176:179], v119 offset:16384
    ds_read_b128 v[180:183], v119 offset:17408
    ds_read_b128 v[184:187], v119 offset:18432
    ds_read_b128 v[188:191], v119 offset:19456
    v_pk_fma_f32 v[16:17], v[32:33], v[120:121], v[120:121] op_sel:[0,1,0] op_sel_hi:[1,1,0]
    v_pk_fma_f32 v[18:19], v[34:35], v[120:121], v[120:121] op_sel:[0,1,0] op_sel_hi:[1,1,0]
    v_pk_fma_f32 v[20:21], v[36:37], v[120:121], v[120:121] op_sel:[0,1,0] op_sel_hi:[1,1,0]
    v_pk_fma_f32 v[22:23], v[38:39], v[120:121], v[120:121] op_sel:[0,1,0] op_sel_hi:[1,1,0]
    v_pk_fma_f32 v[24:25], v[40:41], v[120:121], v[120:121] op_sel:[0,1,0] op_sel_hi:[1,1,0]
    v_pk_fma_f32 v[26:27], v[42:43], v[120:121], v[120:121] op_sel:[0,1,0] op_sel_hi:[1,1,0]
    v_pk_fma_f32 v[28:29], v[44:45], v[120:121], v[120:121] op_sel:[0,1,0] op_sel_hi:[1,1,0]
    v_pk_fma_f32 v[30:31], v[46:47], v[120:121], v[120:121] op_sel:[0,1,0] op_sel_hi:[1,1,0]
    s_waitcnt vmcnt(2)
    s_mov_b64 exec, 1
    buffer_store_dword v15, off, s[4:7], s35 offset:0
    s_mov_b64 exec, -1
    s_branch Lc_nohalo1
Lc_nohalo:
    ds_read_b128 v[128:131], v119 offset:0
    ds_read_b128 v[132:135], v119 offset:1024
    ds_read_b128 v[136:139], v119 offset:2048
    ds_read_b128 v[140:143], v119 offset:3072
    ds_read_b128 v[144:147], v119 offset:4096
    ds_read_b128 v[148:151], v119 offset:5120
    ds_read_b128 v[152:155], v119 offset:6144
    ds_read_b128 v[156:159], v119 offset:7168
    ds_read_b128 v[160:163], v119 offset:12288
    ds_read_b128 v[164:167], v119 offset:13312
    ds_read_b128 v[168:171], v119 offset:14336
    ds_read_b128 v[172:175], v119 offset:15360
    ds_read_b128 v[176:179], v119 offset:16384
    ds_read_b128 v[180:183], v119 offset:17408
    ds_read_b128 v[184:187], v119 offset:18432
    ds_read_b128 v[188:191], v119 offset:19456
    v_pk_fma_f32 v[16:17], v[32:33], v[120:121], v[120:121] op_sel:[0,1,0] op_sel_hi:[1,1,0]
    v_pk_fma_f32 v[18:19], v[34:35], v[120:121], v[120:121] op_sel:[0,1,0] op_sel_hi:[1,1,0]
    v_pk_fma_f32 v[20:21], v[36:37], v[120:121], v[120:121] op_sel:[0,1,0] op_sel_hi:[1,1,0]
    v_pk_fma_f32 v[22:23], v[38:39], v[120:121], v[120:121] op_sel:[0,1,0] op_sel_hi:[1,1,0]
    v_pk_fma_f32 v[24:25], v[40:41], v[120:121], v[120:121] op_sel:[0,1,0] op_sel_hi:[1,1,0]
    v_pk_fma_f32 v[26:27], v[42:43], v[120:121], v[120:121] op_sel:[0,1,0] op_sel_hi:[1,1,0]
    v_pk_fma_f32 v[28:29], v[44:45], v[120:121], v[120:121] op_sel:[0,1,0] op_sel_hi:[1,1,0]
    v_pk_fma_f32 v[30:31], v[46:47], v[120:121], v[120:121] op_sel:[0,1,0] op_sel_hi:[1,1,0]
    s_waitcnt vmcnt(0)
    s_mov_b64 exec, 1
    buffer_store_dword v15, off, s[4:7], s35 offset:0
    s_mov_b64 exec, -1
Lc_nohalo1:
    s_barrier
    s_cmp_lg_u32 s69, 0
    s_cbranch_scc1 Lc_edge
    buffer_load_dword v10, v14, s[4:7], s36 offen sc1
    s_waitcnt vmcnt(0)
    v_cmp_eq_u32 vcc, 0, v10
    s_nop 0
    s_cbranch_vccz Lpolld5
    s_mov_b32 s39, 0
Lpoll5:
    buffer_load_dword v10, v14, s[4:7], s36 offen sc1
    s_waitcnt vmcnt(0)
    v_cmp_eq_u32 vcc, 0, v10
    s_nop 0
    s_cbranch_vccz Lpolld5
    s_add_u32 s39, s39, 1
    s_cmp_lt_u32 s39, 200000
    s_cbranch_scc1 Lpoll5
Lpolld5:
Lc_hgo:
    s_nop 0
    s_add_u32 s28, s41, 0
    buffer_load_dwordx4 v[56:59], v4, s[4:7], s28 offen offset:0 sc1
    buffer_load_dwordx4 v[60:63], v4, s[4:7], s28 offen offset:1024 sc1
    s_add_u32 s28, s41, 2304
    buffer_load_dwordx4 v[64:67], v4, s[4:7], s28 offen offset:0 sc1
    buffer_load_dwordx4 v[68:71], v8, s[4:7], s28 offen offset:1024 sc1
    s_add_u32 s28, s41, 4608
    buffer_load_dwordx4 v[72:75], v5, s[4:7], s28 offen offset:0 sc1
    s_add_u32 s48, s42, s20
    s_and_b32 s35, s12, 2
    s_mul_i32 s36, s35, 16128
    s_sub_u32 s36, s42, s36
    s_cmp_eq_u32 s35, 0
    s_cselect_b32 s56, s21, s24
    s_cselect_b32 s57, s22, s25
    s_cselect_b32 s58, s23, s26
    s_cselect_b32 s59, 2048, s0
    s_cselect_b32 s59, s59, 8192
    s_add_u32 s56, s56, s36
    s_add_u32 s57, s57, s36
    s_add_u32 s58, s58, s36
    s_and_b32 s35, s12, 1
    s_mul_i32 s35, s35, 14336
    s_add_u32 s59, s59, s35
    s_lshl_b32 s55, s12, 6
    s_add_u32 s55, s55, 151552
    s_mov_b32 s61, 151552
    s_add_u32 s35, s63, 16384
    s_lshl_b32 s36, s16, 8
    s_add_u32 s36, s36, s45
    s_add_u32 s36, s36, 16320
    s_and_b32 s27, s16, 3
    s_cmp_eq_u32 s27, 0
    s_cselect_b32 s101, 1, 0
    s_cmp_eq_u32 s27, 3
    s_cselect_b32 s27, 4, 5
    s_waitcnt vmcnt(4) lgkmcnt(12)
    v_mfma_f32_16x16x32_bf16 v[16:19], v[128:131], v[56:59], v[16:19]
    buffer_load_dwordx4 v[76:79], v5, s[4:7], s28 offen offset:1024 sc1
    ds_read_b128 v[128:131], v119 offset:24576
    v_mfma_f32_16x16x32_bf16 v[20:23], v[132:135], v[56:59], v[20:23]
    ds_read_b128 v[132:135], v119 offset:25600
    v_mfma_f32_16x16x32_bf16 v[24:27], v[136:139], v[56:59], v[24:27]
    ds_read_b128 v[136:139], v119 offset:26624
    v_mfma_f32_16x16x32_bf16 v[28:31], v[140:143], v[56:59], v[28:31]
    ds_read_b128 v[140:143], v119 offset:27648
    s_waitcnt vmcnt(4) lgkmcnt(12)
    v_mfma_f32_16x16x32_bf16 v[16:19], v[144:147], v[60:63], v[16:19]
    s_add_u32 s28, s41, 6912
    buffer_load_dwordx4 v[80:83], v5, s[4:7], s28 offen offset:0 sc1
    ds_read_b128 v[144:147], v119 offset:28672
    v_mfma_f32_16x16x32_bf16 v[20:23], v[148:151], v[60:63], v[20:23]
    ds_read_b128 v[148:151], v119 offset:29696
    v_mfma_f32_16x16x32_bf16 v[24:27], v[152:155], v[60:63], v[24:27]
    ds_read_b128 v[152:155], v119 offset:30720
    v_mfma_f32_16x16x32_bf16 v[28:31], v[156:159], v[60:63], v[28:31]
    ds_read_b128 v[156:159], v119 offset:31744
    s_waitcnt vmcnt(4) lgkmcnt(12)
    v_mfma_f32_16x16x32_bf16 v[16:19], v[160:163], v[64:67], v[16:19]
    buffer_load_dwordx4 v[84:87], v6, s[4:7], s28 offen offset:1024 sc1
    ds_read_b128 v[160:163], v119 offset:36864
    v_mfma_f32_16x16x32_bf16 v[20:23], v[164:167], v[64:67], v[20:23]
    ds_read_b128 v[164:167], v119 offset:37888
    v_mfma_f32_16x16x32_bf16 v[24:27], v[168:171], v[64:67], v[24:27]
    ds_read_b128 v[168:171], v119 offset:38912
    v_mfma_f32_16x16x32_bf16 v[28:31], v[172:175], v[64:67], v[28:31]
    ds_read_b128 v[172:175], v119 offset:39936
    s_waitcnt vmcnt(4) lgkmcnt(12)
    v_mfma_f32_16x16x32_bf16 v[16:19], v[176:179], v[68:71], v[16:19]
    s_add_u32 s28, s41, 9216
    buffer_load_dwordx4 v[88:91], v6, s[4:7], s28 offen offset:0 sc1
    ds_read_b128 v[176:179], v119 offset:40960
    v_mfma_f32_16x16x32_bf16 v[20:23], v[180:183], v[68:71], v[20:23]
    ds_read_b128 v[180:183], v119 offset:41984
    v_mfma_f32_16x16x32_bf16 v[24:27], v[184:187], v[68:71], v[24:27]
    ds_read_b128 v[184:187], v119 offset:43008
    v_mfma_f32_16x16x32_bf16 v[28:31], v[188:191], v[68:71], v[28:31]
    ds_read_b128 v[188:191], v119 offset:44032
    s_waitcnt vmcnt(4) lgkmcnt(12)
    v_mfma_f32_16x16x32_bf16 v[16:19], v[128:131], v[72:75], v[16:19]
    buffer_load_dwordx4 v[92:95], v6, s[4:7], s28 offen offset:1024 sc1
    ds_read_b128 v[128:131], v119 offset:8192
    v_mfma_f32_16x16x32_bf16 v[20:23], v[132:135], v[72:75], v[20:23]
    ds_read_b128 v[132:135], v119 offset:9216
    v_mfma_f32_16x16x32_bf16 v[24:27], v[136:139], v[72:75], v[24:27]
    ds_read_b128 v[136:139], v119 offset:10240
    v_mfma_f32_16x16x32_bf16 v[28:31], v[140:143], v[72:75], v[28:31]
    ds_read_b128 v[140:143], v119 offset:11264
    s_waitcnt vmcnt(4) lgkmcnt(12)
    v_mfma_f32_16x16x32_bf16 v[16:19], v[144:147], v[76:79], v[16:19]
    s_add_u32 s28, s41, 11520
    buffer_load_dwordx4 v[96:99], v9, s[4:7], s28 offen offset:0 sc1
    ds_read_b128 v[144:147], v119 offset:20480
    v_mfma_f32_16x16x32_bf16 v[20:23], v[148:151], v[76:79], v[20:23]
    ds_read_b128 v[148:151], v119 offset:21504
    v_mfma_f32_16x16x32_bf16 v[24:27], v[152:155], v[76:79], v[24:27]
    ds_read_b128 v[152:155], v119 offset:22528
    v_mfma_f32_16x16x32_bf16 v[28:31], v[156:159], v[76:79], v[28:31]
    ds_read_b128 v[156:159], v119 offset:23552
    s_waitcnt vmcnt(4) lgkmcnt(12)
    v_mfma_f32_16x16x32_bf16 v[16:19], v[160:163], v[80:83], v[16:19]
    buffer_load_dwordx4 v[100:103], v7, s[4:7], s28 offen offset:1024 sc1
    ds_read_b128 v[160:163], v119 offset:32768
    v_mfma_f32_16x16x32_bf16 v[20:23], v[164:167], v[80:83], v[20:23]
    ds_read_b128 v[164:167], v119 offset:33792
    v_mfma_f32_16x16x32_bf16 v[24:27], v[168:171], v[80:83], v[24:27]
    ds_read_b128 v[168:171], v119 offset:34816
    v_mfma_f32_16x16x32_bf16 v[28:31], v[172:175], v[80:83], v[28:31]
    ds_read_b128 v[172:175], v119 offset:35840
    s_waitcnt vmcnt(4) lgkmcnt(12)
    v_mfma_f32_16x16x32_bf16 v[16:19], v[176:179], v[84:87], v[16:19]
    s_add_u32 s28, s41, 13824
    buffer_load_dwordx4 v[104:107], v7, s[4:7], s28 offen offset:0 sc1
    ds_read_b128 v[176:179], v119 offset:45056
    v_mfma_f32_16x16x32_bf16 v[20:23], v[180:183], v[84:87], v[20:23]
    ds_read_b128 v[180:183], v119 offset:46080
    v_mfma_f32_16x16x32_bf16 v[24:27], v[184:187], v[84:87], v[24:27]
    ds_read_b128 v[184:187], v119 offset:47104
    v_mfma_f32_16x16x32_bf16 v[28:31], v[188:191], v[84:87], v[28:31]
    ds_read_b128 v[188:191], v119 offset:48128
    s_waitcnt vmcnt(4) lgkmcnt(12)
    v_mfma_f32_16x16x32_bf16 v[16:19], v[128:131], v[88:91], v[16:19]
    buffer_load_dwordx4 v[108:111], v7, s[4:7], s28 offen offset:1024 sc1
    ds_read_b128 v[128:131], v13 offset:0
    v_mfma_f32_16x16x32_bf16 v[20:23], v[132:135], v[88:91], v[20:23]
    ds_read_b128 v[132:135], v13 offset:1024
    v_mfma_f32_16x16x32_bf16 v[24:27], v[136:139], v[88:91], v[24:27]
    ds_read_b128 v[136:139], v13 offset:2048
    v_mfma_f32_16x16x32_bf16 v[28:31], v[140:143], v[88:91], v[28:31]
    ds_read_b128 v[140:143], v13 offset:3072
    s_waitcnt vmcnt(4) lgkmcnt(12)
    v_mfma_f32_16x16x32_bf16 v[16:19], v[144:147], v[92:95], v[16:19]
    ds_read_b128 v[144:147], v13 offset:4096
    v_add_u32 v12, s34, v1
    v_mfma_f32_16x16x32_bf16 v[20:23], v[148:151], v[92:95], v[20:23]
    ds_read_b128 v[148:151], v13 offset:5120
    v_bfe_u32 v10, v0, 4, 1
    v_mfma_f32_16x16x32_bf16 v[24:27], v[152:155], v[92:95], v[24:27]
    ds_read_b128 v[152:155], v13 offset:6144
    v_mul_u32_u24 v10, 14336, v10
    v_mfma_f32_16x16x32_bf16 v[28:31], v[156:159], v[92:95], v[28:31]
    ds_read_b128 v[156:159], v13 offset:7168
    v_lshrrev_b32 v11, 5, v0
    s_waitcnt vmcnt(3) lgkmcnt(12)
    v_mfma_f32_16x16x32_bf16 v[16:19], v[160:163], v[96:99], v[16:19]
    v_lshl_add_u32 v10, v11, 8, v10
    v_and_b32 v11, 15, v0
    v_mfma_f32_16x16x32_bf16 v[20:23], v[164:167], v[96:99], v[20:23]
    v_lshl_add_u32 v4, v11, 4, v10
    v_lshl_add_u32 v5, v11, 2, s55
    v_mfma_f32_16x16x32_bf16 v[24:27], v[168:171], v[96:99], v[24:27]
    v_and_b32 v6, 31, v0
    v_lshl_add_u32 v6, v6, 2, s61
    v_mfma_f32_16x16x32_bf16 v[28:31], v[172:175], v[96:99], v[28:31]
    v_and_b32 v11, 7, v0
    v_min_u32 v11, 6, v11
    s_waitcnt vmcnt(2) lgkmcnt(8)
    v_mfma_f32_16x16x32_bf16 v[16:19], v[176:179], v[100:103], v[16:19]
    v_lshlrev_b32 v11, 2, v11
    v_lshrrev_b32 v10, 3, v0
    v_mfma_f32_16x16x32_bf16 v[20:23], v[180:183], v[100:103], v[20:23]
    v_max_u32 v10, s101, v10
    v_min_u32 v10, s27, v10
    v_mfma_f32_16x16x32_bf16 v[24:27], v[184:187], v[100:103], v[24:27]
    v_lshl_add_u32 v14, v10, 6, v11
    v_mfma_f32_16x16x32_bf16 v[28:31], v[188:191], v[100:103], v[28:31]
    s_waitcnt vmcnt(1) lgkmcnt(4)
    v_mfma_f32_16x16x32_bf16 v[16:19], v[128:131], v[104:107], v[16:19]
    v_mfma_f32_16x16x32_bf16 v[20:23], v[132:135], v[104:107], v[20:23]
    v_mfma_f32_16x16x32_bf16 v[24:27], v[136:139], v[104:107], v[24:27]
    v_mfma_f32_16x16x32_bf16 v[28:31], v[140:143], v[104:107], v[28:31]
    s_waitcnt vmcnt(0) lgkmcnt(0)
    v_mfma_f32_16x16x32_bf16 v[16:19], v[144:147], v[108:111], v[16:19]
    v_mfma_f32_16x16x32_bf16 v[20:23], v[148:151], v[108:111], v[20:23]
    v_mfma_f32_16x16x32_bf16 v[24:27], v[152:155], v[108:111], v[24:27]
    v_mfma_f32_16x16x32_bf16 v[28:31], v[156:159], v[108:111], v[28:31]
    s_nop 4
    v_cvt_pk_bf16_f32 v176, v16, v17
    v_cvt_pk_bf16_f32 v177, v18, v19
    v_cvt_pk_bf16_f32 v178, v20, v21
    v_cvt_pk_bf16_f32 v179, v22, v23
    buffer_store_dwordx4 v[176:179], v1, s[4:7], s48 offen offset:0
    v_cvt_pk_bf16_f32 v180, v24, v25
    v_cvt_pk_bf16_f32 v181, v26, v27
    v_cvt_pk_bf16_f32 v182, v28, v29
    v_cvt_pk_bf16_f32 v183, v30, v31
    buffer_store_dwordx4 v[180:183], v1, s[4:7], s48 offen offset:1024
    ds_write_b128 v12, v[176:179]
    ds_write_b128 v12, v[180:183] offset:1024
    v_pk_add_f32 v[112:113], v[16:17], v[18:19]
    v_pk_mul_f32 v[114:115], v[16:17], v[16:17]
    v_pk_add_f32 v[116:117], v[20:21], v[22:23]
    v_pk_mul_f32 v[118:119], v[18:19], v[18:19]
    v_pk_add_f32 v[112:113], v[112:113], v[24:25]
    v_pk_fma_f32 v[114:115], v[20:21], v[20:21], v[114:115]
    v_pk_add_f32 v[116:117], v[116:117], v[26:27]
    v_pk_fma_f32 v[118:119], v[22:23], v[22:23], v[118:119]
    v_pk_add_f32 v[112:113], v[112:113], v[28:29]
    v_pk_fma_f32 v[114:115], v[24:25], v[24:25], v[114:115]
    v_pk_add_f32 v[116:117], v[116:117], v[30:31]
    v_pk_fma_f32 v[118:119], v[26:27], v[26:27], v[118:119]
    v_pk_fma_f32 v[114:115], v[28:29], v[28:29], v[114:115]
    v_pk_fma_f32 v[118:119], v[30:31], v[30:31], v[118:119]
    v_pk_add_f32 v[112:113], v[112:113], v[116:117]
    v_pk_add_f32 v[114:115], v[114:115], v[118:119]
    v_add_f32 v112, v112, v113
    v_add_f32 v114, v114, v115
    s_nop 1
    v_permlane32_swap_b32 v112, v114
    v_add_f32 v112, v112, v114
    v_mov_b32 v113, v112
    s_nop 1
    v_permlane16_swap_b32 v112, v113
    s_mov_b32 exec_lo, 0xffff
    s_mov_b32 exec_hi, 0xffff
    v_add_f32 v112, v112, v113
    buffer_store_dword v112, v2, s[4:7], s42 offen offset:2048
    s_mov_b64 exec, -1
    v_pk_add_f32 v[32:33], v[32:33], v[16:17]
    v_pk_add_f32 v[34:35], v[34:35], v[18:19]
    v_pk_add_f32 v[36:37], v[36:37], v[20:21]
    v_pk_add_f32 v[38:39], v[38:39], v[22:23]
    v_pk_add_f32 v[40:41], v[40:41], v[24:25]
    v_pk_add_f32 v[42:43], v[42:43], v[26:27]
    v_pk_add_f32 v[44:45], v[44:45], v[28:29]
    v_pk_add_f32 v[46:47], v[46:47], v[30:31]
    v_lshrrev_b32 v28, 4, v0
    v_lshl_add_u32 v28, v28, 11, v1
    s_waitcnt vmcnt(0)
    s_mov_b64 exec, 1
    buffer_store_dword v15, off, s[4:7], s35 offset:0
    s_mov_b64 exec, -1
    s_waitcnt lgkmcnt(0)
    s_barrier
    buffer_load_dword v10, v14, s[4:7], s36 offen sc1
    ds_read_b128 v[144:147], v4 offset:0
    ds_read_b128 v[148:151], v4 offset:28672
    ds_read_b128 v[152:155], v4 offset:512
    ds_read_b128 v[156:159], v4 offset:29184
    ds_read_b128 v[160:163], v4 offset:1024
    ds_read_b128 v[164:167], v4 offset:29696
    ds_read_b128 v[168:171], v4 offset:1536
    ds_read_b128 v[172:175], v4 offset:30208
    s_waitcnt lgkmcnt(7)
    v_mfma_f32_32x32x16_bf16 v[80:95], a[0:3], v[144:147], 0
    v_mfma_f32_32x32x16_bf16 v[112:127], a[112:115], v[144:147], 0
    s_waitcnt vmcnt(0)
    v_cmp_eq_u32 vcc, 0, v10
    s_nop 0
    s_cbranch_vccz Lpolld6
    s_mov_b32 s39, 0
Lpoll6:
    buffer_load_dword v10, v14, s[4:7], s36 offen sc1
    s_waitcnt vmcnt(0)
    v_cmp_eq_u32 vcc, 0, v10
    s_nop 0
    s_cbranch_vccz Lpolld6
    s_add_u32 s39, s39, 1
    s_cmp_lt_u32 s39, 200000
    s_cbranch_scc1 Lpoll6
Lpolld6:
    s_nop 0
    s_add_u32 m0, s59, 0
    s_nop 0
    buffer_load_dwordx4 v1, s[4:7], s56 offen offset:0 sc1 lds
    buffer_load_dwordx4 v1, s[4:7], s56 offen offset:1024 sc1 lds
    s_add_u32 m0, s59, 2048
    s_nop 0
    buffer_load_dwordx4 v1, s[4:7], s57 offen offset:0 sc1 lds
    buffer_load_dwordx4 v1, s[4:7], s57 offen offset:1024 sc1 lds
    s_add_u32 m0, s59, 4096
    s_nop 0
    buffer_load_dwordx4 v1, s[4:7], s58 offen offset:0 sc1 lds
    buffer_load_dwordx4 v1, s[4:7], s58 offen offset:1024 sc1 lds
    s_add_u32 m0, s59, 28672
    s_add_u32 s56, s56, 32256
    buffer_load_dwordx4 v1, s[4:7], s56 offen offset:0 sc1 lds
    s_waitcnt lgkmcnt(6)
    v_mfma_f32_32x32x16_bf16 v[96:111], a[0:3], v[148:151], 0
    v_mfma_f32_32x32x16_bf16 v[128:143], a[112:115], v[148:151], 0
    buffer_load_dwordx4 v1, s[4:7], s56 offen offset:1024 sc1 lds
    s_waitcnt lgkmcnt(5)
    v_mfma_f32_32x32x16_bf16 v[80:95], a[4:7], v[152:155], v[80:95]
    v_mfma_f32_32x32x16_bf16 v[112:127], a[116:119], v[152:155], v[112:127]
    s_add_u32 m0, s59, 30720
    s_add_u32 s57, s57, 32256
    buffer_load_dwordx4 v1, s[4:7], s57 offen offset:0 sc1 lds
    s_waitcnt lgkmcnt(4)
    v_mfma_f32_32x32x16_bf16 v[96:111], a[4:7], v[156:159], v[96:111]
    v_mfma_f32_32x32x16_bf16 v[128:143], a[116:119], v[156:159], v[128:143]
    buffer_load_dwordx4 v1, s[4:7], s57 offen offset:1024 sc1 lds
    s_waitcnt lgkmcnt(3)
    v_mfma_f32_32x32x16_bf16 v[80:95], a[8:11], v[160:163], v[80:95]
    v_mfma_f32_32x32x16_bf16 v[112:127], a[120:123], v[160:163], v[112:127]
    s_add_u32 m0, s59, 32768
    s_add_u32 s58, s58, 32256
    buffer_load_dwordx4 v1, s[4:7], s58 offen offset:0 sc1 lds
    s_waitcnt lgkmcnt(2)
    v_mfma_f32_32x32x16_bf16 v[96:111], a[8:11], v[164:167], v[96:111]
    v_mfma_f32_32x32x16_bf16 v[128:143], a[120:123], v[164:167], v[128:143]
    buffer_load_dwordx4 v1, s[4:7], s58 offen offset:1024 sc1 lds
    s_waitcnt lgkmcnt(1)
    v_mfma_f32_32x32x16_bf16 v[80:95], a[12:15], v[168:171], v[80:95]
    v_mfma_f32_32x32x16_bf16 v[112:127], a[124:127], v[168:171], v[112:127]
    buffer_load_dwordx4 v[24:27], v28, s[4:7], s42 offen offset:2048 sc1
    s_waitcnt lgkmcnt(0)
    v_mfma_f32_32x32x16_bf16 v[96:111], a[12:15], v[172:175], v[96:111]
    v_mfma_f32_32x32x16_bf16 v[128:143], a[124:127], v[172:175], v[128:143]
    s_waitcnt vmcnt(7)
    s_barrier
    ds_read_b128 v[144:147], v4 offset:2048
    ds_read_b128 v[148:151], v4 offset:2560
    ds_read_b128 v[152:155], v4 offset:3072
    ds_read_b128 v[156:159], v4 offset:3584
    ds_read_b128 v[160:163], v4 offset:4096
    ds_read_b128 v[164:167], v4 offset:4608
    ds_read_b128 v[168:171], v4 offset:5120
    s_waitcnt lgkmcnt(6)
    v_mfma_f32_32x32x16_bf16 v[80:95], a[16:19], v[144:147], v[80:95]
    s_add_u32 s37, s47, 24576
    buffer_load_dwordx4 a[0:3], v1, s[4:7], s37 offen offset:0
    ds_read_b128 v[172:175], v4 offset:5632
    s_add_u32 s48, s15, 0
    s_cmp_ge_u32 s48, 7
    s_cselect_b32 s99, 7, 0
    s_sub_u32 s48, s48, s99
    s_lshl_b32 s48, s48, 15
    s_add_u32 s48, s48, s44
    s_waitcnt lgkmcnt(6)
    v_mfma_f32_32x32x16_bf16 v[80:95], a[20:23], v[148:151], v[80:95]
    buffer_load_dwordx4 a[4:7], v1, s[4:7], s37 offen offset:1024
    ds_read_b128 v[144:147], v4 offset:6144
    s_add_u32 s49, s15, 1
    s_cmp_ge_u32 s49, 7
    s_cselect_b32 s99, 7, 0
    s_sub_u32 s49, s49, s99
    s_lshl_b32 s49, s49, 15
    s_add_u32 s49, s49, s44
    s_waitcnt lgkmcnt(6)
    v_mfma_f32_32x32x16_bf16 v[80:95], a[24:27], v[152:155], v[80:95]
    buffer_load_dwordx4 a[8:11], v1, s[4:7], s37 offen offset:2048
    ds_read_b128 v[148:151], v4 offset:6656
    s_add_u32 s50, s15, 2
    s_cmp_ge_u32 s50, 7
    s_cselect_b32 s99, 7, 0
    s_sub_u32 s50, s50, s99
    s_lshl_b32 s50, s50, 15
    s_add_u32 s50, s50, s44
    s_waitcnt lgkmcnt(4)
    v_mfma_f32_32x32x16_bf16 v[80:95], a[28:31], v[156:159], v[80:95]
    ds_read_b128 v[152:155], v4 offset:7168
    s_add_u32 s51, s15, 3
    s_cmp_ge_u32 s51, 7
    s_cselect_b32 s99, 7, 0
    s_sub_u32 s51, s51, s99
    s_lshl_b32 s51, s51, 15
    s_add_u32 s51, s51, s44
    v_mfma_f32_32x32x16_bf16 v[80:95], a[32:35], v[160:163], v[80:95]
    buffer_load_dwordx4 a[12:15], v1, s[4:7], s37 offen offset:3072
    ds_read_b128 v[156:159], v4 offset:7680
    s_add_u32 s52, s15, 4
    s_cmp_ge_u32 s52, 7
    s_cselect_b32 s99, 7, 0
    s_sub_u32 s52, s52, s99
    s_lshl_b32 s52, s52, 15
    s_add_u32 s52, s52, s44
    v_mfma_f32_32x32x16_bf16 v[80:95], a[36:39], v[164:167], v[80:95]
    ds_read_b128 v[160:163], v4 offset:8192
    s_add_u32 s53, s15, 5
    s_cmp_ge_u32 s53, 7
    s_cselect_b32 s99, 7, 0
    s_sub_u32 s53, s53, s99
    s_lshl_b32 s53, s53, 15
    s_add_u32 s53, s53, s44
    s_waitcnt lgkmcnt(4)
    v_mfma_f32_32x32x16_bf16 v[80:95], a[40:43], v[168:171], v[80:95]
    s_add_u32 s37, s47, 28672
    buffer_load_dwordx4 a[112:115], v1, s[4:7], s37 offen offset:0
    ds_read_b128 v[164:167], v4 offset:8704
    s_add_u32 s54, s15, 6
    s_cmp_ge_u32 s54, 7
    s_cselect_b32 s99, 7, 0
    s_sub_u32 s54, s54, s99
    s_lshl_b32 s54, s54, 15
    s_add_u32 s54, s54, s44
    v_mfma_f32_32x32x16_bf16 v[80:95], a[44:47], v[172:175], v[80:95]
    buffer_load_dwordx4 a[116:119], v1, s[4:7], s37 offen offset:1024
    ds_read_b128 v[168:171], v4 offset:9216
    s_add_u32 s59, s41, 16128
    v_mfma_f32_32x32x16_bf16 v[80:95], a[48:51], v[144:147], v[80:95]
    ds_read_b128 v[172:175], v4 offset:9728
    s_mov_b32 vcc_lo, 0xffff
    s_mov_b32 vcc_hi, 0xffff
    s_waitcnt vmcnt(6)
    v_add_f32 v10, v24, v25
    v_cndmask_b32 v11, 0, v27, vcc
    s_waitcnt lgkmcnt(4)
    v_mfma_f32_32x32x16_bf16 v[80:95], a[52:55], v[148:151], v[80:95]
    buffer_load_dwordx4 a[120:123], v1, s[4:7], s37 offen offset:2048
    ds_read_b128 v[144:147], v4 offset:10240
    v_add_f32 v10, v10, v26
    v_add_f32 v10, v10, v11
    v_mov_b32 v11, v10
    s_nop 1
    v_permlane16_swap_b32 v10, v11
    v_mfma_f32_32x32x16_bf16 v[80:95], a[56:59], v[152:155], v[80:95]
    ds_read_b128 v[148:151], v4 offset:10752
    v_add_f32 v10, v10, v11
    v_mov_b32 v11, v10
    s_nop 1
    v_permlane32_swap_b32 v10, v11
    v_mul_f32 v12, 0x3b124925, v10
    v_mfma_f32_32x32x16_bf16 v[80:95], a[60:63], v[156:159], v[80:95]
    s_waitcnt lgkmcnt(3)
    buffer_load_dwordx4 a[124:127], v1, s[4:7], s37 offen offset:3072
    ds_read_b128 v[152:155], v4 offset:11264
    v_mul_f32 v10, 0x3b124925, v11
    v_fma_f32 v10, -v12, v12, v10
    v_max_f32 v10, 0, v10
    v_add_f32 v11, 0x3727c5ac, v10
    v_mfma_f32_32x32x16_bf16 v[80:95], a[64:67], v[160:163], v[80:95]
    ds_read_b128 v[156:159], v4 offset:11776
    v_rsq_f32 v11, v11
    s_nop 0
    ds_write_b32 v5, v11
    v_mfma_f32_32x32x16_bf16 v[80:95], a[68:71], v[164:167], v[80:95]
    s_add_u32 m0, s67, 0
    s_add_u32 s38, s66, 0
    buffer_load_dwordx4 v1, s[4:7], s38 offen offset:0 lds
    ds_read_b128 v[160:163], v4 offset:12288
    v_mfma_f32_32x32x16_bf16 v[80:95], a[72:75], v[168:171], v[80:95]
    s_waitcnt lgkmcnt(4)
    ds_read_b128 v[164:167], v4 offset:12800
    v_mfma_f32_32x32x16_bf16 v[80:95], a[76:79], v[172:175], v[80:95]
    buffer_load_dwordx4 v1, s[4:7], s38 offen offset:1024 lds
    ds_read_b128 v[168:171], v4 offset:13312
    v_mfma_f32_32x32x16_bf16 v[80:95], a[80:83], v[144:147], v[80:95]
    ds_read_b128 v[172:175], v4 offset:13824
    v_mfma_f32_32x32x16_bf16 v[80:95], a[84:87], v[148:151], v[80:95]
    s_waitcnt lgkmcnt(4)
    buffer_load_dwordx4 v1, s[4:7], s38 offen offset:2048 lds
    s_barrier
    ds_read_b32 v24, v6
    ds_read_b32 v25, v6 offset:128
    ds_read_b128 v[144:147], v4 offset:30720
    s_waitcnt lgkmcnt(6)
    v_mfma_f32_32x32x16_bf16 v[80:95], a[88:91], v[152:155], v[80:95]
    ds_read_b128 v[148:151], v4 offset:31232
    v_mfma_f32_32x32x16_bf16 v[80:95], a[92:95], v[156:159], v[80:95]
    buffer_load_dwordx4 v1, s[4:7], s38 offen offset:3072 lds
    ds_read_b128 v[152:155], v4 offset:31744
    v_mfma_f32_32x32x16_bf16 v[80:95], a[96:99], v[160:163], v[80:95]
    s_waitcnt lgkmcnt(4)
    ds_read_b128 v[156:159], v4 offset:32256
    v_rcp_f32 v18, v24
    v_mul_f32 v17, v24, v24
    v_mul_f32 v16, 0xc0135761, v24
    v_mfma_f32_32x32x16_bf16 v[80:95], a[100:103], v[164:167], v[80:95]
    s_waitcnt lgkmcnt(4)
    ds_read_b128 v[160:163], v4 offset:32768
    v_mul_f32 v17, v17, v16
    v_mul_f32 v17, 0x3d372713, v17
    v_rcp_f32 v22, v25
    v_mfma_f32_32x32x16_bf16 v[80:95], a[104:107], v[168:171], v[80:95]
    s_add_u32 m0, s67, 4096
    s_add_u32 s38, s66, 4096
    buffer_load_dwordx4 v1, s[4:7], s38 offen offset:0 lds
    ds_read_b128 v[164:167], v4 offset:33280
    v_mul_f32 v21, v25, v25
    v_mul_f32 v20, 0xc0135761, v25
    v_mul_f32 v21, v21, v20
    v_mul_f32 v21, 0x3d372713, v21
    v_mfma_f32_32x32x16_bf16 v[80:95], a[108:111], v[172:175], v[80:95]
    s_waitcnt lgkmcnt(3)
    buffer_load_dwordx4 v1, s[4:7], s38 offen offset:1024 lds
    ds_read_b128 v[168:171], v4 offset:33792
    v_and_b32 v7, 15, v0
    v_lshlrev_b32 v7, 7, v7
    v_mfma_f32_32x32x16_bf16 v[96:111], a[16:19], v[144:147], v[96:111]
    ds_read_b128 v[172:175], v4 offset:34304
    v_mfma_f32_32x32x16_bf16 v[96:111], a[20:23], v[148:151], v[96:111]
    ds_read_b128 v[144:147], v4 offset:34816
    v_mfma_f32_32x32x16_bf16 v[96:111], a[24:27], v[152:155], v[96:111]
    s_add_u32 s37, s47, 32768
    buffer_load_dwordx4 a[16:19], v1, s[4:7], s37 offen offset:0
    ds_read_b128 v[148:151], v4 offset:35328
    v_pk_mul_f32 v[176:177], v[80:81], v[80:81]
    v_pk_mul_f32 v[178:179], v[82:83], v[82:83]
    v_pk_mul_f32 v[180:181], v[84:85], v[84:85]
    v_pk_mul_f32 v[182:183], v[86:87], v[86:87]
    v_pk_mul_f32 v[184:185], v[88:89], v[88:89]
    v_pk_mul_f32 v[186:187], v[90:91], v[90:91]
    v_pk_mul_f32 v[188:189], v[92:93], v[92:93]
    v_pk_mul_f32 v[190:191], v[94:95], v[94:95]
    v_pk_fma_f32 v[176:177], v[176:177], v[16:17], v[16:17] op_sel:[0,1,0] op_sel_hi:[1,1,0]
    v_pk_fma_f32 v[178:179], v[178:179], v[16:17], v[16:17] op_sel:[0,1,0] op_sel_hi:[1,1,0]
    v_pk_fma_f32 v[180:181], v[180:181], v[16:17], v[16:17] op_sel:[0,1,0] op_sel_hi:[1,1,0]
    v_pk_fma_f32 v[182:183], v[182:183], v[16:17], v[16:17] op_sel:[0,1,0] op_sel_hi:[1,1,0]
    v_pk_fma_f32 v[184:185], v[184:185], v[16:17], v[16:17] op_sel:[0,1,0] op_sel_hi:[1,1,0]
    v_pk_fma_f32 v[186:187], v[186:187], v[16:17], v[16:17] op_sel:[0,1,0] op_sel_hi:[1,1,0]
    v_pk_fma_f32 v[188:189], v[188:189], v[16:17], v[16:17] op_sel:[0,1,0] op_sel_hi:[1,1,0]
    v_pk_fma_f32 v[190:191], v[190:191], v[16:17], v[16:17] op_sel:[0,1,0] op_sel_hi:[1,1,0]
    v_pk_mul_f32 v[176:177], v[176:177], v[80:81]
    v_pk_mul_f32 v[178:179], v[178:179], v[82:83]
    v_pk_mul_f32 v[180:181], v[180:181], v[84:85]
    v_pk_mul_f32 v[182:183], v[182:183], v[86:87]
    v_pk_mul_f32 v[184:185], v[184:185], v[88:89]
    v_pk_mul_f32 v[186:187], v[186:187], v[90:91]
    v_pk_mul_f32 v[188:189], v[188:189], v[92:93]
    v_pk_mul_f32 v[190:191], v[190:191], v[94:95]
    v_exp_f32 v176, v176
    v_exp_f32 v177, v177
    v_exp_f32 v178, v178
    s_waitcnt lgkmcnt(4)
    v_mfma_f32_32x32x16_bf16 v[96:111], a[28:31], v[156:159], v[96:111]
    buffer_load_dwordx4 a[20:23], v1, s[4:7], s37 offen offset:1024
    ds_read_b128 v[152:155], v4 offset:35840
    v_exp_f32 v179, v179
    v_exp_f32 v180, v180
    v_exp_f32 v181, v181
    v_mfma_f32_32x32x16_bf16 v[96:111], a[32:35], v[160:163], v[96:111]
    buffer_load_dwordx4 a[24:27], v1, s[4:7], s37 offen offset:2048
    ds_read_b128 v[156:159], v4 offset:36352
    v_exp_f32 v182, v182
    v_exp_f32 v183, v183
    v_exp_f32 v184, v184
    v_mfma_f32_32x32x16_bf16 v[96:111], a[36:39], v[164:167], v[96:111]
    s_waitcnt lgkmcnt(3)
    buffer_load_dwordx4 a[28:31], v1, s[4:7], s37 offen offset:3072
    ds_read_b128 v[160:163], v4 offset:36864
    v_exp_f32 v185, v185
    v_exp_f32 v186, v186
    v_exp_f32 v187, v187
    v_mfma_f32_32x32x16_bf16 v[96:111], a[40:43], v[168:171], v[96:111]
    s_add_u32 s37, s47, 36864
    buffer_load_dwordx4 a[32:35], v1, s[4:7], s37 offen offset:0
    ds_read_b128 v[164:167], v4 offset:37376
    v_exp_f32 v188, v188
    v_exp_f32 v189, v189
    v_exp_f32 v190, v190
    v_mfma_f32_32x32x16_bf16 v[96:111], a[44:47], v[172:175], v[96:111]
    buffer_load_dwordx4 a[36:39], v1, s[4:7], s37 offen offset:1024
    ds_read_b128 v[168:171], v4 offset:37888
    v_exp_f32 v191, v191
    v_fma_f32 v176, v176, v18, v18
    v_fma_f32 v177, v177, v18, v18
    v_fma_f32 v178, v178, v18, v18
    v_fma_f32 v179, v179, v18, v18
    v_mfma_f32_32x32x16_bf16 v[96:111], a[48:51], v[144:147], v[96:111]
    s_waitcnt lgkmcnt(3)
    ds_read_b128 v[172:175], v4 offset:38400
    v_fma_f32 v180, v180, v18, v18
    v_fma_f32 v181, v181, v18, v18
    v_fma_f32 v182, v182, v18, v18
    v_fma_f32 v183, v183, v18, v18
    v_fma_f32 v184, v184, v18, v18
    v_fma_f32 v185, v185, v18, v18
    v_mfma_f32_32x32x16_bf16 v[96:111], a[52:55], v[148:151], v[96:111]
    buffer_load_dwordx4 a[40:43], v1, s[4:7], s37 offen offset:2048
    ds_read_b128 v[144:147], v4 offset:38912
    v_fma_f32 v186, v186, v18, v18
    v_fma_f32 v187, v187, v18, v18
    v_fma_f32 v188, v188, v18, v18
    v_fma_f32 v189, v189, v18, v18
    v_fma_f32 v190, v190, v18, v18
    v_fma_f32 v191, v191, v18, v18
    v_mfma_f32_32x32x16_bf16 v[96:111], a[56:59], v[152:155], v[96:111]
    buffer_load_dwordx4 a[44:47], v1, s[4:7], s37 offen offset:3072
    ds_read_b128 v[148:151], v4 offset:39424
    v_rcp_f32 v176, v176
    v_rcp_f32 v177, v177
    v_rcp_f32 v178, v178
    v_mfma_f32_32x32x16_bf16 v[96:111], a[60:63], v[156:159], v[96:111]
    s_waitcnt lgkmcnt(3)
    ds_read_b128 v[152:155], v4 offset:39936
    v_rcp_f32 v179, v179
    v_rcp_f32 v180, v180
    v_rcp_f32 v181, v181
    v_mfma_f32_32x32x16_bf16 v[96:111], a[64:67], v[160:163], v[96:111]
    s_add_u32 s37, s47, 40960
    buffer_load_dwordx4 a[48:51], v1, s[4:7], s37 offen offset:0
    ds_read_b128 v[156:159], v4 offset:40448
    v_rcp_f32 v182, v182
    v_rcp_f32 v183, v183
    v_rcp_f32 v184, v184
    v_mfma_f32_32x32x16_bf16 v[96:111], a[68:71], v[164:167], v[96:111]
    ds_read_b128 v[160:163], v4 offset:40960
    v_rcp_f32 v185, v185
    v_rcp_f32 v186, v186
    v_rcp_f32 v187, v187
    v_mfma_f32_32x32x16_bf16 v[96:111], a[72:75], v[168:171], v[96:111]
    s_waitcnt lgkmcnt(3)
    buffer_load_dwordx4 a[52:55], v1, s[4:7], s37 offen offset:1024
    ds_read_b128 v[164:167], v4 offset:41472
    v_rcp_f32 v188, v188
    v_rcp_f32 v189, v189
    v_rcp_f32 v190, v190
    v_mfma_f32_32x32x16_bf16 v[96:111], a[76:79], v[172:175], v[96:111]
    buffer_load_dwordx4 a[56:59], v1, s[4:7], s37 offen offset:2048
    ds_read_b128 v[168:171], v4 offset:41984
    v_rcp_f32 v191, v191
    v_mul_f32 v176, v176, v80
    v_mul_f32 v177, v177, v81
    v_mul_f32 v178, v178, v82
    v_mul_f32 v179, v179, v83
    v_mfma_f32_32x32x16_bf16 v[96:111], a[80:83], v[144:147], v[96:111]
    ds_read_b128 v[172:175], v4 offset:42496
    v_mul_f32 v180, v180, v84
    v_mul_f32 v181, v181, v85
    v_mul_f32 v182, v182, v86
    v_mul_f32 v183, v183, v87
    v_cvt_pk_bf16_f32 v48, v176, v177
    v_cvt_pk_bf16_f32 v49, v178, v179
    v_mfma_f32_32x32x16_bf16 v[96:111], a[84:87], v[148:151], v[96:111]
    s_waitcnt lgkmcnt(3)
    buffer_load_dwordx4 a[60:63], v1, s[4:7], s37 offen offset:3072
    ds_read_b128 v[144:147], v4 offset:2048
    v_cvt_pk_bf16_f32 v50, v180, v181
    v_cvt_pk_bf16_f32 v51, v182, v183
    s_add_u32 s29, s59, s20
    buffer_store_dwordx4 v[48:51], v1, s[4:7], s29 offen offset:0
    v_mul_f32 v184, v184, v88
    v_mul_f32 v185, v185, v89
    v_mul_f32 v186, v186, v90
    v_mul_f32 v187, v187, v91
    v_mfma_f32_32x32x16_bf16 v[96:111], a[88:91], v[152:155], v[96:111]
    ds_read_b128 v[148:151], v4 offset:2560
    v_mul_f32 v188, v188, v92
    v_mul_f32 v189, v189, v93
    v_mul_f32 v190, v190, v94
    v_mul_f32 v191, v191, v95
    v_cvt_pk_bf16_f32 v52, v184, v185
    v_cvt_pk_bf16_f32 v53, v186, v187
    v_mfma_f32_32x32x16_bf16 v[96:111], a[92:95], v[156:159], v[96:111]
    ds_read_b128 v[152:155], v4 offset:3072
    v_cvt_pk_bf16_f32 v54, v188, v189
    v_cvt_pk_bf16_f32 v55, v190, v191
    buffer_store_dwordx4 v[52:55], v1, s[4:7], s29 offen offset:1024
    v_mfma_f32_32x32x16_bf16 v[96:111], a[96:99], v[160:163], v[96:111]
    s_waitcnt lgkmcnt(3)
    ds_read_b128 v[156:159], v4 offset:3584
    v_mfma_f32_32x32x16_bf16 v[96:111], a[100:103], v[164:167], v[96:111]
    ds_read_b128 v[160:163], v4 offset:4096
    v_mfma_f32_32x32x16_bf16 v[96:111], a[104:107], v[168:171], v[96:111]
    s_add_u32 s37, s47, 45056
    buffer_load_dwordx4 a[64:67], v1, s[4:7], s37 offen offset:0
    ds_read_b128 v[164:167], v4 offset:4608
    v_mfma_f32_32x32x16_bf16 v[96:111], a[108:111], v[172:175], v[96:111]
    s_waitcnt lgkmcnt(3)
    ds_read_b128 v[168:171], v4 offset:5120
    v_mfma_f32_32x32x16_bf16 v[112:127], a[128:131], v[144:147], v[112:127]
    buffer_load_dwordx4 a[68:71], v1, s[4:7], s37 offen offset:1024
    ds_read_b128 v[172:175], v4 offset:5632
    v_mfma_f32_32x32x16_bf16 v[112:127], a[132:135], v[148:151], v[112:127]
    ds_read_b128 v[144:147], v4 offset:6144
    v_mfma_f32_32x32x16_bf16 v[112:127], a[136:139], v[152:155], v[112:127]
    ds_read_b128 v[148:151], v4 offset:6656
    s_nop 3
    v_pk_mul_f32 v[176:177], v[96:97], v[96:97]
    v_pk_mul_f32 v[178:179], v[98:99], v[98:99]
    v_pk_mul_f32 v[180:181], v[100:101], v[100:101]
    v_pk_mul_f32 v[182:183], v[102:103], v[102:103]
    v_pk_mul_f32 v[184:185], v[104:105], v[104:105]
    v_pk_mul_f32 v[186:187], v[106:107], v[106:107]
    v_pk_mul_f32 v[188:189], v[108:109], v[108:109]
    v_pk_mul_f32 v[190:191], v[110:111], v[110:111]
    v_pk_fma_f32 v[176:177], v[176:177], v[20:21], v[20:21] op_sel:[0,1,0] op_sel_hi:[1,1,0]
    v_pk_fma_f32 v[178:179], v[178:179], v[20:21], v[20:21] op_sel:[0,1,0] op_sel_hi:[1,1,0]
    v_pk_fma_f32 v[180:181], v[180:181], v[20:21], v[20:21] op_sel:[0,1,0] op_sel_hi:[1,1,0]
    v_pk_fma_f32 v[182:183], v[182:183], v[20:21], v[20:21] op_sel:[0,1,0] op_sel_hi:[1,1,0]
    v_pk_fma_f32 v[184:185], v[184:185], v[20:21], v[20:21] op_sel:[0,1,0] op_sel_hi:[1,1,0]
    v_pk_fma_f32 v[186:187], v[186:187], v[20:21], v[20:21] op_sel:[0,1,0] op_sel_hi:[1,1,0]
    v_pk_fma_f32 v[188:189], v[188:189], v[20:21], v[20:21] op_sel:[0,1,0] op_sel_hi:[1,1,0]
    v_pk_fma_f32 v[190:191], v[190:191], v[20:21], v[20:21] op_sel:[0,1,0] op_sel_hi:[1,1,0]
    v_pk_mul_f32 v[176:177], v[176:177], v[96:97]
    v_pk_mul_f32 v[178:179], v[178:179], v[98:99]
    v_pk_mul_f32 v[180:181], v[180:181], v[100:101]
    v_pk_mul_f32 v[182:183], v[182:183], v[102:103]
    v_pk_mul_f32 v[184:185], v[184:185], v[104:105]
    v_pk_mul_f32 v[186:187], v[186:187], v[106:107]
    v_pk_mul_f32 v[188:189], v[188:189], v[108:109]
    v_pk_mul_f32 v[190:191], v[190:191], v[110:111]
    v_exp_f32 v176, v176
    v_exp_f32 v177, v177
    v_exp_f32 v178, v178
    s_waitcnt lgkmcnt(4)
    v_mfma_f32_32x32x16_bf16 v[112:127], a[140:143], v[156:159], v[112:127]
    buffer_load_dwordx4 a[72:75], v1, s[4:7], s37 offen offset:2048
    ds_read_b128 v[152:155], v4 offset:7168
    v_exp_f32 v179, v179
    v_exp_f32 v180, v180
    v_exp_f32 v181, v181
    v_mfma_f32_32x32x16_bf16 v[112:127], a[144:147], v[160:163], v[112:127]
    buffer_load_dwordx4 a[76:79], v1, s[4:7], s37 offen offset:3072
    ds_read_b128 v[156:159], v4 offset:7680
    v_exp_f32 v182, v182
    v_exp_f32 v183, v183
    v_exp_f32 v184, v184
    v_mfma_f32_32x32x16_bf16 v[112:127], a[148:151], v[164:167], v[112:127]
    s_waitcnt lgkmcnt(3)
    s_add_u32 s37, s47, 49152
    buffer_load_dwordx4 a[80:83], v1, s[4:7], s37 offen offset:0
    ds_read_b128 v[160:163], v4 offset:8192
    v_exp_f32 v185, v185
    v_exp_f32 v186, v186
    v_exp_f32 v187, v187
    v_mfma_f32_32x32x16_bf16 v[112:127], a[152:155], v[168:171], v[112:127]
    buffer_load_dwordx4 a[84:87], v1, s[4:7], s37 offen offset:1024
    ds_read_b128 v[164:167], v4 offset:8704
    v_exp_f32 v188, v188
    v_exp_f32 v189, v189
    v_exp_f32 v190, v190
    v_mfma_f32_32x32x16_bf16 v[112:127], a[156:159], v[172:175], v[112:127]
    buffer_load_dwordx4 a[88:91], v1, s[4:7], s37 offen offset:2048
    ds_read_b128 v[168:171], v4 offset:9216
    v_exp_f32 v191, v191
    v_fma_f32 v176, v176, v22, v22
    v_fma_f32 v177, v177, v22, v22
    v_fma_f32 v178, v178, v22, v22
    v_fma_f32 v179, v179, v22, v22
    v_mfma_f32_32x32x16_bf16 v[112:127], a[160:163], v[144:147], v[112:127]
    s_waitcnt lgkmcnt(3)
    buffer_load_dwordx4 a[92:95], v1, s[4:7], s37 offen offset:3072
    ds_read_b128 v[172:175], v4 offset:9728
    v_fma_f32 v180, v180, v22, v22
    v_fma_f32 v181, v181, v22, v22
    v_fma_f32 v182, v182, v22, v22
    v_fma_f32 v183, v183, v22, v22
    v_fma_f32 v184, v184, v22, v22
    v_fma_f32 v185, v185, v22, v22
    v_mfma_f32_32x32x16_bf16 v[112:127], a[164:167], v[148:151], v[112:127]
    ds_read_b128 v[144:147], v4 offset:10240
    v_fma_f32 v186, v186, v22, v22
    v_fma_f32 v187, v187, v22, v22
    v_fma_f32 v188, v188, v22, v22
    v_fma_f32 v189, v189, v22, v22
    v_fma_f32 v190, v190, v22, v22
    v_fma_f32 v191, v191, v22, v22
    v_mfma_f32_32x32x16_bf16 v[112:127], a[168:171], v[152:155], v[112:127]
    s_add_u32 s37, s47, 53248
    buffer_load_dwordx4 a[96:99], v1, s[4:7], s37 offen offset:0
    ds_read_b128 v[148:151], v4 offset:10752
    v_rcp_f32 v176, v176
    v_rcp_f32 v177, v177
    v_rcp_f32 v178, v178
    v_mfma_f32_32x32x16_bf16 v[112:127], a[172:175], v[156:159], v[112:127]
    s_waitcnt lgkmcnt(3)
    buffer_load_dwordx4 a[100:103], v1, s[4:7], s37 offen offset:1024
    ds_read_b128 v[152:155], v4 offset:11264
    v_rcp_f32 v179, v179
    v_rcp_f32 v180, v180
    v_rcp_f32 v181, v181
    v_mfma_f32_32x32x16_bf16 v[112:127], a[176:179], v[160:163], v[112:127]
    ds_read_b128 v[156:159], v4 offset:11776
    v_rcp_f32 v182, v182
    v_rcp_f32 v183, v183
    v_rcp_f32 v184, v184
    v_mfma_f32_32x32x16_bf16 v[112:127], a[180:183], v[164:167], v[112:127]
    s_waitcnt vmcnt(10)
    buffer_load_dwordx4 a[104:107], v1, s[4:7], s37 offen offset:2048
    ds_read_b128 v[160:163], v4 offset:12288
    s_mov_b64 exec, 1
    buffer_store_dword v15, off, s[4:7], s65 offset:0
    s_mov_b64 exec, -1
    v_rcp_f32 v185, v185
    v_rcp_f32 v186, v186
    v_rcp_f32 v187, v187
    v_mfma_f32_32x32x16_bf16 v[112:127], a[184:187], v[168:171], v[112:127]
    s_waitcnt lgkmcnt(3)
    buffer_load_dwordx4 a[108:111], v1, s[4:7], s37 offen offset:3072
    ds_read_b128 v[164:167], v4 offset:12800
    v_rcp_f32 v188, v188
    v_rcp_f32 v189, v189
    v_rcp_f32 v190, v190
    v_mfma_f32_32x32x16_bf16 v[112:127], a[188:191], v[172:175], v[112:127]
    ds_read_b128 v[168:171], v4 offset:13312
    v_rcp_f32 v191, v191
    v_mul_f32 v176, v176, v96
    v_mul_f32 v177, v177, v97
    v_mul_f32 v178, v178, v98
    v_mul_f32 v179, v179, v99
    v_mfma_f32_32x32x16_bf16 v[112:127], a[192:195], v[144:147], v[112:127]
    buffer_load_dwordx4 v1, s[4:7], s38 offen offset:2048 lds
    ds_read_b128 v[172:175], v4 offset:13824
    v_mul_f32 v180, v180, v100
    v_mul_f32 v181, v181, v101
    v_mul_f32 v182, v182, v102
    v_mul_f32 v183, v183, v103
    v_cvt_pk_bf16_f32 v56, v176, v177
    v_cvt_pk_bf16_f32 v57, v178, v179
    v_mfma_f32_32x32x16_bf16 v[112:127], a[196:199], v[148:151], v[112:127]
    s_waitcnt lgkmcnt(3)
    buffer_load_dwordx4 v1, s[4:7], s38 offen offset:3072 lds
    ds_read_b128 v[144:147], v4 offset:30720
    v_cvt_pk_bf16_f32 v58, v180, v181
    v_cvt_pk_bf16_f32 v59, v182, v183
    s_add_u32 s29, s48, 0
    buffer_store_dwordx4 v[56:59], v1, s[4:7], s29 offen offset:2048 sc1
    v_mul_f32 v184, v184, v104
    v_mul_f32 v185, v185, v105
    v_mul_f32 v186, v186, v106
    v_mul_f32 v187, v187, v107
    v_mfma_f32_32x32x16_bf16 v[112:127], a[200:203], v[152:155], v[112:127]
    ds_read_b128 v[148:151], v4 offset:31232
    v_mul_f32 v188, v188, v108
    v_mul_f32 v189, v189, v109
    v_mul_f32 v190, v190, v110
    v_mul_f32 v191, v191, v111
    v_cvt_pk_bf16_f32 v60, v184, v185
    v_cvt_pk_bf16_f32 v61, v186, v187
    v_mfma_f32_32x32x16_bf16 v[112:127], a[204:207], v[156:159], v[112:127]
    ds_read_b128 v[152:155], v4 offset:31744
    v_cvt_pk_bf16_f32 v62, v188, v189
    v_cvt_pk_bf16_f32 v63, v190, v191
    buffer_store_dwordx4 v[60:63], v1, s[4:7], s29 offen offset:3072 sc1
    v_mfma_f32_32x32x16_bf16 v[112:127], a[208:211], v[160:163], v[112:127]
    s_waitcnt lgkmcnt(3)
    ds_read_b128 v[156:159], v4 offset:32256
    v_mfma_f32_32x32x16_bf16 v[112:127], a[212:215], v[164:167], v[112:127]
    ds_read_b128 v[160:163], v4 offset:32768
    v_mfma_f32_32x32x16_bf16 v[112:127], a[216:219], v[168:171], v[112:127]
    s_add_u32 m0, s67, 8192
    s_add_u32 s38, s66, 8192
    buffer_load_dwordx4 v1, s[4:7], s38 offen offset:0 lds
    ds_read_b128 v[164:167], v4 offset:33280
    v_mfma_f32_32x32x16_bf16 v[112:127], a[220:223], v[172:175], v[112:127]
    s_waitcnt lgkmcnt(3)
    ds_read_b128 v[168:171], v4 offset:33792
    v_mfma_f32_32x32x16_bf16 v[128:143], a[128:131], v[144:147], v[128:143]
    buffer_load_dwordx4 v1, s[4:7], s38 offen offset:1024 lds
    ds_read_b128 v[172:175], v4 offset:34304
    v_mfma_f32_32x32x16_bf16 v[128:143], a[132:135], v[148:151], v[128:143]
    ds_read_b128 v[144:147], v4 offset:34816
    v_mfma_f32_32x32x16_bf16 v[128:143], a[136:139], v[152:155], v[128:143]
    ds_read_b128 v[148:151], v4 offset:35328
    s_add_u32 s36, s64, 0
    buffer_load_dword v10, v3, s[4:7], s36 offen sc1
    s_nop 1
    v_pk_mul_f32 v[176:177], v[112:113], v[112:113]
    v_pk_mul_f32 v[178:179], v[114:115], v[114:115]
    v_pk_mul_f32 v[180:181], v[116:117], v[116:117]
    v_pk_mul_f32 v[182:183], v[118:119], v[118:119]
    v_pk_mul_f32 v[184:185], v[120:121], v[120:121]
    v_pk_mul_f32 v[186:187], v[122:123], v[122:123]
    v_pk_mul_f32 v[188:189], v[124:125], v[124:125]
    v_pk_mul_f32 v[190:191], v[126:127], v[126:127]
    v_pk_fma_f32 v[176:177], v[176:177], v[16:17], v[16:17] op_sel:[0,1,0] op_sel_hi:[1,1,0]
    v_pk_fma_f32 v[178:179], v[178:179], v[16:17], v[16:17] op_sel:[0,1,0] op_sel_hi:[1,1,0]
    v_pk_fma_f32 v[180:181], v[180:181], v[16:17], v[16:17] op_sel:[0,1,0] op_sel_hi:[1,1,0]
    v_pk_fma_f32 v[182:183], v[182:183], v[16:17], v[16:17] op_sel:[0,1,0] op_sel_hi:[1,1,0]
    v_pk_fma_f32 v[184:185], v[184:185], v[16:17], v[16:17] op_sel:[0,1,0] op_sel_hi:[1,1,0]
    v_pk_fma_f32 v[186:187], v[186:187], v[16:17], v[16:17] op_sel:[0,1,0] op_sel_hi:[1,1,0]
    v_pk_fma_f32 v[188:189], v[188:189], v[16:17], v[16:17] op_sel:[0,1,0] op_sel_hi:[1,1,0]
    v_pk_fma_f32 v[190:191], v[190:191], v[16:17], v[16:17] op_sel:[0,1,0] op_sel_hi:[1,1,0]
    v_pk_mul_f32 v[176:177], v[176:177], v[112:113]
    v_pk_mul_f32 v[178:179], v[178:179], v[114:115]
    v_pk_mul_f32 v[180:181], v[180:181], v[116:117]
    v_pk_mul_f32 v[182:183], v[182:183], v[118:119]
    v_pk_mul_f32 v[184:185], v[184:185], v[120:121]
    v_pk_mul_f32 v[186:187], v[186:187], v[122:123]
    v_pk_mul_f32 v[188:189], v[188:189], v[124:125]
    v_pk_mul_f32 v[190:191], v[190:191], v[126:127]
    v_exp_f32 v176, v176
    v_exp_f32 v177, v177
    v_exp_f32 v178, v178
    s_waitcnt lgkmcnt(4)
    v_mfma_f32_32x32x16_bf16 v[128:143], a[140:143], v[156:159], v[128:143]
    buffer_load_dwordx4 v1, s[4:7], s38 offen offset:2048 lds
    ds_read_b128 v[152:155], v4 offset:35840
    v_exp_f32 v179, v179
    v_exp_f32 v180, v180
    v_exp_f32 v181, v181
    v_mfma_f32_32x32x16_bf16 v[128:143], a[144:147], v[160:163], v[128:143]
    buffer_load_dwordx4 v1, s[4:7], s38 offen offset:3072 lds
    ds_read_b128 v[156:159], v4 offset:36352
    v_exp_f32 v182, v182
    v_exp_f32 v183, v183
    v_exp_f32 v184, v184
    v_mfma_f32_32x32x16_bf16 v[128:143], a[148:151], v[164:167], v[128:143]
    s_waitcnt lgkmcnt(3)
    s_add_u32 m0, s67, 12288
    s_add_u32 s38, s66, 12288
    buffer_load_dwordx4 v1, s[4:7], s38 offen offset:0 lds
    ds_read_b128 v[160:163], v4 offset:36864
    v_exp_f32 v185, v185
    v_exp_f32 v186, v186
    v_exp_f32 v187, v187
    v_mfma_f32_32x32x16_bf16 v[128:143], a[152:155], v[168:171], v[128:143]
    buffer_load_dwordx4 v1, s[4:7], s38 offen offset:1024 lds
    ds_read_b128 v[164:167], v4 offset:37376
    v_exp_f32 v188, v188
    v_exp_f32 v189, v189
    v_exp_f32 v190, v190
    v_mfma_f32_32x32x16_bf16 v[128:143], a[156:159], v[172:175], v[128:143]
    buffer_load_dwordx4 v1, s[4:7], s38 offen offset:2048 lds
    ds_read_b128 v[168:171], v4 offset:37888
    v_exp_f32 v191, v191
    v_fma_f32 v176, v176, v18, v18
    v_fma_f32 v177, v177, v18, v18
    v_fma_f32 v178, v178, v18, v18
    v_fma_f32 v179, v179, v18, v18
    v_mfma_f32_32x32x16_bf16 v[128:143], a[160:163], v[144:147], v[128:143]
    s_waitcnt lgkmcnt(3)
    buffer_load_dwordx4 v1, s[4:7], s38 offen offset:3072 lds
    ds_read_b128 v[172:175], v4 offset:38400
    v_fma_f32 v180, v180, v18, v18
    v_fma_f32 v181, v181, v18, v18
    v_fma_f32 v182, v182, v18, v18
    v_fma_f32 v183, v183, v18, v18
    v_fma_f32 v184, v184, v18, v18
    v_fma_f32 v185, v185, v18, v18
    v_mfma_f32_32x32x16_bf16 v[128:143], a[164:167], v[148:151], v[128:143]
    ds_read_b128 v[144:147], v4 offset:38912
    v_fma_f32 v186, v186, v18, v18
    v_fma_f32 v187, v187, v18, v18
    v_fma_f32 v188, v188, v18, v18
    v_fma_f32 v189, v189, v18, v18
    v_fma_f32 v190, v190, v18, v18
    v_fma_f32 v191, v191, v18, v18
    v_mfma_f32_32x32x16_bf16 v[128:143], a[168:171], v[152:155], v[128:143]
    s_add_u32 m0, s67, 16384
    s_add_u32 s38, s66, 16384
    buffer_load_dwordx4 v1, s[4:7], s38 offen offset:0 lds
    ds_read_b128 v[148:151], v4 offset:39424
    v_rcp_f32 v176, v176
    v_rcp_f32 v177, v177
    v_rcp_f32 v178, v178
    v_mfma_f32_32x32x16_bf16 v[128:143], a[172:175], v[156:159], v[128:143]
    s_waitcnt lgkmcnt(3)
    buffer_load_dwordx4 v1, s[4:7], s38 offen offset:1024 lds
    ds_read_b128 v[152:155], v4 offset:39936
    v_rcp_f32 v179, v179
    v_rcp_f32 v180, v180
    v_rcp_f32 v181, v181
    v_mfma_f32_32x32x16_bf16 v[128:143], a[176:179], v[160:163], v[128:143]
    ds_read_b128 v[156:159], v4 offset:40448
    v_rcp_f32 v182, v182
    v_rcp_f32 v183, v183
    v_rcp_f32 v184, v184
    v_mfma_f32_32x32x16_bf16 v[128:143], a[180:183], v[164:167], v[128:143]
    s_waitcnt vmcnt(11)
    buffer_load_dwordx4 v1, s[4:7], s38 offen offset:2048 lds
    ds_read_b128 v[160:163], v4 offset:40960
    s_mov_b64 exec, 1
    buffer_store_dword v15, off, s[4:7], s65 offset:32
    s_mov_b64 exec, -1
    s_waitcnt vmcnt(10)
    v_cmp_eq_u32 vcc, 0, v10
    s_nop 0
    s_cbranch_vccz Lpolld7
    s_mov_b32 s39, 0
Lpoll7:
    buffer_load_dword v10, v3, s[4:7], s36 offen sc1
    s_waitcnt vmcnt(0)
    v_cmp_eq_u32 vcc, 0, v10
    s_nop 0
    s_cbranch_vccz Lpolld7
    s_add_u32 s39, s39, 1
    s_cmp_lt_u32 s39, 200000
    s_cbranch_scc1 Lpoll7
Lpolld7:
    s_nop 0
    v_rcp_f32 v185, v185
    v_rcp_f32 v186, v186
    v_rcp_f32 v187, v187
    v_mfma_f32_32x32x16_bf16 v[128:143], a[184:187], v[168:171], v[128:143]
    s_waitcnt lgkmcnt(3)
    s_add_u32 s37, s59, s21
    buffer_load_dwordx4 a[128:131], v1, s[4:7], s37 offen offset:0 sc1
    ds_read_b128 v[164:167], v4 offset:41472
    v_rcp_f32 v188, v188
    v_rcp_f32 v189, v189
    v_rcp_f32 v190, v190
    v_mfma_f32_32x32x16_bf16 v[128:143], a[188:191], v[172:175], v[128:143]
    buffer_load_dwordx4 a[132:135], v1, s[4:7], s37 offen offset:1024 sc1
    ds_read_b128 v[168:171], v4 offset:41984
    v_rcp_f32 v191, v191
    v_mul_f32 v176, v176, v112
    v_mul_f32 v177, v177, v113
    v_mul_f32 v178, v178, v114
    v_mul_f32 v179, v179, v115
    v_mfma_f32_32x32x16_bf16 v[128:143], a[192:195], v[144:147], v[128:143]
    s_add_u32 s37, s59, s22
    buffer_load_dwordx4 a[136:139], v1, s[4:7], s37 offen offset:0 sc1
    ds_read_b128 v[172:175], v4 offset:42496
    v_mul_f32 v180, v180, v116
    v_mul_f32 v181, v181, v117
    v_mul_f32 v182, v182, v118
    v_mul_f32 v183, v183, v119
    v_cvt_pk_bf16_f32 v64, v176, v177
    v_cvt_pk_bf16_f32 v65, v178, v179
    v_mfma_f32_32x32x16_bf16 v[128:143], a[196:199], v[148:151], v[128:143]
    s_waitcnt lgkmcnt(3)
    v_cvt_pk_bf16_f32 v66, v180, v181
    v_cvt_pk_bf16_f32 v67, v182, v183
    s_add_u32 s29, s42, s20
    buffer_store_dwordx4 v[64:67], v1, s[4:7], s29 offen offset:0
    v_mul_f32 v184, v184, v120
    v_mul_f32 v185, v185, v121
    v_mul_f32 v186, v186, v122
    v_mul_f32 v187, v187, v123
    v_mfma_f32_32x32x16_bf16 v[128:143], a[200:203], v[152:155], v[128:143]
    v_mul_f32 v188, v188, v124
    v_mul_f32 v189, v189, v125
    v_mul_f32 v190, v190, v126
    v_mul_f32 v191, v191, v127
    v_cvt_pk_bf16_f32 v68, v184, v185
    v_cvt_pk_bf16_f32 v69, v186, v187
    v_mfma_f32_32x32x16_bf16 v[128:143], a[204:207], v[156:159], v[128:143]
    v_cvt_pk_bf16_f32 v70, v188, v189
    v_cvt_pk_bf16_f32 v71, v190, v191
    buffer_store_dwordx4 v[68:71], v1, s[4:7], s29 offen offset:1024
    v_mfma_f32_32x32x16_bf16 v[128:143], a[208:211], v[160:163], v[128:143]
    s_waitcnt lgkmcnt(0)
    v_mfma_f32_32x32x16_bf16 v[128:143], a[212:215], v[164:167], v[128:143]
    v_mfma_f32_32x32x16_bf16 v[128:143], a[216:219], v[168:171], v[128:143]
    buffer_load_dwordx4 a[140:143], v1, s[4:7], s37 offen offset:1024 sc1
    v_mfma_f32_32x32x16_bf16 v[128:143], a[220:223], v[172:175], v[128:143]
    v_mfma_f32_32x32x16_bf16 v[80:95], a[224:227], v[48:51], 0
    s_add_u32 s37, s59, s23
    buffer_load_dwordx4 a[144:147], v1, s[4:7], s37 offen offset:0 sc1
    v_mfma_f32_32x32x16_bf16 v[96:111], a[228:231], v[48:51], 0
    v_mfma_f32_32x32x16_bf16 v[80:95], a[232:235], v[52:55], v[80:95]
    buffer_load_dwordx4 a[148:151], v1, s[4:7], s37 offen offset:1024 sc1
    s_add_u32 s36, s64, 32
    buffer_load_dword v10, v3, s[4:7], s36 offen sc1
    s_nop 3
    v_pk_mul_f32 v[176:177], v[128:129], v[128:129]
    v_pk_mul_f32 v[178:179], v[130:131], v[130:131]
    v_pk_mul_f32 v[180:181], v[132:133], v[132:133]
    v_pk_mul_f32 v[182:183], v[134:135], v[134:135]
    v_pk_mul_f32 v[184:185], v[136:137], v[136:137]
    v_pk_mul_f32 v[186:187], v[138:139], v[138:139]
    v_pk_mul_f32 v[188:189], v[140:141], v[140:141]
    v_pk_mul_f32 v[190:191], v[142:143], v[142:143]
    v_pk_fma_f32 v[176:177], v[176:177], v[20:21], v[20:21] op_sel:[0,1,0] op_sel_hi:[1,1,0]
    v_pk_fma_f32 v[178:179], v[178:179], v[20:21], v[20:21] op_sel:[0,1,0] op_sel_hi:[1,1,0]
    v_pk_fma_f32 v[180:181], v[180:181], v[20:21], v[20:21] op_sel:[0,1,0] op_sel_hi:[1,1,0]
    v_pk_fma_f32 v[182:183], v[182:183], v[20:21], v[20:21] op_sel:[0,1,0] op_sel_hi:[1,1,0]
    v_pk_fma_f32 v[184:185], v[184:185], v[20:21], v[20:21] op_sel:[0,1,0] op_sel_hi:[1,1,0]
    v_pk_fma_f32 v[186:187], v[186:187], v[20:21], v[20:21] op_sel:[0,1,0] op_sel_hi:[1,1,0]
    v_pk_fma_f32 v[188:189], v[188:189], v[20:21], v[20:21] op_sel:[0,1,0] op_sel_hi:[1,1,0]
    v_pk_fma_f32 v[190:191], v[190:191], v[20:21], v[20:21] op_sel:[0,1,0] op_sel_hi:[1,1,0]
    v_pk_mul_f32 v[176:177], v[176:177], v[128:129]
    v_pk_mul_f32 v[178:179], v[178:179], v[130:131]
    v_pk_mul_f32 v[180:181], v[180:181], v[132:133]
    v_pk_mul_f32 v[182:183], v[182:183], v[134:135]
    v_pk_mul_f32 v[184:185], v[184:185], v[136:137]
    v_pk_mul_f32 v[186:187], v[186:187], v[138:139]
    v_pk_mul_f32 v[188:189], v[188:189], v[140:141]
    v_pk_mul_f32 v[190:191], v[190:191], v[142:143]
    v_exp_f32 v176, v176
    v_exp_f32 v177, v177
    v_exp_f32 v178, v178
    v_mfma_f32_32x32x16_bf16 v[96:111], a[236:239], v[52:55], v[96:111]
    s_waitcnt vmcnt(8)
    s_add_u32 s37, s59, s24
    buffer_load_dwordx4 a[152:155], v1, s[4:7], s37 offen offset:0 sc1
    v_exp_f32 v179, v179
    v_exp_f32 v180, v180
    v_exp_f32 v181, v181
    v_mfma_f32_32x32x16_bf16 v[80:95], a[240:243], a[128:131], v[80:95]
    buffer_load_dwordx4 a[156:159], v1, s[4:7], s37 offen offset:1024 sc1
    v_exp_f32 v182, v182
    v_exp_f32 v183, v183
    v_exp_f32 v184, v184
    v_mfma_f32_32x32x16_bf16 v[96:111], a[244:247], a[128:131], v[96:111]
    s_waitcnt vmcnt(9)
    s_add_u32 s37, s59, s25
    buffer_load_dwordx4 a[160:163], v1, s[4:7], s37 offen offset:0 sc1
    v_exp_f32 v185, v185
    v_exp_f32 v186, v186
    v_mfma_f32_32x32x16_bf16 v[80:95], a[248:251], a[132:135], v[80:95]
    buffer_load_dwordx4 a[164:167], v1, s[4:7], s37 offen offset:1024 sc1
    v_exp_f32 v187, v187
    v_exp_f32 v188, v188
    v_exp_f32 v189, v189
    v_mfma_f32_32x32x16_bf16 v[96:111], a[252:255], a[132:135], v[96:111]
    s_waitcnt vmcnt(10)
    v_exp_f32 v190, v190
    v_exp_f32 v191, v191
    v_fma_f32 v176, v176, v22, v22
    v_mfma_f32_32x32x16_bf16 v[80:95], v[192:195], a[136:139], v[80:95]
    s_add_u32 s37, s59, s26
    buffer_load_dwordx4 a[168:171], v1, s[4:7], s37 offen offset:0 sc1
    v_fma_f32 v177, v177, v22, v22
    v_fma_f32 v178, v178, v22, v22
    v_fma_f32 v179, v179, v22, v22
    v_fma_f32 v180, v180, v22, v22
    v_fma_f32 v181, v181, v22, v22
    v_fma_f32 v182, v182, v22, v22
    v_mfma_f32_32x32x16_bf16 v[96:111], v[196:199], a[136:139], v[96:111]
    s_waitcnt vmcnt(8)
    v_fma_f32 v183, v183, v22, v22
    v_fma_f32 v184, v184, v22, v22
    v_fma_f32 v185, v185, v22, v22
    v_fma_f32 v186, v186, v22, v22
    v_fma_f32 v187, v187, v22, v22
    v_mfma_f32_32x32x16_bf16 v[80:95], v[200:203], a[140:143], v[80:95]
    buffer_load_dwordx4 a[172:175], v1, s[4:7], s37 offen offset:1024 sc1
    v_fma_f32 v188, v188, v22, v22
    v_fma_f32 v189, v189, v22, v22
    v_fma_f32 v190, v190, v22, v22
    v_fma_f32 v191, v191, v22, v22
    v_rcp_f32 v176, v176
    v_mfma_f32_32x32x16_bf16 v[96:111], v[204:207], a[140:143], v[96:111]
    s_waitcnt vmcnt(8)
    buffer_load_dwordx4 v1, s[4:7], s38 offen offset:3072 lds
    v_rcp_f32 v177, v177
    v_rcp_f32 v178, v178
    v_rcp_f32 v179, v179
    v_mfma_f32_32x32x16_bf16 v[80:95], v[208:211], a[144:147], v[80:95]
    v_rcp_f32 v180, v180
    v_rcp_f32 v181, v181
    v_rcp_f32 v182, v182
    v_mfma_f32_32x32x16_bf16 v[96:111], v[212:215], a[144:147], v[96:111]
    s_add_u32 m0, s67, 20480
    s_add_u32 s38, s66, 20480
    buffer_load_dwordx4 v1, s[4:7], s38 offen offset:0 lds
    s_mov_b64 exec, 1
    buffer_store_dword v15, off, s[4:7], s65 offset:64
    s_mov_b64 exec, -1
    s_waitcnt vmcnt(9)
    v_cmp_eq_u32 vcc, 0, v10
    s_nop 0
    s_cbranch_vccz Lpolld8
    s_mov_b32 s39, 0
Lpoll8:
    buffer_load_dword v10, v3, s[4:7], s36 offen sc1
    s_waitcnt vmcnt(0)
    v_cmp_eq_u32 vcc, 0, v10
    s_nop 0
    s_cbranch_vccz Lpolld8
    s_add_u32 s39, s39, 1
    s_cmp_lt_u32 s39, 200000
    s_cbranch_scc1 Lpoll8
Lpolld8:
    s_nop 0
    v_rcp_f32 v183, v183
    v_rcp_f32 v184, v184
    v_mfma_f32_32x32x16_bf16 v[80:95], v[216:219], a[148:151], v[80:95]
    buffer_load_dwordx4 a[176:179], v1, s[4:7], s49 offen offset:2048 sc1
    v_rcp_f32 v185, v185
    v_rcp_f32 v186, v186
    v_rcp_f32 v187, v187
    v_mfma_f32_32x32x16_bf16 v[96:111], v[220:223], a[148:151], v[96:111]
    s_waitcnt vmcnt(9)
    v_rcp_f32 v188, v188
    v_rcp_f32 v189, v189
    v_rcp_f32 v190, v190
    v_mfma_f32_32x32x16_bf16 v[80:95], v[224:227], a[152:155], v[80:95]
    buffer_load_dwordx4 a[180:183], v1, s[4:7], s49 offen offset:3072 sc1
    v_rcp_f32 v191, v191
    v_mul_f32 v176, v176, v128
    v_mul_f32 v177, v177, v129
    v_mul_f32 v178, v178, v130
    v_mfma_f32_32x32x16_bf16 v[96:111], v[228:231], a[152:155], v[96:111]
    s_waitcnt vmcnt(9)
    v_mul_f32 v179, v179, v131
    v_mul_f32 v180, v180, v132
    v_mul_f32 v181, v181, v133
    v_mul_f32 v182, v182, v134
    v_mul_f32 v183, v183, v135
    v_mfma_f32_32x32x16_bf16 v[80:95], v[232:235], a[156:159], v[80:95]
    buffer_load_dwordx4 a[184:187], v1, s[4:7], s50 offen offset:2048 sc1
    v_cvt_pk_bf16_f32 v72, v176, v177
    v_cvt_pk_bf16_f32 v73, v178, v179
    v_cvt_pk_bf16_f32 v74, v180, v181
    v_cvt_pk_bf16_f32 v75, v182, v183
    s_add_u32 s29, s48, 4096
    buffer_store_dwordx4 v[72:75], v1, s[4:7], s29 offen offset:2048 sc1
    v_mul_f32 v184, v184, v136
    v_mul_f32 v185, v185, v137
    v_mfma_f32_32x32x16_bf16 v[96:111], v[236:239], a[156:159], v[96:111]
    s_waitcnt vmcnt(10)
    v_mul_f32 v186, v186, v138
    v_mul_f32 v187, v187, v139
    v_mul_f32 v188, v188, v140
    v_mul_f32 v189, v189, v141
    v_mul_f32 v190, v190, v142
    v_mfma_f32_32x32x16_bf16 v[80:95], v[240:243], a[160:163], v[80:95]
    v_mul_f32 v191, v191, v143
    v_cvt_pk_bf16_f32 v76, v184, v185
    v_cvt_pk_bf16_f32 v77, v186, v187
    v_cvt_pk_bf16_f32 v78, v188, v189
    v_cvt_pk_bf16_f32 v79, v190, v191
    buffer_store_dwordx4 v[76:79], v1, s[4:7], s29 offen offset:3072 sc1
    v_mfma_f32_32x32x16_bf16 v[96:111], v[244:247], a[160:163], v[96:111]
    s_waitcnt vmcnt(10)
    v_mfma_f32_32x32x16_bf16 v[80:95], v[248:251], a[164:167], v[80:95]
    v_mfma_f32_32x32x16_bf16 v[96:111], v[252:255], a[164:167], v[96:111]
    s_waitcnt vmcnt(9)
    buffer_load_dwordx4 a[188:191], v1, s[4:7], s50 offen offset:3072 sc1
    v_mfma_f32_32x32x16_bf16 v[80:95], a[0:3], a[168:171], v[80:95]
    v_mfma_f32_32x32x16_bf16 v[96:111], a[4:7], a[168:171], v[96:111]
    s_waitcnt vmcnt(9)
    buffer_load_dwordx4 a[192:195], v1, s[4:7], s51 offen offset:2048 sc1
    v_mfma_f32_32x32x16_bf16 v[80:95], a[8:11], a[172:175], v[80:95]
    v_mfma_f32_32x32x16_bf16 v[96:111], a[12:15], a[172:175], v[96:111]
    v_mfma_f32_32x32x16_bf16 v[112:127], a[224:227], v[56:59], 0
    buffer_load_dwordx4 a[196:199], v1, s[4:7], s51 offen offset:3072 sc1
    v_mfma_f32_32x32x16_bf16 v[128:143], a[228:231], v[56:59], 0
    v_mfma_f32_32x32x16_bf16 v[112:127], a[232:235], v[60:63], v[112:127]
    buffer_load_dwordx4 a[200:203], v1, s[4:7], s52 offen offset:2048 sc1
    s_add_u32 s36, s64, 64
    buffer_load_dword v10, v3, s[4:7], s36 offen sc1
    s_barrier
    v_mfma_f32_32x32x16_bf16 v[128:143], a[236:239], v[60:63], v[128:143]
    s_waitcnt vmcnt(9)
    v_mfma_f32_32x32x16_bf16 v[112:127], a[240:243], a[176:179], v[112:127]
    buffer_load_dwordx4 a[204:207], v1, s[4:7], s52 offen offset:3072 sc1
    v_mfma_f32_32x32x16_bf16 v[128:143], a[244:247], a[176:179], v[128:143]
    s_waitcnt vmcnt(9)
    v_mfma_f32_32x32x16_bf16 v[112:127], a[248:251], a[180:183], v[112:127]
    buffer_load_dwordx4 a[208:211], v1, s[4:7], s53 offen offset:2048 sc1
    v_mfma_f32_32x32x16_bf16 v[128:143], a[252:255], a[180:183], v[128:143]
    s_waitcnt vmcnt(9)
    v_mfma_f32_32x32x16_bf16 v[112:127], v[192:195], a[184:187], v[112:127]
    buffer_load_dwordx4 a[212:215], v1, s[4:7], s53 offen offset:3072 sc1
    v_mfma_f32_32x32x16_bf16 v[128:143], v[196:199], a[184:187], v[128:143]
    s_waitcnt vmcnt(7)
    v_mfma_f32_32x32x16_bf16 v[112:127], v[200:203], a[188:191], v[112:127]
    v_mfma_f32_32x32x16_bf16 v[128:143], v[204:207], a[188:191], v[128:143]
    s_waitcnt vmcnt(6)
    buffer_load_dwordx4 a[216:219], v1, s[4:7], s54 offen offset:2048 sc1
    v_mfma_f32_32x32x16_bf16 v[112:127], v[208:211], a[192:195], v[112:127]
    v_mfma_f32_32x32x16_bf16 v[128:143], v[212:215], a[192:195], v[128:143]
    buffer_load_dwordx4 a[220:223], v1, s[4:7], s54 offen offset:3072 sc1
    s_mov_b64 exec, 1
    buffer_store_dword v15, off, s[4:7], s65 offset:96
    s_mov_b64 exec, -1
    s_waitcnt vmcnt(6)
    v_cmp_eq_u32 vcc, 0, v10
    s_nop 0
    s_cbranch_vccz Lpolld9
    s_mov_b32 s39, 0
Lpoll9:
    buffer_load_dword v10, v3, s[4:7], s36 offen sc1
    s_waitcnt vmcnt(0)
    v_cmp_eq_u32 vcc, 0, v10
    s_nop 0
    s_cbranch_vccz Lpolld9
    s_add_u32 s39, s39, 1
    s_cmp_lt_u32 s39, 200000
    s_cbranch_scc1 Lpoll9
Lpolld9:
    s_nop 0
    v_mfma_f32_32x32x16_bf16 v[112:127], v[216:219], a[196:199], v[112:127]
    s_add_u32 s37, s42, s21
    buffer_load_dwordx4 a[128:131], v1, s[4:7], s37 offen offset:0 sc1
    v_mfma_f32_32x32x16_bf16 v[128:143], v[220:223], a[196:199], v[128:143]
    v_mfma_f32_32x32x16_bf16 v[112:127], v[224:227], a[200:203], v[112:127]
    buffer_load_dwordx4 a[132:135], v1, s[4:7], s37 offen offset:1024 sc1
    v_mfma_f32_32x32x16_bf16 v[128:143], v[228:231], a[200:203], v[128:143]
    s_waitcnt vmcnt(7)
    v_mfma_f32_32x32x16_bf16 v[112:127], v[232:235], a[204:207], v[112:127]
    v_mfma_f32_32x32x16_bf16 v[128:143], v[236:239], a[204:207], v[128:143]
    s_waitcnt vmcnt(6)
    s_add_u32 s37, s42, s22
    buffer_load_dwordx4 a[136:139], v1, s[4:7], s37 offen offset:0 sc1
    v_mfma_f32_32x32x16_bf16 v[112:127], v[240:243], a[208:211], v[112:127]
    v_mfma_f32_32x32x16_bf16 v[128:143], v[244:247], a[208:211], v[128:143]
    s_waitcnt vmcnt(6)
    buffer_load_dwordx4 a[140:143], v1, s[4:7], s37 offen offset:1024 sc1
    v_mfma_f32_32x32x16_bf16 v[112:127], v[248:251], a[212:215], v[112:127]
    v_mfma_f32_32x32x16_bf16 v[128:143], v[252:255], a[212:215], v[128:143]
    s_waitcnt vmcnt(6)
    s_add_u32 s37, s42, s23
    buffer_load_dwordx4 a[144:147], v1, s[4:7], s37 offen offset:0 sc1
    v_mfma_f32_32x32x16_bf16 v[112:127], a[0:3], a[216:219], v[112:127]
    v_mfma_f32_32x32x16_bf16 v[128:143], a[4:7], a[216:219], v[128:143]
    s_waitcnt vmcnt(6)
    buffer_load_dwordx4 a[148:151], v1, s[4:7], s37 offen offset:1024 sc1
    v_mfma_f32_32x32x16_bf16 v[112:127], a[8:11], a[220:223], v[112:127]
    v_mfma_f32_32x32x16_bf16 v[128:143], a[12:15], a[220:223], v[128:143]
    v_mfma_f32_32x32x16_bf16 v[80:95], a[112:115], v[64:67], v[80:95]
    s_add_u32 s37, s42, s24
    buffer_load_dwordx4 a[152:155], v1, s[4:7], s37 offen offset:0 sc1
    v_mfma_f32_32x32x16_bf16 v[96:111], a[116:119], v[64:67], v[96:111]
    v_mfma_f32_32x32x16_bf16 v[80:95], a[120:123], v[68:71], v[80:95]
    buffer_load_dwordx4 a[156:159], v1, s[4:7], s37 offen offset:1024 sc1
    s_add_u32 s36, s64, 96
    buffer_load_dword v10, v3, s[4:7], s36 offen sc1
    v_mfma_f32_32x32x16_bf16 v[96:111], a[124:127], v[68:71], v[96:111]
    s_waitcnt vmcnt(8)
    v_mfma_f32_32x32x16_bf16 v[80:95], a[16:19], a[128:131], v[80:95]
    s_add_u32 s37, s42, s25
    buffer_load_dwordx4 a[160:163], v1, s[4:7], s37 offen offset:0 sc1
    v_mfma_f32_32x32x16_bf16 v[96:111], a[20:23], a[128:131], v[96:111]
    s_waitcnt vmcnt(8)
    v_mfma_f32_32x32x16_bf16 v[80:95], a[24:27], a[132:135], v[80:95]
    buffer_load_dwordx4 a[164:167], v1, s[4:7], s37 offen offset:1024 sc1
    v_mfma_f32_32x32x16_bf16 v[96:111], a[28:31], a[132:135], v[96:111]
    s_waitcnt vmcnt(8)
    v_mfma_f32_32x32x16_bf16 v[80:95], a[32:35], a[136:139], v[80:95]
    v_mfma_f32_32x32x16_bf16 v[96:111], a[36:39], a[136:139], v[96:111]
    s_waitcnt vmcnt(7)
    s_add_u32 s37, s42, s26
    buffer_load_dwordx4 a[168:171], v1, s[4:7], s37 offen offset:0 sc1
    v_mfma_f32_32x32x16_bf16 v[80:95], a[40:43], a[140:143], v[80:95]
    s_waitcnt vmcnt(3)
    v_cmp_eq_u32 vcc, 0, v10
    s_nop 0
    s_cbranch_vccz Lpolld10
    s_mov_b32 s39, 0
Lpoll10:
    buffer_load_dword v10, v3, s[4:7], s36 offen sc1
    s_waitcnt vmcnt(0)
    v_cmp_eq_u32 vcc, 0, v10
    s_nop 0
    s_cbranch_vccz Lpolld10
    s_add_u32 s39, s39, 1
    s_cmp_lt_u32 s39, 200000
    s_cbranch_scc1 Lpoll10
Lpolld10:
    s_nop 0
    v_mfma_f32_32x32x16_bf16 v[96:111], a[44:47], a[140:143], v[96:111]
    buffer_load_dwordx4 a[172:175], v1, s[4:7], s37 offen offset:1024 sc1
    v_mfma_f32_32x32x16_bf16 v[80:95], a[48:51], a[144:147], v[80:95]
    v_mfma_f32_32x32x16_bf16 v[96:111], a[52:55], a[144:147], v[96:111]
    s_add_u32 s37, s49, 4096
    buffer_load_dwordx4 a[176:179], v1, s[4:7], s37 offen offset:2048 sc1
    v_mfma_f32_32x32x16_bf16 v[80:95], a[56:59], a[148:151], v[80:95]
    v_mfma_f32_32x32x16_bf16 v[96:111], a[60:63], a[148:151], v[96:111]
    buffer_load_dwordx4 a[180:183], v1, s[4:7], s37 offen offset:3072 sc1
    v_mfma_f32_32x32x16_bf16 v[80:95], a[64:67], a[152:155], v[80:95]
    s_lshl_b32 s35, s12, 14
    s_lshr_b32 s28, s12, 1
    s_lshl_b32 s28, s28, 13
    s_and_b32 s36, s12, 1
    s_lshl_b32 s36, s36, 8
    s_add_u32 s28, s28, s36
    v_add_u32 v10, s35, v1
    v_lshrrev_b32 v11, 4, v0
    v_mfma_f32_32x32x16_bf16 v[96:111], a[68:71], a[152:155], v[96:111]
    s_add_u32 s37, s50, 4096
    buffer_load_dwordx4 a[184:187], v1, s[4:7], s37 offen offset:2048 sc1
    v_lshlrev_b32 v11, 10, v11
    v_and_b32 v12, 15, v0
    v_mfma_f32_32x32x16_bf16 v[80:95], a[72:75], a[156:159], v[80:95]
    v_lshl_add_u32 v11, v12, 4, v11
    v_add_u32 v11, s28, v11
    v_mfma_f32_32x32x16_bf16 v[96:111], a[76:79], a[156:159], v[96:111]
    s_waitcnt vmcnt(6)
    v_mfma_f32_32x32x16_bf16 v[80:95], a[80:83], a[160:163], v[80:95]
    buffer_load_dwordx4 a[188:191], v1, s[4:7], s37 offen offset:3072 sc1
    v_mfma_f32_32x32x16_bf16 v[96:111], a[84:87], a[160:163], v[96:111]
    s_waitcnt vmcnt(6)
    v_mfma_f32_32x32x16_bf16 v[80:95], a[88:91], a[164:167], v[80:95]
    s_add_u32 s37, s51, 4096
    buffer_load_dwordx4 a[192:195], v1, s[4:7], s37 offen offset:2048 sc1
    v_mfma_f32_32x32x16_bf16 v[96:111], a[92:95], a[164:167], v[96:111]
    s_waitcnt vmcnt(6)
    v_mfma_f32_32x32x16_bf16 v[80:95], a[96:99], a[168:171], v[80:95]
    buffer_load_dwordx4 a[196:199], v1, s[4:7], s37 offen offset:3072 sc1
    v_mfma_f32_32x32x16_bf16 v[96:111], a[100:103], a[168:171], v[96:111]
    s_waitcnt vmcnt(6)
    v_mfma_f32_32x32x16_bf16 v[80:95], a[104:107], a[172:175], v[80:95]
    s_add_u32 s37, s52, 4096
    buffer_load_dwordx4 a[200:203], v1, s[4:7], s37 offen offset:2048 sc1
    v_mfma_f32_32x32x16_bf16 v[96:111], a[108:111], a[172:175], v[96:111]
    s_cmp_eq_u32 s18, 1
    s_cbranch_scc1 Lc_tail1
    v_mfma_f32_32x32x16_bf16 v[112:127], a[112:115], v[72:75], v[112:127]
    v_mfma_f32_32x32x16_bf16 v[128:143], a[116:119], v[72:75], v[128:143]
    buffer_load_dwordx4 a[204:207], v1, s[4:7], s37 offen offset:3072 sc1
    v_mfma_f32_32x32x16_bf16 v[112:127], a[120:123], v[76:79], v[112:127]
    v_mfma_f32_32x32x16_bf16 v[128:143], a[124:127], v[76:79], v[128:143]
    s_waitcnt vmcnt(7)
    s_add_u32 s37, s53, 4096
    buffer_load_dwordx4 a[208:211], v1, s[4:7], s37 offen offset:2048 sc1
    ds_write_b128 v10, v[80:83] offset:0
    v_mfma_f32_32x32x16_bf16 v[112:127], a[16:19], a[176:179], v[112:127]
    s_waitcnt vmcnt(7)
    ds_write_b128 v10, v[84:87] offset:1024
    v_mfma_f32_32x32x16_bf16 v[112:127], a[24:27], a[180:183], v[112:127]
    s_waitcnt vmcnt(6)
    buffer_load_dwordx4 a[212:215], v1, s[4:7], s37 offen offset:3072 sc1
    v_mfma_f32_32x32x16_bf16 v[112:127], a[32:35], a[184:187], v[112:127]
    s_waitcnt vmcnt(6)
    ds_write_b128 v10, v[88:91] offset:2048
    v_mfma_f32_32x32x16_bf16 v[112:127], a[40:43], a[188:191], v[112:127]
    s_waitcnt vmcnt(5)
    s_add_u32 s37, s54, 4096
    buffer_load_dwordx4 a[216:219], v1, s[4:7], s37 offen offset:2048 sc1
    ds_write_b128 v10, v[92:95] offset:3072
    v_mfma_f32_32x32x16_bf16 v[112:127], a[48:51], a[192:195], v[112:127]
    s_waitcnt vmcnt(5)
    v_mfma_f32_32x32x16_bf16 v[112:127], a[56:59], a[196:199], v[112:127]
    s_waitcnt vmcnt(4)
    buffer_load_dwordx4 a[220:223], v1, s[4:7], s37 offen offset:3072 sc1
    ds_write_b128 v10, v[96:99] offset:4096
    v_mfma_f32_32x32x16_bf16 v[112:127], a[64:67], a[200:203], v[112:127]
    s_waitcnt vmcnt(4)
    v_mfma_f32_32x32x16_bf16 v[112:127], a[72:75], a[204:207], v[112:127]
    s_waitcnt vmcnt(3)
    ds_write_b128 v10, v[100:103] offset:5120
    v_mfma_f32_32x32x16_bf16 v[112:127], a[80:83], a[208:211], v[112:127]
    s_waitcnt vmcnt(2)
    ds_write_b128 v10, v[104:107] offset:6144
    v_mfma_f32_32x32x16_bf16 v[112:127], a[88:91], a[212:215], v[112:127]
    s_waitcnt vmcnt(1)
    v_mfma_f32_32x32x16_bf16 v[112:127], a[96:99], a[216:219], v[112:127]
    s_waitcnt vmcnt(0)
    ds_write_b128 v10, v[108:111] offset:7168
    v_mfma_f32_32x32x16_bf16 v[112:127], a[104:107], a[220:223], v[112:127]
    v_mfma_f32_32x32x16_bf16 v[128:143], a[20:23], a[176:179], v[128:143]
    s_add_u32 s29, s59, s20
    s_add_u32 s35, s63, 24576
    v_mfma_f32_32x32x16_bf16 v[128:143], a[28:31], a[180:183], v[128:143]
    s_nop 7
    ds_write_b128 v10, v[112:115] offset:8192
    v_mfma_f32_32x32x16_bf16 v[128:143], a[36:39], a[184:187], v[128:143]
    ds_write_b128 v10, v[116:119] offset:9216
    v_mfma_f32_32x32x16_bf16 v[128:143], a[44:47], a[188:191], v[128:143]
    ds_write_b128 v10, v[120:123] offset:10240
    v_mfma_f32_32x32x16_bf16 v[128:143], a[52:55], a[192:195], v[128:143]
    ds_write_b128 v10, v[124:127] offset:11264
    v_mfma_f32_32x32x16_bf16 v[128:143], a[60:63], a[196:199], v[128:143]
    v_mfma_f32_32x32x16_bf16 v[128:143], a[68:71], a[200:203], v[128:143]
    v_mfma_f32_32x32x16_bf16 v[128:143], a[76:79], a[204:207], v[128:143]
    s_waitcnt lgkmcnt(0)
    s_barrier
    ds_read_b128 v[192:195], v11 offset:0
    ds_read_b128 v[196:199], v11 offset:512
    ds_read_b128 v[208:211], v11 offset:16384
    v_mfma_f32_32x32x16_bf16 v[128:143], a[84:87], a[208:211], v[128:143]
    ds_read_b128 v[212:215], v11 offset:16896
    ds_read_b128 v[224:227], v11 offset:32768
    ds_read_b128 v[228:231], v11 offset:33280
    v_mfma_f32_32x32x16_bf16 v[128:143], a[92:95], a[212:215], v[128:143]
    ds_read_b128 v[240:243], v11 offset:49152
    ds_read_b128 v[244:247], v11 offset:49664
    v_mfma_f32_32x32x16_bf16 v[128:143], a[100:103], a[216:219], v[128:143]
    v_mfma_f32_32x32x16_bf16 v[128:143], a[108:111], a[220:223], v[128:143]
    s_nop 11
    ds_write_b128 v10, v[128:131] offset:12288
    ds_write_b128 v10, v[132:135] offset:13312
    ds_write_b128 v10, v[136:139] offset:14336
    ds_write_b128 v10, v[140:143] offset:15360
    s_waitcnt lgkmcnt(11)
    v_pk_add_f32 v[32:33], v[32:33], v[192:193]
    v_pk_add_f32 v[34:35], v[34:35], v[194:195]
    s_waitcnt lgkmcnt(10)
    v_pk_add_f32 v[36:37], v[36:37], v[196:197]
    v_pk_add_f32 v[38:39], v[38:39], v[198:199]
    s_waitcnt lgkmcnt(9)
    v_pk_add_f32 v[32:33], v[32:33], v[208:209]
    v_pk_add_f32 v[34:35], v[34:35], v[210:211]
    s_waitcnt lgkmcnt(8)
    v_pk_add_f32 v[36:37], v[36:37], v[212:213]
    v_pk_add_f32 v[38:39], v[38:39], v[214:215]
    s_waitcnt lgkmcnt(7)
    v_pk_add_f32 v[32:33], v[32:33], v[224:225]
    v_pk_add_f32 v[34:35], v[34:35], v[226:227]
    s_waitcnt lgkmcnt(6)
    v_pk_add_f32 v[36:37], v[36:37], v[228:229]
    v_pk_add_f32 v[38:39], v[38:39], v[230:231]
    s_waitcnt lgkmcnt(5)
    v_pk_add_f32 v[160:161], v[32:33], v[240:241]
    v_pk_add_f32 v[162:163], v[34:35], v[242:243]
    s_waitcnt lgkmcnt(4)
    v_pk_add_f32 v[164:165], v[36:37], v[244:245]
    v_pk_add_f32 v[166:167], v[38:39], v[246:247]
    v_cvt_pk_bf16_f32 v48, v160, v161
    v_cvt_pk_bf16_f32 v49, v162, v163
    v_cvt_pk_bf16_f32 v50, v164, v165
    v_cvt_pk_bf16_f32 v51, v166, v167
    buffer_store_dwordx4 v[48:51], v1, s[4:7], s29 offen offset:0
    s_waitcnt lgkmcnt(0)
    s_barrier
    ds_read_b128 v[200:203], v11 offset:4096
    ds_read_b128 v[204:207], v11 offset:4608
    ds_read_b128 v[216:219], v11 offset:20480
    ds_read_b128 v[220:223], v11 offset:20992
    ds_read_b128 v[232:235], v11 offset:36864
    ds_read_b128 v[236:239], v11 offset:37376
    ds_read_b128 v[248:251], v11 offset:53248
    ds_read_b128 v[252:255], v11 offset:53760
    s_waitcnt lgkmcnt(7)
    v_pk_add_f32 v[40:41], v[40:41], v[200:201]
    v_pk_add_f32 v[42:43], v[42:43], v[202:203]
    s_waitcnt lgkmcnt(6)
    v_pk_add_f32 v[44:45], v[44:45], v[204:205]
    v_pk_add_f32 v[46:47], v[46:47], v[206:207]
    s_waitcnt lgkmcnt(5)
    v_pk_add_f32 v[40:41], v[40:41], v[216:217]
    v_pk_add_f32 v[42:43], v[42:43], v[218:219]
    s_waitcnt lgkmcnt(4)
    v_pk_add_f32 v[44:45], v[44:45], v[220:221]
    v_pk_add_f32 v[46:47], v[46:47], v[222:223]
    s_waitcnt lgkmcnt(3)
    v_pk_add_f32 v[40:41], v[40:41], v[232:233]
    v_pk_add_f32 v[42:43], v[42:43], v[234:235]
    s_waitcnt lgkmcnt(2)
    v_pk_add_f32 v[44:45], v[44:45], v[236:237]
    v_pk_add_f32 v[46:47], v[46:47], v[238:239]
    s_waitcnt lgkmcnt(1)
    v_pk_add_f32 v[168:169], v[40:41], v[248:249]
    v_pk_add_f32 v[170:171], v[42:43], v[250:251]
    s_waitcnt lgkmcnt(0)
    v_pk_add_f32 v[172:173], v[44:45], v[252:253]
    v_pk_add_f32 v[174:175], v[46:47], v[254:255]
    v_cvt_pk_bf16_f32 v52, v168, v169
    v_cvt_pk_bf16_f32 v53, v170, v171
    v_cvt_pk_bf16_f32 v54, v172, v173
    v_cvt_pk_bf16_f32 v55, v174, v175
    buffer_store_dwordx4 v[52:55], v1, s[4:7], s29 offen offset:1024
    s_sub_u32 s29, s29, s20
    v_pk_add_f32 v[112:113], v[160:161], v[162:163]
    v_pk_mul_f32 v[114:115], v[160:161], v[160:161]
    v_pk_add_f32 v[116:117], v[164:165], v[166:167]
    v_pk_mul_f32 v[118:119], v[162:163], v[162:163]
    v_pk_add_f32 v[112:113], v[112:113], v[168:169]
    v_pk_fma_f32 v[114:115], v[164:165], v[164:165], v[114:115]
    v_pk_add_f32 v[116:117], v[116:117], v[170:171]
    v_pk_fma_f32 v[118:119], v[166:167], v[166:167], v[118:119]
    v_pk_add_f32 v[112:113], v[112:113], v[172:173]
    v_pk_fma_f32 v[114:115], v[168:169], v[168:169], v[114:115]
    v_pk_add_f32 v[116:117], v[116:117], v[174:175]
    v_pk_fma_f32 v[118:119], v[170:171], v[170:171], v[118:119]
    v_pk_fma_f32 v[114:115], v[172:173], v[172:173], v[114:115]
    v_pk_fma_f32 v[118:119], v[174:175], v[174:175], v[118:119]
    v_pk_add_f32 v[112:113], v[112:113], v[116:117]
    v_pk_add_f32 v[114:115], v[114:115], v[118:119]
    v_add_f32 v112, v112, v113
    v_add_f32 v114, v114, v115
    s_nop 1
    v_permlane32_swap_b32 v112, v114
    v_add_f32 v112, v112, v114
    v_mov_b32 v113, v112
    s_nop 1
    v_permlane16_swap_b32 v112, v113
    s_mov_b32 exec_lo, 0xffff
    s_mov_b32 exec_hi, 0xffff
    v_add_f32 v112, v112, v113
    buffer_store_dword v112, v2, s[4:7], s29 offen offset:2048
    s_mov_b64 exec, -1
    s_lshr_b32 s28, s14, 4
    s_lshl_b32 s29, s13, 1
    s_add_u32 s28, s28, s29
    s_lshl_b32 s28, s28, 2
    s_add_u32 s40, s28, s12
    s_lshl_b32 s36, s40, 7
    s_add_u32 s36, s36, 54239232
    s_add_u32 s43, s40, s13
    s_mul_i32 s43, s43, 32256
    s_add_u32 s43, s43, 14065408
    v_bfe_u32 v10, v0, 4, 1
    v_mul_u32_u24 v10, 16128, v10
    v_lshrrev_b32 v11, 5, v0
    v_and_b32 v12, 15, v0
    v_lshl_add_u32 v4, v11, 8, v10
    v_lshl_add_u32 v4, v12, 4, v4
    v_mul_u32_u24 v5, 4352, v11
    v_add_u32 v5, v5, v4
    v_add_u32 v5, 0x800, v5
    v_add_u32 v6, 65536, v1
    v_add_u32 v7, 108544, v1
    v_and_b32 v11, 7, v0
    v_min_u32 v11, 7, v11
    v_lshlrev_b32 v11, 2, v11
    v_bfe_u32 v10, v0, 3, 1
    v_lshl_add_u32 v11, v10, 6, v11
    s_and_b32 s29, s14, 15
    s_lshl_b32 s29, s29, 6
    s_add_u32 s29, s29, s40
    s_lshl_b32 s41, s29, 11
    s_add_u32 s41, s41, 47923200
    s_lshl_b32 s42, s29, 12
    s_add_u32 s42, s42, 50020352
    s_lshr_b32 s29, s29, 2
    s_lshl_b32 s29, s29, 5
    s_add_u32 s29, s29, s12
    s_lshl_b32 s29, s29, 2
    s_add_u32 s44, s29, 54345728
    s_lshl_b32 s29, s12, 7
    s_add_u32 s29, s29, 151808
    v_and_b32 v8, 31, v0
    v_lshl_add_u32 v8, v8, 2, s29
    v_lshrrev_b32 v9, 5, v0
    v_lshl_add_u32 v9, v9, 4, s29
    s_waitcnt vmcnt(0)
    s_mov_b64 exec, 1
    buffer_store_dword v15, off, s[4:7], s35 offset:0
    s_mov_b64 exec, -1
    s_branch Lc_qkv
Lc_tail1:
    v_mfma_f32_32x32x16_bf16 v[112:127], a[112:115], v[72:75], v[112:127]
    v_mfma_f32_32x32x16_bf16 v[128:143], a[116:119], v[72:75], v[128:143]
    buffer_load_dwordx4 a[204:207], v1, s[4:7], s37 offen offset:3072 sc1
    v_mfma_f32_32x32x16_bf16 v[112:127], a[120:123], v[76:79], v[112:127]
    v_mfma_f32_32x32x16_bf16 v[128:143], a[124:127], v[76:79], v[128:143]
    s_waitcnt vmcnt(7)
    s_add_u32 s37, s53, 4096
    buffer_load_dwordx4 a[208:211], v1, s[4:7], s37 offen offset:2048 sc1
    ds_write_b128 v10, v[80:83] offset:0
    v_mfma_f32_32x32x16_bf16 v[112:127], a[16:19], a[176:179], v[112:127]
    s_waitcnt vmcnt(7)
    ds_write_b128 v10, v[84:87] offset:1024
    v_mfma_f32_32x32x16_bf16 v[112:127], a[24:27], a[180:183], v[112:127]
    s_waitcnt vmcnt(6)
    buffer_load_dwordx4 a[212:215], v1, s[4:7], s37 offen offset:3072 sc1
    v_mfma_f32_32x32x16_bf16 v[112:127], a[32:35], a[184:187], v[112:127]
    s_waitcnt vmcnt(6)
    ds_write_b128 v10, v[88:91] offset:2048
    v_mfma_f32_32x32x16_bf16 v[112:127], a[40:43], a[188:191], v[112:127]
    s_waitcnt vmcnt(5)
    s_add_u32 s37, s54, 4096
    buffer_load_dwordx4 a[216:219], v1, s[4:7], s37 offen offset:2048 sc1
    ds_write_b128 v10, v[92:95] offset:3072
    v_mfma_f32_32x32x16_bf16 v[112:127], a[48:51], a[192:195], v[112:127]
    s_waitcnt vmcnt(5)
    v_mfma_f32_32x32x16_bf16 v[112:127], a[56:59], a[196:199], v[112:127]
    s_waitcnt vmcnt(4)
    buffer_load_dwordx4 a[220:223], v1, s[4:7], s37 offen offset:3072 sc1
    ds_write_b128 v10, v[96:99] offset:4096
    v_mfma_f32_32x32x16_bf16 v[112:127], a[64:67], a[200:203], v[112:127]
    s_waitcnt vmcnt(4)
    v_mfma_f32_32x32x16_bf16 v[112:127], a[72:75], a[204:207], v[112:127]
    s_waitcnt vmcnt(3)
    ds_write_b128 v10, v[100:103] offset:5120
    v_mfma_f32_32x32x16_bf16 v[112:127], a[80:83], a[208:211], v[112:127]
    s_waitcnt vmcnt(2)
    ds_write_b128 v10, v[104:107] offset:6144
    v_mfma_f32_32x32x16_bf16 v[112:127], a[88:91], a[212:215], v[112:127]
    s_waitcnt vmcnt(1)
    v_mfma_f32_32x32x16_bf16 v[112:127], a[96:99], a[216:219], v[112:127]
    s_waitcnt vmcnt(0)
    ds_write_b128 v10, v[108:111] offset:7168
    v_mfma_f32_32x32x16_bf16 v[112:127], a[104:107], a[220:223], v[112:127]
    v_mfma_f32_32x32x16_bf16 v[128:143], a[20:23], a[176:179], v[128:143]
    v_and_b32 v12, 15, v0
    v_lshrrev_b32 v13, 4, v0
    v_mul_u32_u24 v12, 896, v12
    v_lshl_add_u32 v12, v13, 4, v12
    s_mul_i32 s28, s17, 14336
    s_lshl_b32 s29, s15, 7
    s_add_u32 s28, s28, s29
    v_mfma_f32_32x32x16_bf16 v[128:143], a[28:31], a[180:183], v[128:143]
    s_nop 2
    ds_write_b128 v10, v[112:115] offset:8192
    v_mfma_f32_32x32x16_bf16 v[128:143], a[36:39], a[184:187], v[128:143]
    ds_write_b128 v10, v[116:119] offset:9216
    v_mfma_f32_32x32x16_bf16 v[128:143], a[44:47], a[188:191], v[128:143]
    ds_write_b128 v10, v[120:123] offset:10240
    v_mfma_f32_32x32x16_bf16 v[128:143], a[52:55], a[192:195], v[128:143]
    ds_write_b128 v10, v[124:127] offset:11264
    v_mfma_f32_32x32x16_bf16 v[128:143], a[60:63], a[196:199], v[128:143]
    v_mfma_f32_32x32x16_bf16 v[128:143], a[68:71], a[200:203], v[128:143]
    v_mfma_f32_32x32x16_bf16 v[128:143], a[76:79], a[204:207], v[128:143]
    s_waitcnt lgkmcnt(0)
    s_barrier
    ds_read_b128 v[192:195], v11 offset:0
    ds_read_b128 v[196:199], v11 offset:512
    ds_read_b128 v[208:211], v11 offset:16384
    v_mfma_f32_32x32x16_bf16 v[128:143], a[84:87], a[208:211], v[128:143]
    ds_read_b128 v[212:215], v11 offset:16896
    ds_read_b128 v[224:227], v11 offset:32768
    ds_read_b128 v[228:231], v11 offset:33280
    v_mfma_f32_32x32x16_bf16 v[128:143], a[92:95], a[212:215], v[128:143]
    ds_read_b128 v[240:243], v11 offset:49152
    ds_read_b128 v[244:247], v11 offset:49664
    v_mfma_f32_32x32x16_bf16 v[128:143], a[100:103], a[216:219], v[128:143]
    v_mfma_f32_32x32x16_bf16 v[128:143], a[108:111], a[220:223], v[128:143]
    s_nop 11
    ds_write_b128 v10, v[128:131] offset:12288
    ds_write_b128 v10, v[132:135] offset:13312
    ds_write_b128 v10, v[136:139] offset:14336
    ds_write_b128 v10, v[140:143] offset:15360
    s_waitcnt lgkmcnt(11)
    v_pk_add_f32 v[32:33], v[32:33], v[192:193]
    v_pk_add_f32 v[34:35], v[34:35], v[194:195]
    s_waitcnt lgkmcnt(10)
    v_pk_add_f32 v[36:37], v[36:37], v[196:197]
    v_pk_add_f32 v[38:39], v[38:39], v[198:199]
    s_waitcnt lgkmcnt(9)
    v_pk_add_f32 v[32:33], v[32:33], v[208:209]
    v_pk_add_f32 v[34:35], v[34:35], v[210:211]
    s_waitcnt lgkmcnt(8)
    v_pk_add_f32 v[36:37], v[36:37], v[212:213]
    v_pk_add_f32 v[38:39], v[38:39], v[214:215]
    s_waitcnt lgkmcnt(7)
    v_pk_add_f32 v[32:33], v[32:33], v[224:225]
    v_pk_add_f32 v[34:35], v[34:35], v[226:227]
    s_waitcnt lgkmcnt(6)
    v_pk_add_f32 v[36:37], v[36:37], v[228:229]
    v_pk_add_f32 v[38:39], v[38:39], v[230:231]
    s_waitcnt lgkmcnt(5)
    v_pk_add_f32 v[160:161], v[32:33], v[240:241]
    v_pk_add_f32 v[162:163], v[34:35], v[242:243]
    s_waitcnt lgkmcnt(4)
    v_pk_add_f32 v[164:165], v[36:37], v[244:245]
    v_pk_add_f32 v[166:167], v[38:39], v[246:247]
    v_cvt_pk_bf16_f32 v48, v160, v161
    v_cvt_pk_bf16_f32 v49, v162, v163
    v_cvt_pk_bf16_f32 v50, v164, v165
    v_cvt_pk_bf16_f32 v51, v166, v167
    buffer_store_dwordx4 v[48:51], v12, s[8:11], s28 offen offset:0
    s_waitcnt lgkmcnt(0)
    s_barrier
    ds_read_b128 v[200:203], v11 offset:4096
    ds_read_b128 v[204:207], v11 offset:4608
    ds_read_b128 v[216:219], v11 offset:20480
    ds_read_b128 v[220:223], v11 offset:20992
    ds_read_b128 v[232:235], v11 offset:36864
    ds_read_b128 v[236:239], v11 offset:37376
    ds_read_b128 v[248:251], v11 offset:53248
    ds_read_b128 v[252:255], v11 offset:53760
    s_waitcnt lgkmcnt(7)
    v_pk_add_f32 v[40:41], v[40:41], v[200:201]
    v_pk_add_f32 v[42:43], v[42:43], v[202:203]
    s_waitcnt lgkmcnt(6)
    v_pk_add_f32 v[44:45], v[44:45], v[204:205]
    v_pk_add_f32 v[46:47], v[46:47], v[206:207]
    s_waitcnt lgkmcnt(5)
    v_pk_add_f32 v[40:41], v[40:41], v[216:217]
    v_pk_add_f32 v[42:43], v[42:43], v[218:219]
    s_waitcnt lgkmcnt(4)
    v_pk_add_f32 v[44:45], v[44:45], v[220:221]
    v_pk_add_f32 v[46:47], v[46:47], v[222:223]
    s_waitcnt lgkmcnt(3)
    v_pk_add_f32 v[40:41], v[40:41], v[232:233]
    v_pk_add_f32 v[42:43], v[42:43], v[234:235]
    s_waitcnt lgkmcnt(2)
    v_pk_add_f32 v[44:45], v[44:45], v[236:237]
    v_pk_add_f32 v[46:47], v[46:47], v[238:239]
    s_waitcnt lgkmcnt(1)
    v_pk_add_f32 v[168:169], v[40:41], v[248:249]
    v_pk_add_f32 v[170:171], v[42:43], v[250:251]
    s_waitcnt lgkmcnt(0)
    v_pk_add_f32 v[172:173], v[44:45], v[252:253]
    v_pk_add_f32 v[174:175], v[46:47], v[254:255]
    v_cvt_pk_bf16_f32 v52, v168, v169
    v_cvt_pk_bf16_f32 v53, v170, v171
    v_cvt_pk_bf16_f32 v54, v172, v173
    v_cvt_pk_bf16_f32 v55, v174, v175
    buffer_store_dwordx4 v[52:55], v12, s[8:11], s28 offen offset:64
    s_endpgm
Lc_spare:
    s_lshl_b32 s62, s17, 6
    s_add_u32 s62, s62, s45
    s_lshl_b32 s35, s15, 2
    s_add_u32 s63, s62, s35
    s_lshl_b32 s64, s17, 7
    s_add_u32 s64, s64, s45
    s_add_u32 s64, s64, 32768
    s_add_u32 s65, s64, s35
    v_min_u32 v3, 6, v0
    v_lshlrev_b32 v3, 2, v3
    s_mov_b32 s43, 7856128
    s_lshr_b32 s28, s14, 3
    s_lshl_b32 s28, s28, 2
    s_add_u32 s36, s28, s12
    s_min_u32 s28, s36, 13
    s_lshl_b32 s28, s28, 1
    v_lshrrev_b32 v10, 5, v0
    v_add_u32 v10, s28, v10
    v_mul_u32_u24 v10, 57344, v10
    v_and_b32 v11, 31, v0
    v_lshl_add_u32 v16, v11, 7, v10
    s_mul_i32 s28, s36, 86016
    v_lshl_add_u32 v17, v0, 7, s28
    s_lshl_b32 s28, s36, 13
    v_lshl_add_u32 v18, v0, 7, s28
    s_mul_i32 s28, s13, 917504
    s_add_u32 s28, s28, 9920512
    v_add_u32 v19, s28, v18
    s_mov_b32 s28, 2834432
    buffer_load_dword v20, v16, s[4:7], s28 offen
    s_waitcnt vmcnt(3)
    s_mov_b32 s28, 2838528
    buffer_load_dword v20, v16, s[4:7], s28 offen
    s_waitcnt vmcnt(3)
    s_mov_b32 s28, 2842624
    buffer_load_dword v20, v16, s[4:7], s28 offen
    s_waitcnt vmcnt(3)
    s_mov_b32 s28, 2846720
    buffer_load_dword v20, v16, s[4:7], s28 offen
    s_waitcnt vmcnt(3)
    s_mov_b32 s28, 2850816
    buffer_load_dword v20, v16, s[4:7], s28 offen
    s_waitcnt vmcnt(3)
    s_mov_b32 s28, 2854912
    buffer_load_dword v20, v16, s[4:7], s28 offen
    s_waitcnt vmcnt(3)
    s_mov_b32 s28, 2859008
    buffer_load_dword v20, v16, s[4:7], s28 offen
    s_waitcnt vmcnt(3)
    s_mov_b32 s28, 2863104
    buffer_load_dword v20, v16, s[4:7], s28 offen
    s_waitcnt vmcnt(3)
    s_cmp_eq_u32 s18, 1
    s_cbranch_scc1 Lc_end
    s_mov_b32 s28, 4415488
    buffer_load_dword v20, v17, s[4:7], s28 offen
    s_waitcnt vmcnt(3)
    s_mov_b32 s28, 4423680
    buffer_load_dword v20, v17, s[4:7], s28 offen
    s_waitcnt vmcnt(3)
    s_mov_b32 s28, 4431872
    buffer_load_dword v20, v17, s[4:7], s28 offen
    s_waitcnt vmcnt(3)
    s_mov_b32 s28, 4440064
    buffer_load_dword v20, v17, s[4:7], s28 offen
    s_waitcnt vmcnt(3)
    s_mov_b32 s28, 4448256
    buffer_load_dword v20, v17, s[4:7], s28 offen
    s_waitcnt vmcnt(3)
    s_mov_b32 s28, 4456448
    buffer_load_dword v20, v17, s[4:7], s28 offen
    s_waitcnt vmcnt(3)
    s_mov_b32 s28, 4464640
    buffer_load_dword v20, v17, s[4:7], s28 offen
    s_waitcnt vmcnt(3)
    s_mov_b32 s28, 4472832
    buffer_load_dword v20, v17, s[4:7], s28 offen
    s_waitcnt vmcnt(3)
    s_mov_b32 s28, 4481024
    buffer_load_dword v20, v17, s[4:7], s28 offen
    s_waitcnt vmcnt(3)
    s_mov_b32 s28, 4489216
    buffer_load_dword v20, v17, s[4:7], s28 offen
    s_waitcnt vmcnt(3)
    s_mov_b32 s28, 4497408
    buffer_load_dword v20, v17, s[4:7], s28 offen
    s_waitcnt vmcnt(3)
    s_cmp_eq_u32 s18, 1
    s_cbranch_scc1 Lc_end
    s_barrier
    s_add_u32 m0, s67, 0
    s_add_u32 s38, s66, 0
    buffer_load_dwordx4 v1, s[4:7], s38 offen offset:0 lds
    buffer_load_dwordx4 v1, s[4:7], s38 offen offset:1024 lds
    buffer_load_dwordx4 v1, s[4:7], s38 offen offset:2048 lds
    buffer_load_dwordx4 v1, s[4:7], s38 offen offset:3072 lds
    s_add_u32 m0, s67, 4096
    s_add_u32 s38, s66, 4096
    buffer_load_dwordx4 v1, s[4:7], s38 offen offset:0 lds
    buffer_load_dwordx4 v1, s[4:7], s38 offen offset:1024 lds
    buffer_load_dwordx4 v1, s[4:7], s38 offen offset:2048 lds
    buffer_load_dwordx4 v1, s[4:7], s38 offen offset:3072 lds
    s_add_u32 m0, s67, 8192
    s_add_u32 s38, s66, 8192
    buffer_load_dwordx4 v1, s[4:7], s38 offen offset:0 lds
    buffer_load_dwordx4 v1, s[4:7], s38 offen offset:1024 lds
    buffer_load_dwordx4 v1, s[4:7], s38 offen offset:2048 lds
    buffer_load_dwordx4 v1, s[4:7], s38 offen offset:3072 lds
    s_add_u32 m0, s67, 12288
    s_add_u32 s38, s66, 12288
    buffer_load_dwordx4 v1, s[4:7], s38 offen offset:0 lds
    buffer_load_dwordx4 v1, s[4:7], s38 offen offset:1024 lds
    buffer_load_dwordx4 v1, s[4:7], s38 offen offset:2048 lds
    buffer_load_dwordx4 v1, s[4:7], s38 offen offset:3072 lds
    s_add_u32 m0, s67, 16384
    s_add_u32 s38, s66, 16384
    buffer_load_dwordx4 v1, s[4:7], s38 offen offset:0 lds
    buffer_load_dwordx4 v1, s[4:7], s38 offen offset:1024 lds
    buffer_load_dwordx4 v1, s[4:7], s38 offen offset:2048 lds
    buffer_load_dwordx4 v1, s[4:7], s38 offen offset:3072 lds
    s_add_u32 m0, s67, 20480
    s_add_u32 s38, s66, 20480
    buffer_load_dwordx4 v1, s[4:7], s38 offen offset:0 lds
    s_lshl_b32 s28, s13, 1
    s_add_u32 s28, s28, s17
    s_mul_i32 s28, s28, 16128
    s_add_u32 s28, s28, 14065408
    v_min_u32 v10, 13, v0
    v_lshrrev_b32 v11, 1, v10
    v_mul_u32_u24 v11, 2304, v11
    v_and_b32 v10, 1, v10
    v_lshl_add_u32 v11, v10, 7, v11
    buffer_load_dword v20, v11, s[4:7], s28 offen offset:2048 sc1
    s_add_u32 s28, s28, 22147072
    v_mov_b32 v24, -1
    v_mov_b32 v25, -1
    v_mov_b32 v26, -1
    v_mov_b32 v27, -1
    buffer_store_dwordx4 v[24:27], v1, s[4:7], s28 offen offset:0 sc1
    buffer_store_dwordx4 v[24:27], v1, s[4:7], s28 offen offset:1024 sc1
    s_add_u32 s28, s28, 2304
    buffer_store_dwordx4 v[24:27], v1, s[4:7], s28 offen offset:0 sc1
    buffer_store_dwordx4 v[24:27], v1, s[4:7], s28 offen offset:1024 sc1
    s_add_u32 s28, s28, 2304
    buffer_store_dwordx4 v[24:27], v1, s[4:7], s28 offen offset:0 sc1
    buffer_store_dwordx4 v[24:27], v1, s[4:7], s28 offen offset:1024 sc1
    s_add_u32 s28, s28, 2304
    buffer_store_dwordx4 v[24:27], v1, s[4:7], s28 offen offset:0 sc1
    buffer_store_dwordx4 v[24:27], v1, s[4:7], s28 offen offset:1024 sc1
    s_add_u32 s28, s28, 2304
    buffer_store_dwordx4 v[24:27], v1, s[4:7], s28 offen offset:0 sc1
    buffer_store_dwordx4 v[24:27], v1, s[4:7], s28 offen offset:1024 sc1
    s_add_u32 s28, s28, 2304
    buffer_store_dwordx4 v[24:27], v1, s[4:7], s28 offen offset:0 sc1
    buffer_store_dwordx4 v[24:27], v1, s[4:7], s28 offen offset:1024 sc1
    s_add_u32 s28, s28, 2304
    buffer_store_dwordx4 v[24:27], v1, s[4:7], s28 offen offset:0 sc1
    buffer_store_dwordx4 v[24:27], v1, s[4:7], s28 offen offset:1024 sc1
    s_add_u32 s28, s28, 2304
    s_add_u32 s35, s63, 24576
    s_waitcnt vmcnt(0)
    s_cmp_lg_u32 s61, 0
    s_cbranch_scc1 Lc_sp1
    s_mov_b64 exec, 1
    buffer_store_dword v15, off, s[4:7], s35 offset:0
    s_mov_b64 exec, -1
    s_branch Lc_sp2
Lc_sp1:
    s_mov_b64 exec, 1
    buffer_store_dword v15, off, s[4:7], s35 offset:0 sc1
    s_mov_b64 exec, -1
Lc_sp2:
    s_lshr_b32 s28, s14, 4
    s_lshl_b32 s29, s13, 1
    s_add_u32 s28, s28, s29
    s_lshl_b32 s28, s28, 2
    s_add_u32 s40, s28, s12
    s_lshl_b32 s36, s40, 7
    s_add_u32 s36, s36, 54239232
    s_add_u32 s43, s40, s13
    s_mul_i32 s43, s43, 32256
    s_add_u32 s43, s43, 14065408
    v_bfe_u32 v10, v0, 4, 1
    v_mul_u32_u24 v10, 16128, v10
    v_lshrrev_b32 v11, 5, v0
    v_and_b32 v12, 15, v0
    v_lshl_add_u32 v4, v11, 8, v10
    v_lshl_add_u32 v4, v12, 4, v4
    v_mul_u32_u24 v5, 4352, v11
    v_add_u32 v5, v5, v4
    v_add_u32 v5, 0x800, v5
    v_add_u32 v6, 65536, v1
    v_add_u32 v7, 108544, v1
    v_and_b32 v11, 7, v0
    v_min_u32 v11, 7, v11
    v_lshlrev_b32 v11, 2, v11
    v_bfe_u32 v10, v0, 3, 1
    v_lshl_add_u32 v11, v10, 6, v11
    s_and_b32 s29, s14, 15
    s_lshl_b32 s29, s29, 6
    s_add_u32 s29, s29, s40
    s_lshl_b32 s41, s29, 11
    s_add_u32 s41, s41, 47923200
    s_lshl_b32 s42, s29, 12
    s_add_u32 s42, s42, 50020352
    s_lshr_b32 s29, s29, 2
    s_lshl_b32 s29, s29, 5
    s_add_u32 s29, s29, s12
    s_lshl_b32 s29, s29, 2
    s_add_u32 s44, s29, 54345728
    s_lshl_b32 s29, s12, 7
    s_add_u32 s29, s29, 151808
    v_and_b32 v8, 31, v0
    v_lshl_add_u32 v8, v8, 2, s29
    v_lshrrev_b32 v9, 5, v0
    v_lshl_add_u32 v9, v9, 4, s29
    s_waitcnt vmcnt(0)
    s_barrier
Lc_qkv:
    buffer_load_dword v10, v11, s[4:7], s36 offen sc1
    ds_read_b128 a[128:131], v6 offset:2048
    ds_read_b128 a[132:135], v6 offset:1024
    ds_read_b128 a[136:139], v6 offset:5120
    ds_read_b128 a[140:143], v6 offset:4096
    ds_read_b128 a[144:147], v6 offset:8192
    ds_read_b128 a[148:151], v6 offset:7168
    ds_read_b128 a[152:155], v6 offset:0
    ds_read_b128 a[156:159], v6 offset:11264
    ds_read_b128 a[160:163], v6 offset:10240
    ds_read_b128 a[164:167], v6 offset:14336
    ds_read_b128 a[168:171], v6 offset:13312
    ds_read_b128 a[172:175], v6 offset:17408
    s_waitcnt vmcnt(0)
    v_cmp_eq_u32 vcc, 0, v10
    s_nop 0
    s_cbranch_vccz Lpolld11
    s_mov_b32 s39, 0
Lpoll11:
    buffer_load_dword v10, v11, s[4:7], s36 offen sc1
    s_waitcnt vmcnt(0)
    v_cmp_eq_u32 vcc, 0, v10
    s_nop 0
    s_cbranch_vccz Lpolld11
    s_add_u32 s39, s39, 1
    s_cmp_lt_u32 s39, 200000
    s_cbranch_scc1 Lpoll11
Lpolld11:
    s_nop 0
    s_add_u32 s37, s43, 0
    buffer_load_dwordx4 a[0:3], v4, s[4:7], s37 offen offset:0 sc1
    buffer_load_dwordx4 a[4:7], v4, s[4:7], s37 offen offset:512 sc1
    buffer_load_dwordx4 a[8:11], v4, s[4:7], s37 offen offset:1024 sc1
    buffer_load_dwordx4 a[12:15], v4, s[4:7], s37 offen offset:1536 sc1
    s_add_u32 s37, s43, 2304
    buffer_load_dwordx4 a[16:19], v4, s[4:7], s37 offen offset:0 sc1
    buffer_load_dwordx4 a[20:23], v4, s[4:7], s37 offen offset:512 sc1
    s_waitcnt vmcnt(5) lgkmcnt(10)
    v_mfma_f32_32x32x16_bf16 v[64:79], a[0:3], a[128:131], 0
    ds_read_b128 a[176:179], v6 offset:16384
    v_mfma_f32_32x32x16_bf16 v[48:63], a[132:135], a[0:3], 0
    s_waitcnt vmcnt(4) lgkmcnt(9)
    ds_read_b128 a[180:183], v6 offset:3072
    v_mfma_f32_32x32x16_bf16 v[64:79], a[4:7], a[136:139], v[64:79]
    buffer_load_dwordx4 a[24:27], v4, s[4:7], s37 offen offset:1024 sc1
    ds_read_b128 a[184:187], v6 offset:20480
    v_mfma_f32_32x32x16_bf16 v[48:63], a[140:143], a[4:7], v[48:63]
    s_waitcnt vmcnt(4) lgkmcnt(9)
    ds_read_b128 a[188:191], v6 offset:19456
    v_mfma_f32_32x32x16_bf16 v[64:79], a[8:11], a[144:147], v[64:79]
    buffer_load_dwordx4 a[28:31], v4, s[4:7], s37 offen offset:1536 sc1
    ds_read_b128 a[192:195], v6 offset:23552
    v_mfma_f32_32x32x16_bf16 v[48:63], a[148:151], a[8:11], v[48:63]
    s_waitcnt vmcnt(4) lgkmcnt(9)
    ds_read_b128 a[196:199], v6 offset:22528
    v_mfma_f32_32x32x16_bf16 v[32:47], a[152:155], a[0:3], 0
    s_add_u32 s37, s43, 4608
    buffer_load_dwordx4 a[32:35], v4, s[4:7], s37 offen offset:0 sc1
    ds_read_b128 a[200:203], v6 offset:26624
    v_mfma_f32_32x32x16_bf16 v[64:79], a[12:15], a[156:159], v[64:79]
    s_waitcnt vmcnt(4) lgkmcnt(9)
    ds_read_b128 a[204:207], v6 offset:25600
    v_mfma_f32_32x32x16_bf16 v[48:63], a[160:163], a[12:15], v[48:63]
    buffer_load_dwordx4 a[36:39], v4, s[4:7], s37 offen offset:512 sc1
    ds_read_b128 a[208:211], v6 offset:6144
    v_mfma_f32_32x32x16_bf16 v[64:79], a[16:19], a[164:167], v[64:79]
    s_waitcnt vmcnt(4) lgkmcnt(9)
    ds_read_b128 a[212:215], v6 offset:29696
    v_mfma_f32_32x32x16_bf16 v[48:63], a[168:171], a[16:19], v[48:63]
    buffer_load_dwordx4 a[40:43], v4, s[4:7], s37 offen offset:1024 sc1
    ds_read_b128 a[216:219], v6 offset:28672
    v_mfma_f32_32x32x16_bf16 v[64:79], a[20:23], a[172:175], v[64:79]
    s_waitcnt lgkmcnt(9)
    ds_read_b128 a[220:223], v6 offset:32768
    v_mfma_f32_32x32x16_bf16 v[48:63], a[176:179], a[20:23], v[48:63]
    buffer_load_dwordx4 a[44:47], v4, s[4:7], s37 offen offset:1536 sc1
    ds_read_b128 a[128:131], v6 offset:31744
    v_mfma_f32_32x32x16_bf16 v[32:47], a[180:183], a[4:7], v[32:47]
    s_waitcnt vmcnt(5) lgkmcnt(9)
    ds_read_b128 a[132:135], v6 offset:35840
    v_mfma_f32_32x32x16_bf16 v[64:79], a[24:27], a[184:187], v[64:79]
    s_add_u32 s37, s43, 6912
    buffer_load_dwordx4 a[48:51], v4, s[4:7], s37 offen offset:0 sc1
    buffer_load_dwordx4 v[16:19], v5, s[4:7], s43 offen offset:0 sc1
    ds_read_b128 a[136:139], v6 offset:34816
    v_mfma_f32_32x32x16_bf16 v[48:63], a[188:191], a[24:27], v[48:63]
    s_waitcnt vmcnt(6) lgkmcnt(9)
    ds_read_b128 a[140:143], v6 offset:9216
    v_mfma_f32_32x32x16_bf16 v[64:79], a[28:31], a[192:195], v[64:79]
    ds_read_b128 a[144:147], v6 offset:38912
    v_mfma_f32_32x32x16_bf16 v[48:63], a[196:199], a[28:31], v[48:63]
    s_waitcnt vmcnt(5) lgkmcnt(9)
    buffer_load_dwordx4 a[52:55], v4, s[4:7], s37 offen offset:512 sc1
    ds_read_b128 a[148:151], v6 offset:37888
    v_mfma_f32_32x32x16_bf16 v[64:79], a[32:35], a[200:203], v[64:79]
    ds_read_b128 a[152:155], v6 offset:41984
    v_mfma_f32_32x32x16_bf16 v[48:63], a[204:207], a[32:35], v[48:63]
    s_waitcnt vmcnt(5) lgkmcnt(9)
    buffer_load_dwordx4 a[56:59], v4, s[4:7], s37 offen offset:1024 sc1
    ds_read_b128 a[156:159], v6 offset:40960
    v_mfma_f32_32x32x16_bf16 v[32:47], a[208:211], a[8:11], v[32:47]
    ds_read_b128 a[160:163], v7 offset:2048
    v_mfma_f32_32x32x16_bf16 v[64:79], a[36:39], a[212:215], v[64:79]
    s_waitcnt vmcnt(5) lgkmcnt(9)
    buffer_load_dwordx4 a[60:63], v4, s[4:7], s37 offen offset:1536 sc1
    ds_read_b128 a[164:167], v7 offset:1024
    v_mfma_f32_32x32x16_bf16 v[48:63], a[216:219], a[36:39], v[48:63]
    ds_read_b128 a[168:171], v6 offset:12288
    v_mfma_f32_32x32x16_bf16 v[64:79], a[40:43], a[220:223], v[64:79]
    s_waitcnt vmcnt(5) lgkmcnt(9)
    s_add_u32 s37, s43, 9216
    buffer_load_dwordx4 a[64:67], v4, s[4:7], s37 offen offset:0 sc1
    buffer_load_dwordx4 v[20:23], v5, s[4:7], s43 offen offset:2304 sc1
    ds_read_b128 a[172:175], v7 offset:5120
    v_mfma_f32_32x32x16_bf16 v[48:63], a[128:131], a[40:43], v[48:63]
    ds_read_b128 a[176:179], v7 offset:4096
    v_mfma_f32_32x32x16_bf16 v[64:79], a[44:47], a[132:135], v[64:79]
    s_waitcnt lgkmcnt(9)
    ds_read_b128 a[180:183], v7 offset:8192
    v_mfma_f32_32x32x16_bf16 v[48:63], a[136:139], a[44:47], v[48:63]
    buffer_load_dwordx4 a[68:71], v4, s[4:7], s37 offen offset:512 sc1
    ds_read_b128 a[184:187], v7 offset:7168
    v_mfma_f32_32x32x16_bf16 v[32:47], a[140:143], a[12:15], v[32:47]
    s_waitcnt vmcnt(7) lgkmcnt(9)
    ds_read_b128 a[188:191], v7 offset:11264
    v_mfma_f32_32x32x16_bf16 v[64:79], a[48:51], a[144:147], v[64:79]
    buffer_load_dwordx4 a[72:75], v4, s[4:7], s37 offen offset:1024 sc1
    ds_read_b128 a[192:195], v7 offset:10240
    v_mfma_f32_32x32x16_bf16 v[48:63], a[148:151], a[48:51], v[48:63]
    s_waitcnt vmcnt(6) lgkmcnt(9)
    ds_read_b128 a[196:199], v6 offset:15360
    v_mfma_f32_32x32x16_bf16 v[64:79], a[52:55], a[152:155], v[64:79]
    buffer_load_dwordx4 a[76:79], v4, s[4:7], s37 offen offset:1536 sc1
    ds_read_b128 a[200:203], v7 offset:14336
    v_mfma_f32_32x32x16_bf16 v[48:63], a[156:159], a[52:55], v[48:63]
    s_waitcnt vmcnt(6) lgkmcnt(9)
    ds_read_b128 a[204:207], v7 offset:13312
    v_mfma_f32_32x32x16_bf16 v[64:79], a[56:59], a[160:163], v[64:79]
    s_add_u32 s37, s43, 11520
    buffer_load_dwordx4 a[80:83], v4, s[4:7], s37 offen offset:0 sc1
    ds_read_b128 a[208:211], v7 offset:17408
    v_mfma_f32_32x32x16_bf16 v[48:63], a[164:167], a[56:59], v[48:63]
    s_waitcnt vmcnt(6) lgkmcnt(9)
    ds_read_b128 a[212:215], v7 offset:16384
    v_mfma_f32_32x32x16_bf16 v[32:47], a[168:171], a[16:19], v[32:47]
    buffer_load_dwordx4 a[84:87], v4, s[4:7], s37 offen offset:512 sc1
    ds_read_b128 a[216:219], v7 offset:20480
    v_mfma_f32_32x32x16_bf16 v[64:79], a[60:63], a[172:175], v[64:79]
    s_waitcnt vmcnt(6) lgkmcnt(9)
    ds_read_b128 a[220:223], v7 offset:19456
    v_mfma_f32_32x32x16_bf16 v[48:63], a[176:179], a[60:63], v[48:63]
    buffer_load_dwordx4 a[88:91], v4, s[4:7], s37 offen offset:1024 sc1
    ds_read_b128 a[128:131], v6 offset:18432
    v_mfma_f32_32x32x16_bf16 v[64:79], a[64:67], a[180:183], v[64:79]
    s_waitcnt vmcnt(5) lgkmcnt(9)
    ds_read_b128 a[132:135], v7 offset:23552
    v_mfma_f32_32x32x16_bf16 v[48:63], a[184:187], a[64:67], v[48:63]
    ds_read_b128 a[136:139], v7 offset:22528
    v_mfma_f32_32x32x16_bf16 v[64:79], a[68:71], a[188:191], v[64:79]
    s_waitcnt lgkmcnt(9)
    buffer_load_dwordx4 a[92:95], v4, s[4:7], s37 offen offset:1536 sc1
    ds_read_b128 a[140:143], v7 offset:26624
    v_mfma_f32_32x32x16_bf16 v[48:63], a[192:195], a[68:71], v[48:63]
    ds_read_b128 a[144:147], v7 offset:25600
    v_mfma_f32_32x32x16_bf16 v[32:47], a[196:199], a[20:23], v[32:47]
    s_waitcnt vmcnt(5) lgkmcnt(9)
    s_add_u32 s37, s43, 13824
    buffer_load_dwordx4 a[96:99], v4, s[4:7], s37 offen offset:0 sc1
    ds_read_b128 a[148:151], v7 offset:29696
    v_mfma_f32_32x32x16_bf16 v[64:79], a[72:75], a[200:203], v[64:79]
    ds_read_b128 a[152:155], v7 offset:28672
    v_mfma_f32_32x32x16_bf16 v[48:63], a[204:207], a[72:75], v[48:63]
    s_waitcnt vmcnt(5) lgkmcnt(9)
    buffer_load_dwordx4 a[100:103], v4, s[4:7], s37 offen offset:512 sc1
    ds_read_b128 a[156:159], v6 offset:21504
    v_mfma_f32_32x32x16_bf16 v[64:79], a[76:79], a[208:211], v[64:79]
    ds_read_b128 a[160:163], v7 offset:32768
    v_mfma_f32_32x32x16_bf16 v[48:63], a[212:215], a[76:79], v[48:63]
    s_waitcnt vmcnt(5) lgkmcnt(9)
    buffer_load_dwordx4 a[104:107], v4, s[4:7], s37 offen offset:1024 sc1
    ds_read_b128 a[164:167], v7 offset:31744
    v_mfma_f32_32x32x16_bf16 v[64:79], a[80:83], a[216:219], v[64:79]
    ds_read_b128 a[168:171], v7 offset:35840
    v_mfma_f32_32x32x16_bf16 v[48:63], a[220:223], a[80:83], v[48:63]
    s_waitcnt vmcnt(5) lgkmcnt(9)
    buffer_load_dwordx4 a[108:111], v4, s[4:7], s37 offen offset:1536 sc1
    ds_read_b128 a[172:175], v7 offset:34816
    v_mfma_f32_32x32x16_bf16 v[32:47], a[128:131], a[24:27], v[32:47]
    ds_read_b128 a[176:179], v7 offset:38912
    v_mfma_f32_32x32x16_bf16 v[64:79], a[84:87], a[132:135], v[64:79]
    s_waitcnt vmcnt(5) lgkmcnt(9)
    ds_read_b128 a[180:183], v7 offset:37888
    v_mfma_f32_32x32x16_bf16 v[48:63], a[136:139], a[84:87], v[48:63]
    ds_read_b128 a[184:187], v6 offset:24576
    v_mfma_f32_32x32x16_bf16 v[64:79], a[88:91], a[140:143], v[64:79]
    s_waitcnt vmcnt(4) lgkmcnt(9)
    ds_read_b128 a[188:191], v7 offset:41984
    v_mfma_f32_32x32x16_bf16 v[48:63], a[144:147], a[88:91], v[48:63]
    ds_read_b128 a[192:195], v7 offset:40960
    v_mfma_f32_32x32x16_bf16 v[64:79], a[92:95], a[148:151], v[64:79]
    s_waitcnt lgkmcnt(9)
    ds_read_b128 a[196:199], v6 offset:27648
    v_mfma_f32_32x32x16_bf16 v[48:63], a[152:155], a[92:95], v[48:63]
    ds_read_b128 a[200:203], v6 offset:30720
    v_mfma_f32_32x32x16_bf16 v[32:47], a[156:159], a[28:31], v[32:47]
    s_waitcnt vmcnt(3) lgkmcnt(9)
    ds_read_b128 a[204:207], v6 offset:33792
    v_mfma_f32_32x32x16_bf16 v[64:79], a[96:99], a[160:163], v[64:79]
    ds_read_b128 a[208:211], v6 offset:36864
    v_mfma_f32_32x32x16_bf16 v[48:63], a[164:167], a[96:99], v[48:63]
    s_waitcnt vmcnt(2) lgkmcnt(9)
    ds_read_b128 a[212:215], v6 offset:39936
    v_add_f32 v16, v16, v17
    v_add_f32 v16, v16, v18
    v_add_f32 v16, v16, v19
    v_add_f32 v16, v16, v20
    v_mfma_f32_32x32x16_bf16 v[64:79], a[100:103], a[168:171], v[64:79]
    ds_read_b128 a[216:219], v7 offset:0
    v_add_f32 v16, v16, v21
    v_add_f32 v16, v16, v22
    v_mov_b32 v17, v16
    s_nop 1
    v_permlane32_swap_b32 v16, v17
    v_mfma_f32_32x32x16_bf16 v[48:63], a[172:175], a[100:103], v[48:63]
    s_waitcnt vmcnt(1) lgkmcnt(9)
    ds_read_b128 a[220:223], v7 offset:3072
    v_mul_f32 v12, 0x3b124925, v16
    v_mul_f32 v10, 0x3b124925, v17
    v_fma_f32 v10, -v12, v12, v10
    v_max_f32 v10, 0, v10
    v_mfma_f32_32x32x16_bf16 v[64:79], a[104:107], a[176:179], v[64:79]
    ds_read_b128 a[128:131], v7 offset:6144
    v_add_f32 v14, 0x3727c5ac, v10
    v_rsq_f32 v14, v14
    s_nop 0
    ds_write_b32 v8, v14
    v_mfma_f32_32x32x16_bf16 v[48:63], a[180:183], a[104:107], v[48:63]
    s_waitcnt vmcnt(0) lgkmcnt(10)
    ds_read_b128 a[132:135], v7 offset:9216
    v_mul_f32 v12, 0x3e8b97f6, v14
    ds_read_b128 v[96:99], v9 offset:0
    ds_read_b128 v[100:103], v9 offset:32
    ds_read_b128 v[104:107], v9 offset:64
    v_mfma_f32_32x32x16_bf16 v[32:47], a[184:187], a[32:35], v[32:47]
    ds_read_b128 a[136:139], v7 offset:12288
    ds_read_b128 v[108:111], v9 offset:96
    v_mfma_f32_32x32x16_bf16 v[64:79], a[108:111], a[188:191], v[64:79]
    s_waitcnt lgkmcnt(14)
    ds_read_b128 a[140:143], v7 offset:15360
    v_mfma_f32_32x32x16_bf16 v[48:63], a[192:195], a[108:111], v[48:63]
    ds_read_b128 a[144:147], v7 offset:18432
    v_mfma_f32_32x32x16_bf16 v[32:47], a[196:199], a[36:39], v[32:47]
    s_waitcnt lgkmcnt(14)
    ds_read_b128 a[148:151], v7 offset:21504
    v_mfma_f32_32x32x16_bf16 v[32:47], a[200:203], a[40:43], v[32:47]
    ds_read_b128 a[152:155], v7 offset:24576
    v_mfma_f32_32x32x16_bf16 v[32:47], a[204:207], a[44:47], v[32:47]
    s_waitcnt lgkmcnt(14)
    ds_read_b128 a[156:159], v7 offset:27648
    v_mfma_f32_32x32x16_bf16 v[32:47], a[208:211], a[48:51], v[32:47]
    ds_read_b128 a[160:163], v7 offset:30720
    v_mfma_f32_32x32x16_bf16 v[32:47], a[212:215], a[52:55], v[32:47]
    s_waitcnt lgkmcnt(14)
    ds_read_b128 a[164:167], v7 offset:33792
    s_nop 0
    v_mul_f32 v48, v48, v14
    v_mul_f32 v49, v49, v14
    v_mul_f32 v50, v50, v14
    v_mul_f32 v51, v51, v14
    v_mul_f32 v52, v52, v14
    v_mfma_f32_32x32x16_bf16 v[32:47], a[216:219], a[56:59], v[32:47]
    ds_read_b128 a[168:171], v7 offset:36864
    v_mul_f32 v53, v53, v14
    v_mul_f32 v54, v54, v14
    v_mul_f32 v55, v55, v14
    v_mul_f32 v56, v56, v14
    v_mul_f32 v57, v57, v14
    v_mfma_f32_32x32x16_bf16 v[32:47], a[220:223], a[60:63], v[32:47]
    s_waitcnt lgkmcnt(13)
    ds_read_b128 a[172:175], v7 offset:39936
    v_mul_f32 v58, v58, v14
    v_mul_f32 v59, v59, v14
    v_mul_f32 v60, v60, v14
    v_mul_f32 v61, v61, v14
    v_mul_f32 v62, v62, v14
    v_mfma_f32_32x32x16_bf16 v[32:47], a[128:131], a[64:67], v[32:47]
    v_mul_f32 v63, v63, v14
    v_cvt_pk_bf16_f32 v120, v48, v49
    v_cvt_pk_bf16_f32 v121, v50, v51
    v_cvt_pk_bf16_f32 v122, v52, v53
    v_cvt_pk_bf16_f32 v123, v54, v55
    v_mfma_f32_32x32x16_bf16 v[32:47], a[132:135], a[68:71], v[32:47]
    v_cvt_pk_bf16_f32 v124, v56, v57
    v_cvt_pk_bf16_f32 v125, v58, v59
    v_cvt_pk_bf16_f32 v126, v60, v61
    v_cvt_pk_bf16_f32 v127, v62, v63
    s_mov_b32 exec_lo, 0
    v_mov_b32 v126, 0x3f803f80
    v_mov_b32 v127, 0x3f80
    s_mov_b32 exec_lo, -1
    buffer_store_dwordx4 v[120:123], v1, s[4:7], s42 offen offset:0 sc1
    s_waitcnt lgkmcnt(8)
    v_mfma_f32_32x32x16_bf16 v[32:47], a[136:139], a[72:75], v[32:47]
    buffer_store_dwordx4 v[124:127], v1, s[4:7], s42 offen offset:1024 sc1
    v_mul_f32 v64, v64, v96
    v_mul_f32 v65, v65, v97
    v_mul_f32 v66, v66, v98
    v_mul_f32 v67, v67, v99
    v_mfma_f32_32x32x16_bf16 v[32:47], a[140:143], a[76:79], v[32:47]
    s_waitcnt lgkmcnt(6)
    v_mul_f32 v68, v68, v100
    v_mul_f32 v69, v69, v101
    v_mul_f32 v70, v70, v102
    v_mul_f32 v71, v71, v103
    v_mul_f32 v72, v72, v104
    v_mfma_f32_32x32x16_bf16 v[32:47], a[144:147], a[80:83], v[32:47]
    v_mul_f32 v73, v73, v105
    v_mul_f32 v74, v74, v106
    v_mul_f32 v75, v75, v107
    v_mul_f32 v76, v76, v108
    v_mul_f32 v77, v77, v109
    v_mfma_f32_32x32x16_bf16 v[32:47], a[148:151], a[84:87], v[32:47]
    s_waitcnt lgkmcnt(4)
    v_mul_f32 v78, v78, v110
    v_mul_f32 v79, v79, v111
    v_cvt_pk_bf16_f32 v112, v64, v65
    v_cvt_pk_bf16_f32 v113, v66, v67
    v_cvt_pk_bf16_f32 v114, v68, v69
    v_mfma_f32_32x32x16_bf16 v[32:47], a[152:155], a[88:91], v[32:47]
    v_cvt_pk_bf16_f32 v115, v70, v71
    v_cvt_pk_bf16_f32 v116, v72, v73
    v_cvt_pk_bf16_f32 v117, v74, v75
    v_cvt_pk_bf16_f32 v118, v76, v77
    v_cvt_pk_bf16_f32 v119, v78, v79
    v_mfma_f32_32x32x16_bf16 v[32:47], a[156:159], a[92:95], v[32:47]
    s_mov_b32 exec_lo, 0x10000000
    s_mov_b32 exec_hi, 0x10000000
    v_mov_b32 v112, 0x3f803f80
    v_mov_b32 v113, 0x3f803f80
    v_mov_b32 v114, 0x3f803f80
    v_mov_b32 v115, 0x3f803f80
    v_mov_b32 v116, 0x3f803f80
    v_mov_b32 v117, 0x3f803f80
    v_mov_b32 v118, 0x3f803f80
    v_mov_b32 v119, 0x3f803f80
    s_mov_b64 exec, -1
    buffer_store_dwordx4 v[112:115], v1, s[4:7], s42 offen offset:2048 sc1
    buffer_store_dwordx4 v[116:119], v1, s[4:7], s42 offen offset:3072 sc1
    s_waitcnt lgkmcnt(2)
    v_mfma_f32_32x32x16_bf16 v[32:47], a[160:163], a[96:99], v[32:47]
    v_mfma_f32_32x32x16_bf16 v[32:47], a[164:167], a[100:103], v[32:47]
    s_waitcnt lgkmcnt(0)
    v_mfma_f32_32x32x16_bf16 v[32:47], a[168:171], a[104:107], v[32:47]
    v_mfma_f32_32x32x16_bf16 v[32:47], a[172:175], a[108:111], v[32:47]
    s_nop 11
    v_pk_mul_f32 v[32:33], v[32:33], v[12:13] op_sel_hi:[1,0]
    v_pk_mul_f32 v[34:35], v[34:35], v[12:13] op_sel_hi:[1,0]
    v_pk_mul_f32 v[36:37], v[36:37], v[12:13] op_sel_hi:[1,0]
    v_pk_mul_f32 v[38:39], v[38:39], v[12:13] op_sel_hi:[1,0]
    v_pk_mul_f32 v[40:41], v[40:41], v[12:13] op_sel_hi:[1,0]
    v_pk_mul_f32 v[42:43], v[42:43], v[12:13] op_sel_hi:[1,0]
    v_pk_mul_f32 v[44:45], v[44:45], v[12:13] op_sel_hi:[1,0]
    v_pk_mul_f32 v[46:47], v[46:47], v[12:13] op_sel_hi:[1,0]
    v_cvt_pk_bf16_f32 v16, v32, v33
    v_cvt_pk_bf16_f32 v17, v34, v35
    v_cvt_pk_bf16_f32 v18, v36, v37
    v_cvt_pk_bf16_f32 v19, v38, v39
    buffer_store_dwordx4 v[16:19], v1, s[4:7], s41 offen sc1
    v_pk_mul_f32 v[10:11], v[32:33], v[48:49]
    v_pk_mul_f32 v[12:13], v[34:35], v[50:51]
    v_pk_fma_f32 v[10:11], v[36:37], v[52:53], v[10:11]
    v_pk_fma_f32 v[12:13], v[38:39], v[54:55], v[12:13]
    v_pk_fma_f32 v[10:11], v[40:41], v[56:57], v[10:11]
    v_pk_fma_f32 v[12:13], v[42:43], v[58:59], v[12:13]
    v_pk_fma_f32 v[10:11], v[44:45], v[60:61], v[10:11]
    v_pk_fma_f32 v[12:13], v[46:47], v[62:63], v[12:13]
    v_pk_add_f32 v[10:11], v[10:11], v[12:13]
    v_add_f32 v10, v10, v11
    v_mov_b32 v11, v10
    v_cvt_pk_bf16_f32 v20, v40, v41
    v_cvt_pk_bf16_f32 v21, v42, v43
    v_permlane32_swap_b32 v10, v11
    s_mov_b32 exec_lo, 0
    v_sub_f32 v44, -v10, v11
    s_mov_b32 exec_lo, -1
    v_cvt_pk_bf16_f32 v22, v44, v45
    v_cvt_pk_bf16_f32 v23, v46, v47
    buffer_store_dwordx4 v[20:23], v1, s[4:7], s41 offen offset:1024 sc1
    s_and_b32 s36, s14, 15
    s_lshr_b32 s28, s40, 4
    s_lshl_b32 s28, s28, 2
    v_and_b32 v10, 15, v0
    v_lshl_add_u32 v182, v10, 7, s28
    s_lshr_b32 s28, s40, 2
    s_lshl_b32 s28, s28, 7
    s_mov_b32 exec_lo, 0
    v_lshl_add_u32 v182, v10, 2, s28
    s_mov_b32 exec_lo, 0xffff
    s_lshl_b32 s28, s36, 11
    v_add_u32 v182, s28, v182
    s_mov_b32 exec_lo, 0xffff0000
    s_mov_b32 exec_hi, 0
    s_lshl_b32 s28, s36, 11
    v_add_u32 v182, s28, v182
    s_mov_b64 exec, -1
    v_mov_b32 v180, 1
    s_mov_b32 s18, 1
    s_lshr_b32 s28, s14, 4
    s_lshl_b32 s55, s13, 1
    s_add_u32 s55, s55, s28
    s_and_b32 s35, s14, 15
    s_mul_i32 s36, s18, 22147072
    s_add_u32 s36, s36, 9920512
    s_lshl_b32 s28, s55, 2
    s_add_u32 s28, s28, s12
    s_lshl_b32 s28, s28, 16
    s_add_u32 s28, s28, s36
    s_add_u32 s48, s28, 17952768
    s_lshl_b32 s28, s55, 4
    s_add_u32 s28, s28, s35
    s_lshl_b32 s28, s28, 13
    s_add_u32 s28, s28, s36
    s_add_u32 s28, s28, 15855616
    s_add_u32 s40, s12, 1
    s_and_b32 s40, s40, 3
    s_lshl_b32 s49, s40, 11
    s_add_u32 s49, s49, s28
    s_add_u32 s41, s12, 2
    s_and_b32 s41, s41, 3
    s_lshl_b32 s50, s41, 11
    s_add_u32 s50, s50, s28
    s_add_u32 s42, s12, 3
    s_and_b32 s42, s42, 3
    s_lshl_b32 s51, s42, 11
    s_add_u32 s51, s51, s28
    s_add_u32 s43, s12, 4
    s_and_b32 s43, s43, 3
    s_lshl_b32 s52, s43, 11
    s_add_u32 s52, s52, s28
    s_lshl_b32 s28, s35, 2
    s_add_u32 s28, s28, s12
    s_lshr_b32 s29, s28, 3
    s_add_u32 s29, s29, s28
    s_mul_i32 s53, s29, 32256
    s_add_u32 s53, s53, s36
    s_add_u32 s53, s53, 4144896
    s_mul_i32 s63, s17, 16128
    s_add_u32 s63, s63, s20
    s_add_u32 s63, s63, 7856128
    s_mul_i32 s45, s18, 49152
    s_add_u32 s45, s45, 54214656
    s_mov_b32 s54, 0
    s_mov_b32 s27, s55
    s_mov_b32 s66, 0x7ff00000
    s_lshl_b32 s62, s55, 4
    s_and_b32 s28, s14, 15
    s_add_u32 s62, s62, s28
    s_lshl_b32 s62, s62, 5
    s_add_u32 s62, s62, s12
    s_lshl_b32 s62, s62, 2
    s_mul_i32 s28, s18, 32768
    s_add_u32 s62, s62, s28
    s_add_u32 s62, s62, 54312960
    s_waitcnt vmcnt(0)
    s_mov_b32 s28, 54345728
    s_barrier
    s_cmp_lg_u32 s12, 0
    s_cbranch_scc1 Lmail1
    s_mov_b32 exec_hi, 15
    buffer_atomic_add v180, v182, s[4:7], s28 offen sc1
    s_mov_b32 exec_hi, -1
Lmail1:
    s_nop 1
    s_branch Lk_wait
Lc_end:
    s_endpgm
Lo_late0:
    s_mov_b32 s39, 0
Lo_spin0:
    buffer_load_dwordx4 v[56:59], v1, s[4:7], s48 offen offset:0 sc1
    buffer_load_dwordx4 v[60:63], v1, s[4:7], s48 offen offset:1024 sc1
    buffer_load_dwordx4 v[64:67], v1, s[4:7], s49 offen offset:0 sc1
    s_waitcnt vmcnt(0)
    v_max3_u32 v116, v56, v58, v59
    v_cmp_eq_u32 vcc, -1, v116
    s_nop 0
    s_cbranch_vccz Lo_got0
    s_add_u32 s39, s39, 1
    s_cmp_lt_u32 s39, 200000
    s_cbranch_scc1 Lo_spin0
Lo_got0:
    buffer_load_dwordx4 v[68:71], v1, s[4:7], s49 offen offset:1024 sc1
    buffer_load_dwordx4 v[72:75], v1, s[4:7], s50 offen offset:0 sc1
    buffer_load_dwordx4 v[76:79], v1, s[4:7], s50 offen offset:1024 sc1
    buffer_load_dwordx4 v[80:83], v1, s[4:7], s51 offen offset:0 sc1
    s_branch Lo_back0
Lo_late1:
    s_mov_b32 s39, 0
Lo_spin1:
    buffer_load_dwordx4 v[60:63], v1, s[4:7], s48 offen offset:1024 sc1
    buffer_load_dwordx4 v[64:67], v1, s[4:7], s49 offen offset:0 sc1
    buffer_load_dwordx4 v[68:71], v1, s[4:7], s49 offen offset:1024 sc1
    s_waitcnt vmcnt(0)
    v_max3_u32 v116, v60, v62, v63
    v_cmp_eq_u32 vcc, -1, v116
    s_nop 0
    s_cbranch_vccz Lo_got1
    s_add_u32 s39, s39, 1
    s_cmp_lt_u32 s39, 200000
    s_cbranch_scc1 Lo_spin1
Lo_got1:
    buffer_load_dwordx4 v[72:75], v1, s[4:7], s50 offen offset:0 sc1
    buffer_load_dwordx4 v[76:79], v1, s[4:7], s50 offen offset:1024 sc1
    buffer_load_dwordx4 v[80:83], v1, s[4:7], s51 offen offset:0 sc1
    buffer_load_dwordx4 v[84:87], v1, s[4:7], s51 offen offset:1024 sc1
    s_branch Lo_back1
Lo_late2:
    s_mov_b32 s39, 0
Lo_spin2:
    buffer_load_dwordx4 v[64:67], v1, s[4:7], s49 offen offset:0 sc1
    buffer_load_dwordx4 v[68:71], v1, s[4:7], s49 offen offset:1024 sc1
    buffer_load_dwordx4 v[72:75], v1, s[4:7], s50 offen offset:0 sc1
    s_waitcnt vmcnt(0)
    v_max3_u32 v116, v64, v66, v67
    v_cmp_eq_u32 vcc, -1, v116
    s_nop 0
    s_cbranch_vccz Lo_got2
    s_add_u32 s39, s39, 1
    s_cmp_lt_u32 s39, 200000
    s_cbranch_scc1 Lo_spin2
Lo_got2:
    buffer_load_dwordx4 v[76:79], v1, s[4:7], s50 offen offset:1024 sc1
    buffer_load_dwordx4 v[80:83], v1, s[4:7], s51 offen offset:0 sc1
    buffer_load_dwordx4 v[84:87], v1, s[4:7], s51 offen offset:1024 sc1
    buffer_load_dwordx4 v[88:91], v1, s[4:7], s52 offen offset:0 sc1
    s_branch Lo_back2
Lo_late3:
    s_mov_b32 s39, 0
Lo_spin3:
    buffer_load_dwordx4 v[68:71], v1, s[4:7], s49 offen offset:1024 sc1
    buffer_load_dwordx4 v[72:75], v1, s[4:7], s50 offen offset:0 sc1
    buffer_load_dwordx4 v[76:79], v1, s[4:7], s50 offen offset:1024 sc1
    s_waitcnt vmcnt(0)
    v_max3_u32 v116, v68, v70, v71
    v_cmp_eq_u32 vcc, -1, v116
    s_nop 0
    s_cbranch_vccz Lo_got3
    s_add_u32 s39, s39, 1
    s_cmp_lt_u32 s39, 200000
    s_cbranch_scc1 Lo_spin3
Lo_got3:
    buffer_load_dwordx4 v[80:83], v1, s[4:7], s51 offen offset:0 sc1
    buffer_load_dwordx4 v[84:87], v1, s[4:7], s51 offen offset:1024 sc1
    buffer_load_dwordx4 v[88:91], v1, s[4:7], s52 offen offset:0 sc1
    buffer_load_dwordx4 v[92:95], v1, s[4:7], s52 offen offset:1024 sc1
    s_branch Lo_back3
Lo_late4:
    s_mov_b32 s39, 0
Lo_spin4:
    buffer_load_dwordx4 v[72:75], v1, s[4:7], s50 offen offset:0 sc1
    buffer_load_dwordx4 v[76:79], v1, s[4:7], s50 offen offset:1024 sc1
    buffer_load_dwordx4 v[80:83], v1, s[4:7], s51 offen offset:0 sc1
    s_waitcnt vmcnt(0)
    v_max3_u32 v116, v72, v74, v75
    v_cmp_eq_u32 vcc, -1, v116
    s_nop 0
    s_cbranch_vccz Lo_got4
    s_add_u32 s39, s39, 1
    s_cmp_lt_u32 s39, 200000
    s_cbranch_scc1 Lo_spin4
Lo_got4:
    buffer_load_dwordx4 v[84:87], v1, s[4:7], s51 offen offset:1024 sc1
    buffer_load_dwordx4 v[88:91], v1, s[4:7], s52 offen offset:0 sc1
    buffer_load_dwordx4 v[92:95], v1, s[4:7], s52 offen offset:1024 sc1
    buffer_load_dwordx4 v[96:99], v1, s[4:7], s53 offen offset:0 sc1
    s_branch Lo_back4
Lo_late5:
    s_mov_b32 s39, 0
Lo_spin5:
    buffer_load_dwordx4 v[76:79], v1, s[4:7], s50 offen offset:1024 sc1
    buffer_load_dwordx4 v[80:83], v1, s[4:7], s51 offen offset:0 sc1
    buffer_load_dwordx4 v[84:87], v1, s[4:7], s51 offen offset:1024 sc1
    s_waitcnt vmcnt(0)
    v_max3_u32 v116, v76, v78, v79
    v_cmp_eq_u32 vcc, -1, v116
    s_nop 0
    s_cbranch_vccz Lo_got5
    s_add_u32 s39, s39, 1
    s_cmp_lt_u32 s39, 200000
    s_cbranch_scc1 Lo_spin5
Lo_got5:
    buffer_load_dwordx4 v[88:91], v1, s[4:7], s52 offen offset:0 sc1
    buffer_load_dwordx4 v[92:95], v1, s[4:7], s52 offen offset:1024 sc1
    buffer_load_dwordx4 v[96:99], v1, s[4:7], s53 offen offset:0 sc1
    buffer_load_dwordx4 v[100:103], v1, s[4:7], s53 offen offset:1024 sc1
    s_branch Lo_back5
Lo_late6:
    s_mov_b32 s39, 0
Lo_spin6:
    buffer_load_dwordx4 v[80:83], v1, s[4:7], s51 offen offset:0 sc1
    buffer_load_dwordx4 v[84:87], v1, s[4:7], s51 offen offset:1024 sc1
    buffer_load_dwordx4 v[88:91], v1, s[4:7], s52 offen offset:0 sc1
    s_waitcnt vmcnt(0)
    v_max3_u32 v116, v80, v82, v83
    v_cmp_eq_u32 vcc, -1, v116
    s_nop 0
    s_cbranch_vccz Lo_got6
    s_add_u32 s39, s39, 1
    s_cmp_lt_u32 s39, 200000
    s_cbranch_scc1 Lo_spin6
Lo_got6:
    buffer_load_dwordx4 v[92:95], v1, s[4:7], s52 offen offset:1024 sc1
    buffer_load_dwordx4 v[96:99], v1, s[4:7], s53 offen offset:0 sc1
    buffer_load_dwordx4 v[100:103], v1, s[4:7], s53 offen offset:1024 sc1
    buffer_load_dwordx2 v[104:105], v114, s[4:7], s54 offen offset:0 sc1
    buffer_load_dwordx2 v[106:107], v114, s[4:7], s54 offen offset:128 sc1
    s_branch Lo_back6
Lo_late7:
    s_mov_b32 s39, 0
Lo_spin7:
    buffer_load_dwordx4 v[84:87], v1, s[4:7], s51 offen offset:1024 sc1
    buffer_load_dwordx4 v[88:91], v1, s[4:7], s52 offen offset:0 sc1
    buffer_load_dwordx4 v[92:95], v1, s[4:7], s52 offen offset:1024 sc1
    s_waitcnt vmcnt(0)
    v_max3_u32 v116, v84, v86, v87
    v_cmp_eq_u32 vcc, -1, v116
    s_nop 0
    s_cbranch_vccz Lo_got7
    s_add_u32 s39, s39, 1
    s_cmp_lt_u32 s39, 200000
    s_cbranch_scc1 Lo_spin7
Lo_got7:
    buffer_load_dwordx4 v[96:99], v1, s[4:7], s53 offen offset:0 sc1
    buffer_load_dwordx4 v[100:103], v1, s[4:7], s53 offen offset:1024 sc1
    buffer_load_dwordx2 v[104:105], v114, s[4:7], s54 offen offset:0 sc1
    buffer_load_dwordx2 v[106:107], v114, s[4:7], s54 offen offset:128 sc1
    buffer_load_dwordx2 v[108:109], v114, s[4:7], s54 offen offset:1024 sc1
    buffer_load_dwordx2 v[110:111], v114, s[4:7], s54 offen offset:1152 sc1
    s_branch Lo_back7
Lo_late8:
    s_mov_b32 s39, 0
Lo_spin8:
    buffer_load_dwordx4 v[88:91], v1, s[4:7], s52 offen offset:0 sc1
    buffer_load_dwordx4 v[92:95], v1, s[4:7], s52 offen offset:1024 sc1
    buffer_load_dwordx4 v[96:99], v1, s[4:7], s53 offen offset:0 sc1
    s_waitcnt vmcnt(0)
    v_max3_u32 v116, v88, v90, v91
    v_cmp_eq_u32 vcc, -1, v116
    s_nop 0
    s_cbranch_vccz Lo_got8
    s_add_u32 s39, s39, 1
    s_cmp_lt_u32 s39, 200000
    s_cbranch_scc1 Lo_spin8
Lo_got8:
    buffer_load_dwordx4 v[100:103], v1, s[4:7], s53 offen offset:1024 sc1
    buffer_load_dwordx2 v[104:105], v114, s[4:7], s54 offen offset:0 sc1
    buffer_load_dwordx2 v[106:107], v114, s[4:7], s54 offen offset:128 sc1
    buffer_load_dwordx2 v[108:109], v114, s[4:7], s54 offen offset:1024 sc1
    buffer_load_dwordx2 v[110:111], v114, s[4:7], s54 offen offset:1152 sc1
    buffer_load_dword v127, off, s[4:7], s101
    buffer_load_dword v127, off, s[4:7], s101
    s_branch Lo_back8
Lo_late9:
    s_mov_b32 s39, 0
Lo_spin9:
    buffer_load_dwordx4 v[92:95], v1, s[4:7], s52 offen offset:1024 sc1
    buffer_load_dwordx4 v[96:99], v1, s[4:7], s53 offen offset:0 sc1
    buffer_load_dwordx4 v[100:103], v1, s[4:7], s53 offen offset:1024 sc1
    s_waitcnt vmcnt(0)
    v_max3_u32 v116, v92, v94, v95
    v_cmp_eq_u32 vcc, -1, v116
    s_nop 0
    s_cbranch_vccz Lo_got9
    s_add_u32 s39, s39, 1
    s_cmp_lt_u32 s39, 200000
    s_cbranch_scc1 Lo_spin9
Lo_got9:
    buffer_load_dwordx2 v[104:105], v114, s[4:7], s54 offen offset:0 sc1
    buffer_load_dwordx2 v[106:107], v114, s[4:7], s54 offen offset:128 sc1
    buffer_load_dwordx2 v[108:109], v114, s[4:7], s54 offen offset:1024 sc1
    buffer_load_dwordx2 v[110:111], v114, s[4:7], s54 offen offset:1152 sc1
    buffer_load_dword v127, off, s[4:7], s101
    buffer_load_dword v127, off, s[4:7], s101
    buffer_load_dword v127, off, s[4:7], s101
    buffer_load_dword v127, off, s[4:7], s101
    s_branch Lo_back9
Lo_late10:
    s_mov_b32 s39, 0
Lo_spin10:
    buffer_load_dwordx4 v[96:99], v1, s[4:7], s53 offen offset:0 sc1
    buffer_load_dwordx4 v[100:103], v1, s[4:7], s53 offen offset:1024 sc1
    buffer_load_dwordx2 v[104:105], v114, s[4:7], s54 offen offset:0 sc1
    buffer_load_dwordx2 v[106:107], v114, s[4:7], s54 offen offset:128 sc1
    s_waitcnt vmcnt(0)
    v_max3_u32 v116, v96, v98, v99
    v_cmp_eq_u32 vcc, -1, v116
    s_nop 0
    s_cbranch_vccz Lo_got10
    s_add_u32 s39, s39, 1
    s_cmp_lt_u32 s39, 200000
    s_cbranch_scc1 Lo_spin10
Lo_got10:
    buffer_load_dwordx2 v[108:109], v114, s[4:7], s54 offen offset:1024 sc1
    buffer_load_dwordx2 v[110:111], v114, s[4:7], s54 offen offset:1152 sc1
    buffer_load_dword v127, off, s[4:7], s101
    buffer_load_dword v127, off, s[4:7], s101
    buffer_load_dword v127, off, s[4:7], s101
    buffer_load_dword v127, off, s[4:7], s101
    buffer_load_dword v127, off, s[4:7], s101
    buffer_load_dword v127, off, s[4:7], s101
    s_branch Lo_back10
Lo_late11:
    s_mov_b32 s39, 0
Lo_spin11:
    buffer_load_dwordx4 v[100:103], v1, s[4:7], s53 offen offset:1024 sc1
    buffer_load_dwordx2 v[104:105], v114, s[4:7], s54 offen offset:0 sc1
    buffer_load_dwordx2 v[106:107], v114, s[4:7], s54 offen offset:128 sc1
    buffer_load_dwordx2 v[108:109], v114, s[4:7], s54 offen offset:1024 sc1
    buffer_load_dwordx2 v[110:111], v114, s[4:7], s54 offen offset:1152 sc1
    s_waitcnt vmcnt(0)
    v_max3_u32 v116, v100, v102, v103
    v_cmp_eq_u32 vcc, -1, v116
    s_nop 0
    s_cbranch_vccz Lo_got11
    s_add_u32 s39, s39, 1
    s_cmp_lt_u32 s39, 200000
    s_cbranch_scc1 Lo_spin11
Lo_got11:
    s_branch Lo_back11
Lo_late12:
    s_mov_b32 s39, 0
Lo_spin12:
    buffer_load_dwordx2 v[104:105], v114, s[4:7], s54 offen offset:0 sc1
    buffer_load_dwordx2 v[106:107], v114, s[4:7], s54 offen offset:128 sc1
    buffer_load_dwordx2 v[108:109], v114, s[4:7], s54 offen offset:1024 sc1
    buffer_load_dwordx2 v[110:111], v114, s[4:7], s54 offen offset:1152 sc1
    s_waitcnt vmcnt(0)
    v_max3_u32 v116, v104, v106, v107
    v_cmp_eq_u32 vcc, -1, v116
    s_nop 0
    s_cbranch_vccz Lo_got12
    s_add_u32 s39, s39, 1
    s_cmp_lt_u32 s39, 200000
    s_cbranch_scc1 Lo_spin12
Lo_got12:
    s_branch Lo_back12
Lo_late13:
    s_mov_b32 s39, 0
Lo_spin13:
    buffer_load_dwordx2 v[108:109], v114, s[4:7], s54 offen offset:1024 sc1
    buffer_load_dwordx2 v[110:111], v114, s[4:7], s54 offen offset:1152 sc1
    s_waitcnt vmcnt(0)
    v_max3_u32 v116, v108, v110, v111
    v_cmp_eq_u32 vcc, -1, v116
    s_nop 0
    s_cbranch_vccz Lo_got13
    s_add_u32 s39, s39, 1
    s_cmp_lt_u32 s39, 200000
    s_cbranch_scc1 Lo_spin13
Lo_got13:
    s_branch Lo_back13
Lc_edge:
    s_mov_b32 s39, 0
Lc_hpoll:
    buffer_load_dword v10, v14, s[4:7], s36 offen sc1
    buffer_load_dwordx4 v[56:59], v12, s[4:7], s41 offen sc1
    s_waitcnt vmcnt(0)
    v_add_u32 v10, -1, v10
    v_max3_u32 v10, v10, v56, v57
    v_max3_u32 v10, v10, v58, v59
    v_cmp_eq_u32 vcc, -1, v10
    s_nop 0
    s_cbranch_vccz Lc_hgo
    s_add_u32 s39, s39, 1
    s_cmp_lt_u32 s39, 200000
    s_cbranch_scc1 Lc_hpoll
    s_branch Lc_hgo
Lc_code_end:
La_slow:
    s_waitcnt vmcnt(0) lgkmcnt(0)
    s_barrier
    s_add_u32 s37, s48, 0
    buffer_load_dwordx4 a[0:3], v1, s[4:7], s37 offen offset:0 sc1
    buffer_load_dwordx4 a[4:7], v1, s[4:7], s37 offen offset:1024 sc1
    buffer_load_dwordx4 a[8:11], v1, s[4:7], s37 offen offset:2048 sc1
    buffer_load_dwordx4 a[12:15], v1, s[4:7], s37 offen offset:3072 sc1
    s_add_u32 s37, s48, 4096
    buffer_load_dwordx4 a[16:19], v1, s[4:7], s37 offen offset:0 sc1
    buffer_load_dwordx4 a[20:23], v1, s[4:7], s37 offen offset:1024 sc1
    buffer_load_dwordx4 a[24:27], v1, s[4:7], s37 offen offset:2048 sc1
    buffer_load_dwordx4 a[28:31], v1, s[4:7], s37 offen offset:3072 sc1
    s_add_u32 s37, s48, 8192
    buffer_load_dwordx4 a[32:35], v1, s[4:7], s37 offen offset:0 sc1
    buffer_load_dwordx4 a[36:39], v1, s[4:7], s37 offen offset:1024 sc1
    buffer_load_dwordx4 a[40:43], v1, s[4:7], s37 offen offset:2048 sc1
    buffer_load_dwordx4 a[44:47], v1, s[4:7], s37 offen offset:3072 sc1
    s_add_u32 s37, s48, 12288
    buffer_load_dwordx4 a[48:51], v1, s[4:7], s37 offen offset:0 sc1
    buffer_load_dwordx4 a[52:55], v1, s[4:7], s37 offen offset:1024 sc1
    s_add_u32 s37, s48, 16384
    buffer_load_dwordx4 a[64:67], v1, s[4:7], s37 offen offset:0 sc1
    buffer_load_dwordx4 a[68:71], v1, s[4:7], s37 offen offset:1024 sc1
    s_add_u32 s37, s48, 20480
    buffer_load_dwordx4 a[80:83], v1, s[4:7], s37 offen offset:0 sc1
    buffer_load_dwordx4 a[84:87], v1, s[4:7], s37 offen offset:1024 sc1
    s_add_u32 s37, s48, 24576
    buffer_load_dwordx4 a[96:99], v1, s[4:7], s37 offen offset:0 sc1
    buffer_load_dwordx4 a[100:103], v1, s[4:7], s37 offen offset:1024 sc1
    s_add_u32 s37, s48, 28672
    buffer_load_dwordx4 a[112:115], v1, s[4:7], s37 offen offset:0 sc1
    buffer_load_dwordx4 a[116:119], v1, s[4:7], s37 offen offset:1024 sc1
    s_add_u32 s37, s48, 32768
    buffer_load_dwordx4 a[128:131], v1, s[4:7], s37 offen offset:0 sc1
    buffer_load_dwordx4 a[132:135], v1, s[4:7], s37 offen offset:1024 sc1
    s_add_u32 s37, s48, 36864
    buffer_load_dwordx4 a[144:147], v1, s[4:7], s37 offen offset:0 sc1
    buffer_load_dwordx4 a[148:151], v1, s[4:7], s37 offen offset:1024 sc1
    s_add_u32 s37, s48, 40960
    buffer_load_dwordx4 a[160:163], v1, s[4:7], s37 offen offset:0 sc1
    buffer_load_dwordx4 a[164:167], v1, s[4:7], s37 offen offset:1024 sc1
    s_add_u32 s37, s48, 45056
    buffer_load_dwordx4 a[176:179], v1, s[4:7], s37 offen offset:0 sc1
    buffer_load_dwordx4 a[180:183], v1, s[4:7], s37 offen offset:1024 sc1
    s_add_u32 s37, s48, 49152
    buffer_load_dwordx4 a[192:195], v1, s[4:7], s37 offen offset:0 sc1
    buffer_load_dwordx4 a[196:199], v1, s[4:7], s37 offen offset:1024 sc1
    s_add_u32 s37, s48, 53248
    buffer_load_dwordx4 a[208:211], v1, s[4:7], s37 offen offset:0 sc1
    buffer_load_dwordx4 a[212:215], v1, s[4:7], s37 offen offset:1024 sc1
    s_add_u32 s37, s48, 57344
    buffer_load_dwordx4 a[224:227], v1, s[4:7], s37 offen offset:0 sc1
    buffer_load_dwordx4 a[228:231], v1, s[4:7], s37 offen offset:1024 sc1
    s_add_u32 s37, s48, 61440
    buffer_load_dwordx4 a[240:243], v1, s[4:7], s37 offen offset:0 sc1
    buffer_load_dwordx4 a[244:247], v1, s[4:7], s37 offen offset:1024 sc1
    s_mov_b32 exec_lo, 0
    v_mov_b32 v22, 0
    v_mov_b32 v23, 0
    v_mov_b32 v30, 0
    v_mov_b32 v31, 0
    v_mov_b32 v38, 0
    v_mov_b32 v39, 0
    v_mov_b32 v46, 0
    v_mov_b32 v47, 0
    s_mov_b32 exec_lo, -1
    v_mov_b32 v144, 0xff800000
    v_mov_b32 v145, 0xff800000
    v_mov_b32 v146, 0xff800000
    v_mov_b32 v147, 0xff800000
    s_waitcnt vmcnt(0)
    v_mfma_f32_32x32x16_bf16 v[112:127], a[0:3], v[16:19], 0
    v_mfma_f32_32x32x16_bf16 v[112:127], a[4:7], v[20:23], v[112:127]
    v_mfma_f32_32x32x16_bf16 v[128:143], a[0:3], v[24:27], 0
    v_mfma_f32_32x32x16_bf16 v[128:143], a[4:7], v[28:31], v[128:143]
    s_nop 9
    v_max3_f32 v144, v112, v113, v144
    v_max3_f32 v144, v114, v115, v144
    v_max3_f32 v144, v116, v117, v144
    v_max3_f32 v144, v118, v119, v144
    v_max3_f32 v144, v120, v121, v144
    v_max3_f32 v144, v122, v123, v144
    v_max3_f32 v144, v124, v125, v144
    v_max3_f32 v144, v126, v127, v144
    v_mfma_f32_32x32x16_bf16 v[112:127], a[16:19], v[16:19], 0
    v_mfma_f32_32x32x16_bf16 v[112:127], a[20:23], v[20:23], v[112:127]
    v_max3_f32 v145, v128, v129, v145
    v_max3_f32 v145, v130, v131, v145
    v_max3_f32 v145, v132, v133, v145
    v_max3_f32 v145, v134, v135, v145
    v_max3_f32 v145, v136, v137, v145
    v_max3_f32 v145, v138, v139, v145
    v_max3_f32 v145, v140, v141, v145
    v_max3_f32 v145, v142, v143, v145
    v_mfma_f32_32x32x16_bf16 v[128:143], a[16:19], v[24:27], 0
    v_mfma_f32_32x32x16_bf16 v[128:143], a[20:23], v[28:31], v[128:143]
    s_nop 1
    v_max3_f32 v144, v112, v113, v144
    v_max3_f32 v144, v114, v115, v144
    v_max3_f32 v144, v116, v117, v144
    v_max3_f32 v144, v118, v119, v144
    v_max3_f32 v144, v120, v121, v144
    v_max3_f32 v144, v122, v123, v144
    v_max3_f32 v144, v124, v125, v144
    v_max3_f32 v144, v126, v127, v144
    v_mfma_f32_32x32x16_bf16 v[112:127], a[32:35], v[16:19], 0
    v_mfma_f32_32x32x16_bf16 v[112:127], a[36:39], v[20:23], v[112:127]
    v_max3_f32 v145, v128, v129, v145
    v_max3_f32 v145, v130, v131, v145
    v_max3_f32 v145, v132, v133, v145
    v_max3_f32 v145, v134, v135, v145
    v_max3_f32 v145, v136, v137, v145
    v_max3_f32 v145, v138, v139, v145
    v_max3_f32 v145, v140, v141, v145
    v_max3_f32 v145, v142, v143, v145
    v_mfma_f32_32x32x16_bf16 v[128:143], a[32:35], v[24:27], 0
    v_mfma_f32_32x32x16_bf16 v[128:143], a[36:39], v[28:31], v[128:143]
    s_nop 1
    v_max3_f32 v144, v112, v113, v144
    v_max3_f32 v144, v114, v115, v144
    v_max3_f32 v144, v116, v117, v144
    v_max3_f32 v144, v118, v119, v144
    v_max3_f32 v144, v120, v121, v144
    v_max3_f32 v144, v122, v123, v144
    v_max3_f32 v144, v124, v125, v144
    v_max3_f32 v144, v126, v127, v144
    v_mfma_f32_32x32x16_bf16 v[112:127], a[48:51], v[16:19], 0
    v_mfma_f32_32x32x16_bf16 v[112:127], a[52:55], v[20:23], v[112:127]
    v_max3_f32 v145, v128, v129, v145
    v_max3_f32 v145, v130, v131, v145
    v_max3_f32 v145, v132, v133, v145
    v_max3_f32 v145, v134, v135, v145
    v_max3_f32 v145, v136, v137, v145
    v_max3_f32 v145, v138, v139, v145
    v_max3_f32 v145, v140, v141, v145
    v_max3_f32 v145, v142, v143, v145
    v_mfma_f32_32x32x16_bf16 v[128:143], a[48:51], v[24:27], 0
    v_mfma_f32_32x32x16_bf16 v[128:143], a[52:55], v[28:31], v[128:143]
    s_nop 1
    v_max3_f32 v144, v112, v113, v144
    v_max3_f32 v144, v114, v115, v144
    v_max3_f32 v144, v116, v117, v144
    v_max3_f32 v144, v118, v119, v144
    v_max3_f32 v144, v120, v121, v144
    v_max3_f32 v144, v122, v123, v144
    v_max3_f32 v144, v124, v125, v144
    v_max3_f32 v144, v126, v127, v144
    v_mfma_f32_32x32x16_bf16 v[112:127], a[64:67], v[16:19], 0
    v_mfma_f32_32x32x16_bf16 v[112:127], a[68:71], v[20:23], v[112:127]
    v_max3_f32 v145, v128, v129, v145
    v_max3_f32 v145, v130, v131, v145
    v_max3_f32 v145, v132, v133, v145
    v_max3_f32 v145, v134, v135, v145
    v_max3_f32 v145, v136, v137, v145
    v_max3_f32 v145, v138, v139, v145
    v_max3_f32 v145, v140, v141, v145
    v_max3_f32 v145, v142, v143, v145
    v_mfma_f32_32x32x16_bf16 v[128:143], a[64:67], v[24:27], 0
    v_mfma_f32_32x32x16_bf16 v[128:143], a[68:71], v[28:31], v[128:143]
    s_nop 1
    v_max3_f32 v144, v112, v113, v144
    v_max3_f32 v144, v114, v115, v144
    v_max3_f32 v144, v116, v117, v144
    v_max3_f32 v144, v118, v119, v144
    v_max3_f32 v144, v120, v121, v144
    v_max3_f32 v144, v122, v123, v144
    v_max3_f32 v144, v124, v125, v144
    v_max3_f32 v144, v126, v127, v144
    v_mfma_f32_32x32x16_bf16 v[112:127], a[80:83], v[16:19], 0
    v_mfma_f32_32x32x16_bf16 v[112:127], a[84:87], v[20:23], v[112:127]
    v_max3_f32 v145, v128, v129, v145
    v_max3_f32 v145, v130, v131, v145
    v_max3_f32 v145, v132, v133, v145
    v_max3_f32 v145, v134, v135, v145
    v_max3_f32 v145, v136, v137, v145
    v_max3_f32 v145, v138, v139, v145
    v_max3_f32 v145, v140, v141, v145
    v_max3_f32 v145, v142, v143, v145
    v_mfma_f32_32x32x16_bf16 v[128:143], a[80:83], v[24:27], 0
    v_mfma_f32_32x32x16_bf16 v[128:143], a[84:87], v[28:31], v[128:143]
    s_nop 1
    v_max3_f32 v144, v112, v113, v144
    v_max3_f32 v144, v114, v115, v144
    v_max3_f32 v144, v116, v117, v144
    v_max3_f32 v144, v118, v119, v144
    v_max3_f32 v144, v120, v121, v144
    v_max3_f32 v144, v122, v123, v144
    v_max3_f32 v144, v124, v125, v144
    v_max3_f32 v144, v126, v127, v144
    v_mfma_f32_32x32x16_bf16 v[112:127], a[96:99], v[16:19], 0
    v_mfma_f32_32x32x16_bf16 v[112:127], a[100:103], v[20:23], v[112:127]
    v_max3_f32 v145, v128, v129, v145
    v_max3_f32 v145, v130, v131, v145
    v_max3_f32 v145, v132, v133, v145
    v_max3_f32 v145, v134, v135, v145
    v_max3_f32 v145, v136, v137, v145
    v_max3_f32 v145, v138, v139, v145
    v_max3_f32 v145, v140, v141, v145
    v_max3_f32 v145, v142, v143, v145
    v_mfma_f32_32x32x16_bf16 v[128:143], a[96:99], v[24:27], 0
    v_mfma_f32_32x32x16_bf16 v[128:143], a[100:103], v[28:31], v[128:143]
    s_nop 1
    v_max3_f32 v144, v112, v113, v144
    v_max3_f32 v144, v114, v115, v144
    v_max3_f32 v144, v116, v117, v144
    v_max3_f32 v144, v118, v119, v144
    v_max3_f32 v144, v120, v121, v144
    v_max3_f32 v144, v122, v123, v144
    v_max3_f32 v144, v124, v125, v144
    v_max3_f32 v144, v126, v127, v144
    v_mfma_f32_32x32x16_bf16 v[112:127], a[112:115], v[16:19], 0
    v_mfma_f32_32x32x16_bf16 v[112:127], a[116:119], v[20:23], v[112:127]
    v_max3_f32 v145, v128, v129, v145
    v_max3_f32 v145, v130, v131, v145
    v_max3_f32 v145, v132, v133, v145
    v_max3_f32 v145, v134, v135, v145
    v_max3_f32 v145, v136, v137, v145
    v_max3_f32 v145, v138, v139, v145
    v_max3_f32 v145, v140, v141, v145
    v_max3_f32 v145, v142, v143, v145
    v_mfma_f32_32x32x16_bf16 v[128:143], a[112:115], v[24:27], 0
    v_mfma_f32_32x32x16_bf16 v[128:143], a[116:119], v[28:31], v[128:143]
    s_nop 1
    v_max3_f32 v144, v112, v113, v144
    v_max3_f32 v144, v114, v115, v144
    v_max3_f32 v144, v116, v117, v144
    v_max3_f32 v144, v118, v119, v144
    v_max3_f32 v144, v120, v121, v144
    v_max3_f32 v144, v122, v123, v144
    v_max3_f32 v144, v124, v125, v144
    v_max3_f32 v144, v126, v127, v144
    v_mfma_f32_32x32x16_bf16 v[112:127], a[128:131], v[16:19], 0
    v_mfma_f32_32x32x16_bf16 v[112:127], a[132:135], v[20:23], v[112:127]
    v_max3_f32 v145, v128, v129, v145
    v_max3_f32 v145, v130, v131, v145
    v_max3_f32 v145, v132, v133, v145
    v_max3_f32 v145, v134, v135, v145
    v_max3_f32 v145, v136, v137, v145
    v_max3_f32 v145, v138, v139, v145
    v_max3_f32 v145, v140, v141, v145
    v_max3_f32 v145, v142, v143, v145
    v_mfma_f32_32x32x16_bf16 v[128:143], a[128:131], v[24:27], 0
    v_mfma_f32_32x32x16_bf16 v[128:143], a[132:135], v[28:31], v[128:143]
    s_nop 1
    v_max3_f32 v144, v112, v113, v144
    v_max3_f32 v144, v114, v115, v144
    v_max3_f32 v144, v116, v117, v144
    v_max3_f32 v144, v118, v119, v144
    v_max3_f32 v144, v120, v121, v144
    v_max3_f32 v144, v122, v123, v144
    v_max3_f32 v144, v124, v125, v144
    v_max3_f32 v144, v126, v127, v144
    v_mfma_f32_32x32x16_bf16 v[112:127], a[144:147], v[16:19], 0
    v_mfma_f32_32x32x16_bf16 v[112:127], a[148:151], v[20:23], v[112:127]
    v_max3_f32 v145, v128, v129, v145
    v_max3_f32 v145, v130, v131, v145
    v_max3_f32 v145, v132, v133, v145
    v_max3_f32 v145, v134, v135, v145
    v_max3_f32 v145, v136, v137, v145
    v_max3_f32 v145, v138, v139, v145
    v_max3_f32 v145, v140, v141, v145
    v_max3_f32 v145, v142, v143, v145
    v_mfma_f32_32x32x16_bf16 v[128:143], a[144:147], v[24:27], 0
    v_mfma_f32_32x32x16_bf16 v[128:143], a[148:151], v[28:31], v[128:143]
    s_nop 1
    v_max3_f32 v144, v112, v113, v144
    v_max3_f32 v144, v114, v115, v144
    v_max3_f32 v144, v116, v117, v144
    v_max3_f32 v144, v118, v119, v144
    v_max3_f32 v144, v120, v121, v144
    v_max3_f32 v144, v122, v123, v144
    v_max3_f32 v144, v124, v125, v144
    v_max3_f32 v144, v126, v127, v144
    v_mfma_f32_32x32x16_bf16 v[112:127], a[160:163], v[16:19], 0
    v_mfma_f32_32x32x16_bf16 v[112:127], a[164:167], v[20:23], v[112:127]
    v_max3_f32 v145, v128, v129, v145
    v_max3_f32 v145, v130, v131, v145
    v_max3_f32 v145, v132, v133, v145
    v_max3_f32 v145, v134, v135, v145
    v_max3_f32 v145, v136, v137, v145
    v_max3_f32 v145, v138, v139, v145
    v_max3_f32 v145, v140, v141, v145
    v_max3_f32 v145, v142, v143, v145
    v_mfma_f32_32x32x16_bf16 v[128:143], a[160:163], v[24:27], 0
    v_mfma_f32_32x32x16_bf16 v[128:143], a[164:167], v[28:31], v[128:143]
    s_nop 1
    v_max3_f32 v144, v112, v113, v144
    v_max3_f32 v144, v114, v115, v144
    v_max3_f32 v144, v116, v117, v144
    v_max3_f32 v144, v118, v119, v144
    v_max3_f32 v144, v120, v121, v144
    v_max3_f32 v144, v122, v123, v144
    v_max3_f32 v144, v124, v125, v144
    v_max3_f32 v144, v126, v127, v144
    v_mfma_f32_32x32x16_bf16 v[112:127], a[176:179], v[16:19], 0
    v_mfma_f32_32x32x16_bf16 v[112:127], a[180:183], v[20:23], v[112:127]
    v_max3_f32 v145, v128, v129, v145
    v_max3_f32 v145, v130, v131, v145
    v_max3_f32 v145, v132, v133, v145
    v_max3_f32 v145, v134, v135, v145
    v_max3_f32 v145, v136, v137, v145
    v_max3_f32 v145, v138, v139, v145
    v_max3_f32 v145, v140, v141, v145
    v_max3_f32 v145, v142, v143, v145
    v_mfma_f32_32x32x16_bf16 v[128:143], a[176:179], v[24:27], 0
    v_mfma_f32_32x32x16_bf16 v[128:143], a[180:183], v[28:31], v[128:143]
    s_nop 1
    v_max3_f32 v144, v112, v113, v144
    v_max3_f32 v144, v114, v115, v144
    v_max3_f32 v144, v116, v117, v144
    v_max3_f32 v144, v118, v119, v144
    v_max3_f32 v144, v120, v121, v144
    v_max3_f32 v144, v122, v123, v144
    v_max3_f32 v144, v124, v125, v144
    v_max3_f32 v144, v126, v127, v144
    v_mfma_f32_32x32x16_bf16 v[112:127], a[192:195], v[16:19], 0
    v_mfma_f32_32x32x16_bf16 v[112:127], a[196:199], v[20:23], v[112:127]
    v_max3_f32 v145, v128, v129, v145
    v_max3_f32 v145, v130, v131, v145
    v_max3_f32 v145, v132, v133, v145
    v_max3_f32 v145, v134, v135, v145
    v_max3_f32 v145, v136, v137, v145
    v_max3_f32 v145, v138, v139, v145
    v_max3_f32 v145, v140, v141, v145
    v_max3_f32 v145, v142, v143, v145
    v_mfma_f32_32x32x16_bf16 v[128:143], a[192:195], v[24:27], 0
    v_mfma_f32_32x32x16_bf16 v[128:143], a[196:199], v[28:31], v[128:143]
    s_nop 1
    v_max3_f32 v144, v112, v113, v144
    v_max3_f32 v144, v114, v115, v144
    v_max3_f32 v144, v116, v117, v144
    v_max3_f32 v144, v118, v119, v144
    v_max3_f32 v144, v120, v121, v144
    v_max3_f32 v144, v122, v123, v144
    v_max3_f32 v144, v124, v125, v144
    v_max3_f32 v144, v126, v127, v144
    v_mfma_f32_32x32x16_bf16 v[112:127], a[208:211], v[16:19], 0
    v_mfma_f32_32x32x16_bf16 v[112:127], a[212:215], v[20:23], v[112:127]
    v_max3_f32 v145, v128, v129, v145
    v_max3_f32 v145, v130, v131, v145
    v_max3_f32 v145, v132, v133, v145
    v_max3_f32 v145, v134, v135, v145
    v_max3_f32 v145, v136, v137, v145
    v_max3_f32 v145, v138, v139, v145
    v_max3_f32 v145, v140, v141, v145
    v_max3_f32 v145, v142, v143, v145
    v_mfma_f32_32x32x16_bf16 v[128:143], a[208:211], v[24:27], 0
    v_mfma_f32_32x32x16_bf16 v[128:143], a[212:215], v[28:31], v[128:143]
    s_nop 1
    v_max3_f32 v144, v112, v113, v144
    v_max3_f32 v144, v114, v115, v144
    v_max3_f32 v144, v116, v117, v144
    v_max3_f32 v144, v118, v119, v144
    v_max3_f32 v144, v120, v121, v144
    v_max3_f32 v144, v122, v123, v144
    v_max3_f32 v144, v124, v125, v144
    v_max3_f32 v144, v126, v127, v144
    v_mfma_f32_32x32x16_bf16 v[112:127], a[224:227], v[16:19], 0
    v_mfma_f32_32x32x16_bf16 v[112:127], a[228:231], v[20:23], v[112:127]
    v_max3_f32 v145, v128, v129, v145
    v_max3_f32 v145, v130, v131, v145
    v_max3_f32 v145, v132, v133, v145
    v_max3_f32 v145, v134, v135, v145
    v_max3_f32 v145, v136, v137, v145
    v_max3_f32 v145, v138, v139, v145
    v_max3_f32 v145, v140, v141, v145
    v_max3_f32 v145, v142, v143, v145
    v_mfma_f32_32x32x16_bf16 v[128:143], a[224:227], v[24:27], 0
    v_mfma_f32_32x32x16_bf16 v[128:143], a[228:231], v[28:31], v[128:143]
    s_nop 1
    v_max3_f32 v144, v112, v113, v144
    v_max3_f32 v144, v114, v115, v144
    v_max3_f32 v144, v116, v117, v144
    v_max3_f32 v144, v118, v119, v144
    v_max3_f32 v144, v120, v121, v144
    v_max3_f32 v144, v122, v123, v144
    v_max3_f32 v144, v124, v125, v144
    v_max3_f32 v144, v126, v127, v144
    v_mfma_f32_32x32x16_bf16 v[112:127], a[240:243], v[16:19], 0
    v_mfma_f32_32x32x16_bf16 v[112:127], a[244:247], v[20:23], v[112:127]
    v_max3_f32 v145, v128, v129, v145
    v_max3_f32 v145, v130, v131, v145
    v_max3_f32 v145, v132, v133, v145
    v_max3_f32 v145, v134, v135, v145
    v_max3_f32 v145, v136, v137, v145
    v_max3_f32 v145, v138, v139, v145
    v_max3_f32 v145, v140, v141, v145
    v_max3_f32 v145, v142, v143, v145
    v_mfma_f32_32x32x16_bf16 v[128:143], a[240:243], v[24:27], 0
    v_mfma_f32_32x32x16_bf16 v[128:143], a[244:247], v[28:31], v[128:143]
    s_nop 1
    v_max3_f32 v144, v112, v113, v144
    v_max3_f32 v144, v114, v115, v144
    v_max3_f32 v144, v116, v117, v144
    v_max3_f32 v144, v118, v119, v144
    v_max3_f32 v144, v120, v121, v144
    v_max3_f32 v144, v122, v123, v144
    v_max3_f32 v144, v124, v125, v144
    v_max3_f32 v144, v126, v127, v144
    v_mfma_f32_32x32x16_bf16 v[112:127], a[0:3], v[32:35], 0
    v_mfma_f32_32x32x16_bf16 v[112:127], a[4:7], v[36:39], v[112:127]
    v_max3_f32 v145, v128, v129, v145
    v_max3_f32 v145, v130, v131, v145
    v_max3_f32 v145, v132, v133, v145
    v_max3_f32 v145, v134, v135, v145
    v_max3_f32 v145, v136, v137, v145
    v_max3_f32 v145, v138, v139, v145
    v_max3_f32 v145, v140, v141, v145
    v_max3_f32 v145, v142, v143, v145
    v_mfma_f32_32x32x16_bf16 v[128:143], a[16:19], v[32:35], 0
    v_mfma_f32_32x32x16_bf16 v[128:143], a[20:23], v[36:39], v[128:143]
    s_nop 1
    v_max3_f32 v146, v112, v113, v146
    v_max3_f32 v146, v114, v115, v146
    v_max3_f32 v146, v116, v117, v146
    v_max3_f32 v146, v118, v119, v146
    v_max3_f32 v146, v120, v121, v146
    v_max3_f32 v146, v122, v123, v146
    v_max3_f32 v146, v124, v125, v146
    v_max3_f32 v146, v126, v127, v146
    v_mfma_f32_32x32x16_bf16 v[112:127], a[32:35], v[32:35], 0
    v_mfma_f32_32x32x16_bf16 v[112:127], a[36:39], v[36:39], v[112:127]
    v_max3_f32 v146, v128, v129, v146
    v_max3_f32 v146, v130, v131, v146
    v_max3_f32 v146, v132, v133, v146
    v_max3_f32 v146, v134, v135, v146
    v_max3_f32 v146, v136, v137, v146
    v_max3_f32 v146, v138, v139, v146
    v_max3_f32 v146, v140, v141, v146
    v_max3_f32 v146, v142, v143, v146
    v_mfma_f32_32x32x16_bf16 v[128:143], a[48:51], v[32:35], 0
    v_mfma_f32_32x32x16_bf16 v[128:143], a[52:55], v[36:39], v[128:143]
    s_nop 1
    v_max3_f32 v146, v112, v113, v146
    v_max3_f32 v146, v114, v115, v146
    v_max3_f32 v146, v116, v117, v146
    v_max3_f32 v146, v118, v119, v146
    v_max3_f32 v146, v120, v121, v146
    v_max3_f32 v146, v122, v123, v146
    v_max3_f32 v146, v124, v125, v146
    v_max3_f32 v146, v126, v127, v146
    v_mfma_f32_32x32x16_bf16 v[112:127], a[64:67], v[32:35], 0
    v_mfma_f32_32x32x16_bf16 v[112:127], a[68:71], v[36:39], v[112:127]
    v_max3_f32 v146, v128, v129, v146
    v_max3_f32 v146, v130, v131, v146
    v_max3_f32 v146, v132, v133, v146
    v_max3_f32 v146, v134, v135, v146
    v_max3_f32 v146, v136, v137, v146
    v_max3_f32 v146, v138, v139, v146
    v_max3_f32 v146, v140, v141, v146
    v_max3_f32 v146, v142, v143, v146
    v_mfma_f32_32x32x16_bf16 v[128:143], a[80:83], v[32:35], 0
    v_mfma_f32_32x32x16_bf16 v[128:143], a[84:87], v[36:39], v[128:143]
    s_nop 1
    v_max3_f32 v146, v112, v113, v146
    v_max3_f32 v146, v114, v115, v146
    v_max3_f32 v146, v116, v117, v146
    v_max3_f32 v146, v118, v119, v146
    v_max3_f32 v146, v120, v121, v146
    v_max3_f32 v146, v122, v123, v146
    v_max3_f32 v146, v124, v125, v146
    v_max3_f32 v146, v126, v127, v146
    v_mfma_f32_32x32x16_bf16 v[112:127], a[0:3], v[40:43], 0
    v_mfma_f32_32x32x16_bf16 v[112:127], a[4:7], v[44:47], v[112:127]
    v_max3_f32 v146, v128, v129, v146
    v_max3_f32 v146, v130, v131, v146
    v_max3_f32 v146, v132, v133, v146
    v_max3_f32 v146, v134, v135, v146
    v_max3_f32 v146, v136, v137, v146
    v_max3_f32 v146, v138, v139, v146
    v_max3_f32 v146, v140, v141, v146
    v_max3_f32 v146, v142, v143, v146
    v_mfma_f32_32x32x16_bf16 v[128:143], a[96:99], v[32:35], 0
    v_mfma_f32_32x32x16_bf16 v[128:143], a[100:103], v[36:39], v[128:143]
    s_nop 1
    v_max3_f32 v147, v112, v113, v147
    v_max3_f32 v147, v114, v115, v147
    v_max3_f32 v147, v116, v117, v147
    v_max3_f32 v147, v118, v119, v147
    v_max3_f32 v147, v120, v121, v147
    v_max3_f32 v147, v122, v123, v147
    v_max3_f32 v147, v124, v125, v147
    v_max3_f32 v147, v126, v127, v147
    v_mfma_f32_32x32x16_bf16 v[112:127], a[16:19], v[40:43], 0
    v_mfma_f32_32x32x16_bf16 v[112:127], a[20:23], v[44:47], v[112:127]
    v_max3_f32 v146, v128, v129, v146
    v_max3_f32 v146, v130, v131, v146
    v_max3_f32 v146, v132, v133, v146
    v_max3_f32 v146, v134, v135, v146
    v_max3_f32 v146, v136, v137, v146
    v_max3_f32 v146, v138, v139, v146
    v_max3_f32 v146, v140, v141, v146
    v_max3_f32 v146, v142, v143, v146
    v_mfma_f32_32x32x16_bf16 v[128:143], a[112:115], v[32:35], 0
    v_mfma_f32_32x32x16_bf16 v[128:143], a[116:119], v[36:39], v[128:143]
    s_nop 1
    v_max3_f32 v147, v112, v113, v147
    v_max3_f32 v147, v114, v115, v147
    v_max3_f32 v147, v116, v117, v147
    v_max3_f32 v147, v118, v119, v147
    v_max3_f32 v147, v120, v121, v147
    v_max3_f32 v147, v122, v123, v147
    v_max3_f32 v147, v124, v125, v147
    v_max3_f32 v147, v126, v127, v147
    v_mfma_f32_32x32x16_bf16 v[112:127], a[32:35], v[40:43], 0
    v_mfma_f32_32x32x16_bf16 v[112:127], a[36:39], v[44:47], v[112:127]
    v_max3_f32 v146, v128, v129, v146
    v_max3_f32 v146, v130, v131, v146
    v_max3_f32 v146, v132, v133, v146
    v_max3_f32 v146, v134, v135, v146
    v_max3_f32 v146, v136, v137, v146
    v_max3_f32 v146, v138, v139, v146
    v_max3_f32 v146, v140, v141, v146
    v_max3_f32 v146, v142, v143, v146
    v_mfma_f32_32x32x16_bf16 v[128:143], a[128:131], v[32:35], 0
    v_mfma_f32_32x32x16_bf16 v[128:143], a[132:135], v[36:39], v[128:143]
    s_nop 1
    v_max3_f32 v147, v112, v113, v147
    v_max3_f32 v147, v114, v115, v147
    v_max3_f32 v147, v116, v117, v147
    v_max3_f32 v147, v118, v119, v147
    v_max3_f32 v147, v120, v121, v147
    v_max3_f32 v147, v122, v123, v147
    v_max3_f32 v147, v124, v125, v147
    v_max3_f32 v147, v126, v127, v147
    v_mfma_f32_32x32x16_bf16 v[112:127], a[48:51], v[40:43], 0
    v_mfma_f32_32x32x16_bf16 v[112:127], a[52:55], v[44:47], v[112:127]
    v_max3_f32 v146, v128, v129, v146
    v_max3_f32 v146, v130, v131, v146
    v_max3_f32 v146, v132, v133, v146
    v_max3_f32 v146, v134, v135, v146
    v_max3_f32 v146, v136, v137, v146
    v_max3_f32 v146, v138, v139, v146
    v_max3_f32 v146, v140, v141, v146
    v_max3_f32 v146, v142, v143, v146
    v_mfma_f32_32x32x16_bf16 v[128:143], a[144:147], v[32:35], 0
    v_mfma_f32_32x32x16_bf16 v[128:143], a[148:151], v[36:39], v[128:143]
    s_nop 1
    v_max3_f32 v147, v112, v113, v147
    v_max3_f32 v147, v114, v115, v147
    v_max3_f32 v147, v116, v117, v147
    v_max3_f32 v147, v118, v119, v147
    v_max3_f32 v147, v120, v121, v147
    v_max3_f32 v147, v122, v123, v147
    v_max3_f32 v147, v124, v125, v147
    v_max3_f32 v147, v126, v127, v147
    v_mfma_f32_32x32x16_bf16 v[112:127], a[64:67], v[40:43], 0
    v_mfma_f32_32x32x16_bf16 v[112:127], a[68:71], v[44:47], v[112:127]
    v_max3_f32 v146, v128, v129, v146
    v_max3_f32 v146, v130, v131, v146
    v_max3_f32 v146, v132, v133, v146
    v_max3_f32 v146, v134, v135, v146
    v_max3_f32 v146, v136, v137, v146
    v_max3_f32 v146, v138, v139, v146
    v_max3_f32 v146, v140, v141, v146
    v_max3_f32 v146, v142, v143, v146
    v_mfma_f32_32x32x16_bf16 v[128:143], a[160:163], v[32:35], 0
    v_mfma_f32_32x32x16_bf16 v[128:143], a[164:167], v[36:39], v[128:143]
    s_nop 1
    v_max3_f32 v147, v112, v113, v147
    v_max3_f32 v147, v114, v115, v147
    v_max3_f32 v147, v116, v117, v147
    v_max3_f32 v147, v118, v119, v147
    v_max3_f32 v147, v120, v121, v147
    v_max3_f32 v147, v122, v123, v147
    v_max3_f32 v147, v124, v125, v147
    v_max3_f32 v147, v126, v127, v147
    v_mfma_f32_32x32x16_bf16 v[112:127], a[80:83], v[40:43], 0
    v_mfma_f32_32x32x16_bf16 v[112:127], a[84:87], v[44:47], v[112:127]
    v_max3_f32 v146, v128, v129, v146
    v_max3_f32 v146, v130, v131, v146
    v_max3_f32 v146, v132, v133, v146
    v_max3_f32 v146, v134, v135, v146
    v_max3_f32 v146, v136, v137, v146
    v_max3_f32 v146, v138, v139, v146
    v_max3_f32 v146, v140, v141, v146
    v_max3_f32 v146, v142, v143, v146
    v_mfma_f32_32x32x16_bf16 v[128:143], a[176:179], v[32:35], 0
    v_mfma_f32_32x32x16_bf16 v[128:143], a[180:183], v[36:39], v[128:143]
    s_nop 1
    v_max3_f32 v147, v112, v113, v147
    v_max3_f32 v147, v114, v115, v147
    v_max3_f32 v147, v116, v117, v147
    v_max3_f32 v147, v118, v119, v147
    v_max3_f32 v147, v120, v121, v147
    v_max3_f32 v147, v122, v123, v147
    v_max3_f32 v147, v124, v125, v147
    v_max3_f32 v147, v126, v127, v147
    v_mfma_f32_32x32x16_bf16 v[112:127], a[96:99], v[40:43], 0
    v_mfma_f32_32x32x16_bf16 v[112:127], a[100:103], v[44:47], v[112:127]
    v_max3_f32 v146, v128, v129, v146
    v_max3_f32 v146, v130, v131, v146
    v_max3_f32 v146, v132, v133, v146
    v_max3_f32 v146, v134, v135, v146
    v_max3_f32 v146, v136, v137, v146
    v_max3_f32 v146, v138, v139, v146
    v_max3_f32 v146, v140, v141, v146
    v_max3_f32 v146, v142, v143, v146
    v_mfma_f32_32x32x16_bf16 v[128:143], a[192:195], v[32:35], 0
    v_mfma_f32_32x32x16_bf16 v[128:143], a[196:199], v[36:39], v[128:143]
    s_nop 1
    v_max3_f32 v147, v112, v113, v147
    v_max3_f32 v147, v114, v115, v147
    v_max3_f32 v147, v116, v117, v147
    v_max3_f32 v147, v118, v119, v147
    v_max3_f32 v147, v120, v121, v147
    v_max3_f32 v147, v122, v123, v147
    v_max3_f32 v147, v124, v125, v147
    v_max3_f32 v147, v126, v127, v147
    v_mfma_f32_32x32x16_bf16 v[112:127], a[112:115], v[40:43], 0
    v_mfma_f32_32x32x16_bf16 v[112:127], a[116:119], v[44:47], v[112:127]
    v_max3_f32 v146, v128, v129, v146
    v_max3_f32 v146, v130, v131, v146
    v_max3_f32 v146, v132, v133, v146
    v_max3_f32 v146, v134, v135, v146
    v_max3_f32 v146, v136, v137, v146
    v_max3_f32 v146, v138, v139, v146
    v_max3_f32 v146, v140, v141, v146
    v_max3_f32 v146, v142, v143, v146
    v_mfma_f32_32x32x16_bf16 v[128:143], a[208:211], v[32:35], 0
    v_mfma_f32_32x32x16_bf16 v[128:143], a[212:215], v[36:39], v[128:143]
    s_nop 1
    v_max3_f32 v147, v112, v113, v147
    v_max3_f32 v147, v114, v115, v147
    v_max3_f32 v147, v116, v117, v147
    v_max3_f32 v147, v118, v119, v147
    v_max3_f32 v147, v120, v121, v147
    v_max3_f32 v147, v122, v123, v147
    v_max3_f32 v147, v124, v125, v147
    v_max3_f32 v147, v126, v127, v147
    v_mfma_f32_32x32x16_bf16 v[112:127], a[128:131], v[40:43], 0
    v_mfma_f32_32x32x16_bf16 v[112:127], a[132:135], v[44:47], v[112:127]
    v_max3_f32 v146, v128, v129, v146
    v_max3_f32 v146, v130, v131, v146
    v_max3_f32 v146, v132, v133, v146
    v_max3_f32 v146, v134, v135, v146
    v_max3_f32 v146, v136, v137, v146
    v_max3_f32 v146, v138, v139, v146
    v_max3_f32 v146, v140, v141, v146
    v_max3_f32 v146, v142, v143, v146
    v_mfma_f32_32x32x16_bf16 v[128:143], a[224:227], v[32:35], 0
    v_mfma_f32_32x32x16_bf16 v[128:143], a[228:231], v[36:39], v[128:143]
    s_nop 1
    v_max3_f32 v147, v112, v113, v147
    v_max3_f32 v147, v114, v115, v147
    v_max3_f32 v147, v116, v117, v147
    v_max3_f32 v147, v118, v119, v147
    v_max3_f32 v147, v120, v121, v147
    v_max3_f32 v147, v122, v123, v147
    v_max3_f32 v147, v124, v125, v147
    v_max3_f32 v147, v126, v127, v147
    v_mfma_f32_32x32x16_bf16 v[112:127], a[144:147], v[40:43], 0
    v_mfma_f32_32x32x16_bf16 v[112:127], a[148:151], v[44:47], v[112:127]
    v_max3_f32 v146, v128, v129, v146
    v_max3_f32 v146, v130, v131, v146
    v_max3_f32 v146, v132, v133, v146
    v_max3_f32 v146, v134, v135, v146
    v_max3_f32 v146, v136, v137, v146
    v_max3_f32 v146, v138, v139, v146
    v_max3_f32 v146, v140, v141, v146
    v_max3_f32 v146, v142, v143, v146
    v_mfma_f32_32x32x16_bf16 v[128:143], a[240:243], v[32:35], 0
    v_mfma_f32_32x32x16_bf16 v[128:143], a[244:247], v[36:39], v[128:143]
    s_nop 1
    v_max3_f32 v147, v112, v113, v147
    v_max3_f32 v147, v114, v115, v147
    v_max3_f32 v147, v116, v117, v147
    v_max3_f32 v147, v118, v119, v147
    v_max3_f32 v147, v120, v121, v147
    v_max3_f32 v147, v122, v123, v147
    v_max3_f32 v147, v124, v125, v147
    v_max3_f32 v147, v126, v127, v147
    v_mfma_f32_32x32x16_bf16 v[112:127], a[160:163], v[40:43], 0
    v_mfma_f32_32x32x16_bf16 v[112:127], a[164:167], v[44:47], v[112:127]
    v_max3_f32 v146, v128, v129, v146
    v_max3_f32 v146, v130, v131, v146
    v_max3_f32 v146, v132, v133, v146
    v_max3_f32 v146, v134, v135, v146
    v_max3_f32 v146, v136, v137, v146
    v_max3_f32 v146, v138, v139, v146
    v_max3_f32 v146, v140, v141, v146
    v_max3_f32 v146, v142, v143, v146
    v_mfma_f32_32x32x16_bf16 v[128:143], a[176:179], v[40:43], 0
    v_mfma_f32_32x32x16_bf16 v[128:143], a[180:183], v[44:47], v[128:143]
    s_nop 1
    v_max3_f32 v147, v112, v113, v147
    v_max3_f32 v147, v114, v115, v147
    v_max3_f32 v147, v116, v117, v147
    v_max3_f32 v147, v118, v119, v147
    v_max3_f32 v147, v120, v121, v147
    v_max3_f32 v147, v122, v123, v147
    v_max3_f32 v147, v124, v125, v147
    v_max3_f32 v147, v126, v127, v147
    v_mfma_f32_32x32x16_bf16 v[112:127], a[192:195], v[40:43], 0
    v_mfma_f32_32x32x16_bf16 v[112:127], a[196:199], v[44:47], v[112:127]
    v_max3_f32 v147, v128, v129, v147
    v_max3_f32 v147, v130, v131, v147
    v_max3_f32 v147, v132, v133, v147
    v_max3_f32 v147, v134, v135, v147
    v_max3_f32 v147, v136, v137, v147
    v_max3_f32 v147, v138, v139, v147
    v_max3_f32 v147, v140, v141, v147
    v_max3_f32 v147, v142, v143, v147
    v_mfma_f32_32x32x16_bf16 v[128:143], a[208:211], v[40:43], 0
    v_mfma_f32_32x32x16_bf16 v[128:143], a[212:215], v[44:47], v[128:143]
    s_nop 1
    v_max3_f32 v147, v112, v113, v147
    v_max3_f32 v147, v114, v115, v147
    v_max3_f32 v147, v116, v117, v147
    v_max3_f32 v147, v118, v119, v147
    v_max3_f32 v147, v120, v121, v147
    v_max3_f32 v147, v122, v123, v147
    v_max3_f32 v147, v124, v125, v147
    v_max3_f32 v147, v126, v127, v147
    v_mfma_f32_32x32x16_bf16 v[112:127], a[224:227], v[40:43], 0
    v_mfma_f32_32x32x16_bf16 v[112:127], a[228:231], v[44:47], v[112:127]
    v_max3_f32 v147, v128, v129, v147
    v_max3_f32 v147, v130, v131, v147
    v_max3_f32 v147, v132, v133, v147
    v_max3_f32 v147, v134, v135, v147
    v_max3_f32 v147, v136, v137, v147
    v_max3_f32 v147, v138, v139, v147
    v_max3_f32 v147, v140, v141, v147
    v_max3_f32 v147, v142, v143, v147
    v_mfma_f32_32x32x16_bf16 v[128:143], a[240:243], v[40:43], 0
    v_mfma_f32_32x32x16_bf16 v[128:143], a[244:247], v[44:47], v[128:143]
    s_nop 1
    v_max3_f32 v147, v112, v113, v147
    v_max3_f32 v147, v114, v115, v147
    v_max3_f32 v147, v116, v117, v147
    v_max3_f32 v147, v118, v119, v147
    v_max3_f32 v147, v120, v121, v147
    v_max3_f32 v147, v122, v123, v147
    v_max3_f32 v147, v124, v125, v147
    v_max3_f32 v147, v126, v127, v147
    s_nop 1
    v_max3_f32 v147, v128, v129, v147
    v_max3_f32 v147, v130, v131, v147
    v_max3_f32 v147, v132, v133, v147
    v_max3_f32 v147, v134, v135, v147
    v_max3_f32 v147, v136, v137, v147
    v_max3_f32 v147, v138, v139, v147
    v_max3_f32 v147, v140, v141, v147
    v_max3_f32 v147, v142, v143, v147
    v_and_b32 v14, 31, v0
    v_lshlrev_b32 v14, 4, v14
    v_add_u32 v14, 114688, v14
    v_mov_b32 v12, v144
    s_nop 1
    v_permlane32_swap_b32 v12, v144
    v_max_f32 v12, v12, v144
    s_lshl_b32 s28, s40, 9
    s_lshl_b32 s29, s12, 2
    s_add_u32 s29, s29, s28
    v_add_u32 v13, s29, v14
    ds_write_b32 v13, v12
    v_mov_b32 v12, v145
    s_nop 1
    v_permlane32_swap_b32 v12, v145
    v_max_f32 v12, v12, v145
    s_lshl_b32 s28, s41, 9
    s_lshl_b32 s29, s12, 2
    s_add_u32 s29, s29, s28
    v_add_u32 v13, s29, v14
    ds_write_b32 v13, v12
    v_mov_b32 v12, v146
    s_nop 1
    v_permlane32_swap_b32 v12, v146
    v_max_f32 v12, v12, v146
    s_lshl_b32 s28, s42, 9
    s_lshl_b32 s29, s12, 2
    s_add_u32 s29, s29, s28
    v_add_u32 v13, s29, v14
    ds_write_b32 v13, v12
    v_mov_b32 v12, v147
    s_nop 1
    v_permlane32_swap_b32 v12, v147
    v_max_f32 v12, v12, v147
    s_lshl_b32 s28, s43, 9
    s_lshl_b32 s29, s12, 2
    s_add_u32 s29, s29, s28
    v_add_u32 v13, s29, v14
    ds_write_b32 v13, v12
    s_waitcnt lgkmcnt(0)
    s_barrier
    s_lshl_b32 s28, s40, 9
    v_add_u32 v13, s28, v14
    ds_read_b128 v[148:151], v13
    s_waitcnt lgkmcnt(0)
    v_max3_f32 v12, v148, v149, v150
    v_max_f32 v12, v12, v151
    v_sub_f32 v12, 0, v12
    v_and_b32 v148, 0xffff0000, v12
    v_sub_f32 v12, v12, v148
    v_and_b32 v149, 0xffff0000, v12
    v_sub_f32 v12, v12, v149
    v_lshrrev_b32 v148, 16, v148
    s_mov_b32 exec_lo, 0
    v_or_b32 v22, v148, v149
    v_lshrrev_b32 v23, 16, v12
    s_mov_b32 exec_lo, -1
    s_lshl_b32 s28, s41, 9
    v_add_u32 v13, s28, v14
    ds_read_b128 v[148:151], v13
    s_waitcnt lgkmcnt(0)
    v_max3_f32 v12, v148, v149, v150
    v_max_f32 v12, v12, v151
    v_sub_f32 v12, 0, v12
    v_and_b32 v148, 0xffff0000, v12
    v_sub_f32 v12, v12, v148
    v_and_b32 v149, 0xffff0000, v12
    v_sub_f32 v12, v12, v149
    v_lshrrev_b32 v148, 16, v148
    s_mov_b32 exec_lo, 0
    v_or_b32 v30, v148, v149
    v_lshrrev_b32 v31, 16, v12
    s_mov_b32 exec_lo, -1
    s_lshl_b32 s28, s42, 9
    v_add_u32 v13, s28, v14
    ds_read_b128 v[148:151], v13
    s_waitcnt lgkmcnt(0)
    v_max3_f32 v12, v148, v149, v150
    v_max_f32 v12, v12, v151
    v_sub_f32 v12, 0, v12
    v_and_b32 v148, 0xffff0000, v12
    v_sub_f32 v12, v12, v148
    v_and_b32 v149, 0xffff0000, v12
    v_sub_f32 v12, v12, v149
    v_lshrrev_b32 v148, 16, v148
    s_mov_b32 exec_lo, 0
    v_or_b32 v38, v148, v149
    v_lshrrev_b32 v39, 16, v12
    s_mov_b32 exec_lo, -1
    s_lshl_b32 s28, s43, 9
    v_add_u32 v13, s28, v14
    ds_read_b128 v[148:151], v13
    s_waitcnt lgkmcnt(0)
    v_max3_f32 v12, v148, v149, v150
    v_max_f32 v12, v12, v151
    v_sub_f32 v12, 0, v12
    v_and_b32 v148, 0xffff0000, v12
    v_sub_f32 v12, v12, v148
    v_and_b32 v149, 0xffff0000, v12
    v_sub_f32 v12, v12, v149
    v_lshrrev_b32 v148, 16, v148
    s_mov_b32 exec_lo, 0
    v_or_b32 v46, v148, v149
    v_lshrrev_b32 v47, 16, v12
    s_mov_b32 exec_lo, -1
    s_waitcnt vmcnt(0) lgkmcnt(0)
    s_barrier
    s_mov_b32 s54, 1
    s_nop 1
    s_branch La_main
Lc_slowbody:
    s_add_u32 s29, s40, s20
    s_nop 1
    v_cvt_pk_bf16_f32 v48, v16, v17
    v_cvt_pk_bf16_f32 v49, v18, v19
    v_cvt_pk_bf16_f32 v50, v20, v21
    v_cvt_pk_bf16_f32 v51, v22, v23
    buffer_store_dwordx4 v[48:51], v1, s[4:7], s29 offen offset:0 sc1
    v_cvt_pk_bf16_f32 v52, v24, v25
    v_cvt_pk_bf16_f32 v53, v26, v27
    v_cvt_pk_bf16_f32 v54, v28, v29
    v_cvt_pk_bf16_f32 v55, v30, v31
    buffer_store_dwordx4 v[52:55], v1, s[4:7], s29 offen offset:1024 sc1
    v_pk_add_f32 v[112:113], v[16:17], v[18:19]
    v_pk_mul_f32 v[114:115], v[16:17], v[16:17]
    v_pk_add_f32 v[116:117], v[20:21], v[22:23]
    v_pk_mul_f32 v[118:119], v[18:19], v[18:19]
    v_pk_add_f32 v[112:113], v[112:113], v[24:25]
    v_pk_fma_f32 v[114:115], v[20:21], v[20:21], v[114:115]
    v_pk_add_f32 v[116:117], v[116:117], v[26:27]
    v_pk_fma_f32 v[118:119], v[22:23], v[22:23], v[118:119]
    v_pk_add_f32 v[112:113], v[112:113], v[28:29]
    v_pk_fma_f32 v[114:115], v[24:25], v[24:25], v[114:115]
    v_pk_add_f32 v[116:117], v[116:117], v[30:31]
    v_pk_fma_f32 v[118:119], v[26:27], v[26:27], v[118:119]
    v_pk_fma_f32 v[114:115], v[28:29], v[28:29], v[114:115]
    v_pk_fma_f32 v[118:119], v[30:31], v[30:31], v[118:119]
    v_pk_add_f32 v[112:113], v[112:113], v[116:117]
    v_pk_add_f32 v[114:115], v[114:115], v[118:119]
    v_add_f32 v112, v112, v113
    v_add_f32 v114, v114, v115
    s_nop 1
    v_permlane32_swap_b32 v112, v114
    v_add_f32 v112, v112, v114
    v_mov_b32 v113, v112
    s_nop 1
    v_permlane16_swap_b32 v112, v113
    s_mov_b32 exec_lo, 0xffff
    s_mov_b32 exec_hi, 0xffff
    v_add_f32 v112, v112, v113
    buffer_store_dword v112, v2, s[4:7], s40 offen offset:2048 sc1
    s_mov_b64 exec, -1
    ds_read_b128 v[128:131], v1 offset:0
    ds_read_b128 v[132:135], v1 offset:1024
    ds_read_b128 v[136:139], v1 offset:2048
    ds_read_b128 v[140:143], v1 offset:3072
    ds_read_b128 v[144:147], v1 offset:4096
    ds_read_b128 v[148:151], v1 offset:5120
    ds_read_b128 v[152:155], v1 offset:6144
    ds_read_b128 v[156:159], v1 offset:7168
    ds_read_b128 v[160:163], v1 offset:8192
    ds_read_b128 v[164:167], v1 offset:9216
    ds_read_b128 v[168:171], v1 offset:10240
    ds_read_b128 v[172:175], v1 offset:11264
    ds_read_b128 v[176:179], v1 offset:12288
    ds_read_b128 v[180:183], v1 offset:13312
    ds_read_b128 v[184:187], v1 offset:14336
    ds_read_b128 v[188:191], v1 offset:15360
    v_pk_mul_f32 v[32:33], v[16:17], 1.0 op_sel_hi:[1,0]
    v_pk_mul_f32 v[34:35], v[18:19], 1.0 op_sel_hi:[1,0]
    v_pk_mul_f32 v[36:37], v[20:21], 1.0 op_sel_hi:[1,0]
    v_pk_mul_f32 v[38:39], v[22:23], 1.0 op_sel_hi:[1,0]
    v_pk_mul_f32 v[40:41], v[24:25], 1.0 op_sel_hi:[1,0]
    v_pk_mul_f32 v[42:43], v[26:27], 1.0 op_sel_hi:[1,0]
    v_pk_mul_f32 v[44:45], v[28:29], 1.0 op_sel_hi:[1,0]
    v_pk_mul_f32 v[46:47], v[30:31], 1.0 op_sel_hi:[1,0]
    s_add_u32 s48, s40, s20
    s_add_u32 s49, s40, s21
    s_add_u32 s50, s40, s22
    s_add_u32 s51, s40, s23
    s_add_u32 s52, s40, s24
    s_add_u32 s53, s40, s25
    s_add_u32 s54, s40, s26
    v_lshrrev_b32 v116, 4, v0
    v_lshl_add_u32 v116, v116, 11, v1
    s_waitcnt vmcnt(0)
    s_mov_b64 exec, 1
    buffer_store_dword v15, off, s[4:7], s63 offset:0 sc1
    s_mov_b64 exec, -1
    buffer_load_dword v125, v3, s[4:7], s62 offen sc1
    s_waitcnt vmcnt(0)
    v_cmp_eq_u32 vcc, 0, v125
    s_nop 0
    s_cbranch_vccz Lpolld12
    s_mov_b32 s39, 0
Lpoll12:
    buffer_load_dword v125, v3, s[4:7], s62 offen sc1
    s_waitcnt vmcnt(0)
    v_cmp_eq_u32 vcc, 0, v125
    s_nop 0
    s_cbranch_vccz Lpolld12
    s_add_u32 s39, s39, 1
    s_cmp_lt_u32 s39, 200000
    s_cbranch_scc1 Lpoll12
Lpolld12:
    s_nop 0
    buffer_load_dwordx4 v[64:67], v1, s[4:7], s49 offen offset:0 sc1
    buffer_load_dwordx4 v[68:71], v1, s[4:7], s49 offen offset:1024 sc1
    buffer_load_dwordx4 v[72:75], v1, s[4:7], s50 offen offset:0 sc1
    buffer_load_dwordx4 v[76:79], v1, s[4:7], s50 offen offset:1024 sc1
    buffer_load_dwordx4 v[80:83], v1, s[4:7], s51 offen offset:0 sc1
    buffer_load_dwordx4 v[112:115], v116, s[4:7], s40 offen offset:2048 sc1
    s_waitcnt lgkmcnt(12)
    v_mfma_f32_16x16x32_bf16 v[16:19], v[128:131], v[48:51], 0
    ds_read_b128 v[128:131], v1 offset:16384
    v_mfma_f32_16x16x32_bf16 v[20:23], v[132:135], v[48:51], 0
    ds_read_b128 v[132:135], v1 offset:17408
    v_mfma_f32_16x16x32_bf16 v[24:27], v[136:139], v[48:51], 0
    ds_read_b128 v[136:139], v1 offset:18432
    v_mfma_f32_16x16x32_bf16 v[28:31], v[140:143], v[48:51], 0
    ds_read_b128 v[140:143], v1 offset:19456
    s_waitcnt lgkmcnt(12)
    v_mfma_f32_16x16x32_bf16 v[16:19], v[144:147], v[52:55], v[16:19]
    ds_read_b128 v[144:147], v1 offset:20480
    v_mfma_f32_16x16x32_bf16 v[20:23], v[148:151], v[52:55], v[20:23]
    ds_read_b128 v[148:151], v1 offset:21504
    v_mfma_f32_16x16x32_bf16 v[24:27], v[152:155], v[52:55], v[24:27]
    ds_read_b128 v[152:155], v1 offset:22528
    v_mfma_f32_16x16x32_bf16 v[28:31], v[156:159], v[52:55], v[28:31]
    ds_read_b128 v[156:159], v1 offset:23552
    s_waitcnt vmcnt(5) lgkmcnt(12)
    v_mfma_f32_16x16x32_bf16 v[16:19], v[160:163], v[64:67], v[16:19]
    buffer_load_dwordx4 v[84:87], v1, s[4:7], s51 offen offset:1024 sc1
    ds_read_b128 v[160:163], v1 offset:24576
    v_mfma_f32_16x16x32_bf16 v[20:23], v[164:167], v[64:67], v[20:23]
    ds_read_b128 v[164:167], v1 offset:25600
    v_mfma_f32_16x16x32_bf16 v[24:27], v[168:171], v[64:67], v[24:27]
    ds_read_b128 v[168:171], v1 offset:26624
    v_mfma_f32_16x16x32_bf16 v[28:31], v[172:175], v[64:67], v[28:31]
    ds_read_b128 v[172:175], v1 offset:27648
    s_waitcnt vmcnt(5) lgkmcnt(12)
    v_mfma_f32_16x16x32_bf16 v[16:19], v[176:179], v[68:71], v[16:19]
    buffer_load_dwordx4 v[88:91], v1, s[4:7], s52 offen offset:0 sc1
    ds_read_b128 v[176:179], v1 offset:28672
    v_mfma_f32_16x16x32_bf16 v[20:23], v[180:183], v[68:71], v[20:23]
    ds_read_b128 v[180:183], v1 offset:29696
    v_mfma_f32_16x16x32_bf16 v[24:27], v[184:187], v[68:71], v[24:27]
    ds_read_b128 v[184:187], v1 offset:30720
    v_mfma_f32_16x16x32_bf16 v[28:31], v[188:191], v[68:71], v[28:31]
    ds_read_b128 v[188:191], v1 offset:31744
    s_waitcnt vmcnt(5) lgkmcnt(12)
    v_mfma_f32_16x16x32_bf16 v[16:19], v[128:131], v[72:75], v[16:19]
    buffer_load_dwordx4 v[92:95], v1, s[4:7], s52 offen offset:1024 sc1
    ds_read_b128 v[128:131], v1 offset:32768
    v_mfma_f32_16x16x32_bf16 v[20:23], v[132:135], v[72:75], v[20:23]
    ds_read_b128 v[132:135], v1 offset:33792
    v_mfma_f32_16x16x32_bf16 v[24:27], v[136:139], v[72:75], v[24:27]
    ds_read_b128 v[136:139], v1 offset:34816
    v_mfma_f32_16x16x32_bf16 v[28:31], v[140:143], v[72:75], v[28:31]
    ds_read_b128 v[140:143], v1 offset:35840
    s_waitcnt vmcnt(5) lgkmcnt(12)
    v_mfma_f32_16x16x32_bf16 v[16:19], v[144:147], v[76:79], v[16:19]
    buffer_load_dwordx4 v[96:99], v1, s[4:7], s53 offen offset:0 sc1
    ds_read_b128 v[144:147], v1 offset:36864
    v_mfma_f32_16x16x32_bf16 v[20:23], v[148:151], v[76:79], v[20:23]
    ds_read_b128 v[148:151], v1 offset:37888
    v_mfma_f32_16x16x32_bf16 v[24:27], v[152:155], v[76:79], v[24:27]
    ds_read_b128 v[152:155], v1 offset:38912
    v_mfma_f32_16x16x32_bf16 v[28:31], v[156:159], v[76:79], v[28:31]
    ds_read_b128 v[156:159], v1 offset:39936
    s_waitcnt vmcnt(5) lgkmcnt(12)
    v_mfma_f32_16x16x32_bf16 v[16:19], v[160:163], v[80:83], v[16:19]
    buffer_load_dwordx4 v[100:103], v1, s[4:7], s53 offen offset:1024 sc1
    ds_read_b128 v[160:163], v1 offset:40960
    v_mfma_f32_16x16x32_bf16 v[20:23], v[164:167], v[80:83], v[20:23]
    ds_read_b128 v[164:167], v1 offset:41984
    v_mfma_f32_16x16x32_bf16 v[24:27], v[168:171], v[80:83], v[24:27]
    ds_read_b128 v[168:171], v1 offset:43008
    v_mfma_f32_16x16x32_bf16 v[28:31], v[172:175], v[80:83], v[28:31]
    ds_read_b128 v[172:175], v1 offset:44032
    s_waitcnt vmcnt(4) lgkmcnt(12)
    v_mfma_f32_16x16x32_bf16 v[16:19], v[176:179], v[84:87], v[16:19]
    buffer_load_dwordx4 v[104:107], v1, s[4:7], s54 offen offset:0 sc1
    ds_read_b128 v[176:179], v1 offset:45056
    v_mfma_f32_16x16x32_bf16 v[20:23], v[180:183], v[84:87], v[20:23]
    ds_read_b128 v[180:183], v1 offset:46080
    s_mov_b32 vcc_lo, 0xffff
    v_mfma_f32_16x16x32_bf16 v[24:27], v[184:187], v[84:87], v[24:27]
    ds_read_b128 v[184:187], v1 offset:47104
    s_mov_b32 vcc_hi, 0xffff
    v_mfma_f32_16x16x32_bf16 v[28:31], v[188:191], v[84:87], v[28:31]
    ds_read_b128 v[188:191], v1 offset:48128
    v_add_f32 v126, v112, v113
    s_waitcnt vmcnt(4) lgkmcnt(12)
    v_mfma_f32_16x16x32_bf16 v[16:19], v[128:131], v[88:91], v[16:19]
    buffer_load_dwordx4 v[108:111], v1, s[4:7], s54 offen offset:1024 sc1
    ds_read_b128 v[128:131], v1 offset:49152
    v_mfma_f32_16x16x32_bf16 v[20:23], v[132:135], v[88:91], v[20:23]
    ds_read_b128 v[132:135], v1 offset:50176
    v_cndmask_b32 v127, 0, v115, vcc
    v_mfma_f32_16x16x32_bf16 v[24:27], v[136:139], v[88:91], v[24:27]
    ds_read_b128 v[136:139], v1 offset:51200
    v_add_f32 v126, v126, v114
    v_mfma_f32_16x16x32_bf16 v[28:31], v[140:143], v[88:91], v[28:31]
    ds_read_b128 v[140:143], v1 offset:52224
    v_add_f32 v126, v126, v127
    s_waitcnt vmcnt(4) lgkmcnt(12)
    v_mfma_f32_16x16x32_bf16 v[16:19], v[144:147], v[92:95], v[16:19]
    ds_read_b128 v[144:147], v1 offset:53248
    v_mov_b32 v127, v126
    v_mfma_f32_16x16x32_bf16 v[20:23], v[148:151], v[92:95], v[20:23]
    ds_read_b128 v[148:151], v1 offset:54272
    v_permlane16_swap_b32 v126, v127
    v_mfma_f32_16x16x32_bf16 v[24:27], v[152:155], v[92:95], v[24:27]
    ds_read_b128 v[152:155], v1 offset:55296
    v_add_f32 v126, v126, v127
    v_mfma_f32_16x16x32_bf16 v[28:31], v[156:159], v[92:95], v[28:31]
    ds_read_b128 v[156:159], v1 offset:56320
    v_mov_b32 v127, v126
    s_waitcnt vmcnt(3) lgkmcnt(12)
    v_mfma_f32_16x16x32_bf16 v[16:19], v[160:163], v[96:99], v[16:19]
    v_permlane32_swap_b32 v126, v127
    v_mul_f32 v120, 0x3b124925, v126
    v_mfma_f32_16x16x32_bf16 v[20:23], v[164:167], v[96:99], v[20:23]
    v_mul_f32 v127, 0x3b124925, v127
    v_fma_f32 v127, -v120, v120, v127
    v_mfma_f32_16x16x32_bf16 v[24:27], v[168:171], v[96:99], v[24:27]
    v_max_f32 v127, 0, v127
    v_add_f32 v121, 0x3727c5ac, v127
    v_mfma_f32_16x16x32_bf16 v[28:31], v[172:175], v[96:99], v[28:31]
    v_rsq_f32 v121, v121
    s_nop 0
    v_mul_f32 v126, v121, v121
    s_waitcnt vmcnt(2) lgkmcnt(8)
    v_mfma_f32_16x16x32_bf16 v[16:19], v[176:179], v[100:103], v[16:19]
    v_mov_b32 v125, 0x3727c5ac
    v_fma_f32 v126, v126, v127, v125
    v_mfma_f32_16x16x32_bf16 v[20:23], v[180:183], v[100:103], v[20:23]
    v_rsq_f32 v126, v126
    s_nop 0
    v_mul_f32 v126, v126, v121
    v_mfma_f32_16x16x32_bf16 v[24:27], v[184:187], v[100:103], v[24:27]
    v_rcp_f32 v124, v126
    v_mul_f32 v123, v126, v126
    v_mfma_f32_16x16x32_bf16 v[28:31], v[188:191], v[100:103], v[28:31]
    v_mul_f32 v122, 0xc0135761, v126
    v_mul_f32 v123, v123, v122
    s_waitcnt vmcnt(1) lgkmcnt(4)
    v_mfma_f32_16x16x32_bf16 v[16:19], v[128:131], v[104:107], v[16:19]
    v_mul_f32 v123, 0x3d372713, v123
    v_mul_f32 v120, -v120, v121
    v_mfma_f32_16x16x32_bf16 v[20:23], v[132:135], v[104:107], v[20:23]
    v_add_u32 v119, 114688, v1
    v_mfma_f32_16x16x32_bf16 v[24:27], v[136:139], v[104:107], v[24:27]
    v_mfma_f32_16x16x32_bf16 v[28:31], v[140:143], v[104:107], v[28:31]
    s_waitcnt vmcnt(0) lgkmcnt(0)
    v_mfma_f32_16x16x32_bf16 v[16:19], v[144:147], v[108:111], v[16:19]
    v_mfma_f32_16x16x32_bf16 v[20:23], v[148:151], v[108:111], v[20:23]
    v_mfma_f32_16x16x32_bf16 v[24:27], v[152:155], v[108:111], v[24:27]
    v_mfma_f32_16x16x32_bf16 v[28:31], v[156:159], v[108:111], v[28:31]
    s_add_u32 s29, s41, s20
    s_add_u32 s29, s29, 16128
    s_add_u32 s28, s68, s29
    s_nop 1
    v_pk_mul_f32 v[128:129], v[16:17], v[16:17]
    v_pk_mul_f32 v[130:131], v[18:19], v[18:19]
    v_pk_mul_f32 v[132:133], v[20:21], v[20:21]
    v_pk_mul_f32 v[134:135], v[22:23], v[22:23]
    v_pk_fma_f32 v[128:129], v[128:129], v[122:123], v[122:123] op_sel:[0,1,0] op_sel_hi:[1,1,0]
    v_pk_fma_f32 v[130:131], v[130:131], v[122:123], v[122:123] op_sel:[0,1,0] op_sel_hi:[1,1,0]
    v_pk_fma_f32 v[132:133], v[132:133], v[122:123], v[122:123] op_sel:[0,1,0] op_sel_hi:[1,1,0]
    v_pk_fma_f32 v[134:135], v[134:135], v[122:123], v[122:123] op_sel:[0,1,0] op_sel_hi:[1,1,0]
    v_pk_mul_f32 v[128:129], v[128:129], v[16:17]
    v_pk_mul_f32 v[130:131], v[130:131], v[18:19]
    v_pk_mul_f32 v[132:133], v[132:133], v[20:21]
    v_pk_mul_f32 v[134:135], v[134:135], v[22:23]
    v_exp_f32 v128, v128
    v_exp_f32 v129, v129
    v_exp_f32 v130, v130
    v_exp_f32 v131, v131
    v_exp_f32 v132, v132
    v_exp_f32 v133, v133
    v_exp_f32 v134, v134
    v_exp_f32 v135, v135
    v_pk_fma_f32 v[128:129], v[128:129], v[124:125], v[124:125] op_sel_hi:[1,0,0]
    v_pk_fma_f32 v[130:131], v[130:131], v[124:125], v[124:125] op_sel_hi:[1,0,0]
    v_pk_fma_f32 v[132:133], v[132:133], v[124:125], v[124:125] op_sel_hi:[1,0,0]
    v_pk_fma_f32 v[134:135], v[134:135], v[124:125], v[124:125] op_sel_hi:[1,0,0]
    v_rcp_f32 v128, v128
    v_rcp_f32 v129, v129
    v_rcp_f32 v130, v130
    v_rcp_f32 v131, v131
    v_rcp_f32 v132, v132
    v_rcp_f32 v133, v133
    v_rcp_f32 v134, v134
    v_rcp_f32 v135, v135
    v_pk_mul_f32 v[128:129], v[128:129], v[16:17]
    v_pk_mul_f32 v[130:131], v[130:131], v[18:19]
    v_pk_mul_f32 v[132:133], v[132:133], v[20:21]
    v_pk_mul_f32 v[134:135], v[134:135], v[22:23]
    v_cvt_pk_bf16_f32 v48, v128, v129
    v_cvt_pk_bf16_f32 v49, v130, v131
    v_cvt_pk_bf16_f32 v50, v132, v133
    v_cvt_pk_bf16_f32 v51, v134, v135
    buffer_store_dwordx4 v[48:51], v1, s[4:7], s29 offen sc1
    v_pk_mul_f32 v[128:129], v[24:25], v[24:25]
    v_pk_mul_f32 v[130:131], v[26:27], v[26:27]
    v_pk_mul_f32 v[132:133], v[28:29], v[28:29]
    v_pk_mul_f32 v[134:135], v[30:31], v[30:31]
    v_pk_fma_f32 v[128:129], v[128:129], v[122:123], v[122:123] op_sel:[0,1,0] op_sel_hi:[1,1,0]
    v_pk_fma_f32 v[130:131], v[130:131], v[122:123], v[122:123] op_sel:[0,1,0] op_sel_hi:[1,1,0]
    v_pk_fma_f32 v[132:133], v[132:133], v[122:123], v[122:123] op_sel:[0,1,0] op_sel_hi:[1,1,0]
    v_pk_fma_f32 v[134:135], v[134:135], v[122:123], v[122:123] op_sel:[0,1,0] op_sel_hi:[1,1,0]
    v_pk_mul_f32 v[128:129], v[128:129], v[24:25]
    v_pk_mul_f32 v[130:131], v[130:131], v[26:27]
    v_pk_mul_f32 v[132:133], v[132:133], v[28:29]
    v_pk_mul_f32 v[134:135], v[134:135], v[30:31]
    v_exp_f32 v128, v128
    v_exp_f32 v129, v129
    v_exp_f32 v130, v130
    v_exp_f32 v131, v131
    v_exp_f32 v132, v132
    v_exp_f32 v133, v133
    v_exp_f32 v134, v134
    v_exp_f32 v135, v135
    v_pk_fma_f32 v[128:129], v[128:129], v[124:125], v[124:125] op_sel_hi:[1,0,0]
    v_pk_fma_f32 v[130:131], v[130:131], v[124:125], v[124:125] op_sel_hi:[1,0,0]
    v_pk_fma_f32 v[132:133], v[132:133], v[124:125], v[124:125] op_sel_hi:[1,0,0]
    v_pk_fma_f32 v[134:135], v[134:135], v[124:125], v[124:125] op_sel_hi:[1,0,0]
    v_rcp_f32 v128, v128
    v_rcp_f32 v129, v129
    v_rcp_f32 v130, v130
    v_rcp_f32 v131, v131
    v_rcp_f32 v132, v132
    v_rcp_f32 v133, v133
    v_rcp_f32 v134, v134
    v_rcp_f32 v135, v135
    v_pk_mul_f32 v[128:129], v[128:129], v[24:25]
    v_pk_mul_f32 v[130:131], v[130:131], v[26:27]
    v_pk_mul_f32 v[132:133], v[132:133], v[28:29]
    v_pk_mul_f32 v[134:135], v[134:135], v[30:31]
    v_cvt_pk_bf16_f32 v52, v128, v129
    v_cvt_pk_bf16_f32 v53, v130, v131
    v_cvt_pk_bf16_f32 v54, v132, v133
    v_cvt_pk_bf16_f32 v55, v134, v135
    buffer_store_dwordx4 v[52:55], v1, s[4:7], s29 offen offset:1024 sc1
    s_add_u32 s35, s63, 8192
    s_add_u32 s36, s62, 8128
    s_cmp_eq_u32 s68, 0
    s_cbranch_scc1 Lc_nohalo_s
    s_mov_b32 exec_lo, s69
    s_mov_b32 exec_hi, s69
    buffer_store_dwordx4 v[48:51], v11, s[4:7], s28 offen sc1
    buffer_store_dwordx4 v[52:55], v11, s[4:7], s28 offen offset:1024 sc1
    s_mov_b64 exec, -1
    ds_read_b128 v[128:131], v119 offset:0
    ds_read_b128 v[132:135], v119 offset:1024
    ds_read_b128 v[136:139], v119 offset:2048
    ds_read_b128 v[140:143], v119 offset:3072
    ds_read_b128 v[144:147], v119 offset:4096
    ds_read_b128 v[148:151], v119 offset:5120
    ds_read_b128 v[152:155], v119 offset:6144
    ds_read_b128 v[156:159], v119 offset:7168
    ds_read_b128 v[160:163], v119 offset:12288
    ds_read_b128 v[164:167], v119 offset:13312
    ds_read_b128 v[168:171], v119 offset:14336
    ds_read_b128 v[172:175], v119 offset:15360
    ds_read_b128 v[176:179], v119 offset:16384
    ds_read_b128 v[180:183], v119 offset:17408
    ds_read_b128 v[184:187], v119 offset:18432
    ds_read_b128 v[188:191], v119 offset:19456
    v_pk_fma_f32 v[16:17], v[32:33], v[120:121], v[120:121] op_sel:[0,1,0] op_sel_hi:[1,1,0]
    v_pk_fma_f32 v[18:19], v[34:35], v[120:121], v[120:121] op_sel:[0,1,0] op_sel_hi:[1,1,0]
    v_pk_fma_f32 v[20:21], v[36:37], v[120:121], v[120:121] op_sel:[0,1,0] op_sel_hi:[1,1,0]
    v_pk_fma_f32 v[22:23], v[38:39], v[120:121], v[120:121] op_sel:[0,1,0] op_sel_hi:[1,1,0]
    v_pk_fma_f32 v[24:25], v[40:41], v[120:121], v[120:121] op_sel:[0,1,0] op_sel_hi:[1,1,0]
    v_pk_fma_f32 v[26:27], v[42:43], v[120:121], v[120:121] op_sel:[0,1,0] op_sel_hi:[1,1,0]
    v_pk_fma_f32 v[28:29], v[44:45], v[120:121], v[120:121] op_sel:[0,1,0] op_sel_hi:[1,1,0]
    v_pk_fma_f32 v[30:31], v[46:47], v[120:121], v[120:121] op_sel:[0,1,0] op_sel_hi:[1,1,0]
    s_waitcnt vmcnt(2)
    s_mov_b64 exec, 1
    buffer_store_dword v15, off, s[4:7], s35 offset:0 sc1
    s_mov_b64 exec, -1
    s_branch Lc_nohalo1_s
Lc_nohalo_s:
    ds_read_b128 v[128:131], v119 offset:0
    ds_read_b128 v[132:135], v119 offset:1024
    ds_read_b128 v[136:139], v119 offset:2048
    ds_read_b128 v[140:143], v119 offset:3072
    ds_read_b128 v[144:147], v119 offset:4096
    ds_read_b128 v[148:151], v119 offset:5120
    ds_read_b128 v[152:155], v119 offset:6144
    ds_read_b128 v[156:159], v119 offset:7168
    ds_read_b128 v[160:163], v119 offset:12288
    ds_read_b128 v[164:167], v119 offset:13312
    ds_read_b128 v[168:171], v119 offset:14336
    ds_read_b128 v[172:175], v119 offset:15360
    ds_read_b128 v[176:179], v119 offset:16384
    ds_read_b128 v[180:183], v119 offset:17408
    ds_read_b128 v[184:187], v119 offset:18432
    ds_read_b128 v[188:191], v119 offset:19456
    v_pk_fma_f32 v[16:17], v[32:33], v[120:121], v[120:121] op_sel:[0,1,0] op_sel_hi:[1,1,0]
    v_pk_fma_f32 v[18:19], v[34:35], v[120:121], v[120:121] op_sel:[0,1,0] op_sel_hi:[1,1,0]
    v_pk_fma_f32 v[20:21], v[36:37], v[120:121], v[120:121] op_sel:[0,1,0] op_sel_hi:[1,1,0]
    v_pk_fma_f32 v[22:23], v[38:39], v[120:121], v[120:121] op_sel:[0,1,0] op_sel_hi:[1,1,0]
    v_pk_fma_f32 v[24:25], v[40:41], v[120:121], v[120:121] op_sel:[0,1,0] op_sel_hi:[1,1,0]
    v_pk_fma_f32 v[26:27], v[42:43], v[120:121], v[120:121] op_sel:[0,1,0] op_sel_hi:[1,1,0]
    v_pk_fma_f32 v[28:29], v[44:45], v[120:121], v[120:121] op_sel:[0,1,0] op_sel_hi:[1,1,0]
    v_pk_fma_f32 v[30:31], v[46:47], v[120:121], v[120:121] op_sel:[0,1,0] op_sel_hi:[1,1,0]
    s_waitcnt vmcnt(0)
    s_mov_b64 exec, 1
    buffer_store_dword v15, off, s[4:7], s35 offset:0 sc1
    s_mov_b64 exec, -1
Lc_nohalo1_s:
    s_barrier
    s_cmp_lg_u32 s69, 0
    s_cbranch_scc1 Lc_edge_s
    buffer_load_dword v10, v14, s[4:7], s36 offen sc1
    s_waitcnt vmcnt(0)
    v_cmp_eq_u32 vcc, 0, v10
    s_nop 0
    s_cbranch_vccz Lpolld13
    s_mov_b32 s39, 0
Lpoll13:
    buffer_load_dword v10, v14, s[4:7], s36 offen sc1
    s_waitcnt vmcnt(0)
    v_cmp_eq_u32 vcc, 0, v10
    s_nop 0
    s_cbranch_vccz Lpolld13
    s_add_u32 s39, s39, 1
    s_cmp_lt_u32 s39, 200000
    s_cbranch_scc1 Lpoll13
Lpolld13:
Lc_hgo_s:
    s_nop 0
    s_add_u32 s28, s41, 0
    buffer_load_dwordx4 v[56:59], v4, s[4:7], s28 offen offset:0 sc1
    buffer_load_dwordx4 v[60:63], v4, s[4:7], s28 offen offset:1024 sc1
    s_add_u32 s28, s41, 2304
    buffer_load_dwordx4 v[64:67], v4, s[4:7], s28 offen offset:0 sc1
    buffer_load_dwordx4 v[68:71], v8, s[4:7], s28 offen offset:1024 sc1
    s_add_u32 s28, s41, 4608
    buffer_load_dwordx4 v[72:75], v5, s[4:7], s28 offen offset:0 sc1
    s_add_u32 s48, s42, s20
    s_and_b32 s35, s12, 2
    s_mul_i32 s36, s35, 16128
    s_sub_u32 s36, s42, s36
    s_cmp_eq_u32 s35, 0
    s_cselect_b32 s56, s21, s24
    s_cselect_b32 s57, s22, s25
    s_cselect_b32 s58, s23, s26
    s_cselect_b32 s59, 2048, s0
    s_cselect_b32 s59, s59, 8192
    s_add_u32 s56, s56, s36
    s_add_u32 s57, s57, s36
    s_add_u32 s58, s58, s36
    s_and_b32 s35, s12, 1
    s_mul_i32 s35, s35, 14336
    s_add_u32 s59, s59, s35
    s_lshl_b32 s55, s12, 6
    s_add_u32 s55, s55, 151552
    s_mov_b32 s61, 151552
    s_add_u32 s35, s63, 16384
    s_lshl_b32 s36, s16, 8
    s_add_u32 s36, s36, s45
    s_add_u32 s36, s36, 16320
    s_and_b32 s27, s16, 3
    s_cmp_eq_u32 s27, 0
    s_cselect_b32 s101, 1, 0
    s_cmp_eq_u32 s27, 3
    s_cselect_b32 s27, 4, 5
    s_waitcnt vmcnt(4) lgkmcnt(12)
    v_mfma_f32_16x16x32_bf16 v[16:19], v[128:131], v[56:59], v[16:19]
    buffer_load_dwordx4 v[76:79], v5, s[4:7], s28 offen offset:1024 sc1
    ds_read_b128 v[128:131], v119 offset:24576
    v_mfma_f32_16x16x32_bf16 v[20:23], v[132:135], v[56:59], v[20:23]
    ds_read_b128 v[132:135], v119 offset:25600
    v_mfma_f32_16x16x32_bf16 v[24:27], v[136:139], v[56:59], v[24:27]
    ds_read_b128 v[136:139], v119 offset:26624
    v_mfma_f32_16x16x32_bf16 v[28:31], v[140:143], v[56:59], v[28:31]
    ds_read_b128 v[140:143], v119 offset:27648
    s_waitcnt vmcnt(4) lgkmcnt(12)
    v_mfma_f32_16x16x32_bf16 v[16:19], v[144:147], v[60:63], v[16:19]
    s_add_u32 s28, s41, 6912
    buffer_load_dwordx4 v[80:83], v5, s[4:7], s28 offen offset:0 sc1
    ds_read_b128 v[144:147], v119 offset:28672
    v_mfma_f32_16x16x32_bf16 v[20:23], v[148:151], v[60:63], v[20:23]
    ds_read_b128 v[148:151], v119 offset:29696
    v_mfma_f32_16x16x32_bf16 v[24:27], v[152:155], v[60:63], v[24:27]
    ds_read_b128 v[152:155], v119 offset:30720
    v_mfma_f32_16x16x32_bf16 v[28:31], v[156:159], v[60:63], v[28:31]
    ds_read_b128 v[156:159], v119 offset:31744
    s_waitcnt vmcnt(4) lgkmcnt(12)
    v_mfma_f32_16x16x32_bf16 v[16:19], v[160:163], v[64:67], v[16:19]
    buffer_load_dwordx4 v[84:87], v6, s[4:7], s28 offen offset:1024 sc1
    ds_read_b128 v[160:163], v119 offset:36864
    v_mfma_f32_16x16x32_bf16 v[20:23], v[164:167], v[64:67], v[20:23]
    ds_read_b128 v[164:167], v119 offset:37888
    v_mfma_f32_16x16x32_bf16 v[24:27], v[168:171], v[64:67], v[24:27]
    ds_read_b128 v[168:171], v119 offset:38912
    v_mfma_f32_16x16x32_bf16 v[28:31], v[172:175], v[64:67], v[28:31]
    ds_read_b128 v[172:175], v119 offset:39936
    s_waitcnt vmcnt(4) lgkmcnt(12)
    v_mfma_f32_16x16x32_bf16 v[16:19], v[176:179], v[68:71], v[16:19]
    s_add_u32 s28, s41, 9216
    buffer_load_dwordx4 v[88:91], v6, s[4:7], s28 offen offset:0 sc1
    ds_read_b128 v[176:179], v119 offset:40960
    v_mfma_f32_16x16x32_bf16 v[20:23], v[180:183], v[68:71], v[20:23]
    ds_read_b128 v[180:183], v119 offset:41984
    v_mfma_f32_16x16x32_bf16 v[24:27], v[184:187], v[68:71], v[24:27]
    ds_read_b128 v[184:187], v119 offset:43008
    v_mfma_f32_16x16x32_bf16 v[28:31], v[188:191], v[68:71], v[28:31]
    ds_read_b128 v[188:191], v119 offset:44032
    s_waitcnt vmcnt(4) lgkmcnt(12)
    v_mfma_f32_16x16x32_bf16 v[16:19], v[128:131], v[72:75], v[16:19]
    buffer_load_dwordx4 v[92:95], v6, s[4:7], s28 offen offset:1024 sc1
    ds_read_b128 v[128:131], v119 offset:8192
    v_mfma_f32_16x16x32_bf16 v[20:23], v[132:135], v[72:75], v[20:23]
    ds_read_b128 v[132:135], v119 offset:9216
    v_mfma_f32_16x16x32_bf16 v[24:27], v[136:139], v[72:75], v[24:27]
    ds_read_b128 v[136:139], v119 offset:10240
    v_mfma_f32_16x16x32_bf16 v[28:31], v[140:143], v[72:75], v[28:31]
    ds_read_b128 v[140:143], v119 offset:11264
    s_waitcnt vmcnt(4) lgkmcnt(12)
    v_mfma_f32_16x16x32_bf16 v[16:19], v[144:147], v[76:79], v[16:19]
    s_add_u32 s28, s41, 11520
    buffer_load_dwordx4 v[96:99], v9, s[4:7], s28 offen offset:0 sc1
    ds_read_b128 v[144:147], v119 offset:20480
    v_mfma_f32_16x16x32_bf16 v[20:23], v[148:151], v[76:79], v[20:23]
    ds_read_b128 v[148:151], v119 offset:21504
    v_mfma_f32_16x16x32_bf16 v[24:27], v[152:155], v[76:79], v[24:27]
    ds_read_b128 v[152:155], v119 offset:22528
    v_mfma_f32_16x16x32_bf16 v[28:31], v[156:159], v[76:79], v[28:31]
    ds_read_b128 v[156:159], v119 offset:23552
    s_waitcnt vmcnt(4) lgkmcnt(12)
    v_mfma_f32_16x16x32_bf16 v[16:19], v[160:163], v[80:83], v[16:19]
    buffer_load_dwordx4 v[100:103], v7, s[4:7], s28 offen offset:1024 sc1
    ds_read_b128 v[160:163], v119 offset:32768
    v_mfma_f32_16x16x32_bf16 v[20:23], v[164:167], v[80:83], v[20:23]
    ds_read_b128 v[164:167], v119 offset:33792
    v_mfma_f32_16x16x32_bf16 v[24:27], v[168:171], v[80:83], v[24:27]
    ds_read_b128 v[168:171], v119 offset:34816
    v_mfma_f32_16x16x32_bf16 v[28:31], v[172:175], v[80:83], v[28:31]
    ds_read_b128 v[172:175], v119 offset:35840
    s_waitcnt vmcnt(4) lgkmcnt(12)
    v_mfma_f32_16x16x32_bf16 v[16:19], v[176:179], v[84:87], v[16:19]
    s_add_u32 s28, s41, 13824
    buffer_load_dwordx4 v[104:107], v7, s[4:7], s28 offen offset:0 sc1
    ds_read_b128 v[176:179], v119 offset:45056
    v_mfma_f32_16x16x32_bf16 v[20:23], v[180:183], v[84:87], v[20:23]
    ds_read_b128 v[180:183], v119 offset:46080
    v_mfma_f32_16x16x32_bf16 v[24:27], v[184:187], v[84:87], v[24:27]
    ds_read_b128 v[184:187], v119 offset:47104
    v_mfma_f32_16x16x32_bf16 v[28:31], v[188:191], v[84:87], v[28:31]
    ds_read_b128 v[188:191], v119 offset:48128
    s_waitcnt vmcnt(4) lgkmcnt(12)
    v_mfma_f32_16x16x32_bf16 v[16:19], v[128:131], v[88:91], v[16:19]
    buffer_load_dwordx4 v[108:111], v7, s[4:7], s28 offen offset:1024 sc1
    ds_read_b128 v[128:131], v13 offset:0
    v_mfma_f32_16x16x32_bf16 v[20:23], v[132:135], v[88:91], v[20:23]
    ds_read_b128 v[132:135], v13 offset:1024
    v_mfma_f32_16x16x32_bf16 v[24:27], v[136:139], v[88:91], v[24:27]
    ds_read_b128 v[136:139], v13 offset:2048
    v_mfma_f32_16x16x32_bf16 v[28:31], v[140:143], v[88:91], v[28:31]
    ds_read_b128 v[140:143], v13 offset:3072
    s_waitcnt vmcnt(4) lgkmcnt(12)
    v_mfma_f32_16x16x32_bf16 v[16:19], v[144:147], v[92:95], v[16:19]
    ds_read_b128 v[144:147], v13 offset:4096
    v_add_u32 v12, s34, v1
    v_mfma_f32_16x16x32_bf16 v[20:23], v[148:151], v[92:95], v[20:23]
    ds_read_b128 v[148:151], v13 offset:5120
    v_bfe_u32 v10, v0, 4, 1
    v_mfma_f32_16x16x32_bf16 v[24:27], v[152:155], v[92:95], v[24:27]
    ds_read_b128 v[152:155], v13 offset:6144
    v_mul_u32_u24 v10, 14336, v10
    v_mfma_f32_16x16x32_bf16 v[28:31], v[156:159], v[92:95], v[28:31]
    ds_read_b128 v[156:159], v13 offset:7168
    v_lshrrev_b32 v11, 5, v0
    s_waitcnt vmcnt(3) lgkmcnt(12)
    v_mfma_f32_16x16x32_bf16 v[16:19], v[160:163], v[96:99], v[16:19]
    v_lshl_add_u32 v10, v11, 8, v10
    v_and_b32 v11, 15, v0
    v_mfma_f32_16x16x32_bf16 v[20:23], v[164:167], v[96:99], v[20:23]
    v_lshl_add_u32 v4, v11, 4, v10
    v_lshl_add_u32 v5, v11, 2, s55
    v_mfma_f32_16x16x32_bf16 v[24:27], v[168:171], v[96:99], v[24:27]
    v_and_b32 v6, 31, v0
    v_lshl_add_u32 v6, v6, 2, s61
    v_mfma_f32_16x16x32_bf16 v[28:31], v[172:175], v[96:99], v[28:31]
    v_and_b32 v11, 7, v0
    v_min_u32 v11, 6, v11
    s_waitcnt vmcnt(2) lgkmcnt(8)
    v_mfma_f32_16x16x32_bf16 v[16:19], v[176:179], v[100:103], v[16:19]
    v_lshlrev_b32 v11, 2, v11
    v_lshrrev_b32 v10, 3, v0
    v_mfma_f32_16x16x32_bf16 v[20:23], v[180:183], v[100:103], v[20:23]
    v_max_u32 v10, s101, v10
    v_min_u32 v10, s27, v10
    v_mfma_f32_16x16x32_bf16 v[24:27], v[184:187], v[100:103], v[24:27]
    v_lshl_add_u32 v14, v10, 6, v11
    v_mfma_f32_16x16x32_bf16 v[28:31], v[188:191], v[100:103], v[28:31]
    s_waitcnt vmcnt(1) lgkmcnt(4)
    v_mfma_f32_16x16x32_bf16 v[16:19], v[128:131], v[104:107], v[16:19]
    v_mfma_f32_16x16x32_bf16 v[20:23], v[132:135], v[104:107], v[20:23]
    v_mfma_f32_16x16x32_bf16 v[24:27], v[136:139], v[104:107], v[24:27]
    v_mfma_f32_16x16x32_bf16 v[28:31], v[140:143], v[104:107], v[28:31]
    s_waitcnt vmcnt(0) lgkmcnt(0)
    v_mfma_f32_16x16x32_bf16 v[16:19], v[144:147], v[108:111], v[16:19]
    v_mfma_f32_16x16x32_bf16 v[20:23], v[148:151], v[108:111], v[20:23]
    v_mfma_f32_16x16x32_bf16 v[24:27], v[152:155], v[108:111], v[24:27]
    v_mfma_f32_16x16x32_bf16 v[28:31], v[156:159], v[108:111], v[28:31]
    s_nop 4
    v_cvt_pk_bf16_f32 v176, v16, v17
    v_cvt_pk_bf16_f32 v177, v18, v19
    v_cvt_pk_bf16_f32 v178, v20, v21
    v_cvt_pk_bf16_f32 v179, v22, v23
    buffer_store_dwordx4 v[176:179], v1, s[4:7], s48 offen offset:0 sc1
    v_cvt_pk_bf16_f32 v180, v24, v25
    v_cvt_pk_bf16_f32 v181, v26, v27
    v_cvt_pk_bf16_f32 v182, v28, v29
    v_cvt_pk_bf16_f32 v183, v30, v31
    buffer_store_dwordx4 v[180:183], v1, s[4:7], s48 offen offset:1024 sc1
    ds_write_b128 v12, v[176:179]
    ds_write_b128 v12, v[180:183] offset:1024
    v_pk_add_f32 v[112:113], v[16:17], v[18:19]
    v_pk_mul_f32 v[114:115], v[16:17], v[16:17]
    v_pk_add_f32 v[116:117], v[20:21], v[22:23]
    v_pk_mul_f32 v[118:119], v[18:19], v[18:19]
    v_pk_add_f32 v[112:113], v[112:113], v[24:25]
    v_pk_fma_f32 v[114:115], v[20:21], v[20:21], v[114:115]
    v_pk_add_f32 v[116:117], v[116:117], v[26:27]
    v_pk_fma_f32 v[118:119], v[22:23], v[22:23], v[118:119]
    v_pk_add_f32 v[112:113], v[112:113], v[28:29]
    v_pk_fma_f32 v[114:115], v[24:25], v[24:25], v[114:115]
    v_pk_add_f32 v[116:117], v[116:117], v[30:31]
    v_pk_fma_f32 v[118:119], v[26:27], v[26:27], v[118:119]
    v_pk_fma_f32 v[114:115], v[28:29], v[28:29], v[114:115]
    v_pk_fma_f32 v[118:119], v[30:31], v[30:31], v[118:119]
    v_pk_add_f32 v[112:113], v[112:113], v[116:117]
    v_pk_add_f32 v[114:115], v[114:115], v[118:119]
    v_add_f32 v112, v112, v113
    v_add_f32 v114, v114, v115
    s_nop 1
    v_permlane32_swap_b32 v112, v114
    v_add_f32 v112, v112, v114
    v_mov_b32 v113, v112
    s_nop 1
    v_permlane16_swap_b32 v112, v113
    s_mov_b32 exec_lo, 0xffff
    s_mov_b32 exec_hi, 0xffff
    v_add_f32 v112, v112, v113
    buffer_store_dword v112, v2, s[4:7], s42 offen offset:2048 sc1
    s_mov_b64 exec, -1
    v_pk_add_f32 v[32:33], v[32:33], v[16:17]
    v_pk_add_f32 v[34:35], v[34:35], v[18:19]
    v_pk_add_f32 v[36:37], v[36:37], v[20:21]
    v_pk_add_f32 v[38:39], v[38:39], v[22:23]
    v_pk_add_f32 v[40:41], v[40:41], v[24:25]
    v_pk_add_f32 v[42:43], v[42:43], v[26:27]
    v_pk_add_f32 v[44:45], v[44:45], v[28:29]
    v_pk_add_f32 v[46:47], v[46:47], v[30:31]
    v_lshrrev_b32 v28, 4, v0
    v_lshl_add_u32 v28, v28, 11, v1
    s_waitcnt vmcnt(0)
    s_mov_b64 exec, 1
    buffer_store_dword v15, off, s[4:7], s35 offset:0 sc1
    s_mov_b64 exec, -1
    s_waitcnt lgkmcnt(0)
    s_barrier
    buffer_load_dword v10, v14, s[4:7], s36 offen sc1
    ds_read_b128 v[144:147], v4 offset:0
    ds_read_b128 v[148:151], v4 offset:28672
    ds_read_b128 v[152:155], v4 offset:512
    ds_read_b128 v[156:159], v4 offset:29184
    ds_read_b128 v[160:163], v4 offset:1024
    ds_read_b128 v[164:167], v4 offset:29696
    ds_read_b128 v[168:171], v4 offset:1536
    ds_read_b128 v[172:175], v4 offset:30208
    s_waitcnt lgkmcnt(7)
    v_mfma_f32_32x32x16_bf16 v[80:95], a[0:3], v[144:147], 0
    v_mfma_f32_32x32x16_bf16 v[112:127], a[112:115], v[144:147], 0
    s_waitcnt vmcnt(0)
    v_cmp_eq_u32 vcc, 0, v10
    s_nop 0
    s_cbranch_vccz Lpolld14
    s_mov_b32 s39, 0
Lpoll14:
    buffer_load_dword v10, v14, s[4:7], s36 offen sc1
    s_waitcnt vmcnt(0)
    v_cmp_eq_u32 vcc, 0, v10
    s_nop 0
    s_cbranch_vccz Lpolld14
    s_add_u32 s39, s39, 1
    s_cmp_lt_u32 s39, 200000
    s_cbranch_scc1 Lpoll14
Lpolld14:
    s_nop 0
    s_add_u32 m0, s59, 0
    s_nop 0
    buffer_load_dwordx4 v1, s[4:7], s56 offen offset:0 sc1 lds
    buffer_load_dwordx4 v1, s[4:7], s56 offen offset:1024 sc1 lds
    s_add_u32 m0, s59, 2048
    s_nop 0
    buffer_load_dwordx4 v1, s[4:7], s57 offen offset:0 sc1 lds
    buffer_load_dwordx4 v1, s[4:7], s57 offen offset:1024 sc1 lds
    s_add_u32 m0, s59, 4096
    s_nop 0
    buffer_load_dwordx4 v1, s[4:7], s58 offen offset:0 sc1 lds
    buffer_load_dwordx4 v1, s[4:7], s58 offen offset:1024 sc1 lds
    s_add_u32 m0, s59, 28672
    s_add_u32 s56, s56, 32256
    buffer_load_dwordx4 v1, s[4:7], s56 offen offset:0 sc1 lds
    s_waitcnt lgkmcnt(6)
    v_mfma_f32_32x32x16_bf16 v[96:111], a[0:3], v[148:151], 0
    v_mfma_f32_32x32x16_bf16 v[128:143], a[112:115], v[148:151], 0
    buffer_load_dwordx4 v1, s[4:7], s56 offen offset:1024 sc1 lds
    s_waitcnt lgkmcnt(5)
    v_mfma_f32_32x32x16_bf16 v[80:95], a[4:7], v[152:155], v[80:95]
    v_mfma_f32_32x32x16_bf16 v[112:127], a[116:119], v[152:155], v[112:127]
    s_add_u32 m0, s59, 30720
    s_add_u32 s57, s57, 32256
    buffer_load_dwordx4 v1, s[4:7], s57 offen offset:0 sc1 lds
    s_waitcnt lgkmcnt(4)
    v_mfma_f32_32x32x16_bf16 v[96:111], a[4:7], v[156:159], v[96:111]
    v_mfma_f32_32x32x16_bf16 v[128:143], a[116:119], v[156:159], v[128:143]
    buffer_load_dwordx4 v1, s[4:7], s57 offen offset:1024 sc1 lds
    s_waitcnt lgkmcnt(3)
    v_mfma_f32_32x32x16_bf16 v[80:95], a[8:11], v[160:163], v[80:95]
    v_mfma_f32_32x32x16_bf16 v[112:127], a[120:123], v[160:163], v[112:127]
    s_add_u32 m0, s59, 32768
    s_add_u32 s58, s58, 32256
    buffer_load_dwordx4 v1, s[4:7], s58 offen offset:0 sc1 lds
    s_waitcnt lgkmcnt(2)
    v_mfma_f32_32x32x16_bf16 v[96:111], a[8:11], v[164:167], v[96:111]
    v_mfma_f32_32x32x16_bf16 v[128:143], a[120:123], v[164:167], v[128:143]
    buffer_load_dwordx4 v1, s[4:7], s58 offen offset:1024 sc1 lds
    s_waitcnt lgkmcnt(1)
    v_mfma_f32_32x32x16_bf16 v[80:95], a[12:15], v[168:171], v[80:95]
    v_mfma_f32_32x32x16_bf16 v[112:127], a[124:127], v[168:171], v[112:127]
    buffer_load_dwordx4 v[24:27], v28, s[4:7], s42 offen offset:2048 sc1
    s_waitcnt lgkmcnt(0)
    v_mfma_f32_32x32x16_bf16 v[96:111], a[12:15], v[172:175], v[96:111]
    v_mfma_f32_32x32x16_bf16 v[128:143], a[124:127], v[172:175], v[128:143]
    s_waitcnt vmcnt(7)
    s_barrier
    ds_read_b128 v[144:147], v4 offset:2048
    ds_read_b128 v[148:151], v4 offset:2560
    ds_read_b128 v[152:155], v4 offset:3072
    ds_read_b128 v[156:159], v4 offset:3584
    ds_read_b128 v[160:163], v4 offset:4096
    ds_read_b128 v[164:167], v4 offset:4608
    ds_read_b128 v[168:171], v4 offset:5120
    s_waitcnt lgkmcnt(6)
    v_mfma_f32_32x32x16_bf16 v[80:95], a[16:19], v[144:147], v[80:95]
    s_add_u32 s37, s47, 24576
    buffer_load_dwordx4 a[0:3], v1, s[4:7], s37 offen offset:0
    ds_read_b128 v[172:175], v4 offset:5632
    s_add_u32 s48, s15, 0
    s_cmp_ge_u32 s48, 7
    s_cselect_b32 s99, 7, 0
    s_sub_u32 s48, s48, s99
    s_lshl_b32 s48, s48, 15
    s_add_u32 s48, s48, s44
    s_waitcnt lgkmcnt(6)
    v_mfma_f32_32x32x16_bf16 v[80:95], a[20:23], v[148:151], v[80:95]
    buffer_load_dwordx4 a[4:7], v1, s[4:7], s37 offen offset:1024
    ds_read_b128 v[144:147], v4 offset:6144
    s_add_u32 s49, s15, 1
    s_cmp_ge_u32 s49, 7
    s_cselect_b32 s99, 7, 0
    s_sub_u32 s49, s49, s99
    s_lshl_b32 s49, s49, 15
    s_add_u32 s49, s49, s44
    s_waitcnt lgkmcnt(6)
    v_mfma_f32_32x32x16_bf16 v[80:95], a[24:27], v[152:155], v[80:95]
    buffer_load_dwordx4 a[8:11], v1, s[4:7], s37 offen offset:2048
    ds_read_b128 v[148:151], v4 offset:6656
    s_add_u32 s50, s15, 2
    s_cmp_ge_u32 s50, 7
    s_cselect_b32 s99, 7, 0
    s_sub_u32 s50, s50, s99
    s_lshl_b32 s50, s50, 15
    s_add_u32 s50, s50, s44
    s_waitcnt lgkmcnt(4)
    v_mfma_f32_32x32x16_bf16 v[80:95], a[28:31], v[156:159], v[80:95]
    ds_read_b128 v[152:155], v4 offset:7168
    s_add_u32 s51, s15, 3
    s_cmp_ge_u32 s51, 7
    s_cselect_b32 s99, 7, 0
    s_sub_u32 s51, s51, s99
    s_lshl_b32 s51, s51, 15
    s_add_u32 s51, s51, s44
    v_mfma_f32_32x32x16_bf16 v[80:95], a[32:35], v[160:163], v[80:95]
    buffer_load_dwordx4 a[12:15], v1, s[4:7], s37 offen offset:3072
    ds_read_b128 v[156:159], v4 offset:7680
    s_add_u32 s52, s15, 4
    s_cmp_ge_u32 s52, 7
    s_cselect_b32 s99, 7, 0
    s_sub_u32 s52, s52, s99
    s_lshl_b32 s52, s52, 15
    s_add_u32 s52, s52, s44
    v_mfma_f32_32x32x16_bf16 v[80:95], a[36:39], v[164:167], v[80:95]
    ds_read_b128 v[160:163], v4 offset:8192
    s_add_u32 s53, s15, 5
    s_cmp_ge_u32 s53, 7
    s_cselect_b32 s99, 7, 0
    s_sub_u32 s53, s53, s99
    s_lshl_b32 s53, s53, 15
    s_add_u32 s53, s53, s44
    s_waitcnt lgkmcnt(4)
    v_mfma_f32_32x32x16_bf16 v[80:95], a[40:43], v[168:171], v[80:95]
    s_add_u32 s37, s47, 28672
    buffer_load_dwordx4 a[112:115], v1, s[4:7], s37 offen offset:0
    ds_read_b128 v[164:167], v4 offset:8704
    s_add_u32 s54, s15, 6
    s_cmp_ge_u32 s54, 7
    s_cselect_b32 s99, 7, 0
    s_sub_u32 s54, s54, s99
    s_lshl_b32 s54, s54, 15
    s_add_u32 s54, s54, s44
    v_mfma_f32_32x32x16_bf16 v[80:95], a[44:47], v[172:175], v[80:95]
    buffer_load_dwordx4 a[116:119], v1, s[4:7], s37 offen offset:1024
    ds_read_b128 v[168:171], v4 offset:9216
    s_add_u32 s59, s41, 16128
    v_mfma_f32_32x32x16_bf16 v[80:95], a[48:51], v[144:147], v[80:95]
    ds_read_b128 v[172:175], v4 offset:9728
    s_mov_b32 vcc_lo, 0xffff
    s_mov_b32 vcc_hi, 0xffff
    s_waitcnt vmcnt(6)
    v_add_f32 v10, v24, v25
    v_cndmask_b32 v11, 0, v27, vcc
    s_waitcnt lgkmcnt(4)
    v_mfma_f32_32x32x16_bf16 v[80:95], a[52:55], v[148:151], v[80:95]
    buffer_load_dwordx4 a[120:123], v1, s[4:7], s37 offen offset:2048
    ds_read_b128 v[144:147], v4 offset:10240
    v_add_f32 v10, v10, v26
    v_add_f32 v10, v10, v11
    v_mov_b32 v11, v10
    s_nop 1
    v_permlane16_swap_b32 v10, v11
    v_mfma_f32_32x32x16_bf16 v[80:95], a[56:59], v[152:155], v[80:95]
    ds_read_b128 v[148:151], v4 offset:10752
    v_add_f32 v10, v10, v11
    v_mov_b32 v11, v10
    s_nop 1
    v_permlane32_swap_b32 v10, v11
    v_mul_f32 v12, 0x3b124925, v10
    v_mfma_f32_32x32x16_bf16 v[80:95], a[60:63], v[156:159], v[80:95]
    s_waitcnt lgkmcnt(3)
    buffer_load_dwordx4 a[124:127], v1, s[4:7], s37 offen offset:3072
    ds_read_b128 v[152:155], v4 offset:11264
    v_mul_f32 v10, 0x3b124925, v11
    v_fma_f32 v10, -v12, v12, v10
    v_max_f32 v10, 0, v10
    v_add_f32 v11, 0x3727c5ac, v10
    v_mfma_f32_32x32x16_bf16 v[80:95], a[64:67], v[160:163], v[80:95]
    ds_read_b128 v[156:159], v4 offset:11776
    v_rsq_f32 v11, v11
    s_nop 0
    ds_write_b32 v5, v11
    v_mfma_f32_32x32x16_bf16 v[80:95], a[68:71], v[164:167], v[80:95]
    s_add_u32 m0, s67, 0
    s_add_u32 s38, s66, 0
    buffer_load_dwordx4 v1, s[4:7], s38 offen offset:0 lds
    ds_read_b128 v[160:163], v4 offset:12288
    v_mfma_f32_32x32x16_bf16 v[80:95], a[72:75], v[168:171], v[80:95]
    s_waitcnt lgkmcnt(4)
    ds_read_b128 v[164:167], v4 offset:12800
    v_mfma_f32_32x32x16_bf16 v[80:95], a[76:79], v[172:175], v[80:95]
    buffer_load_dwordx4 v1, s[4:7], s38 offen offset:1024 lds
    ds_read_b128 v[168:171], v4 offset:13312
    v_mfma_f32_32x32x16_bf16 v[80:95], a[80:83], v[144:147], v[80:95]
    ds_read_b128 v[172:175], v4 offset:13824
    v_mfma_f32_32x32x16_bf16 v[80:95], a[84:87], v[148:151], v[80:95]
    s_waitcnt lgkmcnt(4)
    buffer_load_dwordx4 v1, s[4:7], s38 offen offset:2048 lds
    s_barrier
    ds_read_b32 v24, v6
    ds_read_b32 v25, v6 offset:128
    ds_read_b128 v[144:147], v4 offset:30720
    s_waitcnt lgkmcnt(6)
    v_mfma_f32_32x32x16_bf16 v[80:95], a[88:91], v[152:155], v[80:95]
    ds_read_b128 v[148:151], v4 offset:31232
    v_mfma_f32_32x32x16_bf16 v[80:95], a[92:95], v[156:159], v[80:95]
    buffer_load_dwordx4 v1, s[4:7], s38 offen offset:3072 lds
    ds_read_b128 v[152:155], v4 offset:31744
    v_mfma_f32_32x32x16_bf16 v[80:95], a[96:99], v[160:163], v[80:95]
    s_waitcnt lgkmcnt(4)
    ds_read_b128 v[156:159], v4 offset:32256
    v_rcp_f32 v18, v24
    v_mul_f32 v17, v24, v24
    v_mul_f32 v16, 0xc0135761, v24
    v_mfma_f32_32x32x16_bf16 v[80:95], a[100:103], v[164:167], v[80:95]
    s_waitcnt lgkmcnt(4)
    ds_read_b128 v[160:163], v4 offset:32768
    v_mul_f32 v17, v17, v16
    v_mul_f32 v17, 0x3d372713, v17
    v_rcp_f32 v22, v25
    v_mfma_f32_32x32x16_bf16 v[80:95], a[104:107], v[168:171], v[80:95]
    s_add_u32 m0, s67, 4096
    s_add_u32 s38, s66, 4096
    buffer_load_dwordx4 v1, s[4:7], s38 offen offset:0 lds
    ds_read_b128 v[164:167], v4 offset:33280
    v_mul_f32 v21, v25, v25
    v_mul_f32 v20, 0xc0135761, v25
    v_mul_f32 v21, v21, v20
    v_mul_f32 v21, 0x3d372713, v21
    v_mfma_f32_32x32x16_bf16 v[80:95], a[108:111], v[172:175], v[80:95]
    s_waitcnt lgkmcnt(3)
    buffer_load_dwordx4 v1, s[4:7], s38 offen offset:1024 lds
    ds_read_b128 v[168:171], v4 offset:33792
    v_and_b32 v7, 15, v0
    v_lshlrev_b32 v7, 7, v7
    v_mfma_f32_32x32x16_bf16 v[96:111], a[16:19], v[144:147], v[96:111]
    ds_read_b128 v[172:175], v4 offset:34304
    v_mfma_f32_32x32x16_bf16 v[96:111], a[20:23], v[148:151], v[96:111]
    ds_read_b128 v[144:147], v4 offset:34816
    v_mfma_f32_32x32x16_bf16 v[96:111], a[24:27], v[152:155], v[96:111]
    s_add_u32 s37, s47, 32768
    buffer_load_dwordx4 a[16:19], v1, s[4:7], s37 offen offset:0
    ds_read_b128 v[148:151], v4 offset:35328
    v_pk_mul_f32 v[176:177], v[80:81], v[80:81]
    v_pk_mul_f32 v[178:179], v[82:83], v[82:83]
    v_pk_mul_f32 v[180:181], v[84:85], v[84:85]
    v_pk_mul_f32 v[182:183], v[86:87], v[86:87]
    v_pk_mul_f32 v[184:185], v[88:89], v[88:89]
    v_pk_mul_f32 v[186:187], v[90:91], v[90:91]
    v_pk_mul_f32 v[188:189], v[92:93], v[92:93]
    v_pk_mul_f32 v[190:191], v[94:95], v[94:95]
    v_pk_fma_f32 v[176:177], v[176:177], v[16:17], v[16:17] op_sel:[0,1,0] op_sel_hi:[1,1,0]
    v_pk_fma_f32 v[178:179], v[178:179], v[16:17], v[16:17] op_sel:[0,1,0] op_sel_hi:[1,1,0]
    v_pk_fma_f32 v[180:181], v[180:181], v[16:17], v[16:17] op_sel:[0,1,0] op_sel_hi:[1,1,0]
    v_pk_fma_f32 v[182:183], v[182:183], v[16:17], v[16:17] op_sel:[0,1,0] op_sel_hi:[1,1,0]
    v_pk_fma_f32 v[184:185], v[184:185], v[16:17], v[16:17] op_sel:[0,1,0] op_sel_hi:[1,1,0]
    v_pk_fma_f32 v[186:187], v[186:187], v[16:17], v[16:17] op_sel:[0,1,0] op_sel_hi:[1,1,0]
    v_pk_fma_f32 v[188:189], v[188:189], v[16:17], v[16:17] op_sel:[0,1,0] op_sel_hi:[1,1,0]
    v_pk_fma_f32 v[190:191], v[190:191], v[16:17], v[16:17] op_sel:[0,1,0] op_sel_hi:[1,1,0]
    v_pk_mul_f32 v[176:177], v[176:177], v[80:81]
    v_pk_mul_f32 v[178:179], v[178:179], v[82:83]
    v_pk_mul_f32 v[180:181], v[180:181], v[84:85]
    v_pk_mul_f32 v[182:183], v[182:183], v[86:87]
    v_pk_mul_f32 v[184:185], v[184:185], v[88:89]
    v_pk_mul_f32 v[186:187], v[186:187], v[90:91]
    v_pk_mul_f32 v[188:189], v[188:189], v[92:93]
    v_pk_mul_f32 v[190:191], v[190:191], v[94:95]
    v_exp_f32 v176, v176
    v_exp_f32 v177, v177
    v_exp_f32 v178, v178
    s_waitcnt lgkmcnt(4)
    v_mfma_f32_32x32x16_bf16 v[96:111], a[28:31], v[156:159], v[96:111]
    buffer_load_dwordx4 a[20:23], v1, s[4:7], s37 offen offset:1024
    ds_read_b128 v[152:155], v4 offset:35840
    v_exp_f32 v179, v179
    v_exp_f32 v180, v180
    v_exp_f32 v181, v181
    v_mfma_f32_32x32x16_bf16 v[96:111], a[32:35], v[160:163], v[96:111]
    buffer_load_dwordx4 a[24:27], v1, s[4:7], s37 offen offset:2048
    ds_read_b128 v[156:159], v4 offset:36352
    v_exp_f32 v182, v182
    v_exp_f32 v183, v183
    v_exp_f32 v184, v184
    v_mfma_f32_32x32x16_bf16 v[96:111], a[36:39], v[164:167], v[96:111]
    s_waitcnt lgkmcnt(3)
    buffer_load_dwordx4 a[28:31], v1, s[4:7], s37 offen offset:3072
    ds_read_b128 v[160:163], v4 offset:36864
    v_exp_f32 v185, v185
    v_exp_f32 v186, v186
    v_exp_f32 v187, v187
    v_mfma_f32_32x32x16_bf16 v[96:111], a[40:43], v[168:171], v[96:111]
    s_add_u32 s37, s47, 36864
    buffer_load_dwordx4 a[32:35], v1, s[4:7], s37 offen offset:0
    ds_read_b128 v[164:167], v4 offset:37376
    v_exp_f32 v188, v188
    v_exp_f32 v189, v189
    v_exp_f32 v190, v190
    v_mfma_f32_32x32x16_bf16 v[96:111], a[44:47], v[172:175], v[96:111]
    buffer_load_dwordx4 a[36:39], v1, s[4:7], s37 offen offset:1024
    ds_read_b128 v[168:171], v4 offset:37888
    v_exp_f32 v191, v191
    v_fma_f32 v176, v176, v18, v18
    v_fma_f32 v177, v177, v18, v18
    v_fma_f32 v178, v178, v18, v18
    v_fma_f32 v179, v179, v18, v18
    v_mfma_f32_32x32x16_bf16 v[96:111], a[48:51], v[144:147], v[96:111]
    s_waitcnt lgkmcnt(3)
    ds_read_b128 v[172:175], v4 offset:38400
    v_fma_f32 v180, v180, v18, v18
    v_fma_f32 v181, v181, v18, v18
    v_fma_f32 v182, v182, v18, v18
    v_fma_f32 v183, v183, v18, v18
    v_fma_f32 v184, v184, v18, v18
    v_fma_f32 v185, v185, v18, v18
    v_mfma_f32_32x32x16_bf16 v[96:111], a[52:55], v[148:151], v[96:111]
    buffer_load_dwordx4 a[40:43], v1, s[4:7], s37 offen offset:2048
    ds_read_b128 v[144:147], v4 offset:38912
    v_fma_f32 v186, v186, v18, v18
    v_fma_f32 v187, v187, v18, v18
    v_fma_f32 v188, v188, v18, v18
    v_fma_f32 v189, v189, v18, v18
    v_fma_f32 v190, v190, v18, v18
    v_fma_f32 v191, v191, v18, v18
    v_mfma_f32_32x32x16_bf16 v[96:111], a[56:59], v[152:155], v[96:111]
    buffer_load_dwordx4 a[44:47], v1, s[4:7], s37 offen offset:3072
    ds_read_b128 v[148:151], v4 offset:39424
    v_rcp_f32 v176, v176
    v_rcp_f32 v177, v177
    v_rcp_f32 v178, v178
    v_mfma_f32_32x32x16_bf16 v[96:111], a[60:63], v[156:159], v[96:111]
    s_waitcnt lgkmcnt(3)
    ds_read_b128 v[152:155], v4 offset:39936
    v_rcp_f32 v179, v179
    v_rcp_f32 v180, v180
    v_rcp_f32 v181, v181
    v_mfma_f32_32x32x16_bf16 v[96:111], a[64:67], v[160:163], v[96:111]
    s_add_u32 s37, s47, 40960
    buffer_load_dwordx4 a[48:51], v1, s[4:7], s37 offen offset:0
    ds_read_b128 v[156:159], v4 offset:40448
    v_rcp_f32 v182, v182
    v_rcp_f32 v183, v183
    v_rcp_f32 v184, v184
    v_mfma_f32_32x32x16_bf16 v[96:111], a[68:71], v[164:167], v[96:111]
    ds_read_b128 v[160:163], v4 offset:40960
    v_rcp_f32 v185, v185
    v_rcp_f32 v186, v186
    v_rcp_f32 v187, v187
    v_mfma_f32_32x32x16_bf16 v[96:111], a[72:75], v[168:171], v[96:111]
    s_waitcnt lgkmcnt(3)
    buffer_load_dwordx4 a[52:55], v1, s[4:7], s37 offen offset:1024
    ds_read_b128 v[164:167], v4 offset:41472
    v_rcp_f32 v188, v188
    v_rcp_f32 v189, v189
    v_rcp_f32 v190, v190
    v_mfma_f32_32x32x16_bf16 v[96:111], a[76:79], v[172:175], v[96:111]
    buffer_load_dwordx4 a[56:59], v1, s[4:7], s37 offen offset:2048
    ds_read_b128 v[168:171], v4 offset:41984
    v_rcp_f32 v191, v191
    v_mul_f32 v176, v176, v80
    v_mul_f32 v177, v177, v81
    v_mul_f32 v178, v178, v82
    v_mul_f32 v179, v179, v83
    v_mfma_f32_32x32x16_bf16 v[96:111], a[80:83], v[144:147], v[96:111]
    ds_read_b128 v[172:175], v4 offset:42496
    v_mul_f32 v180, v180, v84
    v_mul_f32 v181, v181, v85
    v_mul_f32 v182, v182, v86
    v_mul_f32 v183, v183, v87
    v_cvt_pk_bf16_f32 v48, v176, v177
    v_cvt_pk_bf16_f32 v49, v178, v179
    v_mfma_f32_32x32x16_bf16 v[96:111], a[84:87], v[148:151], v[96:111]
    s_waitcnt lgkmcnt(3)
    buffer_load_dwordx4 a[60:63], v1, s[4:7], s37 offen offset:3072
    ds_read_b128 v[144:147], v4 offset:2048
    v_cvt_pk_bf16_f32 v50, v180, v181
    v_cvt_pk_bf16_f32 v51, v182, v183
    s_add_u32 s29, s59, s20
    buffer_store_dwordx4 v[48:51], v1, s[4:7], s29 offen offset:0 sc1
    v_mul_f32 v184, v184, v88
    v_mul_f32 v185, v185, v89
    v_mul_f32 v186, v186, v90
    v_mul_f32 v187, v187, v91
    v_mfma_f32_32x32x16_bf16 v[96:111], a[88:91], v[152:155], v[96:111]
    ds_read_b128 v[148:151], v4 offset:2560
    v_mul_f32 v188, v188, v92
    v_mul_f32 v189, v189, v93
    v_mul_f32 v190, v190, v94
    v_mul_f32 v191, v191, v95
    v_cvt_pk_bf16_f32 v52, v184, v185
    v_cvt_pk_bf16_f32 v53, v186, v187
    v_mfma_f32_32x32x16_bf16 v[96:111], a[92:95], v[156:159], v[96:111]
    ds_read_b128 v[152:155], v4 offset:3072
    v_cvt_pk_bf16_f32 v54, v188, v189
    v_cvt_pk_bf16_f32 v55, v190, v191
    buffer_store_dwordx4 v[52:55], v1, s[4:7], s29 offen offset:1024 sc1
    v_mfma_f32_32x32x16_bf16 v[96:111], a[96:99], v[160:163], v[96:111]
    s_waitcnt lgkmcnt(3)
    ds_read_b128 v[156:159], v4 offset:3584
    v_mfma_f32_32x32x16_bf16 v[96:111], a[100:103], v[164:167], v[96:111]
    ds_read_b128 v[160:163], v4 offset:4096
    v_mfma_f32_32x32x16_bf16 v[96:111], a[104:107], v[168:171], v[96:111]
    s_add_u32 s37, s47, 45056
    buffer_load_dwordx4 a[64:67], v1, s[4:7], s37 offen offset:0
    ds_read_b128 v[164:167], v4 offset:4608
    v_mfma_f32_32x32x16_bf16 v[96:111], a[108:111], v[172:175], v[96:111]
    s_waitcnt lgkmcnt(3)
    ds_read_b128 v[168:171], v4 offset:5120
    v_mfma_f32_32x32x16_bf16 v[112:127], a[128:131], v[144:147], v[112:127]
    buffer_load_dwordx4 a[68:71], v1, s[4:7], s37 offen offset:1024
    ds_read_b128 v[172:175], v4 offset:5632
    v_mfma_f32_32x32x16_bf16 v[112:127], a[132:135], v[148:151], v[112:127]
    ds_read_b128 v[144:147], v4 offset:6144
    v_mfma_f32_32x32x16_bf16 v[112:127], a[136:139], v[152:155], v[112:127]
    ds_read_b128 v[148:151], v4 offset:6656
    s_nop 3
    v_pk_mul_f32 v[176:177], v[96:97], v[96:97]
    v_pk_mul_f32 v[178:179], v[98:99], v[98:99]
    v_pk_mul_f32 v[180:181], v[100:101], v[100:101]
    v_pk_mul_f32 v[182:183], v[102:103], v[102:103]
    v_pk_mul_f32 v[184:185], v[104:105], v[104:105]
    v_pk_mul_f32 v[186:187], v[106:107], v[106:107]
    v_pk_mul_f32 v[188:189], v[108:109], v[108:109]
    v_pk_mul_f32 v[190:191], v[110:111], v[110:111]
    v_pk_fma_f32 v[176:177], v[176:177], v[20:21], v[20:21] op_sel:[0,1,0] op_sel_hi:[1,1,0]
    v_pk_fma_f32 v[178:179], v[178:179], v[20:21], v[20:21] op_sel:[0,1,0] op_sel_hi:[1,1,0]
    v_pk_fma_f32 v[180:181], v[180:181], v[20:21], v[20:21] op_sel:[0,1,0] op_sel_hi:[1,1,0]
    v_pk_fma_f32 v[182:183], v[182:183], v[20:21], v[20:21] op_sel:[0,1,0] op_sel_hi:[1,1,0]
    v_pk_fma_f32 v[184:185], v[184:185], v[20:21], v[20:21] op_sel:[0,1,0] op_sel_hi:[1,1,0]
    v_pk_fma_f32 v[186:187], v[186:187], v[20:21], v[20:21] op_sel:[0,1,0] op_sel_hi:[1,1,0]
    v_pk_fma_f32 v[188:189], v[188:189], v[20:21], v[20:21] op_sel:[0,1,0] op_sel_hi:[1,1,0]
    v_pk_fma_f32 v[190:191], v[190:191], v[20:21], v[20:21] op_sel:[0,1,0] op_sel_hi:[1,1,0]
    v_pk_mul_f32 v[176:177], v[176:177], v[96:97]
    v_pk_mul_f32 v[178:179], v[178:179], v[98:99]
    v_pk_mul_f32 v[180:181], v[180:181], v[100:101]
    v_pk_mul_f32 v[182:183], v[182:183], v[102:103]
    v_pk_mul_f32 v[184:185], v[184:185], v[104:105]
    v_pk_mul_f32 v[186:187], v[186:187], v[106:107]
    v_pk_mul_f32 v[188:189], v[188:189], v[108:109]
    v_pk_mul_f32 v[190:191], v[190:191], v[110:111]
    v_exp_f32 v176, v176
    v_exp_f32 v177, v177
    v_exp_f32 v178, v178
    s_waitcnt lgkmcnt(4)
    v_mfma_f32_32x32x16_bf16 v[112:127], a[140:143], v[156:159], v[112:127]
    buffer_load_dwordx4 a[72:75], v1, s[4:7], s37 offen offset:2048
    ds_read_b128 v[152:155], v4 offset:7168
    v_exp_f32 v179, v179
    v_exp_f32 v180, v180
    v_exp_f32 v181, v181
    v_mfma_f32_32x32x16_bf16 v[112:127], a[144:147], v[160:163], v[112:127]
    buffer_load_dwordx4 a[76:79], v1, s[4:7], s37 offen offset:3072
    ds_read_b128 v[156:159], v4 offset:7680
    v_exp_f32 v182, v182
    v_exp_f32 v183, v183
    v_exp_f32 v184, v184
    v_mfma_f32_32x32x16_bf16 v[112:127], a[148:151], v[164:167], v[112:127]
    s_waitcnt lgkmcnt(3)
    s_add_u32 s37, s47, 49152
    buffer_load_dwordx4 a[80:83], v1, s[4:7], s37 offen offset:0
    ds_read_b128 v[160:163], v4 offset:8192
    v_exp_f32 v185, v185
    v_exp_f32 v186, v186
    v_exp_f32 v187, v187
    v_mfma_f32_32x32x16_bf16 v[112:127], a[152:155], v[168:171], v[112:127]
    buffer_load_dwordx4 a[84:87], v1, s[4:7], s37 offen offset:1024
    ds_read_b128 v[164:167], v4 offset:8704
    v_exp_f32 v188, v188
    v_exp_f32 v189, v189
    v_exp_f32 v190, v190
    v_mfma_f32_32x32x16_bf16 v[112:127], a[156:159], v[172:175], v[112:127]
    buffer_load_dwordx4 a[88:91], v1, s[4:7], s37 offen offset:2048
    ds_read_b128 v[168:171], v4 offset:9216
    v_exp_f32 v191, v191
    v_fma_f32 v176, v176, v22, v22
    v_fma_f32 v177, v177, v22, v22
    v_fma_f32 v178, v178, v22, v22
    v_fma_f32 v179, v179, v22, v22
    v_mfma_f32_32x32x16_bf16 v[112:127], a[160:163], v[144:147], v[112:127]
    s_waitcnt lgkmcnt(3)
    buffer_load_dwordx4 a[92:95], v1, s[4:7], s37 offen offset:3072
    ds_read_b128 v[172:175], v4 offset:9728
    v_fma_f32 v180, v180, v22, v22
    v_fma_f32 v181, v181, v22, v22
    v_fma_f32 v182, v182, v22, v22
    v_fma_f32 v183, v183, v22, v22
    v_fma_f32 v184, v184, v22, v22
    v_fma_f32 v185, v185, v22, v22
    v_mfma_f32_32x32x16_bf16 v[112:127], a[164:167], v[148:151], v[112:127]
    ds_read_b128 v[144:147], v4 offset:10240
    v_fma_f32 v186, v186, v22, v22
    v_fma_f32 v187, v187, v22, v22
    v_fma_f32 v188, v188, v22, v22
    v_fma_f32 v189, v189, v22, v22
    v_fma_f32 v190, v190, v22, v22
    v_fma_f32 v191, v191, v22, v22
    v_mfma_f32_32x32x16_bf16 v[112:127], a[168:171], v[152:155], v[112:127]
    s_add_u32 s37, s47, 53248
    buffer_load_dwordx4 a[96:99], v1, s[4:7], s37 offen offset:0
    ds_read_b128 v[148:151], v4 offset:10752
    v_rcp_f32 v176, v176
    v_rcp_f32 v177, v177
    v_rcp_f32 v178, v178
    v_mfma_f32_32x32x16_bf16 v[112:127], a[172:175], v[156:159], v[112:127]
    s_waitcnt lgkmcnt(3)
    buffer_load_dwordx4 a[100:103], v1, s[4:7], s37 offen offset:1024
    ds_read_b128 v[152:155], v4 offset:11264
    v_rcp_f32 v179, v179
    v_rcp_f32 v180, v180
    v_rcp_f32 v181, v181
    v_mfma_f32_32x32x16_bf16 v[112:127], a[176:179], v[160:163], v[112:127]
    ds_read_b128 v[156:159], v4 offset:11776
    v_rcp_f32 v182, v182
    v_rcp_f32 v183, v183
    v_rcp_f32 v184, v184
    v_mfma_f32_32x32x16_bf16 v[112:127], a[180:183], v[164:167], v[112:127]
    s_waitcnt vmcnt(10)
    buffer_load_dwordx4 a[104:107], v1, s[4:7], s37 offen offset:2048
    ds_read_b128 v[160:163], v4 offset:12288
    s_mov_b64 exec, 1
    buffer_store_dword v15, off, s[4:7], s65 offset:0 sc1
    s_mov_b64 exec, -1
    v_rcp_f32 v185, v185
    v_rcp_f32 v186, v186
    v_rcp_f32 v187, v187
    v_mfma_f32_32x32x16_bf16 v[112:127], a[184:187], v[168:171], v[112:127]
    s_waitcnt lgkmcnt(3)
    buffer_load_dwordx4 a[108:111], v1, s[4:7], s37 offen offset:3072
    ds_read_b128 v[164:167], v4 offset:12800
    v_rcp_f32 v188, v188
    v_rcp_f32 v189, v189
    v_rcp_f32 v190, v190
    v_mfma_f32_32x32x16_bf16 v[112:127], a[188:191], v[172:175], v[112:127]
    ds_read_b128 v[168:171], v4 offset:13312
    v_rcp_f32 v191, v191
    v_mul_f32 v176, v176, v96
    v_mul_f32 v177, v177, v97
    v_mul_f32 v178, v178, v98
    v_mul_f32 v179, v179, v99
    v_mfma_f32_32x32x16_bf16 v[112:127], a[192:195], v[144:147], v[112:127]
    buffer_load_dwordx4 v1, s[4:7], s38 offen offset:2048 lds
    ds_read_b128 v[172:175], v4 offset:13824
    v_mul_f32 v180, v180, v100
    v_mul_f32 v181, v181, v101
    v_mul_f32 v182, v182, v102
    v_mul_f32 v183, v183, v103
    v_cvt_pk_bf16_f32 v56, v176, v177
    v_cvt_pk_bf16_f32 v57, v178, v179
    v_mfma_f32_32x32x16_bf16 v[112:127], a[196:199], v[148:151], v[112:127]
    s_waitcnt lgkmcnt(3)
    buffer_load_dwordx4 v1, s[4:7], s38 offen offset:3072 lds
    ds_read_b128 v[144:147], v4 offset:30720
    v_cvt_pk_bf16_f32 v58, v180, v181
    v_cvt_pk_bf16_f32 v59, v182, v183
    s_add_u32 s29, s48, 0
    buffer_store_dwordx4 v[56:59], v1, s[4:7], s29 offen offset:2048 sc1
    v_mul_f32 v184, v184, v104
    v_mul_f32 v185, v185, v105
    v_mul_f32 v186, v186, v106
    v_mul_f32 v187, v187, v107
    v_mfma_f32_32x32x16_bf16 v[112:127], a[200:203], v[152:155], v[112:127]
    ds_read_b128 v[148:151], v4 offset:31232
    v_mul_f32 v188, v188, v108
    v_mul_f32 v189, v189, v109
    v_mul_f32 v190, v190, v110
    v_mul_f32 v191, v191, v111
    v_cvt_pk_bf16_f32 v60, v184, v185
    v_cvt_pk_bf16_f32 v61, v186, v187
    v_mfma_f32_32x32x16_bf16 v[112:127], a[204:207], v[156:159], v[112:127]
    ds_read_b128 v[152:155], v4 offset:31744
    v_cvt_pk_bf16_f32 v62, v188, v189
    v_cvt_pk_bf16_f32 v63, v190, v191
    buffer_store_dwordx4 v[60:63], v1, s[4:7], s29 offen offset:3072 sc1
    v_mfma_f32_32x32x16_bf16 v[112:127], a[208:211], v[160:163], v[112:127]
    s_waitcnt lgkmcnt(3)
    ds_read_b128 v[156:159], v4 offset:32256
    v_mfma_f32_32x32x16_bf16 v[112:127], a[212:215], v[164:167], v[112:127]
    ds_read_b128 v[160:163], v4 offset:32768
    v_mfma_f32_32x32x16_bf16 v[112:127], a[216:219], v[168:171], v[112:127]
    s_add_u32 m0, s67, 8192
    s_add_u32 s38, s66, 8192
    buffer_load_dwordx4 v1, s[4:7], s38 offen offset:0 lds
    ds_read_b128 v[164:167], v4 offset:33280
    v_mfma_f32_32x32x16_bf16 v[112:127], a[220:223], v[172:175], v[112:127]
    s_waitcnt lgkmcnt(3)
    ds_read_b128 v[168:171], v4 offset:33792
    v_mfma_f32_32x32x16_bf16 v[128:143], a[128:131], v[144:147], v[128:143]
    buffer_load_dwordx4 v1, s[4:7], s38 offen offset:1024 lds
    ds_read_b128 v[172:175], v4 offset:34304
    v_mfma_f32_32x32x16_bf16 v[128:143], a[132:135], v[148:151], v[128:143]
    ds_read_b128 v[144:147], v4 offset:34816
    v_mfma_f32_32x32x16_bf16 v[128:143], a[136:139], v[152:155], v[128:143]
    ds_read_b128 v[148:151], v4 offset:35328
    s_add_u32 s36, s64, 0
    buffer_load_dword v10, v3, s[4:7], s36 offen sc1
    s_nop 1
    v_pk_mul_f32 v[176:177], v[112:113], v[112:113]
    v_pk_mul_f32 v[178:179], v[114:115], v[114:115]
    v_pk_mul_f32 v[180:181], v[116:117], v[116:117]
    v_pk_mul_f32 v[182:183], v[118:119], v[118:119]
    v_pk_mul_f32 v[184:185], v[120:121], v[120:121]
    v_pk_mul_f32 v[186:187], v[122:123], v[122:123]
    v_pk_mul_f32 v[188:189], v[124:125], v[124:125]
    v_pk_mul_f32 v[190:191], v[126:127], v[126:127]
    v_pk_fma_f32 v[176:177], v[176:177], v[16:17], v[16:17] op_sel:[0,1,0] op_sel_hi:[1,1,0]
    v_pk_fma_f32 v[178:179], v[178:179], v[16:17], v[16:17] op_sel:[0,1,0] op_sel_hi:[1,1,0]
    v_pk_fma_f32 v[180:181], v[180:181], v[16:17], v[16:17] op_sel:[0,1,0] op_sel_hi:[1,1,0]
    v_pk_fma_f32 v[182:183], v[182:183], v[16:17], v[16:17] op_sel:[0,1,0] op_sel_hi:[1,1,0]
    v_pk_fma_f32 v[184:185], v[184:185], v[16:17], v[16:17] op_sel:[0,1,0] op_sel_hi:[1,1,0]
    v_pk_fma_f32 v[186:187], v[186:187], v[16:17], v[16:17] op_sel:[0,1,0] op_sel_hi:[1,1,0]
    v_pk_fma_f32 v[188:189], v[188:189], v[16:17], v[16:17] op_sel:[0,1,0] op_sel_hi:[1,1,0]
    v_pk_fma_f32 v[190:191], v[190:191], v[16:17], v[16:17] op_sel:[0,1,0] op_sel_hi:[1,1,0]
    v_pk_mul_f32 v[176:177], v[176:177], v[112:113]
    v_pk_mul_f32 v[178:179], v[178:179], v[114:115]
    v_pk_mul_f32 v[180:181], v[180:181], v[116:117]
    v_pk_mul_f32 v[182:183], v[182:183], v[118:119]
    v_pk_mul_f32 v[184:185], v[184:185], v[120:121]
    v_pk_mul_f32 v[186:187], v[186:187], v[122:123]
    v_pk_mul_f32 v[188:189], v[188:189], v[124:125]
    v_pk_mul_f32 v[190:191], v[190:191], v[126:127]
    v_exp_f32 v176, v176
    v_exp_f32 v177, v177
    v_exp_f32 v178, v178
    s_waitcnt lgkmcnt(4)
    v_mfma_f32_32x32x16_bf16 v[128:143], a[140:143], v[156:159], v[128:143]
    buffer_load_dwordx4 v1, s[4:7], s38 offen offset:2048 lds
    ds_read_b128 v[152:155], v4 offset:35840
    v_exp_f32 v179, v179
    v_exp_f32 v180, v180
    v_exp_f32 v181, v181
    v_mfma_f32_32x32x16_bf16 v[128:143], a[144:147], v[160:163], v[128:143]
    buffer_load_dwordx4 v1, s[4:7], s38 offen offset:3072 lds
    ds_read_b128 v[156:159], v4 offset:36352
    v_exp_f32 v182, v182
    v_exp_f32 v183, v183
    v_exp_f32 v184, v184
    v_mfma_f32_32x32x16_bf16 v[128:143], a[148:151], v[164:167], v[128:143]
    s_waitcnt lgkmcnt(3)
    s_add_u32 m0, s67, 12288
    s_add_u32 s38, s66, 12288
    buffer_load_dwordx4 v1, s[4:7], s38 offen offset:0 lds
    ds_read_b128 v[160:163], v4 offset:36864
    v_exp_f32 v185, v185
    v_exp_f32 v186, v186
    v_exp_f32 v187, v187
    v_mfma_f32_32x32x16_bf16 v[128:143], a[152:155], v[168:171], v[128:143]
    buffer_load_dwordx4 v1, s[4:7], s38 offen offset:1024 lds
    ds_read_b128 v[164:167], v4 offset:37376
    v_exp_f32 v188, v188
    v_exp_f32 v189, v189
    v_exp_f32 v190, v190
    v_mfma_f32_32x32x16_bf16 v[128:143], a[156:159], v[172:175], v[128:143]
    buffer_load_dwordx4 v1, s[4:7], s38 offen offset:2048 lds
    ds_read_b128 v[168:171], v4 offset:37888
    v_exp_f32 v191, v191
    v_fma_f32 v176, v176, v18, v18
    v_fma_f32 v177, v177, v18, v18
    v_fma_f32 v178, v178, v18, v18
    v_fma_f32 v179, v179, v18, v18
    v_mfma_f32_32x32x16_bf16 v[128:143], a[160:163], v[144:147], v[128:143]
    s_waitcnt lgkmcnt(3)
    buffer_load_dwordx4 v1, s[4:7], s38 offen offset:3072 lds
    ds_read_b128 v[172:175], v4 offset:38400
    v_fma_f32 v180, v180, v18, v18
    v_fma_f32 v181, v181, v18, v18
    v_fma_f32 v182, v182, v18, v18
    v_fma_f32 v183, v183, v18, v18
    v_fma_f32 v184, v184, v18, v18
    v_fma_f32 v185, v185, v18, v18
    v_mfma_f32_32x32x16_bf16 v[128:143], a[164:167], v[148:151], v[128:143]
    ds_read_b128 v[144:147], v4 offset:38912
    v_fma_f32 v186, v186, v18, v18
    v_fma_f32 v187, v187, v18, v18
    v_fma_f32 v188, v188, v18, v18
    v_fma_f32 v189, v189, v18, v18
    v_fma_f32 v190, v190, v18, v18
    v_fma_f32 v191, v191, v18, v18
    v_mfma_f32_32x32x16_bf16 v[128:143], a[168:171], v[152:155], v[128:143]
    s_add_u32 m0, s67, 16384
    s_add_u32 s38, s66, 16384
    buffer_load_dwordx4 v1, s[4:7], s38 offen offset:0 lds
    ds_read_b128 v[148:151], v4 offset:39424
    v_rcp_f32 v176, v176
    v_rcp_f32 v177, v177
    v_rcp_f32 v178, v178
    v_mfma_f32_32x32x16_bf16 v[128:143], a[172:175], v[156:159], v[128:143]
    s_waitcnt lgkmcnt(3)
    buffer_load_dwordx4 v1, s[4:7], s38 offen offset:1024 lds
    ds_read_b128 v[152:155], v4 offset:39936
    v_rcp_f32 v179, v179
    v_rcp_f32 v180, v180
    v_rcp_f32 v181, v181
    v_mfma_f32_32x32x16_bf16 v[128:143], a[176:179], v[160:163], v[128:143]
    ds_read_b128 v[156:159], v4 offset:40448
    v_rcp_f32 v182, v182
    v_rcp_f32 v183, v183
    v_rcp_f32 v184, v184
    v_mfma_f32_32x32x16_bf16 v[128:143], a[180:183], v[164:167], v[128:143]
    s_waitcnt vmcnt(11)
    buffer_load_dwordx4 v1, s[4:7], s38 offen offset:2048 lds
    ds_read_b128 v[160:163], v4 offset:40960
    s_mov_b64 exec, 1
    buffer_store_dword v15, off, s[4:7], s65 offset:32 sc1
    s_mov_b64 exec, -1
    s_waitcnt vmcnt(10)
    v_cmp_eq_u32 vcc, 0, v10
    s_nop 0
    s_cbranch_vccz Lpolld15
    s_mov_b32 s39, 0
Lpoll15:
    buffer_load_dword v10, v3, s[4:7], s36 offen sc1
    s_waitcnt vmcnt(0)
    v_cmp_eq_u32 vcc, 0, v10
    s_nop 0
    s_cbranch_vccz Lpolld15
    s_add_u32 s39, s39, 1
    s_cmp_lt_u32 s39, 200000
    s_cbranch_scc1 Lpoll15
Lpolld15:
    s_nop 0
    v_rcp_f32 v185, v185
    v_rcp_f32 v186, v186
    v_rcp_f32 v187, v187
    v_mfma_f32_32x32x16_bf16 v[128:143], a[184:187], v[168:171], v[128:143]
    s_waitcnt lgkmcnt(3)
    s_add_u32 s37, s59, s21
    buffer_load_dwordx4 a[128:131], v1, s[4:7], s37 offen offset:0 sc1
    ds_read_b128 v[164:167], v4 offset:41472
    v_rcp_f32 v188, v188
    v_rcp_f32 v189, v189
    v_rcp_f32 v190, v190
    v_mfma_f32_32x32x16_bf16 v[128:143], a[188:191], v[172:175], v[128:143]
    buffer_load_dwordx4 a[132:135], v1, s[4:7], s37 offen offset:1024 sc1
    ds_read_b128 v[168:171], v4 offset:41984
    v_rcp_f32 v191, v191
    v_mul_f32 v176, v176, v112
    v_mul_f32 v177, v177, v113
    v_mul_f32 v178, v178, v114
    v_mul_f32 v179, v179, v115
    v_mfma_f32_32x32x16_bf16 v[128:143], a[192:195], v[144:147], v[128:143]
    s_add_u32 s37, s59, s22
    buffer_load_dwordx4 a[136:139], v1, s[4:7], s37 offen offset:0 sc1
    ds_read_b128 v[172:175], v4 offset:42496
    v_mul_f32 v180, v180, v116
    v_mul_f32 v181, v181, v117
    v_mul_f32 v182, v182, v118
    v_mul_f32 v183, v183, v119
    v_cvt_pk_bf16_f32 v64, v176, v177
    v_cvt_pk_bf16_f32 v65, v178, v179
    v_mfma_f32_32x32x16_bf16 v[128:143], a[196:199], v[148:151], v[128:143]
    s_waitcnt lgkmcnt(3)
    v_cvt_pk_bf16_f32 v66, v180, v181
    v_cvt_pk_bf16_f32 v67, v182, v183
    s_add_u32 s29, s42, s20
    buffer_store_dwordx4 v[64:67], v1, s[4:7], s29 offen offset:0 sc1
    v_mul_f32 v184, v184, v120
    v_mul_f32 v185, v185, v121
    v_mul_f32 v186, v186, v122
    v_mul_f32 v187, v187, v123
    v_mfma_f32_32x32x16_bf16 v[128:143], a[200:203], v[152:155], v[128:143]
    v_mul_f32 v188, v188, v124
    v_mul_f32 v189, v189, v125
    v_mul_f32 v190, v190, v126
    v_mul_f32 v191, v191, v127
    v_cvt_pk_bf16_f32 v68, v184, v185
    v_cvt_pk_bf16_f32 v69, v186, v187
    v_mfma_f32_32x32x16_bf16 v[128:143], a[204:207], v[156:159], v[128:143]
    v_cvt_pk_bf16_f32 v70, v188, v189
    v_cvt_pk_bf16_f32 v71, v190, v191
    buffer_store_dwordx4 v[68:71], v1, s[4:7], s29 offen offset:1024 sc1
    v_mfma_f32_32x32x16_bf16 v[128:143], a[208:211], v[160:163], v[128:143]
    s_waitcnt lgkmcnt(0)
    v_mfma_f32_32x32x16_bf16 v[128:143], a[212:215], v[164:167], v[128:143]
    v_mfma_f32_32x32x16_bf16 v[128:143], a[216:219], v[168:171], v[128:143]
    buffer_load_dwordx4 a[140:143], v1, s[4:7], s37 offen offset:1024 sc1
    v_mfma_f32_32x32x16_bf16 v[128:143], a[220:223], v[172:175], v[128:143]
    v_mfma_f32_32x32x16_bf16 v[80:95], a[224:227], v[48:51], 0
    s_add_u32 s37, s59, s23
    buffer_load_dwordx4 a[144:147], v1, s[4:7], s37 offen offset:0 sc1
    v_mfma_f32_32x32x16_bf16 v[96:111], a[228:231], v[48:51], 0
    v_mfma_f32_32x32x16_bf16 v[80:95], a[232:235], v[52:55], v[80:95]
    buffer_load_dwordx4 a[148:151], v1, s[4:7], s37 offen offset:1024 sc1
    s_add_u32 s36, s64, 32
    buffer_load_dword v10, v3, s[4:7], s36 offen sc1
    s_nop 3
    v_pk_mul_f32 v[176:177], v[128:129], v[128:129]
    v_pk_mul_f32 v[178:179], v[130:131], v[130:131]
    v_pk_mul_f32 v[180:181], v[132:133], v[132:133]
    v_pk_mul_f32 v[182:183], v[134:135], v[134:135]
    v_pk_mul_f32 v[184:185], v[136:137], v[136:137]
    v_pk_mul_f32 v[186:187], v[138:139], v[138:139]
    v_pk_mul_f32 v[188:189], v[140:141], v[140:141]
    v_pk_mul_f32 v[190:191], v[142:143], v[142:143]
    v_pk_fma_f32 v[176:177], v[176:177], v[20:21], v[20:21] op_sel:[0,1,0] op_sel_hi:[1,1,0]
    v_pk_fma_f32 v[178:179], v[178:179], v[20:21], v[20:21] op_sel:[0,1,0] op_sel_hi:[1,1,0]
    v_pk_fma_f32 v[180:181], v[180:181], v[20:21], v[20:21] op_sel:[0,1,0] op_sel_hi:[1,1,0]
    v_pk_fma_f32 v[182:183], v[182:183], v[20:21], v[20:21] op_sel:[0,1,0] op_sel_hi:[1,1,0]
    v_pk_fma_f32 v[184:185], v[184:185], v[20:21], v[20:21] op_sel:[0,1,0] op_sel_hi:[1,1,0]
    v_pk_fma_f32 v[186:187], v[186:187], v[20:21], v[20:21] op_sel:[0,1,0] op_sel_hi:[1,1,0]
    v_pk_fma_f32 v[188:189], v[188:189], v[20:21], v[20:21] op_sel:[0,1,0] op_sel_hi:[1,1,0]
    v_pk_fma_f32 v[190:191], v[190:191], v[20:21], v[20:21] op_sel:[0,1,0] op_sel_hi:[1,1,0]
    v_pk_mul_f32 v[176:177], v[176:177], v[128:129]
    v_pk_mul_f32 v[178:179], v[178:179], v[130:131]
    v_pk_mul_f32 v[180:181], v[180:181], v[132:133]
    v_pk_mul_f32 v[182:183], v[182:183], v[134:135]
    v_pk_mul_f32 v[184:185], v[184:185], v[136:137]
    v_pk_mul_f32 v[186:187], v[186:187], v[138:139]
    v_pk_mul_f32 v[188:189], v[188:189], v[140:141]
    v_pk_mul_f32 v[190:191], v[190:191], v[142:143]
    v_exp_f32 v176, v176
    v_exp_f32 v177, v177
    v_exp_f32 v178, v178
    v_mfma_f32_32x32x16_bf16 v[96:111], a[236:239], v[52:55], v[96:111]
    s_waitcnt vmcnt(8)
    s_add_u32 s37, s59, s24
    buffer_load_dwordx4 a[152:155], v1, s[4:7], s37 offen offset:0 sc1
    v_exp_f32 v179, v179
    v_exp_f32 v180, v180
    v_exp_f32 v181, v181
    v_mfma_f32_32x32x16_bf16 v[80:95], a[240:243], a[128:131], v[80:95]
    buffer_load_dwordx4 a[156:159], v1, s[4:7], s37 offen offset:1024 sc1
    v_exp_f32 v182, v182
    v_exp_f32 v183, v183
    v_exp_f32 v184, v184
    v_mfma_f32_32x32x16_bf16 v[96:111], a[244:247], a[128:131], v[96:111]
    s_waitcnt vmcnt(9)
    s_add_u32 s37, s59, s25
    buffer_load_dwordx4 a[160:163], v1, s[4:7], s37 offen offset:0 sc1
    v_exp_f32 v185, v185
    v_exp_f32 v186, v186
    v_mfma_f32_32x32x16_bf16 v[80:95], a[248:251], a[132:135], v[80:95]
    buffer_load_dwordx4 a[164:167], v1, s[4:7], s37 offen offset:1024 sc1
    v_exp_f32 v187, v187
    v_exp_f32 v188, v188
    v_exp_f32 v189, v189
    v_mfma_f32_32x32x16_bf16 v[96:111], a[252:255], a[132:135], v[96:111]
    s_waitcnt vmcnt(10)
    v_exp_f32 v190, v190
    v_exp_f32 v191, v191
    v_fma_f32 v176, v176, v22, v22
    v_mfma_f32_32x32x16_bf16 v[80:95], v[192:195], a[136:139], v[80:95]
    s_add_u32 s37, s59, s26
    buffer_load_dwordx4 a[168:171], v1, s[4:7], s37 offen offset:0 sc1
    v_fma_f32 v177, v177, v22, v22
    v_fma_f32 v178, v178, v22, v22
    v_fma_f32 v179, v179, v22, v22
    v_fma_f32 v180, v180, v22, v22
    v_fma_f32 v181, v181, v22, v22
    v_fma_f32 v182, v182, v22, v22
    v_mfma_f32_32x32x16_bf16 v[96:111], v[196:199], a[136:139], v[96:111]
    s_waitcnt vmcnt(8)
    v_fma_f32 v183, v183, v22, v22
    v_fma_f32 v184, v184, v22, v22
    v_fma_f32 v185, v185, v22, v22
    v_fma_f32 v186, v186, v22, v22
    v_fma_f32 v187, v187, v22, v22
    v_mfma_f32_32x32x16_bf16 v[80:95], v[200:203], a[140:143], v[80:95]
    buffer_load_dwordx4 a[172:175], v1, s[4:7], s37 offen offset:1024 sc1
    v_fma_f32 v188, v188, v22, v22
    v_fma_f32 v189, v189, v22, v22
    v_fma_f32 v190, v190, v22, v22
    v_fma_f32 v191, v191, v22, v22
    v_rcp_f32 v176, v176
    v_mfma_f32_32x32x16_bf16 v[96:111], v[204:207], a[140:143], v[96:111]
    s_waitcnt vmcnt(8)
    buffer_load_dwordx4 v1, s[4:7], s38 offen offset:3072 lds
    v_rcp_f32 v177, v177
    v_rcp_f32 v178, v178
    v_rcp_f32 v179, v179
    v_mfma_f32_32x32x16_bf16 v[80:95], v[208:211], a[144:147], v[80:95]
    v_rcp_f32 v180, v180
    v_rcp_f32 v181, v181
    v_rcp_f32 v182, v182
    v_mfma_f32_32x32x16_bf16 v[96:111], v[212:215], a[144:147], v[96:111]
    s_add_u32 m0, s67, 20480
    s_add_u32 s38, s66, 20480
    buffer_load_dwordx4 v1, s[4:7], s38 offen offset:0 lds
    s_mov_b64 exec, 1
    buffer_store_dword v15, off, s[4:7], s65 offset:64 sc1
    s_mov_b64 exec, -1
    s_waitcnt vmcnt(9)
    v_cmp_eq_u32 vcc, 0, v10
    s_nop 0
    s_cbranch_vccz Lpolld16
    s_mov_b32 s39, 0
Lpoll16:
    buffer_load_dword v10, v3, s[4:7], s36 offen sc1
    s_waitcnt vmcnt(0)
    v_cmp_eq_u32 vcc, 0, v10
    s_nop 0
    s_cbranch_vccz Lpolld16
    s_add_u32 s39, s39, 1
    s_cmp_lt_u32 s39, 200000
    s_cbranch_scc1 Lpoll16
Lpolld16:
    s_nop 0
    v_rcp_f32 v183, v183
    v_rcp_f32 v184, v184
    v_mfma_f32_32x32x16_bf16 v[80:95], v[216:219], a[148:151], v[80:95]
    buffer_load_dwordx4 a[176:179], v1, s[4:7], s49 offen offset:2048 sc1
    v_rcp_f32 v185, v185
    v_rcp_f32 v186, v186
    v_rcp_f32 v187, v187
    v_mfma_f32_32x32x16_bf16 v[96:111], v[220:223], a[148:151], v[96:111]
    s_waitcnt vmcnt(9)
    v_rcp_f32 v188, v188
    v_rcp_f32 v189, v189
    v_rcp_f32 v190, v190
    v_mfma_f32_32x32x16_bf16 v[80:95], v[224:227], a[152:155], v[80:95]
    buffer_load_dwordx4 a[180:183], v1, s[4:7], s49 offen offset:3072 sc1
    v_rcp_f32 v191, v191
    v_mul_f32 v176, v176, v128
    v_mul_f32 v177, v177, v129
    v_mul_f32 v178, v178, v130
    v_mfma_f32_32x32x16_bf16 v[96:111], v[228:231], a[152:155], v[96:111]
    s_waitcnt vmcnt(9)
    v_mul_f32 v179, v179, v131
    v_mul_f32 v180, v180, v132
    v_mul_f32 v181, v181, v133
    v_mul_f32 v182, v182, v134
    v_mul_f32 v183, v183, v135
    v_mfma_f32_32x32x16_bf16 v[80:95], v[232:235], a[156:159], v[80:95]
    buffer_load_dwordx4 a[184:187], v1, s[4:7], s50 offen offset:2048 sc1
    v_cvt_pk_bf16_f32 v72, v176, v177
    v_cvt_pk_bf16_f32 v73, v178, v179
    v_cvt_pk_bf16_f32 v74, v180, v181
    v_cvt_pk_bf16_f32 v75, v182, v183
    s_add_u32 s29, s48, 4096
    buffer_store_dwordx4 v[72:75], v1, s[4:7], s29 offen offset:2048 sc1
    v_mul_f32 v184, v184, v136
    v_mul_f32 v185, v185, v137
    v_mfma_f32_32x32x16_bf16 v[96:111], v[236:239], a[156:159], v[96:111]
    s_waitcnt vmcnt(10)
    v_mul_f32 v186, v186, v138
    v_mul_f32 v187, v187, v139
    v_mul_f32 v188, v188, v140
    v_mul_f32 v189, v189, v141
    v_mul_f32 v190, v190, v142
    v_mfma_f32_32x32x16_bf16 v[80:95], v[240:243], a[160:163], v[80:95]
    v_mul_f32 v191, v191, v143
    v_cvt_pk_bf16_f32 v76, v184, v185
    v_cvt_pk_bf16_f32 v77, v186, v187
    v_cvt_pk_bf16_f32 v78, v188, v189
    v_cvt_pk_bf16_f32 v79, v190, v191
    buffer_store_dwordx4 v[76:79], v1, s[4:7], s29 offen offset:3072 sc1
    v_mfma_f32_32x32x16_bf16 v[96:111], v[244:247], a[160:163], v[96:111]
    s_waitcnt vmcnt(10)
    v_mfma_f32_32x32x16_bf16 v[80:95], v[248:251], a[164:167], v[80:95]
    v_mfma_f32_32x32x16_bf16 v[96:111], v[252:255], a[164:167], v[96:111]
    s_waitcnt vmcnt(9)
    buffer_load_dwordx4 a[188:191], v1, s[4:7], s50 offen offset:3072 sc1
    v_mfma_f32_32x32x16_bf16 v[80:95], a[0:3], a[168:171], v[80:95]
    v_mfma_f32_32x32x16_bf16 v[96:111], a[4:7], a[168:171], v[96:111]
    s_waitcnt vmcnt(9)
    buffer_load_dwordx4 a[192:195], v1, s[4:7], s51 offen offset:2048 sc1
    v_mfma_f32_32x32x16_bf16 v[80:95], a[8:11], a[172:175], v[80:95]
    v_mfma_f32_32x32x16_bf16 v[96:111], a[12:15], a[172:175], v[96:111]
    v_mfma_f32_32x32x16_bf16 v[112:127], a[224:227], v[56:59], 0
    buffer_load_dwordx4 a[196:199], v1, s[4:7], s51 offen offset:3072 sc1
    v_mfma_f32_32x32x16_bf16 v[128:143], a[228:231], v[56:59], 0
    v_mfma_f32_32x32x16_bf16 v[112:127], a[232:235], v[60:63], v[112:127]
    buffer_load_dwordx4 a[200:203], v1, s[4:7], s52 offen offset:2048 sc1
    s_add_u32 s36, s64, 64
    buffer_load_dword v10, v3, s[4:7], s36 offen sc1
    s_barrier
    v_mfma_f32_32x32x16_bf16 v[128:143], a[236:239], v[60:63], v[128:143]
    s_waitcnt vmcnt(9)
    v_mfma_f32_32x32x16_bf16 v[112:127], a[240:243], a[176:179], v[112:127]
    buffer_load_dwordx4 a[204:207], v1, s[4:7], s52 offen offset:3072 sc1
    v_mfma_f32_32x32x16_bf16 v[128:143], a[244:247], a[176:179], v[128:143]
    s_waitcnt vmcnt(9)
    v_mfma_f32_32x32x16_bf16 v[112:127], a[248:251], a[180:183], v[112:127]
    buffer_load_dwordx4 a[208:211], v1, s[4:7], s53 offen offset:2048 sc1
    v_mfma_f32_32x32x16_bf16 v[128:143], a[252:255], a[180:183], v[128:143]
    s_waitcnt vmcnt(9)
    v_mfma_f32_32x32x16_bf16 v[112:127], v[192:195], a[184:187], v[112:127]
    buffer_load_dwordx4 a[212:215], v1, s[4:7], s53 offen offset:3072 sc1
    v_mfma_f32_32x32x16_bf16 v[128:143], v[196:199], a[184:187], v[128:143]
    s_waitcnt vmcnt(7)
    v_mfma_f32_32x32x16_bf16 v[112:127], v[200:203], a[188:191], v[112:127]
    v_mfma_f32_32x32x16_bf16 v[128:143], v[204:207], a[188:191], v[128:143]
    s_waitcnt vmcnt(6)
    buffer_load_dwordx4 a[216:219], v1, s[4:7], s54 offen offset:2048 sc1
    v_mfma_f32_32x32x16_bf16 v[112:127], v[208:211], a[192:195], v[112:127]
    v_mfma_f32_32x32x16_bf16 v[128:143], v[212:215], a[192:195], v[128:143]
    buffer_load_dwordx4 a[220:223], v1, s[4:7], s54 offen offset:3072 sc1
    s_mov_b64 exec, 1
    buffer_store_dword v15, off, s[4:7], s65 offset:96 sc1
    s_mov_b64 exec, -1
    s_waitcnt vmcnt(6)
    v_cmp_eq_u32 vcc, 0, v10
    s_nop 0
    s_cbranch_vccz Lpolld17
    s_mov_b32 s39, 0
Lpoll17:
    buffer_load_dword v10, v3, s[4:7], s36 offen sc1
    s_waitcnt vmcnt(0)
    v_cmp_eq_u32 vcc, 0, v10
    s_nop 0
    s_cbranch_vccz Lpolld17
    s_add_u32 s39, s39, 1
    s_cmp_lt_u32 s39, 200000
    s_cbranch_scc1 Lpoll17
Lpolld17:
    s_nop 0
    v_mfma_f32_32x32x16_bf16 v[112:127], v[216:219], a[196:199], v[112:127]
    s_add_u32 s37, s42, s21
    buffer_load_dwordx4 a[128:131], v1, s[4:7], s37 offen offset:0 sc1
    v_mfma_f32_32x32x16_bf16 v[128:143], v[220:223], a[196:199], v[128:143]
    v_mfma_f32_32x32x16_bf16 v[112:127], v[224:227], a[200:203], v[112:127]
    buffer_load_dwordx4 a[132:135], v1, s[4:7], s37 offen offset:1024 sc1
    v_mfma_f32_32x32x16_bf16 v[128:143], v[228:231], a[200:203], v[128:143]
    s_waitcnt vmcnt(7)
    v_mfma_f32_32x32x16_bf16 v[112:127], v[232:235], a[204:207], v[112:127]
    v_mfma_f32_32x32x16_bf16 v[128:143], v[236:239], a[204:207], v[128:143]
    s_waitcnt vmcnt(6)
    s_add_u32 s37, s42, s22
    buffer_load_dwordx4 a[136:139], v1, s[4:7], s37 offen offset:0 sc1
    v_mfma_f32_32x32x16_bf16 v[112:127], v[240:243], a[208:211], v[112:127]
    v_mfma_f32_32x32x16_bf16 v[128:143], v[244:247], a[208:211], v[128:143]
    s_waitcnt vmcnt(6)
    buffer_load_dwordx4 a[140:143], v1, s[4:7], s37 offen offset:1024 sc1
    v_mfma_f32_32x32x16_bf16 v[112:127], v[248:251], a[212:215], v[112:127]
    v_mfma_f32_32x32x16_bf16 v[128:143], v[252:255], a[212:215], v[128:143]
    s_waitcnt vmcnt(6)
    s_add_u32 s37, s42, s23
    buffer_load_dwordx4 a[144:147], v1, s[4:7], s37 offen offset:0 sc1
    v_mfma_f32_32x32x16_bf16 v[112:127], a[0:3], a[216:219], v[112:127]
    v_mfma_f32_32x32x16_bf16 v[128:143], a[4:7], a[216:219], v[128:143]
    s_waitcnt vmcnt(6)
    buffer_load_dwordx4 a[148:151], v1, s[4:7], s37 offen offset:1024 sc1
    v_mfma_f32_32x32x16_bf16 v[112:127], a[8:11], a[220:223], v[112:127]
    v_mfma_f32_32x32x16_bf16 v[128:143], a[12:15], a[220:223], v[128:143]
    v_mfma_f32_32x32x16_bf16 v[80:95], a[112:115], v[64:67], v[80:95]
    s_add_u32 s37, s42, s24
    buffer_load_dwordx4 a[152:155], v1, s[4:7], s37 offen offset:0 sc1
    v_mfma_f32_32x32x16_bf16 v[96:111], a[116:119], v[64:67], v[96:111]
    v_mfma_f32_32x32x16_bf16 v[80:95], a[120:123], v[68:71], v[80:95]
    buffer_load_dwordx4 a[156:159], v1, s[4:7], s37 offen offset:1024 sc1
    s_add_u32 s36, s64, 96
    buffer_load_dword v10, v3, s[4:7], s36 offen sc1
    v_mfma_f32_32x32x16_bf16 v[96:111], a[124:127], v[68:71], v[96:111]
    s_waitcnt vmcnt(8)
    v_mfma_f32_32x32x16_bf16 v[80:95], a[16:19], a[128:131], v[80:95]
    s_add_u32 s37, s42, s25
    buffer_load_dwordx4 a[160:163], v1, s[4:7], s37 offen offset:0 sc1
    v_mfma_f32_32x32x16_bf16 v[96:111], a[20:23], a[128:131], v[96:111]
    s_waitcnt vmcnt(8)
    v_mfma_f32_32x32x16_bf16 v[80:95], a[24:27], a[132:135], v[80:95]
    buffer_load_dwordx4 a[164:167], v1, s[4:7], s37 offen offset:1024 sc1
    v_mfma_f32_32x32x16_bf16 v[96:111], a[28:31], a[132:135], v[96:111]
    s_waitcnt vmcnt(8)
    v_mfma_f32_32x32x16_bf16 v[80:95], a[32:35], a[136:139], v[80:95]
    v_mfma_f32_32x32x16_bf16 v[96:111], a[36:39], a[136:139], v[96:111]
    s_waitcnt vmcnt(7)
    s_add_u32 s37, s42, s26
    buffer_load_dwordx4 a[168:171], v1, s[4:7], s37 offen offset:0 sc1
    v_mfma_f32_32x32x16_bf16 v[80:95], a[40:43], a[140:143], v[80:95]
    s_waitcnt vmcnt(3)
    v_cmp_eq_u32 vcc, 0, v10
    s_nop 0
    s_cbranch_vccz Lpolld18
    s_mov_b32 s39, 0
Lpoll18:
    buffer_load_dword v10, v3, s[4:7], s36 offen sc1
    s_waitcnt vmcnt(0)
    v_cmp_eq_u32 vcc, 0, v10
    s_nop 0
    s_cbranch_vccz Lpolld18
    s_add_u32 s39, s39, 1
    s_cmp_lt_u32 s39, 200000
    s_cbranch_scc1 Lpoll18
Lpolld18:
    s_nop 0
    v_mfma_f32_32x32x16_bf16 v[96:111], a[44:47], a[140:143], v[96:111]
    buffer_load_dwordx4 a[172:175], v1, s[4:7], s37 offen offset:1024 sc1
    v_mfma_f32_32x32x16_bf16 v[80:95], a[48:51], a[144:147], v[80:95]
    v_mfma_f32_32x32x16_bf16 v[96:111], a[52:55], a[144:147], v[96:111]
    s_add_u32 s37, s49, 4096
    buffer_load_dwordx4 a[176:179], v1, s[4:7], s37 offen offset:2048 sc1
    v_mfma_f32_32x32x16_bf16 v[80:95], a[56:59], a[148:151], v[80:95]
    v_mfma_f32_32x32x16_bf16 v[96:111], a[60:63], a[148:151], v[96:111]
    buffer_load_dwordx4 a[180:183], v1, s[4:7], s37 offen offset:3072 sc1
    v_mfma_f32_32x32x16_bf16 v[80:95], a[64:67], a[152:155], v[80:95]
    s_lshl_b32 s35, s12, 14
    s_lshr_b32 s28, s12, 1
    s_lshl_b32 s28, s28, 13
    s_and_b32 s36, s12, 1
    s_lshl_b32 s36, s36, 8
    s_add_u32 s28, s28, s36
    v_add_u32 v10, s35, v1
    v_lshrrev_b32 v11, 4, v0
    v_mfma_f32_32x32x16_bf16 v[96:111], a[68:71], a[152:155], v[96:111]
    s_add_u32 s37, s50, 4096
    buffer_load_dwordx4 a[184:187], v1, s[4:7], s37 offen offset:2048 sc1
    v_lshlrev_b32 v11, 10, v11
    v_and_b32 v12, 15, v0
    v_mfma_f32_32x32x16_bf16 v[80:95], a[72:75], a[156:159], v[80:95]
    v_lshl_add_u32 v11, v12, 4, v11
    v_add_u32 v11, s28, v11
    v_mfma_f32_32x32x16_bf16 v[96:111], a[76:79], a[156:159], v[96:111]
    s_waitcnt vmcnt(6)
    v_mfma_f32_32x32x16_bf16 v[80:95], a[80:83], a[160:163], v[80:95]
    buffer_load_dwordx4 a[188:191], v1, s[4:7], s37 offen offset:3072 sc1
    v_mfma_f32_32x32x16_bf16 v[96:111], a[84:87], a[160:163], v[96:111]
    s_waitcnt vmcnt(6)
    v_mfma_f32_32x32x16_bf16 v[80:95], a[88:91], a[164:167], v[80:95]
    s_add_u32 s37, s51, 4096
    buffer_load_dwordx4 a[192:195], v1, s[4:7], s37 offen offset:2048 sc1
    v_mfma_f32_32x32x16_bf16 v[96:111], a[92:95], a[164:167], v[96:111]
    s_waitcnt vmcnt(6)
    v_mfma_f32_32x32x16_bf16 v[80:95], a[96:99], a[168:171], v[80:95]
    buffer_load_dwordx4 a[196:199], v1, s[4:7], s37 offen offset:3072 sc1
    v_mfma_f32_32x32x16_bf16 v[96:111], a[100:103], a[168:171], v[96:111]
    s_waitcnt vmcnt(6)
    v_mfma_f32_32x32x16_bf16 v[80:95], a[104:107], a[172:175], v[80:95]
    s_add_u32 s37, s52, 4096
    buffer_load_dwordx4 a[200:203], v1, s[4:7], s37 offen offset:2048 sc1
    v_mfma_f32_32x32x16_bf16 v[96:111], a[108:111], a[172:175], v[96:111]
    s_cmp_eq_u32 s18, 1
    s_cbranch_scc1 Lc_tail1_s
    v_mfma_f32_32x32x16_bf16 v[112:127], a[112:115], v[72:75], v[112:127]
    v_mfma_f32_32x32x16_bf16 v[128:143], a[116:119], v[72:75], v[128:143]
    buffer_load_dwordx4 a[204:207], v1, s[4:7], s37 offen offset:3072 sc1
    v_mfma_f32_32x32x16_bf16 v[112:127], a[120:123], v[76:79], v[112:127]
    v_mfma_f32_32x32x16_bf16 v[128:143], a[124:127], v[76:79], v[128:143]
    s_waitcnt vmcnt(7)
    s_add_u32 s37, s53, 4096
    buffer_load_dwordx4 a[208:211], v1, s[4:7], s37 offen offset:2048 sc1
    ds_write_b128 v10, v[80:83] offset:0
    v_mfma_f32_32x32x16_bf16 v[112:127], a[16:19], a[176:179], v[112:127]
    s_waitcnt vmcnt(7)
    ds_write_b128 v10, v[84:87] offset:1024
    v_mfma_f32_32x32x16_bf16 v[112:127], a[24:27], a[180:183], v[112:127]
    s_waitcnt vmcnt(6)
    buffer_load_dwordx4 a[212:215], v1, s[4:7], s37 offen offset:3072 sc1
    v_mfma_f32_32x32x16_bf16 v[112:127], a[32:35], a[184:187], v[112:127]
    s_waitcnt vmcnt(6)
    ds_write_b128 v10, v[88:91] offset:2048
    v_mfma_f32_32x32x16_bf16 v[112:127], a[40:43], a[188:191], v[112:127]
    s_waitcnt vmcnt(5)
    s_add_u32 s37, s54, 4096
    buffer_load_dwordx4 a[216:219], v1, s[4:7], s37 offen offset:2048 sc1
    ds_write_b128 v10, v[92:95] offset:3072
    v_mfma_f32_32x32x16_bf16 v[112:127], a[48:51], a[192:195], v[112:127]
    s_waitcnt vmcnt(5)
    v_mfma_f32_32x32x16_bf16 v[112:127], a[56:59], a[196:199], v[112:127]
    s_waitcnt vmcnt(4)
    buffer_load_dwordx4 a[220:223], v1, s[4:7], s37 offen offset:3072 sc1
    ds_write_b128 v10, v[96:99] offset:4096
    v_mfma_f32_32x32x16_bf16 v[112:127], a[64:67], a[200:203], v[112:127]
    s_waitcnt vmcnt(4)
    v_mfma_f32_32x32x16_bf16 v[112:127], a[72:75], a[204:207], v[112:127]
    s_waitcnt vmcnt(3)
    ds_write_b128 v10, v[100:103] offset:5120
    v_mfma_f32_32x32x16_bf16 v[112:127], a[80:83], a[208:211], v[112:127]
    s_waitcnt vmcnt(2)
    ds_write_b128 v10, v[104:107] offset:6144
    v_mfma_f32_32x32x16_bf16 v[112:127], a[88:91], a[212:215], v[112:127]
    s_waitcnt vmcnt(1)
    v_mfma_f32_32x32x16_bf16 v[112:127], a[96:99], a[216:219], v[112:127]
    s_waitcnt vmcnt(0)
    ds_write_b128 v10, v[108:111] offset:7168
    v_mfma_f32_32x32x16_bf16 v[112:127], a[104:107], a[220:223], v[112:127]
    v_mfma_f32_32x32x16_bf16 v[128:143], a[20:23], a[176:179], v[128:143]
    s_add_u32 s29, s59, s20
    s_add_u32 s35, s63, 24576
    v_mfma_f32_32x32x16_bf16 v[128:143], a[28:31], a[180:183], v[128:143]
    s_nop 7
    ds_write_b128 v10, v[112:115] offset:8192
    v_mfma_f32_32x32x16_bf16 v[128:143], a[36:39], a[184:187], v[128:143]
    ds_write_b128 v10, v[116:119] offset:9216
    v_mfma_f32_32x32x16_bf16 v[128:143], a[44:47], a[188:191], v[128:143]
    ds_write_b128 v10, v[120:123] offset:10240
    v_mfma_f32_32x32x16_bf16 v[128:143], a[52:55], a[192:195], v[128:143]
    ds_write_b128 v10, v[124:127] offset:11264
    v_mfma_f32_32x32x16_bf16 v[128:143], a[60:63], a[196:199], v[128:143]
    v_mfma_f32_32x32x16_bf16 v[128:143], a[68:71], a[200:203], v[128:143]
    v_mfma_f32_32x32x16_bf16 v[128:143], a[76:79], a[204:207], v[128:143]
    s_waitcnt lgkmcnt(0)
    s_barrier
    ds_read_b128 v[192:195], v11 offset:0
    ds_read_b128 v[196:199], v11 offset:512
    ds_read_b128 v[208:211], v11 offset:16384
    v_mfma_f32_32x32x16_bf16 v[128:143], a[84:87], a[208:211], v[128:143]
    ds_read_b128 v[212:215], v11 offset:16896
    ds_read_b128 v[224:227], v11 offset:32768
    ds_read_b128 v[228:231], v11 offset:33280
    v_mfma_f32_32x32x16_bf16 v[128:143], a[92:95], a[212:215], v[128:143]
    ds_read_b128 v[240:243], v11 offset:49152
    ds_read_b128 v[244:247], v11 offset:49664
    v_mfma_f32_32x32x16_bf16 v[128:143], a[100:103], a[216:219], v[128:143]
    v_mfma_f32_32x32x16_bf16 v[128:143], a[108:111], a[220:223], v[128:143]
    s_nop 11
    ds_write_b128 v10, v[128:131] offset:12288
    ds_write_b128 v10, v[132:135] offset:13312
    ds_write_b128 v10, v[136:139] offset:14336
    ds_write_b128 v10, v[140:143] offset:15360
    s_waitcnt lgkmcnt(11)
    v_pk_add_f32 v[32:33], v[32:33], v[192:193]
    v_pk_add_f32 v[34:35], v[34:35], v[194:195]
    s_waitcnt lgkmcnt(10)
    v_pk_add_f32 v[36:37], v[36:37], v[196:197]
    v_pk_add_f32 v[38:39], v[38:39], v[198:199]
    s_waitcnt lgkmcnt(9)
    v_pk_add_f32 v[32:33], v[32:33], v[208:209]
    v_pk_add_f32 v[34:35], v[34:35], v[210:211]
    s_waitcnt lgkmcnt(8)
    v_pk_add_f32 v[36:37], v[36:37], v[212:213]
    v_pk_add_f32 v[38:39], v[38:39], v[214:215]
    s_waitcnt lgkmcnt(7)
    v_pk_add_f32 v[32:33], v[32:33], v[224:225]
    v_pk_add_f32 v[34:35], v[34:35], v[226:227]
    s_waitcnt lgkmcnt(6)
    v_pk_add_f32 v[36:37], v[36:37], v[228:229]
    v_pk_add_f32 v[38:39], v[38:39], v[230:231]
    s_waitcnt lgkmcnt(5)
    v_pk_add_f32 v[160:161], v[32:33], v[240:241]
    v_pk_add_f32 v[162:163], v[34:35], v[242:243]
    s_waitcnt lgkmcnt(4)
    v_pk_add_f32 v[164:165], v[36:37], v[244:245]
    v_pk_add_f32 v[166:167], v[38:39], v[246:247]
    v_cvt_pk_bf16_f32 v48, v160, v161
    v_cvt_pk_bf16_f32 v49, v162, v163
    v_cvt_pk_bf16_f32 v50, v164, v165
    v_cvt_pk_bf16_f32 v51, v166, v167
    buffer_store_dwordx4 v[48:51], v1, s[4:7], s29 offen offset:0 sc1
    s_waitcnt lgkmcnt(0)
    s_barrier
    ds_read_b128 v[200:203], v11 offset:4096
    ds_read_b128 v[204:207], v11 offset:4608
    ds_read_b128 v[216:219], v11 offset:20480
    ds_read_b128 v[220:223], v11 offset:20992
    ds_read_b128 v[232:235], v11 offset:36864
    ds_read_b128 v[236:239], v11 offset:37376
    ds_read_b128 v[248:251], v11 offset:53248
    ds_read_b128 v[252:255], v11 offset:53760
    s_waitcnt lgkmcnt(7)
    v_pk_add_f32 v[40:41], v[40:41], v[200:201]
    v_pk_add_f32 v[42:43], v[42:43], v[202:203]
    s_waitcnt lgkmcnt(6)
    v_pk_add_f32 v[44:45], v[44:45], v[204:205]
    v_pk_add_f32 v[46:47], v[46:47], v[206:207]
    s_waitcnt lgkmcnt(5)
    v_pk_add_f32 v[40:41], v[40:41], v[216:217]
    v_pk_add_f32 v[42:43], v[42:43], v[218:219]
    s_waitcnt lgkmcnt(4)
    v_pk_add_f32 v[44:45], v[44:45], v[220:221]
    v_pk_add_f32 v[46:47], v[46:47], v[222:223]
    s_waitcnt lgkmcnt(3)
    v_pk_add_f32 v[40:41], v[40:41], v[232:233]
    v_pk_add_f32 v[42:43], v[42:43], v[234:235]
    s_waitcnt lgkmcnt(2)
    v_pk_add_f32 v[44:45], v[44:45], v[236:237]
    v_pk_add_f32 v[46:47], v[46:47], v[238:239]
    s_waitcnt lgkmcnt(1)
    v_pk_add_f32 v[168:169], v[40:41], v[248:249]
    v_pk_add_f32 v[170:171], v[42:43], v[250:251]
    s_waitcnt lgkmcnt(0)
    v_pk_add_f32 v[172:173], v[44:45], v[252:253]
    v_pk_add_f32 v[174:175], v[46:47], v[254:255]
    v_cvt_pk_bf16_f32 v52, v168, v169
    v_cvt_pk_bf16_f32 v53, v170, v171
    v_cvt_pk_bf16_f32 v54, v172, v173
    v_cvt_pk_bf16_f32 v55, v174, v175
    buffer_store_dwordx4 v[52:55], v1, s[4:7], s29 offen offset:1024 sc1
    s_sub_u32 s29, s29, s20
    v_pk_add_f32 v[112:113], v[160:161], v[162:163]
    v_pk_mul_f32 v[114:115], v[160:161], v[160:161]
    v_pk_add_f32 v[116:117], v[164:165], v[166:167]
    v_pk_mul_f32 v[118:119], v[162:163], v[162:163]
    v_pk_add_f32 v[112:113], v[112:113], v[168:169]
    v_pk_fma_f32 v[114:115], v[164:165], v[164:165], v[114:115]
    v_pk_add_f32 v[116:117], v[116:117], v[170:171]
    v_pk_fma_f32 v[118:119], v[166:167], v[166:167], v[118:119]
    v_pk_add_f32 v[112:113], v[112:113], v[172:173]
    v_pk_fma_f32 v[114:115], v[168:169], v[168:169], v[114:115]
    v_pk_add_f32 v[116:117], v[116:117], v[174:175]
    v_pk_fma_f32 v[118:119], v[170:171], v[170:171], v[118:119]
    v_pk_fma_f32 v[114:115], v[172:173], v[172:173], v[114:115]
    v_pk_fma_f32 v[118:119], v[174:175], v[174:175], v[118:119]
    v_pk_add_f32 v[112:113], v[112:113], v[116:117]
    v_pk_add_f32 v[114:115], v[114:115], v[118:119]
    v_add_f32 v112, v112, v113
    v_add_f32 v114, v114, v115
    s_nop 1
    v_permlane32_swap_b32 v112, v114
    v_add_f32 v112, v112, v114
    v_mov_b32 v113, v112
    s_nop 1
    v_permlane16_swap_b32 v112, v113
    s_mov_b32 exec_lo, 0xffff
    s_mov_b32 exec_hi, 0xffff
    v_add_f32 v112, v112, v113
    buffer_store_dword v112, v2, s[4:7], s29 offen offset:2048 sc1
    s_mov_b64 exec, -1
    s_lshr_b32 s28, s14, 4
    s_lshl_b32 s29, s13, 1
    s_add_u32 s28, s28, s29
    s_lshl_b32 s28, s28, 2
    s_add_u32 s40, s28, s12
    s_lshl_b32 s36, s40, 7
    s_add_u32 s36, s36, 54239232
    s_add_u32 s43, s40, s13
    s_mul_i32 s43, s43, 32256
    s_add_u32 s43, s43, 14065408
    v_bfe_u32 v10, v0, 4, 1
    v_mul_u32_u24 v10, 16128, v10
    v_lshrrev_b32 v11, 5, v0
    v_and_b32 v12, 15, v0
    v_lshl_add_u32 v4, v11, 8, v10
    v_lshl_add_u32 v4, v12, 4, v4
    v_mul_u32_u24 v5, 4352, v11
    v_add_u32 v5, v5, v4
    v_add_u32 v5, 0x800, v5
    v_add_u32 v6, 65536, v1
    v_add_u32 v7, 108544, v1
    v_and_b32 v11, 7, v0
    v_min_u32 v11, 7, v11
    v_lshlrev_b32 v11, 2, v11
    v_bfe_u32 v10, v0, 3, 1
    v_lshl_add_u32 v11, v10, 6, v11
    s_and_b32 s29, s14, 15
    s_lshl_b32 s29, s29, 6
    s_add_u32 s29, s29, s40
    s_lshl_b32 s41, s29, 11
    s_add_u32 s41, s41, 47923200
    s_lshl_b32 s42, s29, 12
    s_add_u32 s42, s42, 50020352
    s_lshr_b32 s29, s29, 2
    s_lshl_b32 s29, s29, 5
    s_add_u32 s29, s29, s12
    s_lshl_b32 s29, s29, 2
    s_add_u32 s44, s29, 54345728
    s_lshl_b32 s29, s12, 7
    s_add_u32 s29, s29, 151808
    v_and_b32 v8, 31, v0
    v_lshl_add_u32 v8, v8, 2, s29
    v_lshrrev_b32 v9, 5, v0
    v_lshl_add_u32 v9, v9, 4, s29
    s_waitcnt vmcnt(0)
    s_mov_b64 exec, 1
    buffer_store_dword v15, off, s[4:7], s35 offset:0 sc1
    s_mov_b64 exec, -1
    s_branch Lc_qkv
Lc_tail1_s:
    v_mfma_f32_32x32x16_bf16 v[112:127], a[112:115], v[72:75], v[112:127]
    v_mfma_f32_32x32x16_bf16 v[128:143], a[116:119], v[72:75], v[128:143]
    buffer_load_dwordx4 a[204:207], v1, s[4:7], s37 offen offset:3072 sc1
    v_mfma_f32_32x32x16_bf16 v[112:127], a[120:123], v[76:79], v[112:127]
    v_mfma_f32_32x32x16_bf16 v[128:143], a[124:127], v[76:79], v[128:143]
    s_waitcnt vmcnt(7)
    s_add_u32 s37, s53, 4096
    buffer_load_dwordx4 a[208:211], v1, s[4:7], s37 offen offset:2048 sc1
    ds_write_b128 v10, v[80:83] offset:0
    v_mfma_f32_32x32x16_bf16 v[112:127], a[16:19], a[176:179], v[112:127]
    s_waitcnt vmcnt(7)
    ds_write_b128 v10, v[84:87] offset:1024
    v_mfma_f32_32x32x16_bf16 v[112:127], a[24:27], a[180:183], v[112:127]
    s_waitcnt vmcnt(6)
    buffer_load_dwordx4 a[212:215], v1, s[4:7], s37 offen offset:3072 sc1
    v_mfma_f32_32x32x16_bf16 v[112:127], a[32:35], a[184:187], v[112:127]
    s_waitcnt vmcnt(6)
    ds_write_b128 v10, v[88:91] offset:2048
    v_mfma_f32_32x32x16_bf16 v[112:127], a[40:43], a[188:191], v[112:127]
    s_waitcnt vmcnt(5)
    s_add_u32 s37, s54, 4096
    buffer_load_dwordx4 a[216:219], v1, s[4:7], s37 offen offset:2048 sc1
    ds_write_b128 v10, v[92:95] offset:3072
    v_mfma_f32_32x32x16_bf16 v[112:127], a[48:51], a[192:195], v[112:127]
    s_waitcnt vmcnt(5)
    v_mfma_f32_32x32x16_bf16 v[112:127], a[56:59], a[196:199], v[112:127]
    s_waitcnt vmcnt(4)
    buffer_load_dwordx4 a[220:223], v1, s[4:7], s37 offen offset:3072 sc1
    ds_write_b128 v10, v[96:99] offset:4096
    v_mfma_f32_32x32x16_bf16 v[112:127], a[64:67], a[200:203], v[112:127]
    s_waitcnt vmcnt(4)
    v_mfma_f32_32x32x16_bf16 v[112:127], a[72:75], a[204:207], v[112:127]
    s_waitcnt vmcnt(3)
    ds_write_b128 v10, v[100:103] offset:5120
    v_mfma_f32_32x32x16_bf16 v[112:127], a[80:83], a[208:211], v[112:127]
    s_waitcnt vmcnt(2)
    ds_write_b128 v10, v[104:107] offset:6144
    v_mfma_f32_32x32x16_bf16 v[112:127], a[88:91], a[212:215], v[112:127]
    s_waitcnt vmcnt(1)
    v_mfma_f32_32x32x16_bf16 v[112:127], a[96:99], a[216:219], v[112:127]
    s_waitcnt vmcnt(0)
    ds_write_b128 v10, v[108:111] offset:7168
    v_mfma_f32_32x32x16_bf16 v[112:127], a[104:107], a[220:223], v[112:127]
    v_mfma_f32_32x32x16_bf16 v[128:143], a[20:23], a[176:179], v[128:143]
    v_and_b32 v12, 15, v0
    v_lshrrev_b32 v13, 4, v0
    v_mul_u32_u24 v12, 896, v12
    v_lshl_add_u32 v12, v13, 4, v12
    s_mul_i32 s28, s17, 14336
    s_lshl_b32 s29, s15, 7
    s_add_u32 s28, s28, s29
    v_mfma_f32_32x32x16_bf16 v[128:143], a[28:31], a[180:183], v[128:143]
    s_nop 2
    ds_write_b128 v10, v[112:115] offset:8192
    v_mfma_f32_32x32x16_bf16 v[128:143], a[36:39], a[184:187], v[128:143]
    ds_write_b128 v10, v[116:119] offset:9216
    v_mfma_f32_32x32x16_bf16 v[128:143], a[44:47], a[188:191], v[128:143]
    ds_write_b128 v10, v[120:123] offset:10240
    v_mfma_f32_32x32x16_bf16 v[128:143], a[52:55], a[192:195], v[128:143]
    ds_write_b128 v10, v[124:127] offset:11264
    v_mfma_f32_32x32x16_bf16 v[128:143], a[60:63], a[196:199], v[128:143]
    v_mfma_f32_32x32x16_bf16 v[128:143], a[68:71], a[200:203], v[128:143]
    v_mfma_f32_32x32x16_bf16 v[128:143], a[76:79], a[204:207], v[128:143]
    s_waitcnt lgkmcnt(0)
    s_barrier
    ds_read_b128 v[192:195], v11 offset:0
    ds_read_b128 v[196:199], v11 offset:512
    ds_read_b128 v[208:211], v11 offset:16384
    v_mfma_f32_32x32x16_bf16 v[128:143], a[84:87], a[208:211], v[128:143]
    ds_read_b128 v[212:215], v11 offset:16896
    ds_read_b128 v[224:227], v11 offset:32768
    ds_read_b128 v[228:231], v11 offset:33280
    v_mfma_f32_32x32x16_bf16 v[128:143], a[92:95], a[212:215], v[128:143]
    ds_read_b128 v[240:243], v11 offset:49152
    ds_read_b128 v[244:247], v11 offset:49664
    v_mfma_f32_32x32x16_bf16 v[128:143], a[100:103], a[216:219], v[128:143]
    v_mfma_f32_32x32x16_bf16 v[128:143], a[108:111], a[220:223], v[128:143]
    s_nop 11
    ds_write_b128 v10, v[128:131] offset:12288
    ds_write_b128 v10, v[132:135] offset:13312
    ds_write_b128 v10, v[136:139] offset:14336
    ds_write_b128 v10, v[140:143] offset:15360
    s_waitcnt lgkmcnt(11)
    v_pk_add_f32 v[32:33], v[32:33], v[192:193]
    v_pk_add_f32 v[34:35], v[34:35], v[194:195]
    s_waitcnt lgkmcnt(10)
    v_pk_add_f32 v[36:37], v[36:37], v[196:197]
    v_pk_add_f32 v[38:39], v[38:39], v[198:199]
    s_waitcnt lgkmcnt(9)
    v_pk_add_f32 v[32:33], v[32:33], v[208:209]
    v_pk_add_f32 v[34:35], v[34:35], v[210:211]
    s_waitcnt lgkmcnt(8)
    v_pk_add_f32 v[36:37], v[36:37], v[212:213]
    v_pk_add_f32 v[38:39], v[38:39], v[214:215]
    s_waitcnt lgkmcnt(7)
    v_pk_add_f32 v[32:33], v[32:33], v[224:225]
    v_pk_add_f32 v[34:35], v[34:35], v[226:227]
    s_waitcnt lgkmcnt(6)
    v_pk_add_f32 v[36:37], v[36:37], v[228:229]
    v_pk_add_f32 v[38:39], v[38:39], v[230:231]
    s_waitcnt lgkmcnt(5)
    v_pk_add_f32 v[160:161], v[32:33], v[240:241]
    v_pk_add_f32 v[162:163], v[34:35], v[242:243]
    s_waitcnt lgkmcnt(4)
    v_pk_add_f32 v[164:165], v[36:37], v[244:245]
    v_pk_add_f32 v[166:167], v[38:39], v[246:247]
    v_cvt_pk_bf16_f32 v48, v160, v161
    v_cvt_pk_bf16_f32 v49, v162, v163
    v_cvt_pk_bf16_f32 v50, v164, v165
    v_cvt_pk_bf16_f32 v51, v166, v167
    buffer_store_dwordx4 v[48:51], v12, s[8:11], s28 offen offset:0
    s_waitcnt lgkmcnt(0)
    s_barrier
    ds_read_b128 v[200:203], v11 offset:4096
    ds_read_b128 v[204:207], v11 offset:4608
    ds_read_b128 v[216:219], v11 offset:20480
    ds_read_b128 v[220:223], v11 offset:20992
    ds_read_b128 v[232:235], v11 offset:36864
    ds_read_b128 v[236:239], v11 offset:37376
    ds_read_b128 v[248:251], v11 offset:53248
    ds_read_b128 v[252:255], v11 offset:53760
    s_waitcnt lgkmcnt(7)
    v_pk_add_f32 v[40:41], v[40:41], v[200:201]
    v_pk_add_f32 v[42:43], v[42:43], v[202:203]
    s_waitcnt lgkmcnt(6)
    v_pk_add_f32 v[44:45], v[44:45], v[204:205]
    v_pk_add_f32 v[46:47], v[46:47], v[206:207]
    s_waitcnt lgkmcnt(5)
    v_pk_add_f32 v[40:41], v[40:41], v[216:217]
    v_pk_add_f32 v[42:43], v[42:43], v[218:219]
    s_waitcnt lgkmcnt(4)
    v_pk_add_f32 v[44:45], v[44:45], v[220:221]
    v_pk_add_f32 v[46:47], v[46:47], v[222:223]
    s_waitcnt lgkmcnt(3)
    v_pk_add_f32 v[40:41], v[40:41], v[232:233]
    v_pk_add_f32 v[42:43], v[42:43], v[234:235]
    s_waitcnt lgkmcnt(2)
    v_pk_add_f32 v[44:45], v[44:45], v[236:237]
    v_pk_add_f32 v[46:47], v[46:47], v[238:239]
    s_waitcnt lgkmcnt(1)
    v_pk_add_f32 v[168:169], v[40:41], v[248:249]
    v_pk_add_f32 v[170:171], v[42:43], v[250:251]
    s_waitcnt lgkmcnt(0)
    v_pk_add_f32 v[172:173], v[44:45], v[252:253]
    v_pk_add_f32 v[174:175], v[46:47], v[254:255]
    v_cvt_pk_bf16_f32 v52, v168, v169
    v_cvt_pk_bf16_f32 v53, v170, v171
    v_cvt_pk_bf16_f32 v54, v172, v173
    v_cvt_pk_bf16_f32 v55, v174, v175
    buffer_store_dwordx4 v[52:55], v12, s[8:11], s28 offen offset:64
    s_endpgm
Lc_edge_s:
    s_mov_b32 s39, 0
Lc_hpoll_s:
    buffer_load_dword v10, v14, s[4:7], s36 offen sc1
    buffer_load_dwordx4 v[56:59], v12, s[4:7], s41 offen sc1
    s_waitcnt vmcnt(0)
    v_add_u32 v10, -1, v10
    v_max3_u32 v10, v10, v56, v57
    v_max3_u32 v10, v10, v58, v59
    v_cmp_eq_u32 vcc, -1, v10
    s_nop 0
    s_cbranch_vccz Lc_hgo_s
    s_add_u32 s39, s39, 1
    s_cmp_lt_u32 s39, 200000
    s_cbranch_scc1 Lc_hpoll_s
    s_branch Lc_hgo_s
.fill 64, 4, 0xbf800000
.section .rodata,"a"
.p2align 6
.amdhsa_kernel interleave_layers__mha_block__mixer_s_mlp__prompt_kernel
  .amdhsa_next_free_vgpr 512
  .amdhsa_next_free_sgpr 102
  .amdhsa_accum_offset 256
  .amdhsa_group_segment_fixed_size 0
  .amdhsa_kernarg_size 88
  .amdhsa_user_sgpr_count 2
  .amdhsa_user_sgpr_kernarg_segment_ptr 1
  .amdhsa_system_sgpr_workgroup_id_x 1
.end_amdhsa_kernel
```
